```python
import torch

def _softmax(x, axis=-1):
    return torch.softmax(x, dim=axis)
def _gelu(x):
    return torch.nn.functional.gelu(x, approximate="tanh")
def _silu(x):
    return torch.nn.functional.silu(x)
def _sigmoid(x):
    return torch.sigmoid(x)
def _layernorm(x, axis=-1, eps=1e-5):
    m = x.mean(dim=axis, keepdim=True)
    v = x.var(dim=axis, keepdim=True, unbiased=False)
    return (x - m) / torch.sqrt(v + eps)
def _scatter_add(tgt, idx, src, axis=0):
    return tgt.clone().index_add_(axis, idx, src)
def _segment_sum(src, seg, n):
    out = torch.zeros((n,) + src.shape[1:], dtype=src.dtype)
    return out.index_add_(0, seg, src)
def _pad(x, pw):
    flat = tuple(v for pair in reversed(pw) for v in pair)
    return torch.nn.functional.pad(x, flat)

kernel_name = 'interleave_layers__spectral_fnet__swiglu_ffn__prompt'

def setup_inputs():

    _w = (lambda a: (lambda t: t.to(torch.bfloat16) if t.is_floating_point() else t)(torch.as_tensor(a)))
    def _A_setup():
        B, S, D = 1, 2048, 576
        ns = torch.arange(S)[:, None] * torch.arange(S)[None, :]
        nd = torch.arange(D)[:, None] * torch.arange(D)[None, :]
        Ws_re = torch.cos(-2.0 * torch.pi * ns / S).to(float)
        Ws_im = torch.sin(-2.0 * torch.pi * ns / S).to(float)
        Wd_re = torch.cos(-2.0 * torch.pi * nd / D).to(float)
        Wd_im = torch.sin(-2.0 * torch.pi * nd / D).to(float)
        return {
            "x": _w((lambda *s: torch.randn(*s, dtype=torch.bfloat16) * 0.05)(B, S, D)),
            "dft_seq_re": _w(Ws_re),
            "dft_seq_im": _w(Ws_im),
            "dft_hid_re": _w(Wd_re),
            "dft_hid_im": _w(Wd_im),
        }
    _A_in = _A_setup()

    def _B_setup():
        B, S, D, F = 1, 2048, 576, 4608
        return {
            "x": _w((lambda *s: torch.randn(*s, dtype=torch.bfloat16) * 0.05)(B, S, D)),
            "w_gate": _w((lambda *s: torch.randn(*s, dtype=torch.bfloat16) * 0.2)(D, F)),
            "w_up": _w((lambda *s: torch.randn(*s, dtype=torch.bfloat16) * 0.2)(D, F)),
            "w_down": _w((lambda *s: torch.randn(*s, dtype=torch.bfloat16) * 0.2)(F, D)),
        }
    _B_in = _B_setup()

    return {
        "A_x": _A_in["x"],
        "A_dft_seq_re": _A_in["dft_seq_re"],
        "A_dft_seq_im": _A_in["dft_seq_im"],
        "A_dft_hid_re": _A_in["dft_hid_re"],
        "A_dft_hid_im": _A_in["dft_hid_im"],
        "B_x": _B_in["x"],
        "B_w_gate": _B_in["w_gate"],
        "B_w_up": _B_in["w_up"],
        "B_w_down": _B_in["w_down"],
    }

def reference(A_x, A_dft_seq_re, A_dft_seq_im, A_dft_hid_re, A_dft_hid_im, B_x, B_w_gate, B_w_up, B_w_down):
    def _A_ref(x, dft_seq_re, dft_seq_im, dft_hid_re, dft_hid_im):
        a = torch.einsum("bsd,ed->bse", x, dft_hid_re)
        b = torch.einsum("bsd,ed->bse", x, dft_hid_im)
        y = torch.einsum("ts,bse->bte", dft_seq_re, a) - torch.einsum("ts,bse->bte", dft_seq_im, b)
        return y

    def _B_ref(x, w_gate, w_up, w_down):
        g = _silu(x @ w_gate)
        u = x @ w_up
        return (g * u) @ w_down

    x = A_x
    x = x + _A_ref(_layernorm(x, axis=-1), A_dft_seq_re, A_dft_seq_im, A_dft_hid_re, A_dft_hid_im)
    x = x + _B_ref(_layernorm(x, axis=-1), B_w_gate, B_w_up, B_w_down)
    x = x + _A_ref(_layernorm(x, axis=-1), A_dft_seq_re, A_dft_seq_im, A_dft_hid_re, A_dft_hid_im)
    x = x + _B_ref(_layernorm(x, axis=-1), B_w_gate, B_w_up, B_w_down)
    return x
```

```asm
; @launch grid=(256,1,1) block=(256,1,1) lds=163840
.amdgcn_target "amdgcn-amd-amdhsa--gfx950"
.text
.globl interleave_layers__spectral_fnet__swiglu_ffn__prompt_kernel
.p2align 8
.type interleave_layers__spectral_fnet__swiglu_ffn__prompt_kernel,@function
interleave_layers__spectral_fnet__swiglu_ffn__prompt_kernel:
    s_load_dwordx2 s[44:45], s[0:1], 0
    s_load_dwordx8 s[48:55], s[0:1], 48
    s_load_dwordx4 s[56:59], s[0:1], 80
    s_cmp_ge_u32 s2, 256
    s_cbranch_scc1 L_exit
    s_getpc_b64 s[20:21]
L_pc:
    s_add_u32 s20, s20, interleave_layers__spectral_fnet__swiglu_ffn__prompt_kernel-L_pc
    s_addc_u32 s21, s21, -1
    s_lshr_b32 s22, s2, 3
    s_lshl_b32 s22, s22, 7
    v_lshl_add_u32 v2, v0, 12, s22
    v_min_u32 v2, L_code_end-interleave_layers__spectral_fnet__swiglu_ffn__prompt_kernel-4, v2
    global_load_dword a255, v2, s[20:21]
    v_lshrrev_b32 v2, 6, v0
    v_and_b32 v1, 63, v0
    v_readfirstlane_b32 s3, v2
    v_lshlrev_b32 v1, 4, v1
    s_bfe_u32 s4, s2, 0x20001
    s_andn2_b32 s7, 1, s2
    s_lshl_b32 s7, s7, 5
    s_lshr_b32 s6, s2, 3
    s_add_u32 s7, s7, s6
    s_and_b32 s5, s7, 3
    s_lshr_b32 s6, s7, 2
    s_mul_i32 s12, s3, 9216
    v_bfe_u32 v226, v0, 3, 3
    v_and_b32 v43, 6, v226
    v_xor_b32 v43, v43, v0
    v_and_b32 v43, 7, v43
    v_and_b32 v227, 4, v226
    v_mad_u32_u24 v226, v227, 3, v226
    v_mul_u32_u24 v226, 73728, v226
    v_lshl_add_u32 v226, v43, 4, v226
    s_lshl_b32 s28, s4, 8
    s_add_u32 s28, s28, s7
    s_mul_i32 s28, s28, 9
    s_add_u32 s28, s28, s3
    s_lshl_b32 s28, s28, 7
    v_cmp_gt_u32 vcc, 64, v0
    v_add_u32 v226, s28, v226
    s_nop 0
    v_cndmask_b32 v227, -2.0, v226, vcc
    v_lshrrev_b32 v2, 2, v0
    v_and_b32 v3, 48, v1
    v_lshl_add_u32 v2, v2, 7, v3
    v_mov_b32 v4, 0
    v_mov_b32 v5, 0
    v_mov_b32 v6, 0
    v_mov_b32 v7, 0
    s_lshl_b32 s25, s2, 9
    s_add_u32 s25, s25, 58720256
    s_lshl_b32 s26, s2, 7
    s_add_u32 s26, s26, 59506688
    v_and_b32 v8, 0x1ff, v2
    v_lshrrev_b32 v9, 4, v0
    v_lshl_add_u32 v8, v9, 17, v8
    v_add_u32 v8, s25, v8
    v_lshrrev_b32 v9, 2, v0
    v_lshl_add_u32 v9, v9, 15, v3
    v_cmp_gt_u32 vcc, 64, v0
    v_add_u32 v9, s26, v9
    s_nop 0
    v_cndmask_b32 v3, v9, v8, vcc
    v_cmp_gt_u32 vcc, 160, v0
    s_mul_i32 s24, s2, 8192
    s_add_u32 s24, s24, 59768832
    v_cndmask_b32 v3, -2.0, v3, vcc
    s_lshl_b32 s25, s7, 2
    s_add_u32 s25, s25, s4
    s_lshl_b32 s25, s25, 8
    s_add_u32 s25, s25, 59375616
    v_and_b32 v8, 0xf0, v1
    v_bfe_u32 v9, v0, 4, 1
    v_lshl_add_u32 v8, v9, 16, v8
    v_lshrrev_b32 v9, 5, v0
    v_cmp_eq_u32 vcc, 5, v9
    v_add_u32 v8, s25, v8
    s_nop 0
    v_cndmask_b32 v3, v3, v8, vcc
    s_cmp_lt_u32 s2, 16
    s_cselect_b64 vcc, -1, 0
    v_cndmask_b32 v2, -2.0, v2, vcc
    s_lshl_b32 s29, s3, 10
    s_and_b32 s20, s2, 1
    s_lshl_b32 s20, s20, 2
    s_lshr_b32 s21, s2, 6
    s_add_u32 s20, s20, s21
    s_bfe_u32 s21, s2, 0x20001
    s_bfe_u32 s22, s2, 0x30003
    s_lshl_b32 s23, s21, 3
    s_add_u32 s23, s23, s22
    s_waitcnt lgkmcnt(0)
    s_mov_b32 s40, s44
    s_mov_b32 s41, s45
    s_mov_b32 s42, 2359296
    s_mov_b32 s43, 0x20000
    s_add_u32 m0, s29, 98304
    s_mov_b32 s8, s58
    s_mov_b32 s9, s59
    s_mov_b32 s10, 0x10000000
    s_mov_b32 s11, 0x20000
    buffer_load_dwordx4 v226, s[40:43], 0 offen offset:0 lds
    s_add_u32 m0, s29, 101888
    s_nop 0
    buffer_load_dwordx4 v226, s[40:43], 0 offen offset:512 lds
    s_add_u32 m0, s29, 105472
    s_nop 0
    buffer_load_dwordx4 v227, s[40:43], 0 offen offset:1024 lds
    buffer_store_dwordx4 v[4:7], v2, s[8:11], s24 offen sc1
    buffer_store_dwordx4 v[4:7], v3, s[8:11], 0 offen sc1
    s_mul_i32 s13, s23, 36864
    s_add_u32 s13, s13, s12
    s_and_b32 s24, s22, 3
    s_lshl_b32 s26, s21, 2
    s_add_u32 s26, s26, s24
    s_mul_i32 s14, s26, 331776
    s_add_u32 s14, s14, s12
    s_add_u32 s14, s14, 11534336
    s_lshr_b32 s24, s3, 1
    s_lshl_b32 s24, s24, 3
    s_sub_u32 s25, 568, s24
    s_mov_b32 s19, 147456
    s_bitcmp1_b32 s3, 0
    s_cselect_b32 s24, s25, s24
    s_cselect_b32 s19, 4294819840, s19
    s_mul_i32 s24, s24, 9216
    s_lshl_b32 s25, s23, 7
    s_add_u32 s18, s24, s25
    s_mov_b32 s58, s2
    s_and_b32 s26, s3, 1
    s_lshl_b32 s26, s26, 2
    s_mov_b32 s42, 5308416
    s_mov_b32 s43, 0x20000
    v_bfe_u32 v12, v0, 3, 3
    v_xor_b32 v13, s26, v12
    v_and_b32 v12, 6, v12
    v_xor_b32 v12, v12, v0
    v_and_b32 v12, 7, v12
    v_mul_u32_u24 v13, 9216, v13
    v_lshl_add_u32 v11, v12, 4, v13
    s_lshl_b32 s26, s2, 1
    s_and_b32 s27, s3, 1
    s_add_u32 s26, s26, s27
    s_mul_i32 s27, s26, 36
    s_mul_i32 s26, s26, 36
    v_cmp_gt_u32 vcc, 576, v1
    v_lshrrev_b32 v8, 4, v1
    v_add_u32 v8, s27, v8
    v_and_b32 v9, 31, v8
    v_lshrrev_b32 v8, 5, v8
    v_mul_u32_u24 v8, 9216, v8
    v_lshl_add_u32 v8, v9, 7, v8
    v_cndmask_b32 v8, -2.0, v8, vcc
    s_cmp_lt_u32 s3, 2
    s_cselect_b64 s[0:1], s[48:49], s[50:51]
    s_mov_b64 s[40:41], s[0:1]
    buffer_load_dword a254, v8, s[40:43], 0 offen
    s_lshr_b32 s26, s26, 2
    v_cmp_gt_u32 vcc, 144, v1
    v_lshrrev_b32 v9, 4, v1
    v_add_u32 v9, s26, v9
    v_and_b32 v10, 7, v9
    v_lshrrev_b32 v9, 3, v9
    v_mul_u32_u24 v9, 9216, v9
    v_lshl_add_u32 v9, v10, 7, v9
    v_cndmask_b32 v9, -2.0, v9, vcc
    s_movk_i32 s26, 8192
    buffer_load_dword a253, v9, s[40:43], s26 offen
    s_lshl_b32 s24, s7, 5
    v_and_b32 v217, 7, v0
    s_lshl_b32 s25, s4, 3
    v_bfe_u32 v36, v0, 3, 3
    s_add_u32 s24, s24, s25
    v_and_b32 v37, 1, v36
    s_mul_i32 s26, s3, 18
    v_add_u32 v215, s26, v36
    s_movk_i32 s27, 896
    v_add3_u32 v37, v37, s26, 16
    v_lshrrev_b32 v38, 1, v36
    v_add_u32 v216, s24, v217
    v_lshl_add_u32 v208, v215, 11, v216
    v_lshlrev_b32 v208, 4, v208
    v_lshl_add_u32 v209, v37, 11, v216
    v_lshl_add_u32 v209, v209, 2, v38
    v_lshlrev_b32 v209, 2, v209
    v_cmp_gt_u32 vcc, 2, v38
    v_lshlrev_b32 v39, 2, v37
    v_sub_u32 v40, 568, v39
    v_cndmask_b32 v39, v40, v39, vcc
    v_lshl_add_u32 v214, v38, 1, v39
    v_and_b32 v39, 6, v217
    v_lshlrev_b32 v39, 4, v39
    v_lshlrev_b32 v40, 7, v217
    v_add_u32 v40, 98304, v40
    v_lshlrev_b32 v220, 3, v215
    v_sub_u32 v221, 1144, v220
    v_add_u32 v222, 64, v220
    v_sub_u32 v223, 1080, v220
    v_lshlrev_b32 v224, 1, v214
    v_lshrrev_b32 v41, 7, v220
    v_xad_u32 v220, v220, v39, v40
    v_mad_u32_u24 v220, v41, s27, v220
    v_lshrrev_b32 v42, 7, v221
    v_xad_u32 v221, v221, v39, v40
    v_mad_u32_u24 v221, v42, s27, v221
    v_lshrrev_b32 v41, 7, v222
    v_xad_u32 v222, v222, v39, v40
    v_mad_u32_u24 v222, v41, s27, v222
    v_lshrrev_b32 v42, 7, v223
    v_xad_u32 v223, v223, v39, v40
    v_mad_u32_u24 v223, v42, s27, v223
    v_lshrrev_b32 v41, 7, v224
    v_xad_u32 v224, v224, v39, v40
    v_mad_u32_u24 v224, v41, s27, v224
    s_movk_i32 s27, 192
    v_mul_u32_u24 v228, 1760, v217
    v_add_u32 v228, 73728, v228
    v_lshlrev_b32 v229, 2, v215
    v_sub_u32 v230, 572, v229
    v_add_u32 v231, 32, v229
    v_subrev_u32 v232, 32, v230
    v_mul_u32_u24 v233, 7282, v229
    v_lshrrev_b32 v233, 16, v233
    v_mad_i32_i24 v233, v233, -9, v229
    v_and_b32 v234, 63, v229
    v_lshl_add_u32 v234, v234, 1, v228
    v_mad_u32_u24 v84, v233, s27, v234
    v_add_u32 v235, 1, v233
    v_add_u32 v236, -8, v233
    v_min_u32 v235, v235, v236
    v_mad_u32_u24 v85, v235, s27, v234
    v_add_u32 v235, 2, v233
    v_add_u32 v236, -7, v233
    v_min_u32 v235, v235, v236
    v_mad_u32_u24 v86, v235, s27, v234
    v_add_u32 v235, 3, v233
    v_add_u32 v236, -6, v233
    v_min_u32 v235, v235, v236
    v_mad_u32_u24 v87, v235, s27, v234
    v_mul_u32_u24 v237, 7282, v230
    v_lshrrev_b32 v237, 16, v237
    v_mad_i32_i24 v237, v237, -9, v230
    v_and_b32 v238, 63, v230
    v_lshl_add_u32 v238, v238, 1, v228
    v_mad_u32_u24 v88, v237, s27, v238
    v_add_u32 v239, 1, v237
    v_add_u32 v240, -8, v237
    v_min_u32 v239, v239, v240
    v_mad_u32_u24 v89, v239, s27, v238
    v_add_u32 v239, 2, v237
    v_add_u32 v240, -7, v237
    v_min_u32 v239, v239, v240
    v_mad_u32_u24 v90, v239, s27, v238
    v_add_u32 v239, 3, v237
    v_add_u32 v240, -6, v237
    v_min_u32 v239, v239, v240
    v_mad_u32_u24 v91, v239, s27, v238
    v_mul_u32_u24 v233, 7282, v231
    v_lshrrev_b32 v233, 16, v233
    v_mad_i32_i24 v233, v233, -9, v231
    s_lshl_b32 s26, s3, 3
    v_and_b32 v234, 63, v231
    v_lshl_add_u32 v234, v234, 1, v228
    v_mad_u32_u24 v92, v233, s27, v234
    v_add_u32 v235, 1, v233
    v_add_u32 v236, -8, v233
    v_min_u32 v235, v235, v236
    s_lshr_b32 s29, s3, 1
    v_mad_u32_u24 v93, v235, s27, v234
    s_lshl_b32 s29, s29, 4
    v_add_u32 v235, 2, v233
    v_add_u32 v236, -7, v233
    v_min_u32 v235, v235, v236
    v_mad_u32_u24 v94, v235, s27, v234
    v_add_u32 v235, 3, v233
    v_add_u32 v236, -6, v233
    v_min_u32 v235, v235, v236
    v_mad_u32_u24 v95, v235, s27, v234
    v_mul_u32_u24 v237, 7282, v232
    v_lshrrev_b32 v237, 16, v237
    v_mad_i32_i24 v237, v237, -9, v232
    v_and_b32 v238, 63, v232
    v_lshl_add_u32 v238, v238, 1, v228
    v_mad_u32_u24 v96, v237, s27, v238
    v_add_u32 v239, 1, v237
    v_add_u32 v240, -8, v237
    v_min_u32 v239, v239, v240
    v_mad_u32_u24 v97, v239, s27, v238
    v_add_u32 v239, 2, v237
    v_add_u32 v240, -7, v237
    v_min_u32 v239, v239, v240
    v_mad_u32_u24 v98, v239, s27, v238
    v_add_u32 v239, 3, v237
    v_add_u32 v240, -6, v237
    v_min_u32 v239, v239, v240
    v_mad_u32_u24 v99, v239, s27, v238
    v_mul_u32_u24 v233, 7282, v214
    v_lshrrev_b32 v233, 16, v233
    v_mad_i32_i24 v233, v233, -9, v214
    v_and_b32 v234, 63, v214
    v_lshl_add_u32 v234, v234, 1, v228
    v_mad_u32_u24 v100, v233, s27, v234
    v_add_u32 v235, 1, v233
    v_add_u32 v236, -8, v233
    v_min_u32 v235, v235, v236
    v_mad_u32_u24 v101, v235, s27, v234
    v_cmp_ne_u32 s[30:31], 0, v215
    v_mov_b32 v213, 0xffff0000
    v_lshlrev_b32 v120, 5, v217
    v_add_u32 v120, 88064, v120
    v_add_u32 v119, s26, v120
    s_and_b32 s26, s3, 1
    v_cndmask_b32 v213, v213, -1, s[30:31]
    s_lshl_b32 s26, s26, 1
    v_and_b32 v228, 15, v0
    v_bfe_u32 v229, v0, 4, 2
    v_add_u32 v230, s29, v228
    v_cmp_eq_u32 s[32:33], 0, v230
    v_cvt_f32_u32 v231, v230
    v_mul_f32 v231, 0x3c800000, v231
    v_lshlrev_b32 v232, 3, v229
    v_cvt_f32_u32 v232, v232
    v_mul_f32 v232, v232, v231
    v_mov_b32 v239, 0x3f003f00
    v_mov_b32 v240, 0xbf003f00
    v_bfe_i32 v241, v0, 0, 1
    v_and_b32 v241, 0x80008000, v241
    v_fmamk_f32 v233, v231, 0x00000000, v232
    v_fmamk_f32 v234, v231, 0x3f800000, v232
    v_cos_f32 v102, v233
    v_cos_f32 v237, v234
    v_sin_f32 v233, v233
    v_sin_f32 v234, v234
    v_cvt_pk_bf16_f32 v102, v102, v237
    v_cvt_pk_bf16_f32 v106, -v233, -v234
    s_mov_b32 s29, 73728
    v_cndmask_b32 v102, v102, v239, s[32:33]
    v_cndmask_b32 v106, v106, v240, s[32:33]
    v_xor_b32 v110, v241, v102
    v_xor_b32 v114, v241, v106
    v_fmamk_f32 v235, v231, 0x40000000, v232
    v_fmamk_f32 v236, v231, 0x40400000, v232
    v_cos_f32 v103, v235
    v_cos_f32 v238, v236
    v_sin_f32 v235, v235
    v_sin_f32 v236, v236
    v_cvt_pk_bf16_f32 v103, v103, v238
    v_cvt_pk_bf16_f32 v107, -v235, -v236
    v_cndmask_b32 v103, v103, v239, s[32:33]
    v_cndmask_b32 v107, v107, v240, s[32:33]
    v_xor_b32 v111, v241, v103
    v_xor_b32 v115, v241, v107
    v_fmamk_f32 v233, v231, 0x40800000, v232
    v_fmamk_f32 v234, v231, 0x40a00000, v232
    v_cos_f32 v104, v233
    v_cos_f32 v237, v234
    v_sin_f32 v233, v233
    v_sin_f32 v234, v234
    v_cvt_pk_bf16_f32 v104, v104, v237
    v_cvt_pk_bf16_f32 v108, -v233, -v234
    v_cndmask_b32 v104, v104, v239, s[32:33]
    v_cndmask_b32 v108, v108, v240, s[32:33]
    v_xor_b32 v112, v241, v104
    v_xor_b32 v116, v241, v108
    v_fmamk_f32 v235, v231, 0x40c00000, v232
    v_fmamk_f32 v236, v231, 0x40e00000, v232
    v_cos_f32 v105, v235
    v_cos_f32 v238, v236
    v_sin_f32 v235, v235
    v_sin_f32 v236, v236
    v_cvt_pk_bf16_f32 v105, v105, v238
    v_cvt_pk_bf16_f32 v109, -v235, -v236
    v_cndmask_b32 v105, v105, v239, s[32:33]
    v_cndmask_b32 v109, v109, v240, s[32:33]
    v_xor_b32 v113, v241, v105
    v_xor_b32 v117, v241, v109
    v_lshrrev_b32 v231, 2, v228
    v_and_b32 v233, 2, v231
    v_add3_u32 v231, v231, v233, s26
    v_mul_u32_u24 v231, 1760, v231
    v_and_b32 v233, 3, v228
    v_mul_u32_u24 v233, 192, v233
    v_lshl_add_u32 v231, v229, 4, v231
    v_add3_u32 v118, v231, v233, s29
    v_and_b32 v233, 2, v229
    v_add3_u32 v229, v229, v233, s26
    v_lshlrev_b32 v211, 5, v229
    v_add_u32 v211, 88064, v211
    v_cndmask_b32 v212, 0, 0.5, s[32:33]
    v_mul_u32_u24 v231, 432, v230
    v_and_b32 v197, 3, v229
    v_lshlrev_b32 v197, 2, v197
    v_add_u32 v197, 88720, v197
    v_mov_b32 v239, 13824
    v_cndmask_b32 v240, v231, v239, s[32:33]
    v_sad_u32 v188, v231, v239, v197
    v_sub_u32 v198, v239, v231
    v_add_u32 v235, 3072, v231
    v_sad_u32 v189, v235, v239, v197
    s_lshl_b32 s26, s5, 12
    v_sub_u32 v199, v239, v235
    s_lshl_b32 s29, s4, 10
    v_add_u32 v233, 6144, v231
    s_add_u32 s26, s26, s29
    v_sad_u32 v190, v233, v239, v197
    s_lshl_b32 s29, s6, 6
    v_sub_u32 v200, v239, v233
    s_add_u32 s26, s26, s29
    v_add_u32 v235, 9216, v231
    v_sad_u32 v191, v235, v239, v197
    v_sub_u32 v201, v239, v235
    v_add_u32 v233, 12288, v231
    v_sad_u32 v192, v233, v239, v197
    v_sub_u32 v202, v239, v233
    v_add_u32 v235, 15360, v240
    v_add_u32 v236, 4294955008, v240
    v_min_u32 v235, v235, v236
    v_sad_u32 v193, v235, v239, v197
    v_sub_u32 v203, v239, v235
    v_add_u32 v233, 18432, v240
    v_add_u32 v234, 4294958080, v240
    v_min_u32 v233, v233, v234
    v_sad_u32 v194, v233, v239, v197
    v_sub_u32 v204, v239, v233
    v_add_u32 v235, 21504, v240
    v_add_u32 v236, 4294961152, v240
    v_min_u32 v235, v235, v236
    v_sad_u32 v195, v235, v239, v197
    v_sub_u32 v205, v239, v235
    v_add_u32 v233, 24576, v240
    v_add_u32 v234, 4294964224, v240
    v_min_u32 v233, v233, v234
    v_sad_u32 v196, v233, v239, v197
    v_sub_u32 v206, v239, v233
    v_subrev_u32 v233, 144, v197
    v_cmp_gt_u32 vcc, 512, v1
    v_cndmask_b32 v197, v233, v197, s[32:33]
    v_lshlrev_b32 v207, 3, v216
    v_cndmask_b32 v188, v189, v188, vcc
    v_cndmask_b32 v190, v191, v190, vcc
    v_cndmask_b32 v192, v193, v192, vcc
    v_cndmask_b32 v194, v195, v194, vcc
    v_cndmask_b32 v196, v197, v196, vcc
    v_cndmask_b32 v207, v207, -2.0, s[30:31]
    v_lshrrev_b32 v235, 3, v0
    v_and_b32 v234, 3, v0
    v_bfe_u32 v236, v0, 2, 1
    v_lshl_add_u32 v121, v235, 2, v234
    v_mul_u32_u24 v121, 48, v121
    v_sub_u32 v121, 90256, v121
    v_lshl_add_u32 v121, v236, 4, v121
    v_cmp_gt_u32 vcc, 72, v0
    v_mul_u32_u24 v236, 1196032, v236
    v_lshl_add_u32 v235, v235, 14, v236
    v_lshl_add_u32 v235, v234, 4, v235
    v_add_u32 v122, s26, v235
    v_cndmask_b32 v123, -2.0, v122, vcc
    s_branch L_body
L_exit:
    s_endpgm
.p2align 12
L_body:
    s_mov_b64 s[20:21], s[56:57]
    s_movk_i32 s22, 64
    s_mov_b32 s23, 0x20000
    s_lshl_b32 s26, s2, 2
    v_lshl_add_u32 v2, v0, 8, s26
    v_mov_b32 v3, 1
    s_mov_b32 s24, 0x3f5db3d7
    s_mov_b32 s25, 0xbf000000
    s_mov_b32 s16, 0x3f441b7d
    s_mov_b32 s17, 0x3f248dbb
    s_mov_b32 s28, 0x3e31d0d4
    s_mov_b32 s29, 0x3f7c1c5c
    s_mov_b32 s38, 0xbf708fb2
    s_mov_b32 s39, 0x3eaf1d44
    s_waitcnt vmcnt(3)
    s_barrier
    ds_read_b64 v[12:13], v220
    ds_read_b64 v[14:15], v221
    ds_read_b64 v[16:17], v222
    ds_read_b64 v[18:19], v223
    ds_read_b32 v20, v224
    buffer_store_dword v3, v2, s[20:23], 0 offen sc1
    s_waitcnt lgkmcnt(4)
    ds_write_b16 v86, v13 offset:4
    v_lshlrev_b32 v124, 16, v12
    ds_write_b16_d16_hi v87, v13 offset:6
    v_and_b32 v125, 0xffff0000, v12
    s_waitcnt lgkmcnt(5)
    ds_write_b16 v88, v14 offset:0
    v_and_b32 v12, v213, v12
    ds_write_b16_d16_hi v89, v14 offset:2
    v_lshlrev_b32 v126, 16, v13
    ds_write_b16 v90, v15 offset:4
    v_and_b32 v127, 0xffff0000, v13
    ds_write_b16_d16_hi v91, v15 offset:6
    v_lshlrev_b32 v128, 16, v14
    s_waitcnt lgkmcnt(8)
    ds_write_b16 v92, v16 offset:0
    v_and_b32 v129, 0xffff0000, v14
    ds_write_b16_d16_hi v93, v16 offset:2
    v_lshlrev_b32 v130, 16, v15
    ds_write_b16 v94, v17 offset:4
    v_and_b32 v131, 0xffff0000, v15
    ds_write_b16_d16_hi v95, v17 offset:6
    v_lshlrev_b32 v132, 16, v16
    s_waitcnt lgkmcnt(11)
    ds_write_b16 v96, v18 offset:0
    v_and_b32 v133, 0xffff0000, v16
    ds_write_b16_d16_hi v97, v18 offset:2
    v_lshlrev_b32 v134, 16, v17
    v_and_b32 v135, 0xffff0000, v17
    ds_write_b16 v98, v19 offset:4
    v_lshlrev_b32 v136, 16, v18
    v_and_b32 v137, 0xffff0000, v18
    ds_write_b16_d16_hi v99, v19 offset:6
    v_lshlrev_b32 v138, 16, v19
    v_and_b32 v139, 0xffff0000, v19
    s_waitcnt lgkmcnt(14)
    ds_write_b16 v100, v20 offset:0
    v_lshlrev_b32 v140, 16, v20
    v_and_b32 v141, 0xffff0000, v20
    ds_write_b16_d16_hi v101, v20 offset:2
    v_pk_add_f32 v[62:63], v[124:125], v[126:127]
    v_pk_mul_f32 v[64:65], v[124:125], v[124:125]
    ds_write_b16 v84, v12 offset:0
    v_pk_fma_f32 v[64:65], v[126:127], v[126:127], v[64:65]
    v_pk_add_f32 v[62:63], v[62:63], v[128:129]
    ds_write_b16_d16_hi v85, v12 offset:2
    v_pk_fma_f32 v[64:65], v[128:129], v[128:129], v[64:65]
    v_pk_add_f32 v[62:63], v[62:63], v[130:131]
    v_pk_fma_f32 v[64:65], v[130:131], v[130:131], v[64:65]
    v_pk_add_f32 v[62:63], v[62:63], v[132:133]
    v_pk_fma_f32 v[64:65], v[132:133], v[132:133], v[64:65]
    v_pk_add_f32 v[62:63], v[62:63], v[134:135]
    v_pk_fma_f32 v[64:65], v[134:135], v[134:135], v[64:65]
    v_pk_add_f32 v[62:63], v[62:63], v[136:137]
    v_pk_fma_f32 v[64:65], v[136:137], v[136:137], v[64:65]
    v_pk_add_f32 v[62:63], v[62:63], v[138:139]
    v_pk_fma_f32 v[64:65], v[138:139], v[138:139], v[64:65]
    v_pk_add_f32 v[62:63], v[62:63], v[140:141]
    v_pk_fma_f32 v[64:65], v[140:141], v[140:141], v[64:65]
    v_add_f32 v62, v62, v63
    v_add_f32 v63, v64, v65
    s_nop 0
    v_add_f32_dpp v62, v62, v62 row_ror:8 row_mask:0xf bank_mask:0xf
    v_add_f32_dpp v63, v63, v63 row_ror:8 row_mask:0xf bank_mask:0xf
    v_mov_b32 v64, v62
    v_mov_b32 v65, v63
    s_nop 0
    v_permlane16_swap_b32 v64, v62
    v_permlane16_swap_b32 v65, v63
    v_pk_add_f32 v[62:63], v[62:63], v[64:65]
    v_mov_b32 v64, v62
    v_mov_b32 v65, v63
    s_nop 0
    v_permlane32_swap_b32 v64, v62
    v_permlane32_swap_b32 v65, v63
    v_pk_add_f32 v[62:63], v[62:63], v[64:65]
    ds_write_b64 v119, v[62:63]
    s_add_u32 m0, s12, 0
    s_mov_b64 s[40:41], s[48:49]
    s_add_u32 s15, s18, 0
    buffer_load_dwordx4 v11, s[40:43], s15 offen  lds
    s_add_u32 m0, s12, 1024
    s_add_u32 s15, s15, s19
    buffer_load_dwordx4 v11, s[40:43], s15 offen  lds
    s_add_u32 m0, s12, 2048
    s_add_u32 s15, s15, s19
    buffer_load_dwordx4 v11, s[40:43], s15 offen  lds
    s_waitcnt lgkmcnt(0)
    s_barrier
    ds_read_b128 v[16:19], v118 offset:0
    ds_read_b128 v[20:23], v118 offset:64
    ds_read_b128 v[64:67], v211
    ds_read_b128 v[68:71], v211 offset:16
    ds_read_b128 v[24:27], v118 offset:576
    ds_read_b128 v[28:31], v118 offset:640
    ds_read_b128 v[32:35], v118 offset:1152
    ds_read_b128 v[36:39], v118 offset:1216
    ds_read_b128 v[72:75], v120
    ds_read_b128 v[76:79], v120 offset:16
    s_waitcnt lgkmcnt(9)
    v_mfma_f32_16x16x32_bf16 v[160:163], v[16:19], v[102:105], 0
    s_add_u32 m0, s12, 3072
    s_add_u32 s15, s15, s19
    buffer_load_dwordx4 v11, s[40:43], s15 offen  lds
    s_waitcnt lgkmcnt(8)
    v_mfma_f32_16x16x32_bf16 v[160:163], v[20:23], v[110:113], v[160:163]
    s_add_u32 m0, s12, 4096
    s_waitcnt lgkmcnt(7)
    v_add_f32 v64, v64, v66
    v_add_f32 v65, v65, v67
    v_mfma_f32_16x16x32_bf16 v[172:175], v[16:19], v[106:109], 0
    s_add_u32 s15, s15, s19
    s_waitcnt lgkmcnt(6)
    v_add_f32 v68, v68, v70
    v_add_f32 v69, v69, v71
    v_mfma_f32_16x16x32_bf16 v[172:175], v[20:23], v[114:117], v[172:175]
    v_add_f32 v64, v64, v68
    v_add_f32 v65, v65, v69
    s_waitcnt lgkmcnt(5)
    v_mfma_f32_16x16x32_bf16 v[164:167], v[24:27], v[102:105], 0
    buffer_load_dwordx4 v11, s[40:43], s15 offen  lds
    s_waitcnt lgkmcnt(4)
    v_mfma_f32_16x16x32_bf16 v[164:167], v[28:31], v[110:113], v[164:167]
    s_add_u32 m0, s12, 5120
    v_mul_f32 v64, 0x3ae38e39, v64
    v_mul_f32 v65, 0x3ae38e39, v65
    v_mfma_f32_16x16x32_bf16 v[176:179], v[24:27], v[106:109], 0
    s_add_u32 s15, s15, s19
    v_fma_f32 v65, -v64, v64, v65
    v_mul_f32 v67, v212, v64
    v_mfma_f32_16x16x32_bf16 v[176:179], v[28:31], v[114:117], v[176:179]
    v_max_f32 v65, 0, v65
    v_sub_f32 v68, v64, v67
    s_waitcnt lgkmcnt(3)
    v_mfma_f32_16x16x32_bf16 v[168:171], v[32:35], v[102:105], 0
    buffer_load_dwordx4 v11, s[40:43], s15 offen  lds
    s_waitcnt lgkmcnt(2)
    v_mfma_f32_16x16x32_bf16 v[168:171], v[36:39], v[110:113], v[168:171]
    v_add_f32 v65, 0x3727c5ac, v65
    s_waitcnt lgkmcnt(1)
    v_add_f32 v72, v72, v74
    v_mfma_f32_16x16x32_bf16 v[180:183], v[32:35], v[106:109], 0
    s_waitcnt lgkmcnt(0)
    v_add_f32 v76, v76, v78
    v_add_f32 v72, v72, v76
    v_mfma_f32_16x16x32_bf16 v[180:183], v[36:39], v[114:117], v[180:183]
    v_rsq_f32 v66, v65
    v_mul_f32 v72, 0x3ae38e39, v72
    v_add_f32 v160, v160, v68
    v_add_f32 v172, v172, v67
    v_pk_add_f32 v[124:125], v[124:125], v[72:73] op_sel_hi:[1,0] neg_lo:[0,1] neg_hi:[0,1]
    v_pk_add_f32 v[126:127], v[126:127], v[72:73] op_sel_hi:[1,0] neg_lo:[0,1] neg_hi:[0,1]
    v_pk_add_f32 v[128:129], v[128:129], v[72:73] op_sel_hi:[1,0] neg_lo:[0,1] neg_hi:[0,1]
    v_pk_add_f32 v[130:131], v[130:131], v[72:73] op_sel_hi:[1,0] neg_lo:[0,1] neg_hi:[0,1]
    v_pk_add_f32 v[16:17], v[164:165], v[168:169]
    v_add_f32 v18, v166, v170
    v_pk_add_f32 v[24:25], v[164:165], v[168:169] neg_lo:[0,1] neg_hi:[0,1]
    v_sub_f32 v26, v166, v170
    v_pk_fma_f32 v[32:33], v[16:17], s[24:25], v[160:161] op_sel:[0,1,0] op_sel_hi:[1,1,1]
    v_fma_f32 v34, v18, -0.5, v162
    v_pk_add_f32 v[20:21], v[176:177], v[180:181]
    v_add_f32 v22, v178, v182
    v_pk_add_f32 v[28:29], v[176:177], v[180:181] neg_lo:[0,1] neg_hi:[0,1]
    v_sub_f32 v30, v178, v182
    v_pk_fma_f32 v[36:37], v[20:21], s[24:25], v[172:173] op_sel:[0,1,0] op_sel_hi:[1,1,1]
    v_fma_f32 v38, v22, -0.5, v174
    v_fma_f32 v150, v29, s24, v33
    v_fma_f32 v151, -v25, s24, v37
    v_fma_f32 v156, -v29, s24, v33
    v_fma_f32 v157, v25, s24, v37
    v_add_f32 v144, v161, v17
    v_add_f32 v145, v173, v21
    v_fma_f32 v152, v30, s24, v34
    v_fma_f32 v153, -v26, s24, v38
    v_fma_f32 v158, -v30, s24, v34
    v_fma_f32 v159, v26, s24, v38
    v_add_f32 v146, v162, v18
    v_add_f32 v147, v174, v22
    v_fma_f32 v148, v28, s24, v32
    v_fma_f32 v149, -v24, s24, v36
    v_fma_f32 v154, -v28, s24, v32
    v_fma_f32 v155, v24, s24, v36
    v_add_f32 v142, v160, v16
    v_add_f32 v143, v172, v20
    v_pk_mul_f32 v[16:17], v[150:151], s[16:17] op_sel_hi:[1,0]
    v_pk_mul_f32 v[18:19], v[156:157], s[28:29] op_sel_hi:[1,0]
    v_pk_mul_f32 v[20:21], v[152:153], s[28:29] op_sel_hi:[1,0]
    v_pk_mul_f32 v[22:23], v[158:159], s[38:39] op_sel_hi:[1,0]
    v_pk_fma_f32 v[150:151], v[150:151], s[16:17], v[16:17] op_sel:[1,1,0] op_sel_hi:[0,1,1] neg_hi:[1,0,0]
    v_pk_fma_f32 v[156:157], v[156:157], s[28:29], v[18:19] op_sel:[1,1,0] op_sel_hi:[0,1,1] neg_hi:[1,0,0]
    v_pk_fma_f32 v[152:153], v[152:153], s[28:29], v[20:21] op_sel:[1,1,0] op_sel_hi:[0,1,1] neg_hi:[1,0,0]
    v_pk_fma_f32 v[158:159], v[158:159], s[38:39], v[22:23] op_sel:[1,1,0] op_sel_hi:[0,1,1] neg_hi:[1,0,0]
    v_pk_add_f32 v[16:17], v[144:145], v[146:147]
    v_pk_add_f32 v[18:19], v[144:145], v[146:147] neg_lo:[0,1] neg_hi:[0,1]
    v_pk_add_f32 v[22:23], v[150:151], v[152:153]
    v_pk_add_f32 v[24:25], v[150:151], v[152:153] neg_lo:[0,1] neg_hi:[0,1]
    v_pk_add_f32 v[28:29], v[156:157], v[158:159]
    v_pk_add_f32 v[30:31], v[156:157], v[158:159] neg_lo:[0,1] neg_hi:[0,1]
    v_pk_fma_f32 v[20:21], v[16:17], s[24:25], v[142:143] op_sel:[0,1,0] op_sel_hi:[1,1,1]
    v_pk_add_f32 v[142:143], v[142:143], v[16:17]
    v_pk_fma_f32 v[26:27], v[22:23], s[24:25], v[148:149] op_sel:[0,1,0] op_sel_hi:[1,1,1]
    v_pk_add_f32 v[148:149], v[148:149], v[22:23]
    v_pk_fma_f32 v[32:33], v[28:29], s[24:25], v[154:155] op_sel:[0,1,0] op_sel_hi:[1,1,1]
    v_pk_add_f32 v[154:155], v[154:155], v[28:29]
    v_pk_fma_f32 v[144:145], v[18:19], s[24:25], v[20:21] op_sel:[1,0,0] op_sel_hi:[0,0,1] neg_hi:[1,0,0]
    v_pk_fma_f32 v[146:147], v[18:19], s[24:25], v[20:21] op_sel:[1,0,0] op_sel_hi:[0,0,1] neg_lo:[1,0,0]
    v_pk_fma_f32 v[150:151], v[24:25], s[24:25], v[26:27] op_sel:[1,0,0] op_sel_hi:[0,0,1] neg_hi:[1,0,0]
    v_pk_fma_f32 v[152:153], v[24:25], s[24:25], v[26:27] op_sel:[1,0,0] op_sel_hi:[0,0,1] neg_lo:[1,0,0]
    v_pk_fma_f32 v[156:157], v[30:31], s[24:25], v[32:33] op_sel:[1,0,0] op_sel_hi:[0,0,1] neg_hi:[1,0,0]
    v_pk_fma_f32 v[158:159], v[30:31], s[24:25], v[32:33] op_sel:[1,0,0] op_sel_hi:[0,0,1] neg_lo:[1,0,0]
    s_cmp_lt_u32 s3, 2
    s_cbranch_scc0 L_pk1
    s_mov_b64 exec, s[32:33]
    v_pk_add_f32 v[158:159], v[148:149], v[158:159] op_sel:[1,1] op_sel_hi:[0,0] neg_hi:[0,1]
    v_pk_add_f32 v[152:153], v[154:155], v[152:153] op_sel:[1,1] op_sel_hi:[0,0] neg_hi:[0,1]
    v_pk_add_f32 v[146:147], v[144:145], v[146:147] op_sel:[1,1] op_sel_hi:[0,0] neg_hi:[0,1]
    v_pk_add_f32 v[156:157], v[150:151], v[156:157] op_sel:[1,1] op_sel_hi:[0,0] neg_hi:[0,1]
    v_add_f32 v16, v143, v143
    v_fmamk_f32 v142, v64, 0xc3900000, v142
    v_mul_f32 v16, v16, v66
    v_pk_fma_f32 v[148:149], v[148:149], 2.0, v[158:159] op_sel:[0,0,1] op_sel_hi:[1,0,0] neg_lo:[0,0,1] neg_hi:[0,0,1]
    v_pk_fma_f32 v[154:155], v[154:155], 2.0, v[152:153] op_sel:[0,0,1] op_sel_hi:[1,0,0] neg_lo:[0,0,1] neg_hi:[0,0,1]
    v_pk_fma_f32 v[144:145], v[144:145], 2.0, v[146:147] op_sel:[0,0,1] op_sel_hi:[1,0,0] neg_lo:[0,0,1] neg_hi:[0,0,1]
    v_pk_fma_f32 v[150:151], v[150:151], 2.0, v[156:157] op_sel:[0,0,1] op_sel_hi:[1,0,0] neg_lo:[0,0,1] neg_hi:[0,0,1]
    v_add_f32 v142, v142, v142
    v_cvt_pk_f16_f32 v27, v16, 0
    v_mov_b32 v143, 0
    s_mov_b64 exec, -1
L_pk1:
    s_brev_b32 s26, 1
    v_pk_mul_f32 v[142:143], v[142:143], v[66:67] op_sel_hi:[1,0]
    v_pk_mul_f32 v[148:149], v[148:149], v[66:67] op_sel_hi:[1,0]
    v_cvt_pk_f16_f32 v18, v142, v143
    v_pk_mul_f32 v[154:155], v[154:155], v[66:67] op_sel_hi:[1,0]
    v_cvt_pk_f16_f32 v19, v148, v149
    v_bitop3_b32 v18, v18, v198, s26 bitop3:0x78
    v_pk_mul_f32 v[144:145], v[144:145], v[66:67] op_sel_hi:[1,0]
    v_cvt_pk_f16_f32 v20, v154, v155
    v_bitop3_b32 v19, v19, v199, s26 bitop3:0x78
    v_pk_mul_f32 v[150:151], v[150:151], v[66:67] op_sel_hi:[1,0]
    v_cvt_pk_f16_f32 v21, v144, v145
    v_permlane32_swap_b32 v18, v19
    v_bitop3_b32 v20, v20, v200, s26 bitop3:0x78
    v_pk_mul_f32 v[156:157], v[156:157], v[66:67] op_sel_hi:[1,0]
    v_cvt_pk_f16_f32 v22, v150, v151
    v_bitop3_b32 v21, v21, v201, s26 bitop3:0x78
    v_pk_add_f16 v16, v18, v19
    v_pk_add_f16 v19, v18, v19 neg_lo:[0,1] neg_hi:[0,1]
    ds_write2_b32 v188, v16, v19 offset0:0 offset1:4
    v_pk_mul_f32 v[146:147], v[146:147], v[66:67] op_sel_hi:[1,0]
    v_cvt_pk_f16_f32 v23, v156, v157
    v_permlane32_swap_b32 v20, v21
    v_bitop3_b32 v22, v22, v202, s26 bitop3:0x78
    v_pk_mul_f32 v[152:153], v[152:153], v[66:67] op_sel_hi:[1,0]
    v_cvt_pk_f16_f32 v24, v146, v147
    v_bitop3_b32 v23, v23, v203, s26 bitop3:0x78
    v_pk_add_f16 v17, v20, v21
    v_pk_add_f16 v21, v20, v21 neg_lo:[0,1] neg_hi:[0,1]
    ds_write2_b32 v190, v17, v21 offset0:0 offset1:4
    v_pk_mul_f32 v[158:159], v[158:159], v[66:67] op_sel_hi:[1,0]
    v_cvt_pk_f16_f32 v25, v152, v153
    v_permlane32_swap_b32 v22, v23
    v_bitop3_b32 v24, v24, v204, s26 bitop3:0x78
    v_pk_add_f32 v[132:133], v[132:133], v[72:73] op_sel_hi:[1,0] neg_lo:[0,1] neg_hi:[0,1]
    v_cvt_pk_f16_f32 v26, v158, v159
    v_bitop3_b32 v25, v25, v205, s26 bitop3:0x78
    v_pk_add_f16 v16, v22, v23
    v_pk_add_f16 v23, v22, v23 neg_lo:[0,1] neg_hi:[0,1]
    ds_write2_b32 v192, v16, v23 offset0:0 offset1:4
    v_pk_add_f32 v[134:135], v[134:135], v[72:73] op_sel_hi:[1,0] neg_lo:[0,1] neg_hi:[0,1]
    v_pk_add_f32 v[136:137], v[136:137], v[72:73] op_sel_hi:[1,0] neg_lo:[0,1] neg_hi:[0,1]
    v_permlane32_swap_b32 v24, v25
    v_bitop3_b32 v26, v26, v206, s26 bitop3:0x78
    v_pk_add_f32 v[138:139], v[138:139], v[72:73] op_sel_hi:[1,0] neg_lo:[0,1] neg_hi:[0,1]
    v_pk_add_f32 v[140:141], v[140:141], v[72:73] op_sel_hi:[1,0] neg_lo:[0,1] neg_hi:[0,1]
    v_pk_add_f16 v17, v24, v25
    v_pk_add_f16 v25, v24, v25 neg_lo:[0,1] neg_hi:[0,1]
    ds_write2_b32 v194, v17, v25 offset0:0 offset1:4
    v_cvt_pk_bf16_f32 v44, v124, v125
    v_cvt_pk_bf16_f32 v45, v126, v127
    v_permlane32_swap_b32 v26, v27
    v_cvt_pk_bf16_f32 v46, v128, v129
    v_cvt_pk_bf16_f32 v47, v130, v131
    v_pk_add_f16 v16, v26, v27
    v_pk_add_f16 v27, v26, v27 neg_lo:[0,1] neg_hi:[0,1]
    ds_write2_b32 v196, v16, v27 offset0:0 offset1:4
    v_cvt_pk_bf16_f32 v48, v132, v133
    v_cvt_pk_bf16_f32 v49, v134, v135
    v_cvt_pk_bf16_f32 v50, v136, v137
    v_cvt_pk_bf16_f32 v51, v138, v139
    v_cvt_pk_bf16_f32 v52, v140, v141
    v_lshrrev_b32 v253, 2, v1
    v_and_b32 v253, 63, v253
    buffer_load_dword v254, v253, s[20:23], 0 offen sc1
    s_mov_b32 s27, 20971520
    buffer_store_dwordx4 v[44:47], v208, s[8:11], s27 offen sc1
    buffer_store_dword v52, v209, s[8:11], s27 offen sc1
    s_mov_b32 s27, 21233664
    buffer_store_dwordx4 v[48:51], v208, s[8:11], s27 offen sc1
    s_mov_b32 s27, 57671680
    buffer_store_dwordx2 v[72:73], v207, s[8:11], s27 offen sc1
    s_waitcnt lgkmcnt(0)
    s_barrier
    ds_read_b128 v[28:31], v121 offset:12288
    ds_read_b128 v[32:35], v121 offset:6144
    ds_read_b128 v[36:39], v121 offset:0
    s_mov_b32 s26, 24117248
    s_waitcnt lgkmcnt(2)
    buffer_store_dwordx4 v[28:31], v122, s[8:11], s26 offen sc1
    s_mov_b32 s26, 24641536
    s_waitcnt lgkmcnt(1)
    buffer_store_dwordx4 v[32:35], v122, s[8:11], s26 offen sc1
    s_mov_b32 s26, 25165824
    s_waitcnt lgkmcnt(0)
    buffer_store_dwordx4 v[36:39], v123, s[8:11], s26 offen sc1
    s_and_b32 s44, s2, 7
    v_and_b32 v229, 63, v0
    s_mul_i32 s44, s44, 9
    v_and_b32 v230, 15, v0
    s_lshr_b32 s21, s2, 4
    v_bfe_u32 v231, v0, 4, 2
    s_add_u32 s44, s44, s21
    v_lshlrev_b32 v220, 4, v231
    s_bfe_u32 s21, s2, 0x10003
    v_xor_b32 v2, v220, v1
    s_lshl_b32 s25, s44, 15
    v_lshlrev_b32 v220, 6, v230
    s_lshl_b32 s26, s3, 3
    v_lshl_add_u32 v249, v231, 12, v220
    s_add_u32 s26, s26, 0
    v_lshrrev_b32 v220, 2, v230
    s_add_u32 s27, s26, s21
    v_xor_b32 v220, s3, v220
    s_sub_u32 s28, 48, s27
    v_lshlrev_b32 v220, 4, v220
    s_cmp_lt_u32 s26, 16
    s_cselect_b32 s27, s27, s28
    v_lshl_add_u32 v220, v229, 6, v220
    s_cmp_eq_u32 s27, 32
    s_cselect_b32 s36, 16, s27
    v_add_u32 v250, 73728, v220
    s_lshl_b32 s27, s36, 9
    v_and_b32 v221, 0x1f0, v1
    s_add_u32 s32, s27, s25
    s_lshl_b32 s26, s3, 3
    s_add_u32 s26, s26, 2
    s_add_u32 s27, s26, s21
    s_sub_u32 s28, 48, s27
    s_cmp_lt_u32 s26, 16
    s_cselect_b32 s27, s27, s28
    s_cmp_eq_u32 s27, 32
    s_cselect_b32 s37, 16, s27
    s_lshl_b32 s27, s37, 9
    s_add_u32 s33, s27, s25
    s_lshl_b32 s26, s3, 3
    s_add_u32 s26, s26, 4
    s_add_u32 s27, s26, s21
    s_sub_u32 s28, 48, s27
    s_cmp_lt_u32 s26, 16
    s_cselect_b32 s27, s27, s28
    s_cmp_eq_u32 s27, 32
    s_cselect_b32 s38, 16, s27
    s_lshl_b32 s27, s38, 9
    s_add_u32 s34, s27, s25
    s_lshl_b32 s26, s3, 3
    s_add_u32 s26, s26, 6
    s_add_u32 s27, s26, s21
    s_sub_u32 s28, 48, s27
    s_cmp_lt_u32 s26, 16
    s_cselect_b32 s27, s27, s28
    s_cmp_eq_u32 s27, 32
    s_cselect_b32 s39, 16, s27
    s_lshl_b32 s27, s39, 9
    s_add_u32 s35, s27, s25
    s_lshl_b32 s28, s3, 8
    s_add_u32 s28, s28, 90112
    v_lshl_add_u32 v220, v230, 4, s28
    s_lshl_b32 s26, s3, 12
    v_lshl_add_u32 v251, v231, 10, v220
    s_add_u32 s26, s26, 114688
    v_lshrrev_b32 v220, 5, v229
    s_lshl_b32 s27, s3, 11
    v_lshl_add_u32 v3, v220, 14, v221
    s_add_u32 s27, s27, 131072
    v_lshrrev_b32 v220, 3, v229
    s_and_b32 s28, s36, 15
    v_and_b32 v221, 0x70, v1
    v_lshl_add_u32 v220, v220, 9, v221
    v_add_u32 v4, s26, v220
    s_lshl_b32 s26, s3, 10
    v_add_u32 v5, s27, v1
    s_xor_b32 s27, s3, 2
    v_bfe_u32 v220, v0, 3, 2
    s_cmp_eq_u32 s28, 0
    s_cselect_b32 s28, s3, s27
    v_and_b32 v221, 4, v0
    s_add_u32 s26, s26, 114688
    v_add_u32 v220, v220, v221
    s_lshl_b32 s29, s27, 8
    v_and_b32 v229, 35, v0
    s_add_u32 s29, s29, 131072
    v_lshl_add_u32 v229, v220, 2, v229
    s_mul_i32 s24, s21, 1196032
    v_lshl_add_u32 v6, v229, 4, s26
    s_lshl_b32 s26, s27, 10
    v_cmp_gt_u32 vcc, 32, v229
    s_add_u32 s26, s26, 114688
    v_sub_u32 v220, 63, v229
    s_lshl_b32 s22, s44, 14
    v_sub_u32 v221, 32, v229
    s_add_u32 s22, s22, s24
    v_and_b32 v221, 31, v221
    s_lshl_b32 s23, s3, 10
    v_sub_u32 v222, 95, v229
    s_add_u32 s22, s22, s23
    v_cndmask_b32 v221, v222, v221, vcc
    s_cmp_eq_u32 s36, 0
    s_cselect_b64 vcc, -1, 0
    v_cndmask_b32 v221, v220, v221, vcc
    s_add_u32 s22, s22, 24117248
    v_lshl_add_u32 v7, v220, 4, s26
    s_lshl_b32 s26, s28, 10
    v_and_b32 v222, 32, v220
    s_add_u32 s26, s26, 114688
    v_and_b32 v223, 7, v220
    v_lshl_add_u32 v222, v223, 2, v222
    v_lshl_add_u32 v9, v222, 2, s29
    s_lshl_b32 s29, s28, 8
    v_bfe_u32 v222, v220, 3, 1
    s_add_u32 s29, s29, 131072
    v_lshl_add_u32 v10, v222, 10, v9
    v_lshl_or_b32 v189, v222, 31, 1.0
    v_bfe_u32 v222, v220, 4, 1
    v_lshl_or_b32 v191, v222, 31, 1.0
    v_lshl_add_u32 v8, v221, 4, s26
    v_and_b32 v222, 32, v221
    v_and_b32 v223, 7, v221
    v_lshl_add_u32 v222, v223, 2, v222
    v_lshl_add_u32 v252, v222, 2, s29
    v_bfe_u32 v222, v221, 3, 1
    v_lshl_add_u32 v248, v222, 10, v252
    v_lshl_or_b32 v188, v222, 31, 1.0
    v_bfe_u32 v222, v221, 4, 1
    v_lshl_or_b32 v190, v222, 31, 1.0
    s_and_b32 s26, s3, 1
    v_and_b32 v230, 15, v0
    v_bfe_u32 v231, v0, 4, 2
    v_lshl_add_u32 v220, v230, 1, s21
    v_cmp_gt_u32 vcc, 8, v230
    v_sub_u32 v222, 48, v220
    v_cvt_f32_u32 v221, v231
    v_cndmask_b32 v220, v222, v220, vcc
    v_cmp_eq_u32 vcc, 32, v220
    v_cvt_f32_u32 v229, s3
    v_cvt_f32_u32 v227, s26
    v_cndmask_b32 v220, v220, 16, vcc
    v_cvt_f32_u32 v220, v220
    v_mul_f32 v222, 0x3d000000, v220
    v_mul_f32 v223, 4.0, v221
    v_mul_f32 v227, 0x3e800000, v227
    v_fma_f32 v223, v223, v222, v227
    v_fmamk_f32 v224, v222, 0x00000000, v223
    v_cos_f32 v236, v224
    v_sin_f32 v240, v224
    v_fmamk_f32 v224, v222, 0x3f800000, v223
    v_cos_f32 v237, v224
    v_sin_f32 v241, v224
    s_lshl_b32 s26, s3, 10
    v_fmamk_f32 v224, v222, 0x40000000, v223
    s_add_u32 s26, s26, 147456
    v_cos_f32 v238, v224
    v_sin_f32 v242, v224
    v_fmamk_f32 v224, v222, 0x40400000, v223
    v_cos_f32 v239, v224
    v_sin_f32 v243, v224
    v_fmamk_f32 v221, v221, 0x41800000, v229
    v_mul_f32 v222, 0x3a000000, v220
    v_mul_f32 v223, v221, v222
    v_cvt_pk_f16_f32 v232, v236, v240
    v_cvt_pk_f16_f32 v233, v237, v241
    v_cvt_pk_f16_f32 v234, v238, v242
    v_cvt_pk_f16_f32 v235, v239, v243
    v_fmamk_f32 v224, v222, 0x00000000, v223
    v_cos_f32 v236, v224
    v_sin_f32 v240, v224
    v_fmamk_f32 v224, v222, 0x40800000, v223
    v_cos_f32 v237, v224
    v_sin_f32 v241, v224
    v_fmamk_f32 v224, v222, 0x41000000, v223
    v_cos_f32 v238, v224
    v_sin_f32 v242, v224
    v_fmamk_f32 v224, v222, 0x41400000, v223
    v_cos_f32 v239, v224
    v_sin_f32 v243, v224
    v_and_b32 v220, 7, v230
    v_lshrrev_b32 v222, 3, v230
    v_lshl_add_u32 v220, v220, 1, v222
    v_cvt_f32_u32 v220, v220
    v_mul_f32 v222, 0x3c800000, v220
    v_mul_f32 v223, v221, v222
    v_fmamk_f32 v224, v222, 0x00000000, v223
    v_fmamk_f32 v225, v222, 0x40800000, v223
    v_cos_f32 v226, v224
    v_cos_f32 v227, v225
    v_sin_f32 v224, v224
    v_sin_f32 v225, v225
    v_cvt_pk_f16_f32 v244, v226, v227
    v_cvt_pk_f16_f32 v246, v224, v225
    v_fmamk_f32 v224, v222, 0x41000000, v223
    v_fmamk_f32 v225, v222, 0x41400000, v223
    v_cos_f32 v226, v224
    v_cos_f32 v227, v225
    v_sin_f32 v224, v224
    v_sin_f32 v225, v225
    v_cvt_pk_f16_f32 v245, v226, v227
    v_cvt_pk_f16_f32 v247, v224, v225
    v_add_u32 v220, s26, v1
    ds_write_b128 v220, v[232:235] offset:0
    ds_write_b128 v220, v[236:239] offset:4096
    ds_write_b128 v220, v[240:243] offset:8192
    ds_write_b128 v220, v[244:247] offset:12288
    s_lshl_b32 s26, s2, 7
    s_add_u32 s26, s26, 59768832
    v_and_b32 v14, 15, v0
    v_lshl_add_u32 v14, v14, 2, s26
    v_cmp_gt_u32 vcc, 64, v0
    v_lshrrev_b32 v15, 4, v0
    v_lshl_add_u32 v14, v15, 15, v14
    v_mov_b32 v15, 1
    v_cndmask_b32 v14, -2.0, v14, vcc
    s_waitcnt vmcnt(7)
    v_cmp_gt_u32 s[46:47], 1, v254
    s_nop 0
    s_cmp_lg_u64 s[46:47], 0
    s_cbranch_scc1 L_notready
L_ready:
    s_waitcnt vmcnt(0) lgkmcnt(0)
    s_barrier
    buffer_store_dword v15, v14, s[8:11], 0 offen sc1
    s_mov_b64 exec, 0
    s_cmp_eq_u32 s3, 0
    s_cbranch_scc1 L_pad_c0_0
    s_cmp_eq_u32 s3, 1
    s_cbranch_scc1 L_pad_c0_1
    s_cmp_eq_u32 s3, 2
    s_cbranch_scc1 L_hopret_c0
    s_branch L_hopret_c0
L_hopret_c0:
    s_mov_b64 exec, -1
    s_cmp_ge_u32 s58, 144
    s_cbranch_scc1 L_idle2
    v_add_u32 v12, 147456, v1
    s_lshl_b32 s26, s3, 10
    v_add_u32 v13, s26, v12
    ds_read_b128 v[72:75], v12 offset:0
    ds_read_b128 v[76:79], v12 offset:1024
    ds_read_b128 v[88:91], v12 offset:4096
    ds_read_b128 v[92:95], v12 offset:5120
    ds_read_b128 v[96:99], v12 offset:6144
    ds_read_b128 v[100:103], v12 offset:7168
    ds_read_b128 v[104:107], v13 offset:4096
    ds_read_b128 v[108:111], v12 offset:8192
    ds_read_b128 v[112:115], v12 offset:9216
    ds_read_b128 v[116:119], v12 offset:10240
    ds_read_b128 v[120:123], v12 offset:11264
    ds_read_b128 v[124:127], v13 offset:8192
    ds_read_b128 v[128:131], v12 offset:12288
    ds_read_b128 v[132:135], v12 offset:13312
    ds_read_b128 v[136:139], v12 offset:14336
    ds_read_b128 v[140:143], v12 offset:15360
    ds_read_b128 v[144:147], v13 offset:12288
    s_add_u32 m0, s12, 6144
    s_add_u32 s15, s15, s19
    buffer_load_dwordx4 v11, s[40:43], s15 offen  lds
    s_add_u32 m0, s12, 7168
    s_add_u32 s15, s15, s19
    buffer_load_dwordx4 v11, s[40:43], s15 offen  lds
    s_add_u32 m0, s12, 8192
    s_add_u32 s15, s15, s19
    buffer_load_dwordx4 v11, s[40:43], s15 offen  lds
    s_add_u32 m0, s12, 36864
    s_mov_b64 s[40:41], s[50:51]
    s_add_u32 s15, s18, 0
    buffer_load_dwordx4 v11, s[40:43], s15 offen  lds
    s_add_u32 m0, s12, 37888
    s_add_u32 s15, s15, s19
    buffer_load_dwordx4 v11, s[40:43], s15 offen  lds
    s_add_u32 m0, s12, 38912
    s_add_u32 s15, s15, s19
    buffer_load_dwordx4 v11, s[40:43], s15 offen  lds
    s_add_u32 m0, s12, 39936
    s_add_u32 s15, s15, s19
    buffer_load_dwordx4 v11, s[40:43], s15 offen  lds
    s_add_u32 m0, s12, 40960
    s_add_u32 s15, s15, s19
    buffer_load_dwordx4 v11, s[40:43], s15 offen  lds
    s_add_u32 m0, s12, 41984
    s_add_u32 s15, s15, s19
    buffer_load_dwordx4 v11, s[40:43], s15 offen  lds
    s_add_u32 m0, s12, 43008
    s_add_u32 s15, s15, s19
    buffer_load_dwordx4 v11, s[40:43], s15 offen  lds
    s_add_u32 m0, s12, 44032
    s_add_u32 s15, s15, s19
    buffer_load_dwordx4 v11, s[40:43], s15 offen  lds
    s_add_u32 m0, s12, 45056
    s_add_u32 s15, s15, s19
    buffer_load_dwordx4 v11, s[40:43], s15 offen  lds
    s_and_b32 s27, s2, 3
    s_lshl_b32 s27, s27, 15
    s_add_u32 s27, s27, 59768832
    v_lshl_add_u32 v14, v0, 7, s27
    s_lshl_b32 s26, s3, 8
    s_add_u32 s27, s27, s26
    v_and_b32 v14, 1, v0
    v_lshl_add_u32 v14, v14, 7, s27
    v_bfe_u32 v15, v0, 1, 5
    v_lshl_add_u32 v14, v15, 10, v14
    s_mov_b32 s45, 524288
    s_nop 0
L_spin4:
    buffer_load_dword v15, v14, s[8:11], 0 offen sc1
    s_sub_u32 s45, s45, 1
    s_cbranch_scc1 L_spin4_x
    s_waitcnt vmcnt(0)
    v_cmp_gt_u32 s[46:47], 1, v15
    s_nop 0
    s_and_b64 exec, exec, s[46:47]
    s_cbranch_scc1 L_spin4
L_spin4_x:
    s_mov_b64 exec, -1
    s_waitcnt vmcnt(0)
    s_add_u32 m0, s23, 73728
    s_add_u32 s27, s22, 0
    buffer_load_dwordx4 v2, s[8:11], s27 offen sc1 lds
    s_add_u32 m0, s23, 77824
    s_add_u32 s27, s22, 4096
    buffer_load_dwordx4 v2, s[8:11], s27 offen sc1 lds
L_pad_c0_0:
    s_cbranch_execz L_hopret_c0
    s_add_u32 m0, s23, 81920
    s_add_u32 s27, s22, 8192
    buffer_load_dwordx4 v2, s[8:11], s27 offen sc1 lds
    s_add_u32 m0, s23, 86016
    s_add_u32 s27, s22, 12288
    buffer_load_dwordx4 v2, s[8:11], s27 offen sc1 lds
    s_add_u32 m0, s23, 90112
    s_add_u32 s27, s22, 16384
    buffer_load_dwordx4 v249, s[8:11], s27 offen sc1 lds
    s_barrier
    s_add_u32 s27, s32, 20971520
    buffer_load_dwordx4 v[56:59], v3, s[8:11], s27 offen sc1
    s_add_u32 s27, s33, 20971520
    buffer_load_dwordx4 v[60:63], v3, s[8:11], s27 offen sc1
    s_add_u32 s27, s34, 20971520
    buffer_load_dwordx4 v[64:67], v3, s[8:11], s27 offen sc1
    s_add_u32 s27, s35, 20971520
    buffer_load_dwordx4 v[68:71], v3, s[8:11], s27 offen sc1
    s_waitcnt vmcnt(4)
    s_barrier
    ds_read_b128 v[32:35], v251 offset:0
    ds_read_b128 v[16:19], v250 offset:0
    ds_read_b128 v[24:27], v250 offset:8192
    ds_read_b128 v[20:23], v250 offset:4096
    ds_read_b128 v[28:31], v250 offset:12288
    s_waitcnt lgkmcnt(4)
    v_mfma_f32_16x16x32_f16 v[164:167], v[32:35], v[72:75], 0
    v_mfma_f32_16x16x32_f16 v[184:187], v[32:35], v[76:79], 0
    s_waitcnt lgkmcnt(3)
    v_mfma_f32_16x16x32_f16 v[148:151], v[16:19], v[72:75], 0
    v_mfma_f32_16x16x32_f16 v[168:171], v[16:19], v[76:79], 0
    s_waitcnt lgkmcnt(2)
    v_mfma_f32_16x16x32_f16 v[156:159], v[24:27], v[72:75], 0
    v_mfma_f32_16x16x32_f16 v[176:179], v[24:27], v[76:79], 0
    s_waitcnt lgkmcnt(1)
    v_mfma_f32_16x16x32_f16 v[152:155], v[20:23], v[72:75], 0
    v_mfma_f32_16x16x32_f16 v[172:175], v[20:23], v[76:79], 0
    s_waitcnt lgkmcnt(0)
    v_mfma_f32_16x16x32_f16 v[160:163], v[28:31], v[72:75], 0
    v_mfma_f32_16x16x32_f16 v[180:183], v[28:31], v[76:79], 0
    v_pk_mul_f32 v[224:225], v[164:165], v[104:105]
    v_pk_mul_f32 v[226:227], v[184:185], v[104:105]
    v_pk_fma_f32 v[224:225], v[184:185], v[124:125], v[224:225]
    v_pk_fma_f32 v[226:227], v[164:165], v[124:125], v[226:227] neg_lo:[1,0,0] neg_hi:[1,0,0]
    v_pk_mul_f32 v[228:229], v[166:167], v[106:107]
    v_pk_mul_f32 v[230:231], v[186:187], v[106:107]
    v_pk_fma_f32 v[228:229], v[186:187], v[126:127], v[228:229]
    v_pk_fma_f32 v[230:231], v[166:167], v[126:127], v[230:231] neg_lo:[1,0,0] neg_hi:[1,0,0]
    v_cvt_pk_f16_f32 v208, v224, v225
    v_cvt_pk_f16_f32 v210, v226, v227
    v_cvt_pk_f16_f32 v220, v226, v227
    v_cvt_pk_f16_f32 v222, -v224, -v225
    v_cvt_pk_f16_f32 v209, v228, v229
    v_cvt_pk_f16_f32 v211, v230, v231
    v_cvt_pk_f16_f32 v221, v230, v231
    v_cvt_pk_f16_f32 v223, -v228, -v229
    v_pk_mul_f32 v[224:225], v[148:149], v[88:89]
    v_pk_mul_f32 v[226:227], v[168:169], v[88:89]
    v_pk_fma_f32 v[224:225], v[168:169], v[108:109], v[224:225]
    v_pk_fma_f32 v[226:227], v[148:149], v[108:109], v[226:227] neg_lo:[1,0,0] neg_hi:[1,0,0]
    v_pk_mul_f32 v[228:229], v[150:151], v[90:91]
    v_pk_mul_f32 v[230:231], v[170:171], v[90:91]
    v_pk_fma_f32 v[228:229], v[170:171], v[110:111], v[228:229]
    v_pk_fma_f32 v[230:231], v[150:151], v[110:111], v[230:231] neg_lo:[1,0,0] neg_hi:[1,0,0]
    v_mfma_f32_16x16x32_f16 v[72:75], v[208:211], v[144:147], 0
    v_cvt_pk_f16_f32 v192, v224, v225
    v_cvt_pk_f16_f32 v194, v226, v227
    v_mfma_f32_16x16x32_f16 v[76:79], v[220:223], v[144:147], 0
    v_cvt_pk_f16_f32 v193, v228, v229
    v_cvt_pk_f16_f32 v195, v230, v231
    v_pk_mul_f32 v[224:225], v[156:157], v[96:97]
    v_pk_mul_f32 v[226:227], v[176:177], v[96:97]
    v_pk_fma_f32 v[224:225], v[176:177], v[116:117], v[224:225]
    v_pk_fma_f32 v[226:227], v[156:157], v[116:117], v[226:227] neg_lo:[1,0,0] neg_hi:[1,0,0]
    v_pk_mul_f32 v[228:229], v[158:159], v[98:99]
    v_pk_mul_f32 v[230:231], v[178:179], v[98:99]
    v_pk_fma_f32 v[228:229], v[178:179], v[118:119], v[228:229]
    v_pk_fma_f32 v[230:231], v[158:159], v[118:119], v[230:231] neg_lo:[1,0,0] neg_hi:[1,0,0]
    v_mfma_f32_16x16x32_f16 v[232:235], v[192:195], v[128:131], 0
    ds_write_b128 v5, v[72:75]
    v_cvt_pk_f16_f32 v200, v224, v225
    v_cvt_pk_f16_f32 v202, v226, v227
    v_cvt_pk_f16_f32 v201, v228, v229
    v_cvt_pk_f16_f32 v203, v230, v231
    v_pk_mul_f32 v[224:225], v[152:153], v[92:93]
    v_pk_mul_f32 v[226:227], v[172:173], v[92:93]
    v_pk_fma_f32 v[224:225], v[172:173], v[112:113], v[224:225]
    v_pk_fma_f32 v[226:227], v[152:153], v[112:113], v[226:227] neg_lo:[1,0,0] neg_hi:[1,0,0]
    v_pk_mul_f32 v[228:229], v[154:155], v[94:95]
    v_pk_mul_f32 v[230:231], v[174:175], v[94:95]
    v_pk_fma_f32 v[228:229], v[174:175], v[114:115], v[228:229]
    v_pk_fma_f32 v[230:231], v[154:155], v[114:115], v[230:231] neg_lo:[1,0,0] neg_hi:[1,0,0]
    v_mfma_f32_16x16x32_f16 v[236:239], v[200:203], v[136:139], 0
    ds_write_b128 v5, v[76:79] offset:1024
    v_cvt_pk_f16_f32 v196, v224, v225
    v_cvt_pk_f16_f32 v198, v226, v227
    v_cvt_pk_f16_f32 v212, v226, v227
    v_cvt_pk_f16_f32 v214, -v224, -v225
    v_cvt_pk_f16_f32 v197, v228, v229
    v_cvt_pk_f16_f32 v199, v230, v231
    v_cvt_pk_f16_f32 v213, v230, v231
    v_cvt_pk_f16_f32 v215, -v228, -v229
    v_pk_mul_f32 v[224:225], v[160:161], v[100:101]
    v_pk_mul_f32 v[226:227], v[180:181], v[100:101]
    v_pk_fma_f32 v[224:225], v[180:181], v[120:121], v[224:225]
    v_pk_fma_f32 v[226:227], v[160:161], v[120:121], v[226:227] neg_lo:[1,0,0] neg_hi:[1,0,0]
    v_pk_mul_f32 v[228:229], v[162:163], v[102:103]
    v_pk_mul_f32 v[230:231], v[182:183], v[102:103]
    v_pk_fma_f32 v[228:229], v[182:183], v[122:123], v[228:229]
    v_pk_fma_f32 v[230:231], v[162:163], v[122:123], v[230:231] neg_lo:[1,0,0] neg_hi:[1,0,0]
    v_mfma_f32_16x16x32_f16 v[240:243], v[196:199], v[132:135], 0
    v_cvt_pk_f16_f32 v204, v224, v225
    v_cvt_pk_f16_f32 v206, v226, v227
    v_cvt_pk_f16_f32 v216, -v226, -v227
    v_cvt_pk_f16_f32 v218, v224, v225
    v_mfma_f32_16x16x32_f16 v[244:247], v[212:215], v[132:135], 0
    v_cvt_pk_f16_f32 v205, v228, v229
    v_cvt_pk_f16_f32 v207, v230, v231
    v_cvt_pk_f16_f32 v217, -v230, -v231
    v_cvt_pk_f16_f32 v219, v228, v229
    v_add_f32 v80, v232, v236
    v_sub_f32 v84, v232, v236
    v_mfma_f32_16x16x32_f16 v[240:243], v[204:207], v[140:143], v[240:243]
    v_add_f32 v81, v233, v237
    v_sub_f32 v85, v233, v237
    v_mfma_f32_16x16x32_f16 v[244:247], v[216:219], v[140:143], v[244:247]
    v_add_f32 v82, v234, v238
    v_sub_f32 v86, v234, v238
    v_add_f32 v83, v235, v239
    v_sub_f32 v87, v235, v239
    s_nop 0
    v_pk_add_f32 v[88:89], v[80:81], v[240:241]
    v_pk_add_f32 v[90:91], v[82:83], v[242:243]
    ds_write_b128 v4, v[88:91] offset:0
    v_pk_add_f32 v[96:97], v[80:81], v[240:241] neg_lo:[0,1] neg_hi:[0,1]
    v_pk_add_f32 v[98:99], v[82:83], v[242:243] neg_lo:[0,1] neg_hi:[0,1]
    ds_write_b128 v4, v[96:99] offset:256
    v_pk_add_f32 v[92:93], v[84:85], v[244:245]
    v_pk_add_f32 v[94:95], v[86:87], v[246:247]
    ds_write_b128 v4, v[92:95] offset:128
    v_pk_add_f32 v[100:101], v[84:85], v[244:245] neg_lo:[0,1] neg_hi:[0,1]
    v_pk_add_f32 v[102:103], v[86:87], v[246:247] neg_lo:[0,1] neg_hi:[0,1]
    ds_write_b128 v4, v[100:103] offset:384
    s_waitcnt lgkmcnt(0)
    s_barrier
    ds_read_b128 v[136:139], v9 offset:0
    s_waitcnt vmcnt(3)
    v_lshlrev_b32 v16, 16, v56
    ds_read_b128 v[140:143], v9 offset:4096
    v_and_b32 v20, 0xffff0000, v56
    ds_read_b128 v[144:147], v10 offset:2048
    s_waitcnt vmcnt(2)
    v_lshlrev_b32 v17, 16, v60
    ds_read_b128 v[148:151], v10 offset:6144
    v_and_b32 v21, 0xffff0000, v60
    ds_read_b32 v136, v252 offset:0
    s_waitcnt vmcnt(1)
    v_lshlrev_b32 v18, 16, v64
    ds_read_b32 v140, v252 offset:4096
    v_and_b32 v22, 0xffff0000, v64
    ds_read_b32 v144, v248 offset:2048
    s_waitcnt vmcnt(0)
    v_lshlrev_b32 v19, 16, v68
    ds_read_b32 v148, v248 offset:6144
    v_and_b32 v23, 0xffff0000, v68
    ds_read_b128 v[104:107], v6 offset:0
    v_lshlrev_b32 v24, 16, v57
    ds_read_b128 v[108:111], v6 offset:4096
    v_and_b32 v28, 0xffff0000, v57
    ds_read_b128 v[112:115], v6 offset:8192
    v_lshlrev_b32 v25, 16, v61
    ds_read_b128 v[116:119], v6 offset:12288
    v_and_b32 v29, 0xffff0000, v61
    ds_read_b128 v[124:127], v7 offset:12288
    v_lshlrev_b32 v26, 16, v65
    ds_read_b128 v[128:131], v7 offset:8192
    v_and_b32 v30, 0xffff0000, v65
    ds_read_b128 v[132:135], v7 offset:4096
    v_lshlrev_b32 v27, 16, v69
    ds_read_b32 v124, v8 offset:12288
    v_and_b32 v31, 0xffff0000, v69
    ds_read_b32 v128, v8 offset:8192
    v_lshlrev_b32 v32, 16, v58
    ds_read_b32 v132, v8 offset:4096
    v_and_b32 v36, 0xffff0000, v58
    v_lshlrev_b32 v33, 16, v62
    v_and_b32 v37, 0xffff0000, v62
    v_lshlrev_b32 v34, 16, v66
    v_and_b32 v38, 0xffff0000, v66
    v_lshlrev_b32 v35, 16, v70
    v_and_b32 v39, 0xffff0000, v70
    v_lshlrev_b32 v40, 16, v59
    v_and_b32 v44, 0xffff0000, v59
    v_lshlrev_b32 v41, 16, v63
    v_and_b32 v45, 0xffff0000, v63
    v_lshlrev_b32 v42, 16, v67
    v_and_b32 v46, 0xffff0000, v67
    v_lshlrev_b32 v43, 16, v71
    v_and_b32 v47, 0xffff0000, v71
    s_waitcnt lgkmcnt(12)
    v_pk_fma_f32 v[136:137], v[140:141], v[188:189], v[136:137]
    s_waitcnt lgkmcnt(10)
    v_pk_fma_f32 v[144:145], v[148:149], v[188:189], v[144:145]
    v_pk_fma_f32 v[138:139], v[142:143], v[188:189], v[138:139] op_sel:[0,1,0]
    v_pk_fma_f32 v[146:147], v[150:151], v[188:189], v[146:147] op_sel:[0,1,0]
    v_pk_fma_f32 v[120:121], v[144:145], v[190:191], v[136:137]
    v_pk_fma_f32 v[122:123], v[146:147], v[190:191], v[138:139] op_sel:[0,1,0]
    s_waitcnt lgkmcnt(9)
    v_pk_add_f32 v[18:19], v[18:19], v[106:107]
    s_waitcnt lgkmcnt(8)
    v_pk_add_f32 v[22:23], v[22:23], v[110:111]
    s_waitcnt lgkmcnt(7)
    v_pk_add_f32 v[26:27], v[26:27], v[114:115]
    s_waitcnt lgkmcnt(6)
    v_pk_add_f32 v[30:31], v[30:31], v[118:119]
    v_pk_add_f32 v[34:35], v[34:35], v[122:123]
    s_waitcnt lgkmcnt(5)
    v_pk_add_f32 v[38:39], v[38:39], v[126:127]
    s_waitcnt lgkmcnt(4)
    v_pk_add_f32 v[42:43], v[42:43], v[130:131]
    s_waitcnt lgkmcnt(3)
    v_pk_add_f32 v[46:47], v[46:47], v[134:135]
    v_cvt_pk_bf16_f32 v68, v19, v23
    v_cvt_pk_bf16_f32 v69, v27, v31
    v_cvt_pk_bf16_f32 v70, v35, v39
    v_cvt_pk_bf16_f32 v71, v43, v47
    s_add_u32 s35, s35, 17825792
    v_cvt_pk_bf16_f32 v64, v18, v22
    v_cvt_pk_bf16_f32 v65, v26, v30
    v_cvt_pk_bf16_f32 v66, v34, v38
    v_cvt_pk_bf16_f32 v67, v42, v46
    s_add_u32 s34, s34, 17825792
    v_pk_add_f32 v[16:17], v[16:17], v[104:105]
    v_pk_add_f32 v[20:21], v[20:21], v[108:109]
    v_pk_add_f32 v[24:25], v[24:25], v[112:113]
    v_pk_add_f32 v[28:29], v[28:29], v[116:117]
    v_pk_add_f32 v[32:33], v[32:33], v[120:121]
    s_waitcnt lgkmcnt(2)
    v_pk_add_f32 v[36:37], v[36:37], v[124:125]
    s_waitcnt lgkmcnt(1)
    v_pk_add_f32 v[40:41], v[40:41], v[128:129]
    s_waitcnt lgkmcnt(0)
    v_pk_add_f32 v[44:45], v[44:45], v[132:133]
    v_cvt_pk_bf16_f32 v60, v17, v21
    v_cvt_pk_bf16_f32 v61, v25, v29
    v_cvt_pk_bf16_f32 v62, v33, v37
    v_cvt_pk_bf16_f32 v63, v41, v45
    s_add_u32 s33, s33, 17825792
    v_cvt_pk_bf16_f32 v56, v16, v20
    v_cvt_pk_bf16_f32 v57, v24, v28
    v_cvt_pk_bf16_f32 v58, v32, v36
    v_cvt_pk_bf16_f32 v59, v40, v44
    s_add_u32 s32, s32, 17825792
    buffer_store_dwordx4 v[68:71], v3, s[8:11], s35 offen sc1
    buffer_store_dwordx4 v[64:67], v3, s[8:11], s34 offen sc1
    buffer_store_dwordx4 v[60:63], v3, s[8:11], s33 offen sc1
    buffer_store_dwordx4 v[56:59], v3, s[8:11], s32 offen sc1
    s_cmp_eq_u32 s44, 0
    s_cbranch_scc0 L_nomu5
    v_lshrrev_b32 v3, 2, v3
    s_lshl_b32 s27, s36, 7
    s_add_u32 s27, s27, 57704448
    buffer_store_dword v104, v3, s[8:11], s27 offen sc1
    s_lshl_b32 s27, s37, 7
    s_add_u32 s27, s27, 57704448
    buffer_store_dword v105, v3, s[8:11], s27 offen sc1
    s_lshl_b32 s27, s38, 7
    s_add_u32 s27, s27, 57704448
    buffer_store_dword v106, v3, s[8:11], s27 offen sc1
    s_lshl_b32 s27, s39, 7
    s_add_u32 s27, s27, 57704448
    buffer_store_dword v107, v3, s[8:11], s27 offen sc1
L_nomu5:
    s_branch L_join3
L_idle2:
    s_add_u32 m0, s12, 6144
    s_add_u32 s15, s15, s19
    buffer_load_dwordx4 v11, s[40:43], s15 offen  lds
    s_add_u32 m0, s12, 7168
    s_add_u32 s15, s15, s19
    buffer_load_dwordx4 v11, s[40:43], s15 offen  lds
    s_add_u32 m0, s12, 8192
    s_add_u32 s15, s15, s19
    buffer_load_dwordx4 v11, s[40:43], s15 offen  lds
    s_cmp_lt_u32 s58, 180
    s_cbranch_scc0 L_noodd
    s_sub_u32 s20, s58, 144
    s_cmp_ge_u32 s20, 18
    s_cselect_b64 s[40:41], s[50:51], s[48:49]
    s_cselect_b32 s21, 18, 0
    s_sub_u32 s21, s20, s21
    s_mul_i32 s22, s21, s19
    s_lshr_b32 s23, s3, 1
    s_lshl_b32 s23, s23, 3
    s_sub_u32 s24, 568, s23
    s_bitcmp1_b32 s3, 0
    s_cselect_b32 s23, s24, s23
    s_mul_i32 s23, s23, 9216
    s_add_u32 s22, s22, s23
    s_add_u32 s22, s22, 8192
    s_add_u32 m0, s12, 73728
    s_nop 0
    buffer_load_dwordx4 v11, s[40:43], s22 offen offset:0 lds
    s_add_u32 m0, s12, 74624
    s_nop 0
    buffer_load_dwordx4 v11, s[40:43], s22 offen offset:128 lds
    s_add_u32 m0, s12, 75520
    s_nop 0
    buffer_load_dwordx4 v11, s[40:43], s22 offen offset:256 lds
    s_add_u32 m0, s12, 76416
    s_nop 0
    buffer_load_dwordx4 v11, s[40:43], s22 offen offset:384 lds
    s_add_u32 m0, s12, 77312
    s_nop 0
    buffer_load_dwordx4 v11, s[40:43], s22 offen offset:512 lds
    s_add_u32 m0, s12, 78208
    s_nop 0
    buffer_load_dwordx4 v11, s[40:43], s22 offen offset:640 lds
    s_add_u32 m0, s12, 79104
    s_nop 0
    buffer_load_dwordx4 v11, s[40:43], s22 offen offset:768 lds
    s_add_u32 m0, s12, 80000
    s_nop 0
    buffer_load_dwordx4 v11, s[40:43], s22 offen offset:896 lds
    s_add_u32 m0, s12, 36864
    s_mov_b64 s[40:41], s[50:51]
    s_add_u32 s15, s18, 0
    buffer_load_dwordx4 v11, s[40:43], s15 offen  lds
    s_add_u32 m0, s12, 37888
    s_add_u32 s15, s15, s19
    buffer_load_dwordx4 v11, s[40:43], s15 offen  lds
    s_add_u32 m0, s12, 38912
    s_add_u32 s15, s15, s19
    buffer_load_dwordx4 v11, s[40:43], s15 offen  lds
    s_add_u32 m0, s12, 39936
    s_add_u32 s15, s15, s19
    buffer_load_dwordx4 v11, s[40:43], s15 offen  lds
    s_add_u32 m0, s12, 40960
    s_add_u32 s15, s15, s19
    buffer_load_dwordx4 v11, s[40:43], s15 offen  lds
    s_add_u32 m0, s12, 41984
    s_add_u32 s15, s15, s19
    buffer_load_dwordx4 v11, s[40:43], s15 offen  lds
    s_add_u32 m0, s12, 43008
    s_add_u32 s15, s15, s19
    buffer_load_dwordx4 v11, s[40:43], s15 offen  lds
    s_add_u32 m0, s12, 44032
    s_add_u32 s15, s15, s19
    buffer_load_dwordx4 v11, s[40:43], s15 offen  lds
    s_add_u32 m0, s12, 45056
    s_add_u32 s15, s15, s19
    buffer_load_dwordx4 v11, s[40:43], s15 offen  lds
    v_bfe_u32 v20, v0, 2, 3
    v_bfe_u32 v21, v0, 5, 1
    v_mul_u32_u24 v21, 18432, v21
    v_lshl_add_u32 v21, v20, 7, v21
    v_and_b32 v20, 6, v20
    v_lshlrev_b32 v20, 4, v20
    v_and_b32 v22, 3, v0
    v_lshlrev_b32 v22, 3, v22
    s_lshl_b32 s21, s3, 11
    s_add_u32 s21, s21, 73728
    v_add3_u32 v21, v21, v22, s21
    v_xor_b32 v23, 0, v20
    v_add_u32 v24, v23, v21
    v_xor_b32 v23, 32, v20
    v_add_u32 v25, v23, v21
    v_xor_b32 v23, 64, v20
    v_add_u32 v26, v23, v21
    v_xor_b32 v23, 96, v20
    v_add_u32 v27, v23, v21
    s_mul_i32 s23, s3, 294912
    s_lshl_b32 s20, s20, 10
    s_add_u32 s23, s23, s20
    s_waitcnt vmcnt(9)
    s_barrier
    ds_read_b64_tr_b16 v[28:29], v24 offset:0
    ds_read_b64_tr_b16 v[30:31], v24 offset:9216
    ds_read_b64_tr_b16 v[32:33], v25 offset:0
    ds_read_b64_tr_b16 v[34:35], v25 offset:9216
    ds_read_b64_tr_b16 v[36:37], v26 offset:0
    ds_read_b64_tr_b16 v[38:39], v26 offset:9216
    ds_read_b64_tr_b16 v[40:41], v27 offset:0
    ds_read_b64_tr_b16 v[42:43], v27 offset:9216
    ds_read_b64_tr_b16 v[44:45], v24 offset:1024
    ds_read_b64_tr_b16 v[46:47], v24 offset:10240
    ds_read_b64_tr_b16 v[48:49], v25 offset:1024
    ds_read_b64_tr_b16 v[50:51], v25 offset:10240
    ds_read_b64_tr_b16 v[52:53], v26 offset:1024
    ds_read_b64_tr_b16 v[54:55], v26 offset:10240
    ds_read_b64_tr_b16 v[56:57], v27 offset:1024
    ds_read_b64_tr_b16 v[58:59], v27 offset:10240
    s_add_u32 s24, s23, 0
    s_waitcnt lgkmcnt(14)
    buffer_store_dwordx4 v[28:31], v1, s[8:11], s24 offen sc1
    s_add_u32 s24, s23, 36864
    s_waitcnt lgkmcnt(12)
    buffer_store_dwordx4 v[32:35], v1, s[8:11], s24 offen sc1
    s_add_u32 s24, s23, 73728
    s_waitcnt lgkmcnt(10)
    buffer_store_dwordx4 v[36:39], v1, s[8:11], s24 offen sc1
    s_add_u32 s24, s23, 110592
    s_waitcnt lgkmcnt(8)
    buffer_store_dwordx4 v[40:43], v1, s[8:11], s24 offen sc1
    s_add_u32 s24, s23, 147456
    s_waitcnt lgkmcnt(6)
    buffer_store_dwordx4 v[44:47], v1, s[8:11], s24 offen sc1
    s_add_u32 s24, s23, 184320
    s_waitcnt lgkmcnt(4)
    buffer_store_dwordx4 v[48:51], v1, s[8:11], s24 offen sc1
    s_add_u32 s24, s23, 221184
    s_waitcnt lgkmcnt(2)
    buffer_store_dwordx4 v[52:55], v1, s[8:11], s24 offen sc1
    s_add_u32 s24, s23, 258048
    s_waitcnt lgkmcnt(0)
    buffer_store_dwordx4 v[56:59], v1, s[8:11], s24 offen sc1
    s_waitcnt lgkmcnt(0)
    s_barrier
    s_branch L_join3
L_noodd:
    s_add_u32 m0, s12, 36864
    s_mov_b64 s[40:41], s[50:51]
    s_add_u32 s15, s18, 0
    buffer_load_dwordx4 v11, s[40:43], s15 offen  lds
    s_add_u32 m0, s12, 37888
    s_add_u32 s15, s15, s19
    buffer_load_dwordx4 v11, s[40:43], s15 offen  lds
    s_add_u32 m0, s12, 38912
    s_add_u32 s15, s15, s19
    buffer_load_dwordx4 v11, s[40:43], s15 offen  lds
    s_add_u32 m0, s12, 39936
    s_add_u32 s15, s15, s19
    buffer_load_dwordx4 v11, s[40:43], s15 offen  lds
    s_add_u32 m0, s12, 40960
    s_add_u32 s15, s15, s19
    buffer_load_dwordx4 v11, s[40:43], s15 offen  lds
    s_add_u32 m0, s12, 41984
    s_add_u32 s15, s15, s19
    buffer_load_dwordx4 v11, s[40:43], s15 offen  lds
    s_add_u32 m0, s12, 43008
    s_add_u32 s15, s15, s19
    buffer_load_dwordx4 v11, s[40:43], s15 offen  lds
    s_add_u32 m0, s12, 44032
    s_add_u32 s15, s15, s19
    buffer_load_dwordx4 v11, s[40:43], s15 offen  lds
    s_add_u32 m0, s12, 45056
    s_add_u32 s15, s15, s19
    buffer_load_dwordx4 v11, s[40:43], s15 offen  lds
L_gate:
    s_and_b32 s26, s2, 3
    s_lshl_b32 s26, s26, 15
    s_add_u32 s26, s26, 59768832
    v_lshl_add_u32 v14, v0, 7, s26
    s_mov_b32 s45, 524288
    s_nop 0
L_spin6:
    buffer_load_dword v15, v14, s[8:11], 0 offen sc1
    s_sub_u32 s45, s45, 1
    s_cbranch_scc1 L_spin6_x
    s_waitcnt vmcnt(0)
    v_cmp_gt_u32 s[46:47], 1, v15
    s_nop 0
    s_and_b64 exec, exec, s[46:47]
    s_cbranch_scc1 L_spin6
L_spin6_x:
    s_mov_b64 exec, -1
    s_waitcnt vmcnt(0)
    s_sub_u32 s20, s58, 180
    s_lshl_b32 s20, s20, 2
    s_add_u32 s20, s20, s3
    s_mul_i32 s20, s20, 61
    v_cmp_gt_u32 vcc, 976, v1
    v_lshrrev_b32 v28, 4, v1
    v_add_u32 v28, s20, v28
    v_and_b32 v29, 31, v28
    v_lshrrev_b32 v28, 5, v28
    v_mul_u32_u24 v28, 9216, v28
    v_lshl_add_u32 v28, v29, 7, v28
    v_add_u32 v28, 4096, v28
    v_cndmask_b32 v28, -2.0, v28, vcc
    s_mov_b64 s[40:41], s[48:49]
    buffer_load_dword v30, v28, s[40:43], 0 offen
    s_mov_b64 s[40:41], s[50:51]
    buffer_load_dword v31, v28, s[40:43], 0 offen
L_join3:
    s_and_b32 s24, s2, 1
    s_lshl_b32 s24, s24, 2
    s_lshr_b32 s25, s2, 6
    s_add_u32 s24, s24, s25
    s_lshl_b32 s24, s24, 2
    s_add_u32 s24, s24, s3
    s_lshl_b32 s25, s24, 10
    s_add_u32 s25, s25, 17825792
    v_bfe_u32 v23, v0, 4, 2
    v_and_b32 v22, 0xf0, v1
    v_lshl_add_u32 v22, v23, 15, v22
    v_add_u32 v6, s25, v22
    v_bfe_u32 v24, v0, 2, 3
    v_bfe_u32 v25, v0, 5, 1
    v_mul_u32_u24 v25, 18432, v25
    v_lshl_add_u32 v25, v24, 7, v25
    v_and_b32 v24, 6, v24
    v_lshl_add_u32 v25, v24, 4, v25
    v_and_b32 v24, 3, v0
    v_lshl_add_u32 v25, v24, 3, v25
    v_xor_b32 v56, 0, v25
    v_xor_b32 v57, 32, v25
    v_xor_b32 v58, 64, v25
    v_xor_b32 v59, 96, v25
    s_lshl_b32 s26, s2, 7
    s_add_u32 s26, s26, 60030976
    v_and_b32 v26, 15, v0
    v_lshl_add_u32 v26, v26, 2, s26
    v_cmp_gt_u32 vcc, 64, v0
    v_lshrrev_b32 v27, 4, v0
    v_lshl_add_u32 v26, v27, 15, v26
    v_mov_b32 v27, 1
    v_cndmask_b32 v26, -2.0, v26, vcc
    s_nop 1
    s_mov_b64 exec, 0
    s_cmp_eq_u32 s3, 0
    s_cbranch_scc1 L_pad_c1_0
    s_cmp_eq_u32 s3, 1
    s_cbranch_scc1 L_pad_c1_1
    s_cmp_eq_u32 s3, 2
    s_cbranch_scc1 L_pad_c1_2
    s_branch L_pad_c1_3
L_hopret_c1:
    s_mov_b64 exec, -1
    s_waitcnt vmcnt(0) lgkmcnt(0)
    s_barrier
    buffer_store_dword v27, v26, s[8:11], 0 offen sc1
    s_add_u32 m0, s12, 73728
    s_mov_b64 s[40:41], s[48:49]
    s_mul_i32 s15, s19, 9
    s_add_u32 s15, s15, s18
    buffer_load_dwordx4 v11, s[40:43], s15 offen  lds
    s_add_u32 m0, s12, 74752
    s_add_u32 s15, s15, s19
    buffer_load_dwordx4 v11, s[40:43], s15 offen  lds
    s_add_u32 m0, s12, 75776
    s_add_u32 s15, s15, s19
    buffer_load_dwordx4 v11, s[40:43], s15 offen  lds
    s_add_u32 m0, s12, 76800
    s_add_u32 s15, s15, s19
    buffer_load_dwordx4 v11, s[40:43], s15 offen  lds
    s_add_u32 m0, s12, 77824
    s_add_u32 s15, s15, s19
    buffer_load_dwordx4 v11, s[40:43], s15 offen  lds
    s_add_u32 m0, s12, 78848
    s_add_u32 s15, s15, s19
    buffer_load_dwordx4 v11, s[40:43], s15 offen  lds
    s_add_u32 m0, s12, 79872
    s_add_u32 s15, s15, s19
    buffer_load_dwordx4 v11, s[40:43], s15 offen  lds
    s_add_u32 m0, s12, 80896
    s_add_u32 s15, s15, s19
    buffer_load_dwordx4 v11, s[40:43], s15 offen  lds
    s_add_u32 m0, s12, 81920
    s_add_u32 s15, s15, s19
    buffer_load_dwordx4 v11, s[40:43], s15 offen  lds
    s_add_u32 m0, s12, 110592
    s_mov_b64 s[40:41], s[50:51]
    s_mul_i32 s15, s19, 9
    s_add_u32 s15, s15, s18
    buffer_load_dwordx4 v11, s[40:43], s15 offen  lds
    s_add_u32 m0, s12, 111616
    s_add_u32 s15, s15, s19
    buffer_load_dwordx4 v11, s[40:43], s15 offen  lds
    s_add_u32 m0, s12, 112640
    s_add_u32 s15, s15, s19
    buffer_load_dwordx4 v11, s[40:43], s15 offen  lds
    s_add_u32 m0, s12, 113664
    s_add_u32 s15, s15, s19
    buffer_load_dwordx4 v11, s[40:43], s15 offen  lds
    s_add_u32 m0, s12, 114688
    s_add_u32 s15, s15, s19
    buffer_load_dwordx4 v11, s[40:43], s15 offen  lds
    s_add_u32 m0, s12, 115712
    s_add_u32 s15, s15, s19
    buffer_load_dwordx4 v11, s[40:43], s15 offen  lds
    s_add_u32 m0, s12, 116736
    s_add_u32 s15, s15, s19
    buffer_load_dwordx4 v11, s[40:43], s15 offen  lds
    s_add_u32 m0, s12, 117760
    s_add_u32 s15, s15, s19
    buffer_load_dwordx4 v11, s[40:43], s15 offen  lds
    s_add_u32 m0, s12, 118784
    s_add_u32 s15, s15, s19
    buffer_load_dwordx4 v11, s[40:43], s15 offen  lds
    s_mov_b32 s24, s2
    s_sub_u32 s44, s24, s2
    s_lshl_b32 s44, s44, 9
    s_add_u32 s44, s44, 131072
    s_lshr_b32 s28, s3, 1
    s_and_b32 s29, s3, 1
    s_cmp_lt_u32 s24, 144
    s_cselect_b32 s38, 0, -2.0
    s_min_u32 s24, s24, 143
    s_and_b32 s26, s24, 3
    s_lshr_b32 s25, s24, 2
    s_mul_i32 s24, s25, 57
    s_lshr_b32 s24, s24, 9
    s_mul_i32 s23, s24, 9
    s_sub_u32 s25, s25, s23
    s_lshl_b32 s22, s24, 2
    s_add_u32 s22, s22, s26
    s_lshl_b32 s22, s22, 1
    s_add_u32 s22, s22, s28
    s_lshl_b32 s27, s22, 2
    s_add_u32 s27, s27, s25
    s_cmp_gt_u32 s25, 4
    s_cselect_b32 s23, 123, 0
    s_add_u32 s27, s27, s23
    s_add_u32 s22, s22, 256
    s_cmp_lg_u32 s25, 4
    s_cselect_b32 s22, s27, s22
    s_lshl_b32 s22, s22, 2
    s_add_u32 s22, s22, s29
    s_mul_i32 s22, s22, 4608
    s_lshl_b32 s23, s24, 2
    s_add_u32 s23, s23, s3
    s_mul_i32 s23, s23, 9
    s_min_u32 s27, s25, 7
    s_add_u32 s23, s23, s27
    s_mul_i32 s23, s23, 36864
    s_sub_u32 s27, s25, s27
    s_lshl_b32 s27, s27, 2
    s_add_u32 s27, s27, s26
    s_lshl_b32 s27, s27, 10
    s_add_u32 s23, s23, s27
    s_add_u32 s23, s23, 11534336
    s_cmp_ge_u32 s25, 7
    s_cselect_b32 s39, 2, 1
    s_lshl_b32 s39, s39, 12
    s_sub_u32 s23, s23, s39
    s_add_u32 s56, s0, 82944
    s_addc_u32 s57, s1, 0
    s_and_b32 s27, s2, 3
    s_lshl_b32 s27, s27, 15
L_pad_c0_1:
    s_cbranch_execz L_hopret_c0
    s_add_u32 s27, s27, 60030976
    v_lshl_add_u32 v20, v0, 7, s27
    s_cmp_ge_u32 s58, 144
    s_cbranch_scc0 L_pre7
    s_cmp_ge_u32 s58, 180
    s_cbranch_scc1 L_pre7
    s_and_b32 s26, s2, 3
    s_lshl_b32 s26, s26, 15
    s_add_u32 s26, s26, 59768832
    v_lshl_add_u32 v22, v0, 7, s26
    s_mov_b32 s45, 524288
    s_nop 0
L_spin8:
    buffer_load_dword v21, v22, s[8:11], 0 offen sc1
    s_sub_u32 s45, s45, 1
    s_cbranch_scc1 L_spin8_x
    s_waitcnt vmcnt(0)
    v_cmp_gt_u32 s[46:47], 1, v21
    s_nop 0
    s_and_b64 exec, exec, s[46:47]
    s_cbranch_scc1 L_spin8
L_spin8_x:
    s_mov_b64 exec, -1
    s_waitcnt vmcnt(0)
    s_mov_b32 s45, 524288
    s_mov_b64 exec, 1
L_spin9:
    buffer_load_dword v21, v20, s[8:11], 0 offen sc1
    s_sub_u32 s45, s45, 1
    s_cbranch_scc1 L_spin9_x
    s_waitcnt vmcnt(0)
    v_cmp_gt_u32 s[46:47], 1, v21
    s_nop 0
    s_and_b64 exec, exec, s[46:47]
    s_cbranch_scc1 L_spin9
L_spin9_x:
    s_mov_b64 exec, -1
    s_waitcnt vmcnt(0)
L_pre7:
    s_mov_b32 s45, 524288
L_spin10:
    buffer_load_dword v21, v20, s[8:11], 0 offen sc1
    s_sub_u32 s45, s45, 1
    s_cbranch_scc1 L_spin10_x
    s_waitcnt vmcnt(0)
    v_cmp_gt_u32 s[46:47], 1, v21
    s_nop 0
    s_and_b64 exec, exec, s[46:47]
    s_cbranch_scc1 L_spin10
L_spin10_x:
    s_mov_b64 exec, -1
    s_waitcnt vmcnt(0)
    s_barrier
L_ffn0:
    s_mov_b32 s16, 0
    buffer_load_dwordx4 a[0:3], v6, s[8:11], s16 offen offset:0 sc1
    buffer_load_dwordx4 a[4:7], v6, s[8:11], s16 offen offset:256 sc1
    buffer_load_dwordx4 a[8:11], v6, s[8:11], s16 offen offset:512 sc1
    buffer_load_dwordx4 a[12:15], v6, s[8:11], s16 offen offset:768 sc1
    s_mov_b32 s16, 131072
    buffer_load_dwordx4 a[16:19], v6, s[8:11], s16 offen offset:0 sc1
    buffer_load_dwordx4 a[20:23], v6, s[8:11], s16 offen offset:256 sc1
    buffer_load_dwordx4 a[24:27], v6, s[8:11], s16 offen offset:512 sc1
    buffer_load_dwordx4 a[28:31], v6, s[8:11], s16 offen offset:768 sc1
    s_mov_b32 s16, 262144
    buffer_load_dwordx4 a[32:35], v6, s[8:11], s16 offen offset:0 sc1
    buffer_load_dwordx4 a[36:39], v6, s[8:11], s16 offen offset:256 sc1
    buffer_load_dwordx4 a[40:43], v6, s[8:11], s16 offen offset:512 sc1
    ds_read_b64_tr_b16 v[44:45], v56 offset:0
    ds_read_b64_tr_b16 v[46:47], v56 offset:9216
    ds_read_b64_tr_b16 v[48:49], v57 offset:0
    ds_read_b64_tr_b16 v[50:51], v57 offset:9216
    ds_read_b64_tr_b16 v[52:53], v58 offset:0
    ds_read_b64_tr_b16 v[54:55], v58 offset:9216
    s_waitcnt vmcnt(10) lgkmcnt(4)
    v_mfma_f32_16x16x32_bf16 v[140:143], v[44:47], a[0:3], 0
    buffer_load_dwordx4 a[44:47], v6, s[8:11], s16 offen offset:768 sc1
    s_waitcnt lgkmcnt(2)
    v_mfma_f32_16x16x32_bf16 v[188:191], v[48:51], a[0:3], 0
    s_mov_b32 s16, 393216
    ds_read_b64_tr_b16 v[60:61], v59 offset:0
    s_lshl_b32 s30, s7, 2
    s_waitcnt lgkmcnt(1)
    v_mfma_f32_16x16x32_bf16 v[204:207], v[52:55], a[0:3], 0
    s_add_u32 s30, s30, s4
    ds_read_b64_tr_b16 v[62:63], v59 offset:9216
    s_lshl_b32 s31, s30, 7
    s_waitcnt vmcnt(10)
    v_mfma_f32_16x16x32_bf16 v[144:147], v[44:47], a[4:7], 0
    s_mul_i32 s32, s3, 589824
    ds_read_b64_tr_b16 v[64:65], v56 offset:36864
    s_add_u32 s31, s31, s32
    v_mfma_f32_16x16x32_bf16 v[192:195], v[48:51], a[4:7], 0
    buffer_load_dwordx4 a[48:51], v6, s[8:11], s16 offen offset:0 sc1
    v_mfma_f32_16x16x32_bf16 v[208:211], v[52:55], a[4:7], 0
    s_add_u32 s31, s31, 17825792
    ds_read_b64_tr_b16 v[66:67], v56 offset:46080
    v_and_b32 v89, 0x70, v1
    s_waitcnt vmcnt(10)
    v_mfma_f32_16x16x32_bf16 v[148:151], v[44:47], a[8:11], 0
    s_lshl_b32 s30, s30, 2
    ds_read_b64_tr_b16 v[68:69], v57 offset:36864
    v_add_u32 v89, s31, v89
    v_mfma_f32_16x16x32_bf16 v[196:199], v[48:51], a[8:11], 0
    s_add_u32 s30, s30, s3
    ds_read_b64_tr_b16 v[70:71], v57 offset:46080
    v_bfe_u32 v90, v0, 3, 3
    v_mfma_f32_16x16x32_bf16 v[212:215], v[52:55], a[8:11], 0
    s_lshl_b32 s30, s30, 6
    v_lshl_add_u32 v85, v90, 15, v89
    v_and_b32 v91, 1, v90
    s_waitcnt vmcnt(9)
    v_mfma_f32_16x16x32_bf16 v[152:155], v[44:47], a[12:15], 0
    buffer_load_dwordx4 a[52:55], v6, s[8:11], s16 offen offset:256 sc1
    v_mfma_f32_16x16x32_bf16 v[200:203], v[48:51], a[12:15], 0
    s_add_u32 s30, s30, 59375616
    v_lshl_add_u32 v89, v91, 15, v89
    v_lshrrev_b32 v90, 1, v90
    v_mfma_f32_16x16x32_bf16 v[216:219], v[52:55], a[12:15], 0
    s_waitcnt lgkmcnt(0)
    v_lshl_add_u32 v86, v90, 2, v89
    v_cmp_gt_u32 vcc, 256, v1
    v_mfma_f32_16x16x32_bf16 v[172:175], v[60:63], a[0:3], 0
    s_lshr_b32 s31, s2, 6
    ds_read_b64_tr_b16 v[44:45], v58 offset:36864
    v_lshrrev_b32 v89, 2, v1
    v_mfma_f32_16x16x32_bf16 v[92:95], v[64:67], a[0:3], 0
    ds_read_b64_tr_b16 v[46:47], v58 offset:46080
    v_add_u32 v89, s30, v89
    v_mfma_f32_16x16x32_bf16 v[124:127], v[68:71], a[0:3], 0
    buffer_load_dwordx4 a[56:59], v6, s[8:11], s16 offen offset:512 sc1
    v_mfma_f32_16x16x32_bf16 v[176:179], v[60:63], a[4:7], 0
    s_and_b32 s30, s2, 1
    ds_read_b64_tr_b16 v[48:49], v59 offset:36864
    v_cndmask_b32 v87, -2.0, v89, vcc
    v_mfma_f32_16x16x32_bf16 v[96:99], v[64:67], a[4:7], 0
    s_lshl_b32 s30, s30, 2
    ds_read_b64_tr_b16 v[50:51], v59 offset:46080
    s_add_u32 s30, s30, s31
    v_mfma_f32_16x16x32_bf16 v[128:131], v[68:71], a[4:7], 0
    s_lshl_b32 s30, s30, 2
    ds_read_b64_tr_b16 v[52:53], v56 offset:1024
    s_add_u32 s30, s30, s3
    v_mfma_f32_16x16x32_bf16 v[180:183], v[60:63], a[8:11], 0
    s_lshl_b32 s30, s30, 11
    ds_read_b64_tr_b16 v[54:55], v56 offset:10240
    s_add_u32 s30, s30, 59375616
    v_mfma_f32_16x16x32_bf16 v[100:103], v[64:67], a[8:11], 0
    buffer_load_dwordx4 a[60:63], v6, s[8:11], s16 offen offset:768 sc1
    v_mfma_f32_16x16x32_bf16 v[132:135], v[68:71], a[8:11], 0
    s_mov_b32 s16, 524288
    v_and_b32 v89, 7, v0
    v_bfe_u32 v90, v0, 3, 1
    v_mfma_f32_16x16x32_bf16 v[184:187], v[60:63], a[12:15], 0
    s_mul_i32 s27, s3, 144
    v_lshl_add_u32 v89, v89, 2, s30
    v_bfe_u32 v20, v0, 3, 3
    v_mfma_f32_16x16x32_bf16 v[104:107], v[64:67], a[12:15], 0
    s_movk_i32 s26, 896
    v_lshl_add_u32 v89, v90, 8, v89
    v_bfe_u32 v90, v0, 4, 2
    v_mfma_f32_16x16x32_bf16 v[136:139], v[68:71], a[12:15], 0
    s_waitcnt lgkmcnt(0)
    v_lshl_add_u32 v88, v90, 6, v89
    v_and_b32 v21, 4, v20
    v_mfma_f32_16x16x32_bf16 v[156:159], v[44:47], a[0:3], 0
    ds_read_b64_tr_b16 v[60:61], v57 offset:1024
    v_add_u32 v21, v20, v21
    v_mfma_f32_16x16x32_bf16 v[108:111], v[48:51], a[0:3], 0
    buffer_load_dwordx4 a[64:67], v6, s[8:11], s16 offen offset:0 sc1
    s_waitcnt vmcnt(12)
    v_mfma_f32_16x16x32_bf16 v[140:143], v[52:55], a[16:19], v[140:143]
    ds_read_b64_tr_b16 v[62:63], v57 offset:10240
    v_and_b32 v20, 6, v20
    v_mfma_f32_16x16x32_bf16 v[160:163], v[44:47], a[4:7], 0
    ds_read_b64_tr_b16 v[64:65], v58 offset:1024
    v_xor_b32 v20, v20, v0
    v_mfma_f32_16x16x32_bf16 v[112:115], v[48:51], a[4:7], 0
    ds_read_b64_tr_b16 v[66:67], v58 offset:10240
    v_and_b32 v20, 7, v20
    s_waitcnt vmcnt(11)
    v_mfma_f32_16x16x32_bf16 v[144:147], v[52:55], a[20:23], v[144:147]
    s_mov_b32 s33, 262144
    ds_read_b64_tr_b16 v[68:69], v59 offset:1024
    v_mul_u32_u24 v21, 1152, v21
    v_mfma_f32_16x16x32_bf16 v[164:167], v[44:47], a[8:11], 0
    buffer_load_dwordx4 v[76:79], v85, s[8:11], 0 offen sc1
    v_mfma_f32_16x16x32_bf16 v[116:119], v[48:51], a[8:11], 0
    ds_read_b64_tr_b16 v[70:71], v59 offset:10240
    v_lshl_add_u32 v20, v20, 4, v21
    s_waitcnt vmcnt(11)
    v_mfma_f32_16x16x32_bf16 v[148:151], v[52:55], a[24:27], v[148:151]
    v_or_b32 v10, s38, v20
    v_bfe_u32 v20, v0, 2, 3
    v_mfma_f32_16x16x32_bf16 v[168:171], v[44:47], a[12:15], 0
    v_bfe_u32 v21, v0, 5, 1
    v_and_b32 v22, 3, v0
    v_mfma_f32_16x16x32_bf16 v[120:123], v[48:51], a[12:15], 0
    v_mul_u32_u24 v21, 18432, v21
    v_lshlrev_b32 v22, 3, v22
    s_waitcnt vmcnt(10)
    v_mfma_f32_16x16x32_bf16 v[152:155], v[52:55], a[28:31], v[152:155]
    s_waitcnt lgkmcnt(0)
    v_lshl_add_u32 v21, v20, 7, v21
    v_and_b32 v20, 6, v20
    v_mfma_f32_16x16x32_bf16 v[188:191], v[60:63], a[16:19], v[188:191]
    buffer_load_dwordx4 v[80:83], v85, s[8:11], s33 offen sc1
    v_mfma_f32_16x16x32_bf16 v[204:207], v[64:67], a[16:19], v[204:207]
    s_mov_b32 s33, 524288
    ds_read_b64_tr_b16 v[44:45], v56 offset:37888
    v_lshlrev_b32 v20, 4, v20
    v_mfma_f32_16x16x32_bf16 v[172:175], v[68:71], a[16:19], v[172:175]
    ds_read_b64_tr_b16 v[46:47], v56 offset:47104
    v_add_u32 v23, s27, v22
    v_mfma_f32_16x16x32_bf16 v[192:195], v[60:63], a[20:23], v[192:195]
    ds_read_b64_tr_b16 v[48:49], v57 offset:37888
    v_sub_u32 v24, 1144, v23
    v_mfma_f32_16x16x32_bf16 v[208:211], v[64:67], a[20:23], v[208:211]
    buffer_load_dword v84, v86, s[8:11], s33 offen sc1
    v_mfma_f32_16x16x32_bf16 v[176:179], v[68:71], a[20:23], v[176:179]
    buffer_load_dwordx4 a[68:71], v6, s[8:11], s16 offen offset:256 sc1
    v_mfma_f32_16x16x32_bf16 v[196:199], v[60:63], a[24:27], v[196:199]
    ds_read_b64_tr_b16 v[50:51], v57 offset:47104
    ds_read_b64_tr_b16 v[52:53], v58 offset:37888
    v_mfma_f32_16x16x32_bf16 v[212:215], v[64:67], a[24:27], v[212:215]
    ds_read_b64_tr_b16 v[54:55], v58 offset:47104
    v_cmp_gt_u32 vcc, 16, v22
    v_mfma_f32_16x16x32_bf16 v[180:183], v[68:71], a[24:27], v[180:183]
    v_add_u32 v25, 128, v23
    v_subrev_u32 v26, 112, v24
    v_mfma_f32_16x16x32_bf16 v[200:203], v[60:63], a[28:31], v[200:203]
    v_cndmask_b32 v25, v26, v25, vcc
    v_lshrrev_b32 v26, 7, v23
    v_mfma_f32_16x16x32_bf16 v[216:219], v[64:67], a[28:31], v[216:219]
    buffer_load_dwordx4 a[72:75], v6, s[8:11], s16 offen offset:512 sc1
    v_mfma_f32_16x16x32_bf16 v[184:187], v[68:71], a[28:31], v[184:187]
    s_waitcnt lgkmcnt(0)
    v_xad_u32 v2, v23, v20, v21
    v_add_u32 v23, 32, v23
    v_mfma_f32_16x16x32_bf16 v[92:95], v[44:47], a[16:19], v[92:95]
    ds_read_b64_tr_b16 v[60:61], v59 offset:37888
    v_mad_u32_u24 v2, v26, s26, v2
    v_mfma_f32_16x16x32_bf16 v[124:127], v[48:51], a[16:19], v[124:127]
    ds_read_b64_tr_b16 v[62:63], v59 offset:47104
    v_lshrrev_b32 v27, 7, v24
    v_mfma_f32_16x16x32_bf16 v[156:159], v[52:55], a[16:19], v[156:159]
    ds_read_b64_tr_b16 v[64:65], v56 offset:2048
    v_xad_u32 v28, v24, v20, v21
    v_mfma_f32_16x16x32_bf16 v[96:99], v[44:47], a[20:23], v[96:99]
    ds_read_b64_tr_b16 v[66:67], v56 offset:11264
    v_mad_u32_u24 v28, v27, s26, v28
    v_mfma_f32_16x16x32_bf16 v[128:131], v[48:51], a[20:23], v[128:131]
    buffer_load_dwordx4 a[76:79], v6, s[8:11], s16 offen offset:768 sc1
    v_mfma_f32_16x16x32_bf16 v[160:163], v[52:55], a[20:23], v[160:163]
    s_mov_b32 s16, 655360
    ds_read_b64_tr_b16 v[68:69], v57 offset:2048
    v_lshl_or_b32 v2, v28, 16, v2
    v_mfma_f32_16x16x32_bf16 v[100:103], v[44:47], a[24:27], v[100:103]
    ds_read_b64_tr_b16 v[70:71], v57 offset:11264
    v_subrev_u32 v24, 32, v24
    v_mfma_f32_16x16x32_bf16 v[132:135], v[48:51], a[24:27], v[132:135]
    v_lshrrev_b32 v26, 7, v23
    v_xad_u32 v3, v23, v20, v21
    v_mfma_f32_16x16x32_bf16 v[164:167], v[52:55], a[24:27], v[164:167]
    s_bfe_u32 s24, s2, 0x20001
    v_mad_u32_u24 v3, v26, s26, v3
    v_add_u32 v23, 32, v23
    v_mfma_f32_16x16x32_bf16 v[104:107], v[44:47], a[28:31], v[104:107]
    buffer_load_dwordx4 a[80:83], v6, s[8:11], s16 offen offset:0 sc1
    v_mfma_f32_16x16x32_bf16 v[136:139], v[48:51], a[28:31], v[136:139]
    s_mul_i32 s24, s24, 144
    v_lshrrev_b32 v27, 7, v24
    v_xad_u32 v28, v24, v20, v21
    v_mfma_f32_16x16x32_bf16 v[168:171], v[52:55], a[28:31], v[168:171]
    s_waitcnt lgkmcnt(0)
    v_mad_u32_u24 v28, v27, s26, v28
    v_subrev_u32 v24, 32, v24
    v_mfma_f32_16x16x32_bf16 v[108:111], v[60:63], a[16:19], v[108:111]
    s_bfe_u32 s25, s2, 0x20003
    ds_read_b64_tr_b16 v[44:45], v58 offset:2048
    v_lshl_or_b32 v3, v28, 16, v3
    s_waitcnt vmcnt(15)
    v_mfma_f32_16x16x32_bf16 v[140:143], v[64:67], a[32:35], v[140:143]
    s_add_u32 s24, s24, s25
    ds_read_b64_tr_b16 v[46:47], v58 offset:11264
    v_lshrrev_b32 v26, 7, v23
    v_mfma_f32_16x16x32_bf16 v[188:191], v[68:71], a[32:35], v[188:191]
    buffer_load_dwordx4 a[84:87], v6, s[8:11], s16 offen offset:256 sc1
    v_mfma_f32_16x16x32_bf16 v[112:115], v[60:63], a[20:23], v[112:115]
    s_lshl_b32 s24, s24, 7
    ds_read_b64_tr_b16 v[48:49], v59 offset:2048
    v_xad_u32 v4, v23, v20, v21
    s_waitcnt vmcnt(15)
    v_mfma_f32_16x16x32_bf16 v[144:147], v[64:67], a[36:39], v[144:147]
    s_add_u32 s24, s24, 58851328
    ds_read_b64_tr_b16 v[50:51], v59 offset:11264
    v_mad_u32_u24 v4, v26, s26, v4
    v_mfma_f32_16x16x32_bf16 v[192:195], v[68:71], a[36:39], v[192:195]
    s_and_b32 s27, s2, 1
    ds_read_b64_tr_b16 v[52:53], v56 offset:38912
    v_add_u32 v23, 32, v23
    v_mfma_f32_16x16x32_bf16 v[116:119], v[60:63], a[24:27], v[116:119]
    s_lshl_b32 s27, s27, 2
    ds_read_b64_tr_b16 v[54:55], v56 offset:48128
    v_lshrrev_b32 v27, 7, v24
    s_waitcnt vmcnt(14)
    v_mfma_f32_16x16x32_bf16 v[148:151], v[64:67], a[40:43], v[148:151]
    buffer_load_dwordx4 a[88:91], v6, s[8:11], s16 offen offset:512 sc1
    v_mfma_f32_16x16x32_bf16 v[196:199], v[68:71], a[40:43], v[196:199]
    s_lshr_b32 s28, s2, 6
    v_xad_u32 v28, v24, v20, v21
    v_subrev_u32 v24, 32, v24
    v_mfma_f32_16x16x32_bf16 v[120:123], v[60:63], a[28:31], v[120:123]
    s_add_u32 s27, s27, s28
    v_mad_u32_u24 v28, v27, s26, v28
    v_lshrrev_b32 v26, 7, v23
    s_waitcnt vmcnt(14)
    v_mfma_f32_16x16x32_bf16 v[152:155], v[64:67], a[44:47], v[152:155]
    s_bfe_u32 s28, s2, 0x20001
    v_lshl_or_b32 v4, v28, 16, v4
    v_xad_u32 v5, v23, v20, v21
    v_mfma_f32_16x16x32_bf16 v[200:203], v[68:71], a[44:47], v[200:203]
    s_waitcnt lgkmcnt(0)
    v_mad_u32_u24 v5, v26, s26, v5
    v_lshrrev_b32 v27, 7, v24
    v_mfma_f32_16x16x32_bf16 v[204:207], v[44:47], a[32:35], v[204:207]
    buffer_load_dwordx4 a[92:95], v6, s[8:11], s16 offen offset:768 sc1
    v_mfma_f32_16x16x32_bf16 v[172:175], v[48:51], a[32:35], v[172:175]
    s_mov_b32 s16, 786432
    ds_read_b64_tr_b16 v[60:61], v57 offset:38912
    v_xad_u32 v28, v24, v20, v21
    v_mfma_f32_16x16x32_bf16 v[92:95], v[52:55], a[32:35], v[92:95]
    s_bfe_u32 s29, s2, 0x30003
    ds_read_b64_tr_b16 v[62:63], v57 offset:48128
    v_mad_u32_u24 v28, v27, s26, v28
    v_mfma_f32_16x16x32_bf16 v[208:211], v[44:47], a[36:39], v[208:211]
    s_lshl_b32 s25, s27, 2
    ds_read_b64_tr_b16 v[64:65], v58 offset:38912
    v_lshl_or_b32 v5, v28, 16, v5
    v_mfma_f32_16x16x32_bf16 v[176:179], v[48:51], a[36:39], v[176:179]
    s_add_u32 s25, s25, s3
    ds_read_b64_tr_b16 v[66:67], v58 offset:48128
    v_lshrrev_b32 v26, 7, v25
    v_mfma_f32_16x16x32_bf16 v[96:99], v[52:55], a[36:39], v[96:99]
    s_mul_i32 s25, s25, 589824
    ds_read_b64_tr_b16 v[68:69], v59 offset:38912
    v_xad_u32 v9, v25, v20, v21
    v_mfma_f32_16x16x32_bf16 v[212:215], v[44:47], a[40:43], v[212:215]
    buffer_load_dwordx4 a[96:99], v6, s[8:11], s16 offen offset:0 sc1
    v_mfma_f32_16x16x32_bf16 v[180:183], v[48:51], a[40:43], v[180:183]
    ds_read_b64_tr_b16 v[70:71], v59 offset:48128
    v_mad_u32_u24 v9, v26, s26, v9
    v_mfma_f32_16x16x32_bf16 v[100:103], v[52:55], a[40:43], v[100:103]
    s_lshl_b32 s26, s2, 2
    v_min_u32 v20, 560, v1
    v_and_b32 v21, 63, v0
    v_mfma_f32_16x16x32_bf16 v[216:219], v[44:47], a[44:47], v[216:219]
    s_add_u32 s26, s26, s3
    v_lshl_add_u32 v8, v20, 5, s24
    v_and_b32 v22, 15, v0
    v_mfma_f32_16x16x32_bf16 v[184:187], v[48:51], a[44:47], v[184:187]
    s_lshl_b32 s24, s28, 3
    v_lshrrev_b32 v23, 4, v21
    s_add_u32 s24, s24, s29
    v_mfma_f32_16x16x32_bf16 v[104:107], v[52:55], a[44:47], v[104:107]
    s_waitcnt lgkmcnt(0)
    s_mul_i32 s24, s24, 9216
    s_add_u32 s25, s25, s24
    v_mfma_f32_16x16x32_bf16 v[124:127], v[60:63], a[32:35], v[124:127]
    buffer_load_dwordx4 a[100:103], v6, s[8:11], s16 offen offset:256 sc1
    v_mfma_f32_16x16x32_bf16 v[156:159], v[64:67], a[32:35], v[156:159]
    s_add_u32 s25, s25, 37748736
    ds_read_b64_tr_b16 v[44:45], v56 offset:3072
    v_add_u32 v7, s25, v1
    v_mfma_f32_16x16x32_bf16 v[108:111], v[68:71], a[32:35], v[108:111]
    s_lshl_b32 s26, s26, 7
    ds_read_b64_tr_b16 v[46:47], v56 offset:12288
    s_add_u32 s26, s26, 58720256
    v_mfma_f32_16x16x32_bf16 v[128:131], v[60:63], a[36:39], v[128:131]
    s_lshr_b32 s24, s29, 2
    ds_read_b64_tr_b16 v[48:49], v56 offset:4096
    v_cmp_gt_u32 vcc, 16, v21
    v_mfma_f32_16x16x32_bf16 v[160:163], v[64:67], a[36:39], v[160:163]
    buffer_load_dwordx4 a[104:107], v6, s[8:11], s16 offen offset:512 sc1
    v_mfma_f32_16x16x32_bf16 v[112:115], v[68:71], a[36:39], v[112:115]
    s_lshl_b32 s24, s24, 1
    ds_read_b64_tr_b16 v[50:51], v56 offset:13312
    v_lshl_add_u32 v24, v21, 2, s26
    v_mfma_f32_16x16x32_bf16 v[132:135], v[60:63], a[40:43], v[132:135]
    s_and_b32 s26, s2, 0xc7
    ds_read_b64_tr_b16 v[52:53], v56 offset:5120
    v_cndmask_b32 v252, -2.0, v24, vcc
    v_mfma_f32_16x16x32_bf16 v[164:167], v[64:67], a[40:43], v[164:167]
    s_lshl_b32 s26, s26, 2
    ds_read_b64_tr_b16 v[54:55], v56 offset:14336
    s_add_u32 s26, s26, s24
    v_mfma_f32_16x16x32_bf16 v[116:119], v[68:71], a[40:43], v[116:119]
    s_lshr_b32 s24, s3, 1
    s_add_u32 s26, s26, s24
    s_lshl_b32 s26, s26, 7
    v_mfma_f32_16x16x32_bf16 v[136:139], v[60:63], a[44:47], v[136:139]
    buffer_load_dwordx4 a[108:111], v6, s[8:11], s16 offen offset:768 sc1
    v_mfma_f32_16x16x32_bf16 v[168:171], v[64:67], a[44:47], v[168:171]
    s_mov_b32 s16, 917504
    s_add_u32 s26, s26, 58720256
    v_and_b32 v24, 7, v21
    v_mfma_f32_16x16x32_bf16 v[120:123], v[68:71], a[44:47], v[120:123]
    s_waitcnt lgkmcnt(0)
    v_lshlrev_b32 v24, 12, v24
    s_waitcnt vmcnt(18)
    v_mfma_f32_16x16x32_bf16 v[140:143], v[44:47], a[48:51], v[140:143]
    ds_read_b64_tr_b16 v[60:61], v57 offset:3072
    v_add_u32 v253, s26, v24
    s_waitcnt vmcnt(14)
    v_mfma_f32_16x16x32_bf16 v[140:143], v[48:51], a[64:67], v[140:143]
    ds_read_b64_tr_b16 v[62:63], v57 offset:12288
    s_waitcnt vmcnt(7)
    v_mfma_f32_16x16x32_bf16 v[140:143], v[52:55], a[80:83], v[140:143]
    buffer_load_dwordx4 a[112:115], v6, s[8:11], s16 offen offset:0 sc1
    v_mfma_f32_16x16x32_bf16 v[144:147], v[44:47], a[52:55], v[144:147]
    ds_read_b64_tr_b16 v[64:65], v57 offset:4096
    v_mfma_f32_16x16x32_bf16 v[144:147], v[48:51], a[68:71], v[144:147]
    ds_read_b64_tr_b16 v[66:67], v57 offset:13312
    v_lshlrev_b32 v85, 16, v76
    s_waitcnt vmcnt(7)
    v_mfma_f32_16x16x32_bf16 v[144:147], v[52:55], a[84:87], v[144:147]
    ds_read_b64_tr_b16 v[68:69], v57 offset:5120
    v_and_b32 v76, 0xffff0000, v76
    v_mfma_f32_16x16x32_bf16 v[148:151], v[44:47], a[56:59], v[148:151]
    ds_read_b64_tr_b16 v[70:71], v57 offset:14336
    v_mul_f32 v89, v85, v85
    v_mfma_f32_16x16x32_bf16 v[148:151], v[48:51], a[72:75], v[148:151]
    v_mul_f32 v90, v76, v76
    v_lshlrev_b32 v86, 16, v77
    s_waitcnt vmcnt(6)
    v_mfma_f32_16x16x32_bf16 v[148:151], v[52:55], a[88:91], v[148:151]
    buffer_load_dwordx4 a[116:119], v6, s[8:11], s16 offen offset:256 sc1
    v_mfma_f32_16x16x32_bf16 v[152:155], v[44:47], a[60:63], v[152:155]
    v_and_b32 v77, 0xffff0000, v77
    v_fma_f32 v89, v86, v86, v89
    v_mfma_f32_16x16x32_bf16 v[152:155], v[48:51], a[76:79], v[152:155]
    v_fma_f32 v90, v77, v77, v90
    v_lshlrev_b32 v85, 16, v78
    s_waitcnt vmcnt(6)
    v_mfma_f32_16x16x32_bf16 v[152:155], v[52:55], a[92:95], v[152:155]
    s_waitcnt lgkmcnt(0)
    v_and_b32 v78, 0xffff0000, v78
    v_fma_f32 v89, v85, v85, v89
    v_mfma_f32_16x16x32_bf16 v[188:191], v[60:63], a[48:51], v[188:191]
    ds_read_b64_tr_b16 v[44:45], v58 offset:3072
    v_fma_f32 v90, v78, v78, v90
    v_mfma_f32_16x16x32_bf16 v[188:191], v[64:67], a[64:67], v[188:191]
    buffer_load_dwordx4 a[120:123], v6, s[8:11], s16 offen offset:512 sc1
    v_mfma_f32_16x16x32_bf16 v[188:191], v[68:71], a[80:83], v[188:191]
    ds_read_b64_tr_b16 v[46:47], v58 offset:12288
    v_lshlrev_b32 v86, 16, v79
    v_mfma_f32_16x16x32_bf16 v[192:195], v[60:63], a[52:55], v[192:195]
    ds_read_b64_tr_b16 v[48:49], v58 offset:4096
    v_and_b32 v79, 0xffff0000, v79
    v_mfma_f32_16x16x32_bf16 v[192:195], v[64:67], a[68:71], v[192:195]
    ds_read_b64_tr_b16 v[50:51], v58 offset:13312
    v_fma_f32 v89, v86, v86, v89
    v_mfma_f32_16x16x32_bf16 v[192:195], v[68:71], a[84:87], v[192:195]
    ds_read_b64_tr_b16 v[52:53], v58 offset:5120
    v_fma_f32 v90, v79, v79, v90
    v_mfma_f32_16x16x32_bf16 v[196:199], v[60:63], a[56:59], v[196:199]
    buffer_load_dwordx4 a[124:127], v6, s[8:11], s16 offen offset:768 sc1
    v_mfma_f32_16x16x32_bf16 v[196:199], v[64:67], a[72:75], v[196:199]
    s_mov_b32 s16, 1048576
    ds_read_b64_tr_b16 v[54:55], v58 offset:14336
    v_lshlrev_b32 v85, 16, v80
    v_mfma_f32_16x16x32_bf16 v[196:199], v[68:71], a[88:91], v[196:199]
    v_and_b32 v80, 0xffff0000, v80
    v_fma_f32 v89, v85, v85, v89
    v_mfma_f32_16x16x32_bf16 v[200:203], v[60:63], a[60:63], v[200:203]
    v_fma_f32 v90, v80, v80, v90
    v_lshlrev_b32 v86, 16, v81
    v_mfma_f32_16x16x32_bf16 v[200:203], v[64:67], a[76:79], v[200:203]
    v_and_b32 v81, 0xffff0000, v81
    v_fma_f32 v89, v86, v86, v89
    v_mfma_f32_16x16x32_bf16 v[200:203], v[68:71], a[92:95], v[200:203]
    s_waitcnt lgkmcnt(0)
    v_fma_f32 v90, v81, v81, v90
    v_lshlrev_b32 v85, 16, v82
    v_mfma_f32_16x16x32_bf16 v[204:207], v[44:47], a[48:51], v[204:207]
    buffer_load_dwordx4 a[128:131], v6, s[8:11], s16 offen offset:0 sc1
    v_mfma_f32_16x16x32_bf16 v[204:207], v[48:51], a[64:67], v[204:207]
    ds_read_b64_tr_b16 v[60:61], v59 offset:3072
    v_and_b32 v82, 0xffff0000, v82
    v_mfma_f32_16x16x32_bf16 v[204:207], v[52:55], a[80:83], v[204:207]
    ds_read_b64_tr_b16 v[62:63], v59 offset:12288
    v_fma_f32 v89, v85, v85, v89
    v_mfma_f32_16x16x32_bf16 v[208:211], v[44:47], a[52:55], v[208:211]
    ds_read_b64_tr_b16 v[64:65], v59 offset:4096
    v_fma_f32 v90, v82, v82, v90
    v_mfma_f32_16x16x32_bf16 v[208:211], v[48:51], a[68:71], v[208:211]
    buffer_load_dwordx4 a[132:135], v6, s[8:11], s16 offen offset:256 sc1
    v_mfma_f32_16x16x32_bf16 v[208:211], v[52:55], a[84:87], v[208:211]
    ds_read_b64_tr_b16 v[66:67], v59 offset:13312
    v_lshlrev_b32 v86, 16, v83
    v_mfma_f32_16x16x32_bf16 v[212:215], v[44:47], a[56:59], v[212:215]
    ds_read_b64_tr_b16 v[68:69], v59 offset:5120
    v_and_b32 v83, 0xffff0000, v83
    v_mfma_f32_16x16x32_bf16 v[212:215], v[48:51], a[72:75], v[212:215]
    ds_read_b64_tr_b16 v[70:71], v59 offset:14336
    v_fma_f32 v89, v86, v86, v89
    v_mfma_f32_16x16x32_bf16 v[212:215], v[52:55], a[88:91], v[212:215]
    v_fma_f32 v90, v83, v83, v90
    v_lshlrev_b32 v85, 16, v84
    v_mfma_f32_16x16x32_bf16 v[216:219], v[44:47], a[60:63], v[216:219]
    v_and_b32 v84, 0xffff0000, v84
    v_fma_f32 v89, v85, v85, v89
    v_mfma_f32_16x16x32_bf16 v[216:219], v[48:51], a[76:79], v[216:219]
    buffer_load_dwordx4 a[136:139], v6, s[8:11], s16 offen offset:512 sc1
    v_mfma_f32_16x16x32_bf16 v[216:219], v[52:55], a[92:95], v[216:219]
    s_waitcnt lgkmcnt(0)
    v_fma_f32 v90, v84, v84, v90
    v_mfma_f32_16x16x32_bf16 v[172:175], v[60:63], a[48:51], v[172:175]
    ds_read_b64_tr_b16 v[44:45], v56 offset:39936
    v_add_f32 v89, v89, v90
    v_mfma_f32_16x16x32_bf16 v[172:175], v[64:67], a[64:67], v[172:175]
    ds_read_b64_tr_b16 v[46:47], v56 offset:49152
    v_add_f32_dpp v89, v89, v89 row_ror:8 row_mask:0xf bank_mask:0xf
    v_mfma_f32_16x16x32_bf16 v[172:175], v[68:71], a[80:83], v[172:175]
    ds_read_b64_tr_b16 v[48:49], v56 offset:40960
    v_mov_b32 v90, v89
    v_mfma_f32_16x16x32_bf16 v[176:179], v[60:63], a[52:55], v[176:179]
    buffer_load_dwordx4 a[140:143], v6, s[8:11], s16 offen offset:768 sc1
    v_mfma_f32_16x16x32_bf16 v[176:179], v[64:67], a[68:71], v[176:179]
    s_mov_b32 s16, 1179648
    ds_read_b64_tr_b16 v[50:51], v56 offset:50176
    v_permlane16_swap_b32 v90, v89
    v_mfma_f32_16x16x32_bf16 v[176:179], v[68:71], a[84:87], v[176:179]
    ds_read_b64_tr_b16 v[52:53], v56 offset:41984
    v_add_f32 v89, v89, v90
    v_mfma_f32_16x16x32_bf16 v[180:183], v[60:63], a[56:59], v[180:183]
    ds_read_b64_tr_b16 v[54:55], v56 offset:51200
    v_mov_b32 v90, v89
    v_mfma_f32_16x16x32_bf16 v[180:183], v[64:67], a[72:75], v[180:183]
    v_mfma_f32_16x16x32_bf16 v[180:183], v[68:71], a[88:91], v[180:183]
    buffer_load_dwordx4 a[144:147], v6, s[8:11], s16 offen offset:0 sc1
    v_mfma_f32_16x16x32_bf16 v[184:187], v[60:63], a[60:63], v[184:187]
    v_permlane32_swap_b32 v90, v89
    v_mfma_f32_16x16x32_bf16 v[184:187], v[64:67], a[76:79], v[184:187]
    v_add_f32 v89, v89, v90
    v_mfma_f32_16x16x32_bf16 v[184:187], v[68:71], a[92:95], v[184:187]
    s_waitcnt lgkmcnt(0)
    v_or_b32 v89, 1, v89
    v_mfma_f32_16x16x32_bf16 v[92:95], v[44:47], a[48:51], v[92:95]
    ds_read_b64_tr_b16 v[60:61], v57 offset:39936
    v_mfma_f32_16x16x32_bf16 v[92:95], v[48:51], a[64:67], v[92:95]
    buffer_store_dword v89, v87, s[8:11], 0 offen sc1
    v_mfma_f32_16x16x32_bf16 v[92:95], v[52:55], a[80:83], v[92:95]
    buffer_load_dwordx4 a[148:151], v6, s[8:11], s16 offen offset:256 sc1
    v_mfma_f32_16x16x32_bf16 v[96:99], v[44:47], a[52:55], v[96:99]
    ds_read_b64_tr_b16 v[62:63], v57 offset:49152
    v_mfma_f32_16x16x32_bf16 v[96:99], v[48:51], a[68:71], v[96:99]
    ds_read_b64_tr_b16 v[64:65], v57 offset:40960
    v_mfma_f32_16x16x32_bf16 v[96:99], v[52:55], a[84:87], v[96:99]
    ds_read_b64_tr_b16 v[66:67], v57 offset:50176
    v_mfma_f32_16x16x32_bf16 v[100:103], v[44:47], a[56:59], v[100:103]
    ds_read_b64_tr_b16 v[68:69], v57 offset:41984
    v_mfma_f32_16x16x32_bf16 v[100:103], v[48:51], a[72:75], v[100:103]
    buffer_load_dwordx4 a[152:155], v6, s[8:11], s16 offen offset:512 sc1
    v_mfma_f32_16x16x32_bf16 v[100:103], v[52:55], a[88:91], v[100:103]
    ds_read_b64_tr_b16 v[70:71], v57 offset:51200
    v_mfma_f32_16x16x32_bf16 v[104:107], v[44:47], a[60:63], v[104:107]
    v_mfma_f32_16x16x32_bf16 v[104:107], v[48:51], a[76:79], v[104:107]
    v_mfma_f32_16x16x32_bf16 v[104:107], v[52:55], a[92:95], v[104:107]
    s_waitcnt lgkmcnt(0)
    v_mfma_f32_16x16x32_bf16 v[124:127], v[60:63], a[48:51], v[124:127]
    ds_read_b64_tr_b16 v[44:45], v58 offset:39936
    v_mfma_f32_16x16x32_bf16 v[124:127], v[64:67], a[64:67], v[124:127]
    buffer_load_dwordx4 a[156:159], v6, s[8:11], s16 offen offset:768 sc1
    v_mfma_f32_16x16x32_bf16 v[124:127], v[68:71], a[80:83], v[124:127]
    s_mov_b32 s16, 1310720
    ds_read_b64_tr_b16 v[46:47], v58 offset:49152
    v_mfma_f32_16x16x32_bf16 v[128:131], v[60:63], a[52:55], v[128:131]
    ds_read_b64_tr_b16 v[48:49], v58 offset:40960
    v_mfma_f32_16x16x32_bf16 v[128:131], v[64:67], a[68:71], v[128:131]
    ds_read_b64_tr_b16 v[50:51], v58 offset:50176
    v_mfma_f32_16x16x32_bf16 v[128:131], v[68:71], a[84:87], v[128:131]
    ds_read_b64_tr_b16 v[52:53], v58 offset:41984
    v_mfma_f32_16x16x32_bf16 v[132:135], v[60:63], a[56:59], v[132:135]
    buffer_load_dwordx4 a[160:163], v6, s[8:11], s16 offen offset:0 sc1
    v_mfma_f32_16x16x32_bf16 v[132:135], v[64:67], a[72:75], v[132:135]
    ds_read_b64_tr_b16 v[54:55], v58 offset:51200
    v_mfma_f32_16x16x32_bf16 v[132:135], v[68:71], a[88:91], v[132:135]
    v_mfma_f32_16x16x32_bf16 v[136:139], v[60:63], a[60:63], v[136:139]
    v_mfma_f32_16x16x32_bf16 v[136:139], v[64:67], a[76:79], v[136:139]
    v_mfma_f32_16x16x32_bf16 v[136:139], v[68:71], a[92:95], v[136:139]
    s_waitcnt lgkmcnt(0)
    v_mfma_f32_16x16x32_bf16 v[156:159], v[44:47], a[48:51], v[156:159]
    buffer_load_dwordx4 a[164:167], v6, s[8:11], s16 offen offset:256 sc1
    v_mfma_f32_16x16x32_bf16 v[156:159], v[48:51], a[64:67], v[156:159]
    ds_read_b64_tr_b16 v[60:61], v59 offset:39936
    v_mfma_f32_16x16x32_bf16 v[156:159], v[52:55], a[80:83], v[156:159]
    ds_read_b64_tr_b16 v[62:63], v59 offset:49152
    v_mfma_f32_16x16x32_bf16 v[160:163], v[44:47], a[52:55], v[160:163]
    ds_read_b64_tr_b16 v[64:65], v59 offset:40960
    v_mfma_f32_16x16x32_bf16 v[160:163], v[48:51], a[68:71], v[160:163]
    buffer_load_dwordx4 a[168:171], v6, s[8:11], s16 offen offset:512 sc1
    v_mfma_f32_16x16x32_bf16 v[160:163], v[52:55], a[84:87], v[160:163]
L_pad_c1_0:
    s_cbranch_execz L_pad_c1_4
    ds_read_b64_tr_b16 v[66:67], v59 offset:50176
    v_mfma_f32_16x16x32_bf16 v[164:167], v[44:47], a[56:59], v[164:167]
    ds_read_b64_tr_b16 v[68:69], v59 offset:41984
    v_mfma_f32_16x16x32_bf16 v[164:167], v[48:51], a[72:75], v[164:167]
    ds_read_b64_tr_b16 v[70:71], v59 offset:51200
    v_mfma_f32_16x16x32_bf16 v[164:167], v[52:55], a[88:91], v[164:167]
    v_mfma_f32_16x16x32_bf16 v[168:171], v[44:47], a[60:63], v[168:171]
    buffer_load_dwordx4 a[172:175], v6, s[8:11], s16 offen offset:768 sc1
    v_mfma_f32_16x16x32_bf16 v[168:171], v[48:51], a[76:79], v[168:171]
    s_mov_b32 s16, 1441792
    v_mfma_f32_16x16x32_bf16 v[168:171], v[52:55], a[92:95], v[168:171]
    s_waitcnt lgkmcnt(0)
    v_mfma_f32_16x16x32_bf16 v[108:111], v[60:63], a[48:51], v[108:111]
    ds_read_b64_tr_b16 v[44:45], v56 offset:6144
    v_mfma_f32_16x16x32_bf16 v[108:111], v[64:67], a[64:67], v[108:111]
    ds_read_b64_tr_b16 v[46:47], v56 offset:15360
    v_mfma_f32_16x16x32_bf16 v[108:111], v[68:71], a[80:83], v[108:111]
    ds_read_b64_tr_b16 v[48:49], v56 offset:7168
    v_mfma_f32_16x16x32_bf16 v[112:115], v[60:63], a[52:55], v[112:115]
    buffer_load_dwordx4 a[176:179], v6, s[8:11], s16 offen offset:0 sc1
    v_mfma_f32_16x16x32_bf16 v[112:115], v[64:67], a[68:71], v[112:115]
    ds_read_b64_tr_b16 v[50:51], v56 offset:16384
    v_mfma_f32_16x16x32_bf16 v[112:115], v[68:71], a[84:87], v[112:115]
    ds_read_b64_tr_b16 v[52:53], v56 offset:8192
    v_mfma_f32_16x16x32_bf16 v[116:119], v[60:63], a[56:59], v[116:119]
    ds_read_b64_tr_b16 v[54:55], v56 offset:17408
    v_mfma_f32_16x16x32_bf16 v[116:119], v[64:67], a[72:75], v[116:119]
    v_mfma_f32_16x16x32_bf16 v[116:119], v[68:71], a[88:91], v[116:119]
    buffer_load_dwordx4 a[180:183], v6, s[8:11], s16 offen offset:256 sc1
    v_mfma_f32_16x16x32_bf16 v[120:123], v[60:63], a[60:63], v[120:123]
    v_mfma_f32_16x16x32_bf16 v[120:123], v[64:67], a[76:79], v[120:123]
    v_mfma_f32_16x16x32_bf16 v[120:123], v[68:71], a[92:95], v[120:123]
    s_waitcnt lgkmcnt(0)
    s_waitcnt vmcnt(22)
    v_mfma_f32_16x16x32_bf16 v[140:143], v[44:47], a[96:99], v[140:143]
    ds_read_b64_tr_b16 v[60:61], v57 offset:6144
    s_waitcnt vmcnt(18)
    v_mfma_f32_16x16x32_bf16 v[140:143], v[48:51], a[112:115], v[140:143]
    buffer_load_dwordx4 a[184:187], v6, s[8:11], s16 offen offset:512 sc1
    s_waitcnt vmcnt(15)
    v_mfma_f32_16x16x32_bf16 v[140:143], v[52:55], a[128:131], v[140:143]
    ds_read_b64_tr_b16 v[62:63], v57 offset:15360
    v_mfma_f32_16x16x32_bf16 v[144:147], v[44:47], a[100:103], v[144:147]
    ds_read_b64_tr_b16 v[64:65], v57 offset:7168
    v_mfma_f32_16x16x32_bf16 v[144:147], v[48:51], a[116:119], v[144:147]
    ds_read_b64_tr_b16 v[66:67], v57 offset:16384
    s_waitcnt vmcnt(14)
    v_mfma_f32_16x16x32_bf16 v[144:147], v[52:55], a[132:135], v[144:147]
    ds_read_b64_tr_b16 v[68:69], v57 offset:8192
    v_mfma_f32_16x16x32_bf16 v[148:151], v[44:47], a[104:107], v[148:151]
    buffer_load_dwordx4 a[188:191], v6, s[8:11], s16 offen offset:768 sc1
    v_mfma_f32_16x16x32_bf16 v[148:151], v[48:51], a[120:123], v[148:151]
    s_mov_b32 s16, 1572864
    ds_read_b64_tr_b16 v[70:71], v57 offset:17408
    s_waitcnt vmcnt(14)
    v_mfma_f32_16x16x32_bf16 v[148:151], v[52:55], a[136:139], v[148:151]
    v_mfma_f32_16x16x32_bf16 v[152:155], v[44:47], a[108:111], v[152:155]
    v_mfma_f32_16x16x32_bf16 v[152:155], v[48:51], a[124:127], v[152:155]
    s_waitcnt vmcnt(13)
    v_mfma_f32_16x16x32_bf16 v[152:155], v[52:55], a[140:143], v[152:155]
    s_waitcnt lgkmcnt(0)
    v_mfma_f32_16x16x32_bf16 v[188:191], v[60:63], a[96:99], v[188:191]
    buffer_load_dwordx4 a[192:195], v6, s[8:11], s16 offen offset:0 sc1
    v_mfma_f32_16x16x32_bf16 v[188:191], v[64:67], a[112:115], v[188:191]
    ds_read_b64_tr_b16 v[44:45], v58 offset:6144
    v_mfma_f32_16x16x32_bf16 v[188:191], v[68:71], a[128:131], v[188:191]
    ds_read_b64_tr_b16 v[46:47], v58 offset:15360
    v_mfma_f32_16x16x32_bf16 v[192:195], v[60:63], a[100:103], v[192:195]
    ds_read_b64_tr_b16 v[48:49], v58 offset:7168
    v_mfma_f32_16x16x32_bf16 v[192:195], v[64:67], a[116:119], v[192:195]
    ds_read_b64_tr_b16 v[50:51], v58 offset:16384
    v_mfma_f32_16x16x32_bf16 v[192:195], v[68:71], a[132:135], v[192:195]
    buffer_load_dwordx4 a[196:199], v6, s[8:11], s16 offen offset:256 sc1
    v_mfma_f32_16x16x32_bf16 v[196:199], v[60:63], a[104:107], v[196:199]
    ds_read_b64_tr_b16 v[52:53], v58 offset:8192
    v_mfma_f32_16x16x32_bf16 v[196:199], v[64:67], a[120:123], v[196:199]
    ds_read_b64_tr_b16 v[54:55], v58 offset:17408
    v_mfma_f32_16x16x32_bf16 v[196:199], v[68:71], a[136:139], v[196:199]
    v_mfma_f32_16x16x32_bf16 v[200:203], v[60:63], a[108:111], v[200:203]
    v_mfma_f32_16x16x32_bf16 v[200:203], v[64:67], a[124:127], v[200:203]
    buffer_load_dwordx4 a[200:203], v6, s[8:11], s16 offen offset:512 sc1
    v_mfma_f32_16x16x32_bf16 v[200:203], v[68:71], a[140:143], v[200:203]
    s_waitcnt lgkmcnt(0)
    v_mfma_f32_16x16x32_bf16 v[204:207], v[44:47], a[96:99], v[204:207]
    ds_read_b64_tr_b16 v[60:61], v59 offset:6144
    v_mfma_f32_16x16x32_bf16 v[204:207], v[48:51], a[112:115], v[204:207]
    ds_read_b64_tr_b16 v[62:63], v59 offset:15360
    v_mfma_f32_16x16x32_bf16 v[204:207], v[52:55], a[128:131], v[204:207]
    ds_read_b64_tr_b16 v[64:65], v59 offset:7168
    v_mfma_f32_16x16x32_bf16 v[208:211], v[44:47], a[100:103], v[208:211]
    buffer_load_dwordx4 a[204:207], v6, s[8:11], s16 offen offset:768 sc1
    v_mfma_f32_16x16x32_bf16 v[208:211], v[48:51], a[116:119], v[208:211]
    s_mov_b32 s16, 1703936
    ds_read_b64_tr_b16 v[66:67], v59 offset:16384
    v_mfma_f32_16x16x32_bf16 v[208:211], v[52:55], a[132:135], v[208:211]
    ds_read_b64_tr_b16 v[68:69], v59 offset:8192
    v_mfma_f32_16x16x32_bf16 v[212:215], v[44:47], a[104:107], v[212:215]
    ds_read_b64_tr_b16 v[70:71], v59 offset:17408
    v_mfma_f32_16x16x32_bf16 v[212:215], v[48:51], a[120:123], v[212:215]
    v_mfma_f32_16x16x32_bf16 v[212:215], v[52:55], a[136:139], v[212:215]
    buffer_load_dwordx4 a[208:211], v6, s[8:11], s16 offen offset:0 sc1
    v_mfma_f32_16x16x32_bf16 v[216:219], v[44:47], a[108:111], v[216:219]
    v_mfma_f32_16x16x32_bf16 v[216:219], v[48:51], a[124:127], v[216:219]
    v_mfma_f32_16x16x32_bf16 v[216:219], v[52:55], a[140:143], v[216:219]
    s_waitcnt lgkmcnt(0)
    v_mfma_f32_16x16x32_bf16 v[172:175], v[60:63], a[96:99], v[172:175]
    ds_read_b64_tr_b16 v[44:45], v56 offset:43008
    v_mfma_f32_16x16x32_bf16 v[172:175], v[64:67], a[112:115], v[172:175]
    buffer_load_dwordx4 a[212:215], v6, s[8:11], s16 offen offset:256 sc1
    v_mfma_f32_16x16x32_bf16 v[172:175], v[68:71], a[128:131], v[172:175]
    ds_read_b64_tr_b16 v[46:47], v56 offset:52224
    v_mfma_f32_16x16x32_bf16 v[176:179], v[60:63], a[100:103], v[176:179]
    ds_read_b64_tr_b16 v[48:49], v56 offset:44032
    v_mfma_f32_16x16x32_bf16 v[176:179], v[64:67], a[116:119], v[176:179]
    ds_read_b64_tr_b16 v[50:51], v56 offset:53248
    v_mfma_f32_16x16x32_bf16 v[176:179], v[68:71], a[132:135], v[176:179]
    ds_read_b64_tr_b16 v[52:53], v56 offset:45056
    v_mfma_f32_16x16x32_bf16 v[180:183], v[60:63], a[104:107], v[180:183]
    ds_read_b64_tr_b16 v[54:55], v56 offset:54272
    v_mfma_f32_16x16x32_bf16 v[180:183], v[64:67], a[120:123], v[180:183]
    buffer_load_dwordx4 a[216:219], v6, s[8:11], s16 offen offset:512 sc1
    v_mfma_f32_16x16x32_bf16 v[180:183], v[68:71], a[136:139], v[180:183]
    v_mfma_f32_16x16x32_bf16 v[184:187], v[60:63], a[108:111], v[184:187]
    v_mfma_f32_16x16x32_bf16 v[184:187], v[64:67], a[124:127], v[184:187]
    v_mfma_f32_16x16x32_bf16 v[184:187], v[68:71], a[140:143], v[184:187]
    s_waitcnt lgkmcnt(0)
    v_mfma_f32_16x16x32_bf16 v[92:95], v[44:47], a[96:99], v[92:95]
    buffer_load_dwordx4 a[220:223], v6, s[8:11], s16 offen offset:768 sc1
    v_mfma_f32_16x16x32_bf16 v[92:95], v[48:51], a[112:115], v[92:95]
    s_mov_b32 s16, 1835008
    ds_read_b64_tr_b16 v[60:61], v57 offset:43008
    v_mfma_f32_16x16x32_bf16 v[92:95], v[52:55], a[128:131], v[92:95]
    ds_read_b64_tr_b16 v[62:63], v57 offset:52224
    v_mfma_f32_16x16x32_bf16 v[96:99], v[44:47], a[100:103], v[96:99]
    ds_read_b64_tr_b16 v[64:65], v57 offset:44032
    v_mfma_f32_16x16x32_bf16 v[96:99], v[48:51], a[116:119], v[96:99]
    ds_read_b64_tr_b16 v[66:67], v57 offset:53248
    v_mfma_f32_16x16x32_bf16 v[96:99], v[52:55], a[132:135], v[96:99]
    buffer_load_dwordx4 a[224:227], v6, s[8:11], s16 offen offset:0 sc1
    v_mfma_f32_16x16x32_bf16 v[100:103], v[44:47], a[104:107], v[100:103]
    ds_read_b64_tr_b16 v[68:69], v57 offset:45056
    v_mfma_f32_16x16x32_bf16 v[100:103], v[48:51], a[120:123], v[100:103]
    ds_read_b64_tr_b16 v[70:71], v57 offset:54272
    v_mfma_f32_16x16x32_bf16 v[100:103], v[52:55], a[136:139], v[100:103]
    v_mfma_f32_16x16x32_bf16 v[104:107], v[44:47], a[108:111], v[104:107]
    v_mfma_f32_16x16x32_bf16 v[104:107], v[48:51], a[124:127], v[104:107]
    buffer_load_dwordx4 a[228:231], v6, s[8:11], s16 offen offset:256 sc1
    v_mfma_f32_16x16x32_bf16 v[104:107], v[52:55], a[140:143], v[104:107]
    s_waitcnt lgkmcnt(0)
    v_mfma_f32_16x16x32_bf16 v[124:127], v[60:63], a[96:99], v[124:127]
    ds_read_b64_tr_b16 v[44:45], v58 offset:43008
    v_mfma_f32_16x16x32_bf16 v[124:127], v[64:67], a[112:115], v[124:127]
    ds_read_b64_tr_b16 v[46:47], v58 offset:52224
    v_mfma_f32_16x16x32_bf16 v[124:127], v[68:71], a[128:131], v[124:127]
    ds_read_b64_tr_b16 v[48:49], v58 offset:44032
    v_mfma_f32_16x16x32_bf16 v[128:131], v[60:63], a[100:103], v[128:131]
    buffer_load_dwordx4 a[232:235], v6, s[8:11], s16 offen offset:512 sc1
    v_mfma_f32_16x16x32_bf16 v[128:131], v[64:67], a[116:119], v[128:131]
    ds_read_b64_tr_b16 v[50:51], v58 offset:53248
    v_mfma_f32_16x16x32_bf16 v[128:131], v[68:71], a[132:135], v[128:131]
    ds_read_b64_tr_b16 v[52:53], v58 offset:45056
    v_mfma_f32_16x16x32_bf16 v[132:135], v[60:63], a[104:107], v[132:135]
    ds_read_b64_tr_b16 v[54:55], v58 offset:54272
    v_mfma_f32_16x16x32_bf16 v[132:135], v[64:67], a[120:123], v[132:135]
    v_mfma_f32_16x16x32_bf16 v[132:135], v[68:71], a[136:139], v[132:135]
    v_mfma_f32_16x16x32_bf16 v[136:139], v[60:63], a[108:111], v[136:139]
    buffer_load_dword v16, v88, s[8:11], 0 offen offset:0 sc1
    v_mfma_f32_16x16x32_bf16 v[136:139], v[64:67], a[124:127], v[136:139]
    buffer_load_dword v17, v88, s[8:11], 0 offen offset:512 sc1
    v_mfma_f32_16x16x32_bf16 v[136:139], v[68:71], a[140:143], v[136:139]
    s_waitcnt lgkmcnt(0)
    v_mfma_f32_16x16x32_bf16 v[156:159], v[44:47], a[96:99], v[156:159]
    buffer_load_dword v18, v88, s[8:11], 0 offen offset:1024 sc1
    v_mfma_f32_16x16x32_bf16 v[156:159], v[48:51], a[112:115], v[156:159]
    buffer_load_dword v19, v88, s[8:11], 0 offen offset:1536 sc1
    v_mfma_f32_16x16x32_bf16 v[156:159], v[52:55], a[128:131], v[156:159]
    buffer_load_dwordx4 a[236:239], v6, s[8:11], s16 offen offset:768 sc1
    v_mfma_f32_16x16x32_bf16 v[160:163], v[44:47], a[100:103], v[160:163]
    s_mov_b32 s16, 1966080
    ds_read_b64_tr_b16 v[60:61], v59 offset:43008
    ds_read_b64_tr_b16 v[62:63], v59 offset:52224
    v_mfma_f32_16x16x32_bf16 v[160:163], v[48:51], a[116:119], v[160:163]
    ds_read_b64_tr_b16 v[64:65], v59 offset:44032
    v_mfma_f32_16x16x32_bf16 v[160:163], v[52:55], a[132:135], v[160:163]
    ds_read_b64_tr_b16 v[66:67], v59 offset:53248
    v_mfma_f32_16x16x32_bf16 v[164:167], v[44:47], a[104:107], v[164:167]
    buffer_load_dwordx4 a[240:243], v6, s[8:11], s16 offen offset:0 sc1
    v_mfma_f32_16x16x32_bf16 v[164:167], v[48:51], a[120:123], v[164:167]
    ds_read_b64_tr_b16 v[68:69], v59 offset:45056
    ds_read_b64_tr_b16 v[70:71], v59 offset:54272
    v_mfma_f32_16x16x32_bf16 v[164:167], v[52:55], a[136:139], v[164:167]
    v_mfma_f32_16x16x32_bf16 v[168:171], v[44:47], a[108:111], v[168:171]
    v_mfma_f32_16x16x32_bf16 v[168:171], v[48:51], a[124:127], v[168:171]
    v_mfma_f32_16x16x32_bf16 v[168:171], v[52:55], a[140:143], v[168:171]
    s_waitcnt lgkmcnt(0)
    v_mfma_f32_16x16x32_bf16 v[108:111], v[60:63], a[96:99], v[108:111]
    s_barrier
    v_add_u32 v56, 73728, v56
    v_mfma_f32_16x16x32_bf16 v[108:111], v[64:67], a[112:115], v[108:111]
    buffer_load_dwordx4 a[244:247], v6, s[8:11], s16 offen offset:256 sc1
    v_mfma_f32_16x16x32_bf16 v[108:111], v[68:71], a[128:131], v[108:111]
    s_add_u32 m0, s12, 36864
    ds_read_b64_tr_b16 v[44:45], v56 offset:0
    v_mfma_f32_16x16x32_bf16 v[112:115], v[60:63], a[100:103], v[112:115]
    s_mov_b64 s[40:41], s[48:49]
    ds_read_b64_tr_b16 v[46:47], v56 offset:9216
    v_mfma_f32_16x16x32_bf16 v[112:115], v[64:67], a[116:119], v[112:115]
    s_add_u32 s15, s18, 4096
    ds_read_b64_tr_b16 v[48:49], v56 offset:1024
    v_mfma_f32_16x16x32_bf16 v[112:115], v[68:71], a[132:135], v[112:115]
    buffer_load_dwordx4 a[248:251], v6, s[8:11], s16 offen offset:512 sc1
    v_mfma_f32_16x16x32_bf16 v[116:119], v[60:63], a[104:107], v[116:119]
    ds_read_b64_tr_b16 v[50:51], v56 offset:10240
    ds_read_b64_tr_b16 v[52:53], v56 offset:2048
    v_mfma_f32_16x16x32_bf16 v[116:119], v[64:67], a[120:123], v[116:119]
    ds_read_b64_tr_b16 v[54:55], v56 offset:11264
    v_mfma_f32_16x16x32_bf16 v[116:119], v[68:71], a[136:139], v[116:119]
    v_mfma_f32_16x16x32_bf16 v[120:123], v[60:63], a[108:111], v[120:123]
    v_mfma_f32_16x16x32_bf16 v[120:123], v[64:67], a[124:127], v[120:123]
    buffer_load_dwordx4 a[252:255], v6, s[8:11], s16 offen offset:768 sc1
    v_mfma_f32_16x16x32_bf16 v[120:123], v[68:71], a[140:143], v[120:123]
    s_waitcnt lgkmcnt(0)
    s_waitcnt vmcnt(32)
    v_mfma_f32_16x16x32_bf16 v[140:143], v[44:47], a[144:147], v[140:143]
    s_mov_b32 s16, 2097152
    v_add_u32 v57, 73728, v57
    s_waitcnt vmcnt(27)
    v_mfma_f32_16x16x32_bf16 v[140:143], v[48:51], a[160:163], v[140:143]
    ds_read_b64_tr_b16 v[60:61], v57 offset:0
    s_waitcnt vmcnt(23)
    v_mfma_f32_16x16x32_bf16 v[140:143], v[52:55], a[176:179], v[140:143]
    ds_read_b64_tr_b16 v[62:63], v57 offset:9216
    v_mfma_f32_16x16x32_bf16 v[144:147], v[44:47], a[148:151], v[144:147]
    buffer_load_dwordx4 v[220:223], v6, s[8:11], s16 offen offset:0 sc1
    v_mfma_f32_16x16x32_bf16 v[144:147], v[48:51], a[164:167], v[144:147]
    ds_read_b64_tr_b16 v[64:65], v57 offset:1024
    s_waitcnt vmcnt(23)
    v_mfma_f32_16x16x32_bf16 v[144:147], v[52:55], a[180:183], v[144:147]
    ds_read_b64_tr_b16 v[66:67], v57 offset:10240
    v_mfma_f32_16x16x32_bf16 v[148:151], v[44:47], a[152:155], v[148:151]
    ds_read_b64_tr_b16 v[68:69], v57 offset:2048
    v_mfma_f32_16x16x32_bf16 v[148:151], v[48:51], a[168:171], v[148:151]
    ds_read_b64_tr_b16 v[70:71], v57 offset:11264
    s_waitcnt vmcnt(22)
    v_mfma_f32_16x16x32_bf16 v[148:151], v[52:55], a[184:187], v[148:151]
    buffer_load_dwordx4 v[224:227], v6, s[8:11], s16 offen offset:256 sc1
    v_mfma_f32_16x16x32_bf16 v[152:155], v[44:47], a[156:159], v[152:155]
    v_mfma_f32_16x16x32_bf16 v[152:155], v[48:51], a[172:175], v[152:155]
    s_waitcnt vmcnt(22)
    v_mfma_f32_16x16x32_bf16 v[152:155], v[52:55], a[188:191], v[152:155]
    s_waitcnt lgkmcnt(0)
    v_mfma_f32_16x16x32_bf16 v[188:191], v[60:63], a[144:147], v[188:191]
    v_add_u32 v58, 73728, v58
    v_mfma_f32_16x16x32_bf16 v[188:191], v[64:67], a[160:163], v[188:191]
    ds_read_b64_tr_b16 v[44:45], v58 offset:0
    v_mfma_f32_16x16x32_bf16 v[188:191], v[68:71], a[176:179], v[188:191]
    buffer_load_dwordx4 v[228:231], v6, s[8:11], s16 offen offset:512 sc1
    v_mfma_f32_16x16x32_bf16 v[192:195], v[60:63], a[148:151], v[192:195]
    ds_read_b64_tr_b16 v[46:47], v58 offset:9216
    v_mfma_f32_16x16x32_bf16 v[192:195], v[64:67], a[164:167], v[192:195]
    ds_read_b64_tr_b16 v[48:49], v58 offset:1024
    v_mfma_f32_16x16x32_bf16 v[192:195], v[68:71], a[180:183], v[192:195]
    ds_read_b64_tr_b16 v[50:51], v58 offset:10240
    v_mfma_f32_16x16x32_bf16 v[196:199], v[60:63], a[152:155], v[196:199]
    ds_read_b64_tr_b16 v[52:53], v58 offset:2048
    v_mfma_f32_16x16x32_bf16 v[196:199], v[64:67], a[168:171], v[196:199]
    buffer_load_dwordx4 v[232:235], v6, s[8:11], s16 offen offset:768 sc1
    v_mfma_f32_16x16x32_bf16 v[196:199], v[68:71], a[184:187], v[196:199]
    s_mov_b32 s16, 2228224
    ds_read_b64_tr_b16 v[54:55], v58 offset:11264
    v_mfma_f32_16x16x32_bf16 v[200:203], v[60:63], a[156:159], v[200:203]
    v_mfma_f32_16x16x32_bf16 v[200:203], v[64:67], a[172:175], v[200:203]
    v_mfma_f32_16x16x32_bf16 v[200:203], v[68:71], a[188:191], v[200:203]
    s_waitcnt lgkmcnt(0)
    v_mfma_f32_16x16x32_bf16 v[204:207], v[44:47], a[144:147], v[204:207]
    buffer_load_dwordx4 v[236:239], v6, s[8:11], s16 offen offset:0 sc1
    v_mfma_f32_16x16x32_bf16 v[204:207], v[48:51], a[160:163], v[204:207]
    v_add_u32 v59, 73728, v59
    v_mfma_f32_16x16x32_bf16 v[204:207], v[52:55], a[176:179], v[204:207]
    ds_read_b64_tr_b16 v[60:61], v59 offset:0
    v_mfma_f32_16x16x32_bf16 v[208:211], v[44:47], a[148:151], v[208:211]
    ds_read_b64_tr_b16 v[62:63], v59 offset:9216
    v_mfma_f32_16x16x32_bf16 v[208:211], v[48:51], a[164:167], v[208:211]
    ds_read_b64_tr_b16 v[64:65], v59 offset:1024
    v_mfma_f32_16x16x32_bf16 v[208:211], v[52:55], a[180:183], v[208:211]
    buffer_load_dwordx4 v[240:243], v6, s[8:11], s16 offen offset:256 sc1
    v_mfma_f32_16x16x32_bf16 v[212:215], v[44:47], a[152:155], v[212:215]
    ds_read_b64_tr_b16 v[66:67], v59 offset:10240
    ds_read_b64_tr_b16 v[68:69], v59 offset:2048
    v_mfma_f32_16x16x32_bf16 v[212:215], v[48:51], a[168:171], v[212:215]
    ds_read_b64_tr_b16 v[70:71], v59 offset:11264
    v_mfma_f32_16x16x32_bf16 v[212:215], v[52:55], a[184:187], v[212:215]
    v_mfma_f32_16x16x32_bf16 v[216:219], v[44:47], a[156:159], v[216:219]
    v_mfma_f32_16x16x32_bf16 v[216:219], v[48:51], a[172:175], v[216:219]
    buffer_load_dwordx4 v[244:247], v6, s[8:11], s16 offen offset:512 sc1
    v_mfma_f32_16x16x32_bf16 v[216:219], v[52:55], a[188:191], v[216:219]
    s_waitcnt lgkmcnt(0)
    v_mfma_f32_16x16x32_bf16 v[172:175], v[60:63], a[144:147], v[172:175]
    ds_read_b64_tr_b16 v[44:45], v56 offset:3072
    v_mfma_f32_16x16x32_bf16 v[172:175], v[64:67], a[160:163], v[172:175]
    s_waitcnt vmcnt(12)
    ds_read_b64_tr_b16 v[46:47], v56 offset:12288
    v_min3_u32 v91, v16, v17, v18
    v_mfma_f32_16x16x32_bf16 v[172:175], v[68:71], a[176:179], v[172:175]
    ds_read_b64_tr_b16 v[48:49], v56 offset:4096
    v_min_u32 v91, v91, v19
    v_mfma_f32_16x16x32_bf16 v[176:179], v[60:63], a[148:151], v[176:179]
    ds_read_b64_tr_b16 v[50:51], v56 offset:13312
    v_cmp_eq_u32 s[46:47], 0, v91
    v_mfma_f32_16x16x32_bf16 v[176:179], v[64:67], a[164:167], v[176:179]
    buffer_load_dwordx4 v[248:251], v6, s[8:11], s16 offen offset:768 sc1
    v_mfma_f32_16x16x32_bf16 v[176:179], v[68:71], a[180:183], v[176:179]
    s_cmp_lg_u64 s[46:47], 0
    s_cbranch_scc1 L_slow11
L_slow11_ret:
    ds_read_b64_tr_b16 v[52:53], v56 offset:5120
    v_mfma_f32_16x16x32_bf16 v[180:183], v[60:63], a[152:155], v[180:183]
    ds_read_b64_tr_b16 v[54:55], v56 offset:14336
    v_mov_b32 v12, v16
    v_mfma_f32_16x16x32_bf16 v[180:183], v[64:67], a[168:171], v[180:183]
    v_mov_b32 v13, v17
    v_mov_b32 v14, v18
    v_mfma_f32_16x16x32_bf16 v[180:183], v[68:71], a[184:187], v[180:183]
    v_mov_b32 v15, v19
    v_permlane16_swap_b32 v12, v16
    v_mfma_f32_16x16x32_bf16 v[184:187], v[60:63], a[156:159], v[184:187]
    buffer_load_dwordx4 v11, s[40:43], s15 offen  lds
    v_mfma_f32_16x16x32_bf16 v[184:187], v[64:67], a[172:175], v[184:187]
    s_add_u32 m0, s12, 37888
    v_permlane16_swap_b32 v13, v17
    v_permlane16_swap_b32 v14, v18
    v_mfma_f32_16x16x32_bf16 v[184:187], v[68:71], a[188:191], v[184:187]
    s_waitcnt lgkmcnt(0)
    v_permlane16_swap_b32 v15, v19
    v_add_f32 v16, v16, v12
    v_mfma_f32_16x16x32_bf16 v[140:143], v[44:47], a[192:195], v[140:143]
    s_add_u32 s15, s15, s19
    ds_read_b64_tr_b16 v[60:61], v57 offset:3072
    v_add_f32 v17, v17, v13
    v_mfma_f32_16x16x32_bf16 v[140:143], v[48:51], a[208:211], v[140:143]
    ds_read_b64_tr_b16 v[62:63], v57 offset:12288
    v_add_f32 v18, v18, v14
    v_mfma_f32_16x16x32_bf16 v[140:143], v[52:55], a[224:227], v[140:143]
    buffer_load_dwordx4 v11, s[40:43], s15 offen  lds
    v_mfma_f32_16x16x32_bf16 v[144:147], v[44:47], a[196:199], v[144:147]
    s_add_u32 m0, s12, 38912
    ds_read_b64_tr_b16 v[64:65], v57 offset:4096
    v_add_f32 v19, v19, v15
    v_mfma_f32_16x16x32_bf16 v[144:147], v[48:51], a[212:215], v[144:147]
    s_add_u32 s15, s15, s19
    ds_read_b64_tr_b16 v[66:67], v57 offset:13312
    v_mov_b32 v12, v16
    v_mfma_f32_16x16x32_bf16 v[144:147], v[52:55], a[228:231], v[144:147]
    ds_read_b64_tr_b16 v[68:69], v57 offset:5120
    v_mov_b32 v13, v17
    v_mfma_f32_16x16x32_bf16 v[148:151], v[44:47], a[200:203], v[148:151]
    ds_read_b64_tr_b16 v[70:71], v57 offset:14336
    v_mov_b32 v14, v18
    v_mfma_f32_16x16x32_bf16 v[148:151], v[48:51], a[216:219], v[148:151]
    buffer_load_dwordx4 v11, s[40:43], s15 offen  lds
    v_mfma_f32_16x16x32_bf16 v[148:151], v[52:55], a[232:235], v[148:151]
    s_add_u32 m0, s12, 39936
    v_mov_b32 v15, v19
    v_permlane32_swap_b32 v12, v16
    v_mfma_f32_16x16x32_bf16 v[152:155], v[44:47], a[204:207], v[152:155]
    s_add_u32 s15, s15, s19
    v_permlane32_swap_b32 v13, v17
    v_permlane32_swap_b32 v14, v18
    v_mfma_f32_16x16x32_bf16 v[152:155], v[48:51], a[220:223], v[152:155]
    v_permlane32_swap_b32 v15, v19
    v_add_f32 v16, v16, v12
    s_waitcnt vmcnt(15)
    v_mfma_f32_16x16x32_bf16 v[152:155], v[52:55], a[236:239], v[152:155]
    s_waitcnt lgkmcnt(0)
    v_add_f32 v17, v17, v13
    v_add_f32 v18, v18, v14
    v_mfma_f32_16x16x32_bf16 v[188:191], v[60:63], a[192:195], v[188:191]
    buffer_load_dwordx4 v11, s[40:43], s15 offen  lds
    v_mfma_f32_16x16x32_bf16 v[188:191], v[64:67], a[208:211], v[188:191]
    s_add_u32 m0, s12, 40960
    ds_read_b64_tr_b16 v[44:45], v58 offset:3072
    v_add_f32 v19, v19, v15
    v_mfma_f32_16x16x32_bf16 v[188:191], v[68:71], a[224:227], v[188:191]
    s_add_u32 s15, s15, s19
    ds_read_b64_tr_b16 v[46:47], v58 offset:12288
    v_mul_f32 v16, 0x3ae38e39, v16
    v_mfma_f32_16x16x32_bf16 v[192:195], v[60:63], a[196:199], v[192:195]
    ds_read_b64_tr_b16 v[48:49], v58 offset:4096
    v_mul_f32 v17, 0x3ae38e39, v17
    v_mfma_f32_16x16x32_bf16 v[192:195], v[64:67], a[212:215], v[192:195]
    ds_read_b64_tr_b16 v[50:51], v58 offset:13312
    v_mul_f32 v18, 0x3ae38e39, v18
    v_mfma_f32_16x16x32_bf16 v[192:195], v[68:71], a[228:231], v[192:195]
    ds_read_b64_tr_b16 v[52:53], v58 offset:5120
    v_mul_f32 v19, 0x3ae38e39, v19
    v_mfma_f32_16x16x32_bf16 v[196:199], v[60:63], a[200:203], v[196:199]
    buffer_load_dwordx4 v11, s[40:43], s15 offen  lds
    v_mfma_f32_16x16x32_bf16 v[196:199], v[64:67], a[216:219], v[196:199]
    s_add_u32 m0, s12, 41984
    ds_read_b64_tr_b16 v[54:55], v58 offset:14336
    v_add_f32 v16, 0x3727c5ac, v16
    v_mfma_f32_16x16x32_bf16 v[196:199], v[68:71], a[232:235], v[196:199]
    s_add_u32 s15, s15, s19
    v_rsq_f32 v12, v16
    v_mfma_f32_16x16x32_bf16 v[200:203], v[60:63], a[204:207], v[200:203]
    v_add_f32 v17, 0x3727c5ac, v17
    v_add_f32 v18, 0x3727c5ac, v18
    v_mfma_f32_16x16x32_bf16 v[200:203], v[64:67], a[220:223], v[200:203]
    v_rsq_f32 v13, v17
    v_mfma_f32_16x16x32_bf16 v[200:203], v[68:71], a[236:239], v[200:203]
    s_waitcnt lgkmcnt(0)
    v_rsq_f32 v14, v18
    v_mfma_f32_16x16x32_bf16 v[204:207], v[44:47], a[192:195], v[204:207]
    buffer_load_dwordx4 v11, s[40:43], s15 offen  lds
    v_mfma_f32_16x16x32_bf16 v[204:207], v[48:51], a[208:211], v[204:207]
    s_add_u32 m0, s12, 43008
    ds_read_b64_tr_b16 v[60:61], v59 offset:3072
    v_add_f32 v19, 0x3727c5ac, v19
    v_mfma_f32_16x16x32_bf16 v[204:207], v[52:55], a[224:227], v[204:207]
    s_add_u32 s15, s15, s19
    ds_read_b64_tr_b16 v[62:63], v59 offset:12288
    v_mul_f32 v12, 0xbfb8aa3b, v12
    v_mfma_f32_16x16x32_bf16 v[208:211], v[44:47], a[196:199], v[208:211]
    ds_read_b64_tr_b16 v[64:65], v59 offset:4096
    v_mul_f32 v13, 0xbfb8aa3b, v13
    v_mfma_f32_16x16x32_bf16 v[208:211], v[48:51], a[212:215], v[208:211]
    buffer_load_dwordx4 v11, s[40:43], s15 offen  lds
    v_mfma_f32_16x16x32_bf16 v[208:211], v[52:55], a[228:231], v[208:211]
    s_add_u32 m0, s12, 44032
    ds_read_b64_tr_b16 v[66:67], v59 offset:13312
    v_mul_f32 v14, 0xbfb8aa3b, v14
    v_mfma_f32_16x16x32_bf16 v[212:215], v[44:47], a[200:203], v[212:215]
    s_add_u32 s15, s15, s19
    ds_read_b64_tr_b16 v[68:69], v59 offset:5120
    ds_read_b64_tr_b16 v[70:71], v59 offset:14336
    v_mfma_f32_16x16x32_bf16 v[212:215], v[48:51], a[216:219], v[212:215]
    v_rsq_f32 v15, v19
    v_mfma_f32_16x16x32_bf16 v[212:215], v[52:55], a[232:235], v[212:215]
    v_mul_f32 v15, 0xbfb8aa3b, v15
    v_mfma_f32_16x16x32_bf16 v[216:219], v[44:47], a[204:207], v[216:219]
    buffer_load_dwordx4 v11, s[40:43], s15 offen  lds
    v_mfma_f32_16x16x32_bf16 v[216:219], v[48:51], a[220:223], v[216:219]
    s_add_u32 m0, s12, 45056
    v_mfma_f32_16x16x32_bf16 v[216:219], v[52:55], a[236:239], v[216:219]
    s_waitcnt lgkmcnt(0)
    v_mfma_f32_16x16x32_bf16 v[172:175], v[60:63], a[192:195], v[172:175]
    s_add_u32 s15, s15, s19
    ds_read_b64_tr_b16 v[44:45], v56 offset:6144
    v_mfma_f32_16x16x32_bf16 v[172:175], v[64:67], a[208:211], v[172:175]
    ds_read_b64_tr_b16 v[46:47], v56 offset:15360
    v_mfma_f32_16x16x32_bf16 v[172:175], v[68:71], a[224:227], v[172:175]
    buffer_load_dwordx4 v11, s[40:43], s15 offen  lds
    v_mfma_f32_16x16x32_bf16 v[176:179], v[60:63], a[196:199], v[176:179]
    s_add_u32 m0, s12, 0
    ds_read_b64_tr_b16 v[48:49], v56 offset:7168
    v_mfma_f32_16x16x32_bf16 v[176:179], v[64:67], a[212:215], v[176:179]
    s_mov_b64 s[40:41], s[52:53]
    ds_read_b64_tr_b16 v[50:51], v56 offset:16384
    v_mfma_f32_16x16x32_bf16 v[176:179], v[68:71], a[228:231], v[176:179]
    ds_read_b64_tr_b16 v[52:53], v56 offset:8192
    v_mfma_f32_16x16x32_bf16 v[180:183], v[60:63], a[200:203], v[180:183]
    ds_read_b64_tr_b16 v[54:55], v56 offset:17408
    v_mfma_f32_16x16x32_bf16 v[180:183], v[64:67], a[216:219], v[180:183]
    v_mfma_f32_16x16x32_bf16 v[180:183], v[68:71], a[232:235], v[180:183]
    buffer_load_dwordx4 v10, s[40:43], s22 offen offset:0  lds
    v_mfma_f32_16x16x32_bf16 v[184:187], v[60:63], a[204:207], v[184:187]
    s_add_u32 m0, s12, 896
    v_mfma_f32_16x16x32_bf16 v[184:187], v[64:67], a[220:223], v[184:187]
    v_mfma_f32_16x16x32_bf16 v[184:187], v[68:71], a[236:239], v[184:187]
    s_waitcnt lgkmcnt(0)
    s_waitcnt vmcnt(21)
    v_mfma_f32_16x16x32_bf16 v[140:143], v[44:47], a[240:243], v[140:143]
    ds_read_b64_tr_b16 v[60:61], v57 offset:6144
    s_waitcnt vmcnt(17)
    v_mfma_f32_16x16x32_bf16 v[140:143], v[48:51], v[220:223], v[140:143]
    buffer_load_dwordx4 v10, s[40:43], s22 offen offset:128  lds
    s_waitcnt vmcnt(14)
    v_mfma_f32_16x16x32_bf16 v[140:143], v[52:55], v[236:239], v[140:143]
    s_add_u32 m0, s12, 1792
    ds_read_b64_tr_b16 v[62:63], v57 offset:15360
    v_mfma_f32_16x16x32_bf16 v[144:147], v[44:47], a[244:247], v[144:147]
    ds_read_b64_tr_b16 v[64:65], v57 offset:7168
    v_mfma_f32_16x16x32_bf16 v[144:147], v[48:51], v[224:227], v[144:147]
    ds_read_b64_tr_b16 v[66:67], v57 offset:16384
    s_waitcnt vmcnt(13)
    v_mfma_f32_16x16x32_bf16 v[144:147], v[52:55], v[240:243], v[144:147]
    ds_read_b64_tr_b16 v[68:69], v57 offset:8192
    v_mfma_f32_16x16x32_bf16 v[148:151], v[44:47], a[248:251], v[148:151]
    buffer_load_dwordx4 v10, s[40:43], s22 offen offset:256  lds
    v_mfma_f32_16x16x32_bf16 v[148:151], v[48:51], v[228:231], v[148:151]
    s_add_u32 m0, s12, 2688
    ds_read_b64_tr_b16 v[70:71], v57 offset:17408
    s_waitcnt vmcnt(13)
    v_mfma_f32_16x16x32_bf16 v[148:151], v[52:55], v[244:247], v[148:151]
    v_mfma_f32_16x16x32_bf16 v[152:155], v[44:47], a[252:255], v[152:155]
    v_mfma_f32_16x16x32_bf16 v[152:155], v[48:51], v[232:235], v[152:155]
    s_waitcnt vmcnt(12)
    v_mfma_f32_16x16x32_bf16 v[152:155], v[52:55], v[248:251], v[152:155]
    s_waitcnt lgkmcnt(0)
    v_mfma_f32_16x16x32_bf16 v[188:191], v[60:63], a[240:243], v[188:191]
    buffer_load_dwordx4 v10, s[40:43], s22 offen offset:384  lds
    v_mfma_f32_16x16x32_bf16 v[188:191], v[64:67], v[220:223], v[188:191]
    s_add_u32 m0, s12, 3584
    ds_read_b64_tr_b16 v[44:45], v58 offset:6144
    ds_read_b64_tr_b16 v[46:47], v58 offset:15360
    v_mfma_f32_16x16x32_bf16 v[188:191], v[68:71], v[236:239], v[188:191]
    ds_read_b64_tr_b16 v[48:49], v58 offset:7168
    ds_read_b64_tr_b16 v[50:51], v58 offset:16384
    v_mfma_f32_16x16x32_bf16 v[192:195], v[60:63], a[244:247], v[192:195]
    ds_read_b64_tr_b16 v[52:53], v58 offset:8192
    v_mul_f32 v20, v12, v140
    v_mfma_f32_16x16x32_bf16 v[192:195], v[64:67], v[224:227], v[192:195]
    buffer_load_dwordx4 v10, s[40:43], s22 offen offset:512  lds
    v_mfma_f32_16x16x32_bf16 v[192:195], v[68:71], v[240:243], v[192:195]
    s_add_u32 m0, s12, 4480
    ds_read_b64_tr_b16 v[54:55], v58 offset:17408
    v_mul_f32 v21, v12, v141
    v_mfma_f32_16x16x32_bf16 v[196:199], v[60:63], a[248:251], v[196:199]
    v_exp_f32 v20, v20
    v_mfma_f32_16x16x32_bf16 v[196:199], v[64:67], v[228:231], v[196:199]
    v_exp_f32 v21, v21
    v_mfma_f32_16x16x32_bf16 v[196:199], v[68:71], v[244:247], v[196:199]
    v_mul_f32 v22, v12, v142
    v_mul_f32 v23, v12, v143
    v_mfma_f32_16x16x32_bf16 v[200:203], v[60:63], a[252:255], v[200:203]
    v_exp_f32 v22, v22
    v_mfma_f32_16x16x32_bf16 v[200:203], v[64:67], v[232:235], v[200:203]
    buffer_load_dwordx4 v10, s[40:43], s22 offen offset:640  lds
    v_mfma_f32_16x16x32_bf16 v[200:203], v[68:71], v[248:251], v[200:203]
    s_waitcnt lgkmcnt(0)
    v_exp_f32 v23, v23
    v_mfma_f32_16x16x32_bf16 v[204:207], v[44:47], a[240:243], v[204:207]
    s_add_u32 m0, s12, 5376
    ds_read_b64_tr_b16 v[60:61], v59 offset:6144
    v_fma_f32 v20, v20, v16, v16
    v_mfma_f32_16x16x32_bf16 v[204:207], v[48:51], v[220:223], v[204:207]
    ds_read_b64_tr_b16 v[62:63], v59 offset:15360
    v_fma_f32 v21, v21, v16, v16
    v_mfma_f32_16x16x32_bf16 v[204:207], v[52:55], v[236:239], v[204:207]
    ds_read_b64_tr_b16 v[64:65], v59 offset:7168
    v_fma_f32 v22, v22, v16, v16
    v_mfma_f32_16x16x32_bf16 v[208:211], v[44:47], a[244:247], v[208:211]
    buffer_load_dwordx4 v10, s[40:43], s22 offen offset:768  lds
    ds_read_b64_tr_b16 v[66:67], v59 offset:16384
    v_mfma_f32_16x16x32_bf16 v[208:211], v[48:51], v[224:227], v[208:211]
    s_add_u32 m0, s12, 6272
    ds_read_b64_tr_b16 v[68:69], v59 offset:8192
    v_fma_f32 v23, v23, v16, v16
    v_mfma_f32_16x16x32_bf16 v[208:211], v[52:55], v[240:243], v[208:211]
    ds_read_b64_tr_b16 v[70:71], v59 offset:17408
    v_mul_f32 v24, v13, v144
    v_mfma_f32_16x16x32_bf16 v[212:215], v[44:47], a[248:251], v[212:215]
    v_rcp_f32 v20, v20
    v_mfma_f32_16x16x32_bf16 v[212:215], v[48:51], v[228:231], v[212:215]
    v_rcp_f32 v21, v21
    v_mfma_f32_16x16x32_bf16 v[212:215], v[52:55], v[244:247], v[212:215]
    buffer_load_dwordx4 v10, s[40:43], s22 offen offset:896  lds
    v_mul_f32 v140, v20, v140
    v_mfma_f32_16x16x32_bf16 v[216:219], v[44:47], a[252:255], v[216:219]
L_pad_c1_1:
    s_cbranch_execz L_pad_c1_5
    s_add_u32 m0, s12, 7168
    v_rcp_f32 v22, v22
    v_mfma_f32_16x16x32_bf16 v[216:219], v[48:51], v[232:235], v[216:219]
    v_rcp_f32 v23, v23
    v_mfma_f32_16x16x32_bf16 v[216:219], v[52:55], v[248:251], v[216:219]
    s_waitcnt lgkmcnt(0)
    v_exp_f32 v24, v24
    v_mfma_f32_16x16x32_bf16 v[172:175], v[60:63], a[240:243], v[172:175]
    s_barrier
    ds_read_b64_tr_b16 v[44:45], v56 offset:36864
    v_mul_f32 v141, v21, v141
    v_mfma_f32_16x16x32_bf16 v[172:175], v[64:67], v[220:223], v[172:175]
    buffer_load_dwordx4 v10, s[40:43], s22 offen offset:1024  lds
    ds_read_b64_tr_b16 v[46:47], v56 offset:46080
    v_mfma_f32_16x16x32_bf16 v[172:175], v[68:71], v[236:239], v[172:175]
    s_add_u32 m0, s12, 73728
    ds_read_b64_tr_b16 v[48:49], v56 offset:37888
    v_mul_f32 v142, v22, v142
    v_mfma_f32_16x16x32_bf16 v[176:179], v[60:63], a[244:247], v[176:179]
    s_mov_b64 s[40:41], s[48:49]
    ds_read_b64_tr_b16 v[50:51], v56 offset:47104
    v_mul_f32 v143, v23, v143
    v_mfma_f32_16x16x32_bf16 v[176:179], v[64:67], v[224:227], v[176:179]
    s_mul_i32 s15, s19, 9
    ds_read_b64_tr_b16 v[52:53], v56 offset:38912
    v_mul_f32 v25, v13, v145
    v_mfma_f32_16x16x32_bf16 v[176:179], v[68:71], v[240:243], v[176:179]
    s_add_u32 s15, s15, s18
    s_add_u32 s15, s15, 4096
    ds_read_b64_tr_b16 v[54:55], v56 offset:48128
    v_mfma_f32_16x16x32_bf16 v[180:183], v[60:63], a[248:251], v[180:183]
    buffer_load_dwordx4 v11, s[40:43], s15 offen  lds
    v_mul_f32 v26, v13, v146
    v_mfma_f32_16x16x32_bf16 v[180:183], v[64:67], v[228:231], v[180:183]
    s_add_u32 m0, s12, 74752
    v_exp_f32 v25, v25
    v_mfma_f32_16x16x32_bf16 v[180:183], v[68:71], v[244:247], v[180:183]
    s_add_u32 s15, s15, s19
    v_exp_f32 v26, v26
    v_mfma_f32_16x16x32_bf16 v[184:187], v[60:63], a[252:255], v[184:187]
    v_mul_f32 v27, v13, v147
    v_fma_f32 v24, v24, v17, v17
    v_mfma_f32_16x16x32_bf16 v[184:187], v[64:67], v[232:235], v[184:187]
    v_exp_f32 v27, v27
    v_mfma_f32_16x16x32_bf16 v[184:187], v[68:71], v[248:251], v[184:187]
    s_waitcnt lgkmcnt(0)
    v_rcp_f32 v24, v24
    v_mfma_f32_16x16x32_bf16 v[92:95], v[44:47], a[144:147], v[92:95]
    buffer_load_dwordx4 v11, s[40:43], s15 offen  lds
    ds_read_b64_tr_b16 v[60:61], v56 offset:39936
    v_mfma_f32_16x16x32_bf16 v[92:95], v[48:51], a[160:163], v[92:95]
    s_add_u32 m0, s12, 75776
    ds_read_b64_tr_b16 v[62:63], v56 offset:49152
    v_fma_f32 v25, v25, v17, v17
    v_mfma_f32_16x16x32_bf16 v[92:95], v[52:55], a[176:179], v[92:95]
    s_add_u32 s15, s15, s19
    ds_read_b64_tr_b16 v[64:65], v56 offset:40960
    v_fma_f32 v26, v26, v17, v17
    v_mfma_f32_16x16x32_bf16 v[96:99], v[44:47], a[148:151], v[96:99]
    ds_read_b64_tr_b16 v[66:67], v56 offset:50176
    v_fma_f32 v27, v27, v17, v17
    v_mfma_f32_16x16x32_bf16 v[96:99], v[48:51], a[164:167], v[96:99]
    ds_read_b64_tr_b16 v[68:69], v56 offset:41984
    v_mul_f32 v144, v24, v144
    v_mfma_f32_16x16x32_bf16 v[96:99], v[52:55], a[180:183], v[96:99]
    ds_read_b64_tr_b16 v[70:71], v56 offset:51200
    v_mul_f32 v28, v14, v148
    v_mfma_f32_16x16x32_bf16 v[100:103], v[44:47], a[152:155], v[100:103]
    buffer_load_dwordx4 v11, s[40:43], s15 offen  lds
    v_mul_f32 v29, v14, v149
    v_mfma_f32_16x16x32_bf16 v[100:103], v[48:51], a[168:171], v[100:103]
    s_add_u32 m0, s12, 76800
    v_rcp_f32 v25, v25
    v_mfma_f32_16x16x32_bf16 v[100:103], v[52:55], a[184:187], v[100:103]
    s_add_u32 s15, s15, s19
    v_rcp_f32 v26, v26
    v_mfma_f32_16x16x32_bf16 v[104:107], v[44:47], a[156:159], v[104:107]
    v_rcp_f32 v27, v27
    v_mfma_f32_16x16x32_bf16 v[104:107], v[48:51], a[172:175], v[104:107]
    v_exp_f32 v28, v28
    v_mfma_f32_16x16x32_bf16 v[104:107], v[52:55], a[188:191], v[104:107]
    s_waitcnt lgkmcnt(0)
    v_exp_f32 v29, v29
    v_mfma_f32_16x16x32_bf16 v[104:107], v[60:63], a[204:207], v[104:107]
    buffer_load_dwordx4 v11, s[40:43], s15 offen  lds
    ds_read_b64_tr_b16 v[44:45], v56 offset:43008
    v_mfma_f32_16x16x32_bf16 v[104:107], v[64:67], a[220:223], v[104:107]
    s_add_u32 m0, s12, 77824
    ds_read_b64_tr_b16 v[46:47], v56 offset:52224
    v_mul_f32 v145, v25, v145
    v_mfma_f32_16x16x32_bf16 v[104:107], v[68:71], a[236:239], v[104:107]
    s_add_u32 s15, s15, s19
    ds_read_b64_tr_b16 v[48:49], v56 offset:44032
    v_mul_f32 v146, v26, v146
    v_mfma_f32_16x16x32_bf16 v[100:103], v[60:63], a[200:203], v[100:103]
    ds_read_b64_tr_b16 v[50:51], v56 offset:53248
    v_mul_f32 v147, v27, v147
    v_mfma_f32_16x16x32_bf16 v[100:103], v[64:67], a[216:219], v[100:103]
    ds_read_b64_tr_b16 v[52:53], v56 offset:45056
    v_mul_f32 v30, v14, v150
    v_mfma_f32_16x16x32_bf16 v[100:103], v[68:71], a[232:235], v[100:103]
    ds_read_b64_tr_b16 v[54:55], v56 offset:54272
    v_mul_f32 v31, v14, v151
    v_mfma_f32_16x16x32_bf16 v[96:99], v[60:63], a[196:199], v[96:99]
    buffer_load_dwordx4 v11, s[40:43], s15 offen  lds
    v_fma_f32 v28, v28, v18, v18
    v_mfma_f32_16x16x32_bf16 v[96:99], v[64:67], a[212:215], v[96:99]
    s_add_u32 m0, s12, 78848
    v_exp_f32 v30, v30
    v_mfma_f32_16x16x32_bf16 v[96:99], v[68:71], a[228:231], v[96:99]
    s_add_u32 s15, s15, s19
    v_exp_f32 v31, v31
    v_mfma_f32_16x16x32_bf16 v[92:95], v[60:63], a[192:195], v[92:95]
    v_rcp_f32 v28, v28
    v_mfma_f32_16x16x32_bf16 v[92:95], v[64:67], a[208:211], v[92:95]
    v_fma_f32 v29, v29, v18, v18
    v_fma_f32 v30, v30, v18, v18
    v_mfma_f32_16x16x32_bf16 v[92:95], v[68:71], a[224:227], v[92:95]
    s_waitcnt lgkmcnt(0)
    v_rcp_f32 v29, v29
    v_mfma_f32_16x16x32_bf16 v[92:95], v[44:47], a[240:243], v[92:95]
    buffer_load_dwordx4 v11, s[40:43], s15 offen  lds
    ds_read_b64_tr_b16 v[60:61], v57 offset:36864
    v_mfma_f32_16x16x32_bf16 v[92:95], v[48:51], v[220:223], v[92:95]
    s_add_u32 m0, s12, 79872
    ds_read_b64_tr_b16 v[62:63], v57 offset:46080
    v_fma_f32 v31, v31, v18, v18
    v_mfma_f32_16x16x32_bf16 v[92:95], v[52:55], v[236:239], v[92:95]
    s_add_u32 s15, s15, s19
    ds_read_b64_tr_b16 v[64:65], v57 offset:37888
    v_mul_f32 v148, v28, v148
    v_mfma_f32_16x16x32_bf16 v[96:99], v[44:47], a[244:247], v[96:99]
    ds_read_b64_tr_b16 v[66:67], v57 offset:47104
    v_mul_f32 v149, v29, v149
    v_mfma_f32_16x16x32_bf16 v[96:99], v[48:51], v[224:227], v[96:99]
    ds_read_b64_tr_b16 v[68:69], v57 offset:38912
    v_mul_f32 v32, v15, v152
    v_mfma_f32_16x16x32_bf16 v[96:99], v[52:55], v[240:243], v[96:99]
    ds_read_b64_tr_b16 v[70:71], v57 offset:48128
    v_mul_f32 v33, v15, v153
    v_mfma_f32_16x16x32_bf16 v[100:103], v[44:47], a[248:251], v[100:103]
    buffer_load_dwordx4 v11, s[40:43], s15 offen  lds
    v_mul_f32 v34, v15, v154
    v_mfma_f32_16x16x32_bf16 v[100:103], v[48:51], v[228:231], v[100:103]
    s_add_u32 m0, s12, 80896
    v_rcp_f32 v30, v30
    v_mfma_f32_16x16x32_bf16 v[100:103], v[52:55], v[244:247], v[100:103]
    s_add_u32 s15, s15, s19
    v_rcp_f32 v31, v31
    v_mfma_f32_16x16x32_bf16 v[104:107], v[44:47], a[252:255], v[104:107]
    v_exp_f32 v32, v32
    v_mfma_f32_16x16x32_bf16 v[104:107], v[48:51], v[232:235], v[104:107]
    v_exp_f32 v33, v33
    v_mfma_f32_16x16x32_bf16 v[104:107], v[52:55], v[248:251], v[104:107]
    s_waitcnt lgkmcnt(0)
    v_exp_f32 v34, v34
    v_mfma_f32_16x16x32_bf16 v[124:127], v[60:63], a[144:147], v[124:127]
    buffer_load_dwordx4 v11, s[40:43], s15 offen  lds
    ds_read_b64_tr_b16 v[44:45], v57 offset:39936
    v_mfma_f32_16x16x32_bf16 v[124:127], v[64:67], a[160:163], v[124:127]
    s_add_u32 m0, s12, 81920
    ds_read_b64_tr_b16 v[46:47], v57 offset:49152
    v_mul_f32 v150, v30, v150
    v_mfma_f32_16x16x32_bf16 v[124:127], v[68:71], a[176:179], v[124:127]
    s_add_u32 s15, s15, s19
    ds_read_b64_tr_b16 v[48:49], v57 offset:40960
    v_mul_f32 v151, v31, v151
    v_mfma_f32_16x16x32_bf16 v[128:131], v[60:63], a[148:151], v[128:131]
    ds_read_b64_tr_b16 v[50:51], v57 offset:50176
    v_mul_f32 v35, v15, v155
    v_mfma_f32_16x16x32_bf16 v[128:131], v[64:67], a[164:167], v[128:131]
    ds_read_b64_tr_b16 v[52:53], v57 offset:41984
    v_fma_f32 v32, v32, v19, v19
    v_mfma_f32_16x16x32_bf16 v[128:131], v[68:71], a[180:183], v[128:131]
    ds_read_b64_tr_b16 v[54:55], v57 offset:51200
    v_fma_f32 v33, v33, v19, v19
    v_mfma_f32_16x16x32_bf16 v[132:135], v[60:63], a[152:155], v[132:135]
    buffer_load_dwordx4 v11, s[40:43], s15 offen  lds
    v_fma_f32 v34, v34, v19, v19
    v_mfma_f32_16x16x32_bf16 v[132:135], v[64:67], a[168:171], v[132:135]
    v_exp_f32 v35, v35
    v_mfma_f32_16x16x32_bf16 v[132:135], v[68:71], a[184:187], v[132:135]
    v_rcp_f32 v32, v32
    v_mfma_f32_16x16x32_bf16 v[136:139], v[60:63], a[156:159], v[136:139]
    v_rcp_f32 v33, v33
    v_mfma_f32_16x16x32_bf16 v[136:139], v[64:67], a[172:175], v[136:139]
    v_rcp_f32 v34, v34
    v_mfma_f32_16x16x32_bf16 v[136:139], v[68:71], a[188:191], v[136:139]
    s_waitcnt lgkmcnt(0)
    v_fma_f32 v35, v35, v19, v19
    v_mul_f32 v152, v32, v152
    v_mfma_f32_16x16x32_bf16 v[136:139], v[44:47], a[204:207], v[136:139]
    ds_read_b64_tr_b16 v[60:61], v57 offset:43008
    v_mul_f32 v153, v33, v153
    v_mfma_f32_16x16x32_bf16 v[136:139], v[48:51], a[220:223], v[136:139]
    ds_read_b64_tr_b16 v[62:63], v57 offset:52224
    v_mul_f32 v154, v34, v154
    v_mfma_f32_16x16x32_bf16 v[136:139], v[52:55], a[236:239], v[136:139]
    ds_read_b64_tr_b16 v[64:65], v57 offset:44032
    v_mul_f32 v20, v12, v188
    v_mfma_f32_16x16x32_bf16 v[132:135], v[44:47], a[200:203], v[132:135]
    ds_read_b64_tr_b16 v[66:67], v57 offset:53248
    v_mul_f32 v21, v12, v189
    v_mfma_f32_16x16x32_bf16 v[132:135], v[48:51], a[216:219], v[132:135]
    ds_read_b64_tr_b16 v[68:69], v57 offset:45056
    v_mul_f32 v22, v12, v190
    v_mfma_f32_16x16x32_bf16 v[132:135], v[52:55], a[232:235], v[132:135]
    ds_read_b64_tr_b16 v[70:71], v57 offset:54272
    v_mul_f32 v23, v12, v191
    v_mfma_f32_16x16x32_bf16 v[128:131], v[44:47], a[196:199], v[128:131]
    v_rcp_f32 v35, v35
    v_mfma_f32_16x16x32_bf16 v[128:131], v[48:51], a[212:215], v[128:131]
    v_exp_f32 v20, v20
    v_mfma_f32_16x16x32_bf16 v[128:131], v[52:55], a[228:231], v[128:131]
    v_exp_f32 v21, v21
    v_mfma_f32_16x16x32_bf16 v[124:127], v[44:47], a[192:195], v[124:127]
    v_exp_f32 v22, v22
    v_mfma_f32_16x16x32_bf16 v[124:127], v[48:51], a[208:211], v[124:127]
    v_exp_f32 v23, v23
    v_mfma_f32_16x16x32_bf16 v[124:127], v[52:55], a[224:227], v[124:127]
    s_waitcnt lgkmcnt(0)
    v_mul_f32 v155, v35, v155
    v_fma_f32 v20, v20, v16, v16
    v_mfma_f32_16x16x32_bf16 v[124:127], v[60:63], a[240:243], v[124:127]
    s_mov_b32 s17, 0
    ds_read_b64_tr_b16 v[44:45], v58 offset:36864
    v_mul_f32 v140, v140, v92
    v_mfma_f32_16x16x32_bf16 v[124:127], v[64:67], v[220:223], v[124:127]
    ds_read_b64_tr_b16 v[46:47], v58 offset:46080
    v_mul_f32 v141, v141, v93
    v_mfma_f32_16x16x32_bf16 v[124:127], v[68:71], v[236:239], v[124:127]
    ds_read_b64_tr_b16 v[48:49], v58 offset:37888
    v_mul_f32 v142, v142, v94
    v_mfma_f32_16x16x32_bf16 v[128:131], v[60:63], a[244:247], v[128:131]
    ds_read_b64_tr_b16 v[50:51], v58 offset:47104
    v_mul_f32 v143, v143, v95
    v_mfma_f32_16x16x32_bf16 v[128:131], v[64:67], v[224:227], v[128:131]
    ds_read_b64_tr_b16 v[52:53], v58 offset:38912
    v_mul_f32 v144, v144, v96
    v_mfma_f32_16x16x32_bf16 v[128:131], v[68:71], v[240:243], v[128:131]
    ds_read_b64_tr_b16 v[54:55], v58 offset:48128
    v_mul_f32 v145, v145, v97
    v_mfma_f32_16x16x32_bf16 v[132:135], v[60:63], a[248:251], v[132:135]
    v_mul_f32 v146, v146, v98
    v_mul_f32 v147, v147, v99
    v_mfma_f32_16x16x32_bf16 v[132:135], v[64:67], v[228:231], v[132:135]
    v_cvt_pk_bf16_f32 v36, v140, v141
    v_cvt_pk_bf16_f32 v37, v142, v143
    v_mfma_f32_16x16x32_bf16 v[132:135], v[68:71], v[244:247], v[132:135]
    v_cvt_pk_bf16_f32 v38, v144, v145
    v_cvt_pk_bf16_f32 v39, v146, v147
    v_mfma_f32_16x16x32_bf16 v[136:139], v[60:63], a[252:255], v[136:139]
    v_mul_f32 v148, v148, v100
    v_mul_f32 v149, v149, v101
    v_mfma_f32_16x16x32_bf16 v[136:139], v[64:67], v[232:235], v[136:139]
    v_mul_f32 v150, v150, v102
    v_mul_f32 v151, v151, v103
    v_mfma_f32_16x16x32_bf16 v[136:139], v[68:71], v[248:251], v[136:139]
    s_waitcnt lgkmcnt(0)
    v_mul_f32 v152, v152, v104
    v_mul_f32 v153, v153, v105
    v_mfma_f32_16x16x32_bf16 v[156:159], v[44:47], a[144:147], v[156:159]
    ds_read_b64_tr_b16 v[60:61], v58 offset:39936
    v_mul_f32 v154, v154, v106
    v_mfma_f32_16x16x32_bf16 v[156:159], v[48:51], a[160:163], v[156:159]
    ds_read_b64_tr_b16 v[62:63], v58 offset:49152
    v_mul_f32 v155, v155, v107
    v_mfma_f32_16x16x32_bf16 v[156:159], v[52:55], a[176:179], v[156:159]
    ds_read_b64_tr_b16 v[64:65], v58 offset:40960
    v_cvt_pk_bf16_f32 v40, v148, v149
    v_mfma_f32_16x16x32_bf16 v[160:163], v[44:47], a[148:151], v[160:163]
    ds_read_b64_tr_b16 v[66:67], v58 offset:50176
    v_cvt_pk_bf16_f32 v41, v150, v151
    v_mfma_f32_16x16x32_bf16 v[160:163], v[48:51], a[164:167], v[160:163]
    ds_read_b64_tr_b16 v[68:69], v58 offset:41984
    v_cvt_pk_bf16_f32 v42, v152, v153
    v_mfma_f32_16x16x32_bf16 v[160:163], v[52:55], a[180:183], v[160:163]
    ds_read_b64_tr_b16 v[70:71], v58 offset:51200
    v_cvt_pk_bf16_f32 v43, v154, v155
    v_mfma_f32_16x16x32_bf16 v[164:167], v[44:47], a[152:155], v[164:167]
    v_rcp_f32 v20, v20
    v_mfma_f32_16x16x32_bf16 v[164:167], v[48:51], a[168:171], v[164:167]
    v_permlane16_swap_b32 v36, v38
    v_permlane16_swap_b32 v37, v39
    v_mfma_f32_16x16x32_bf16 v[164:167], v[52:55], a[184:187], v[164:167]
    buffer_store_dwordx4 v[36:39], v7, s[8:11], s17 offen sc1
    v_permlane16_swap_b32 v40, v42
    v_mfma_f32_16x16x32_bf16 v[168:171], v[44:47], a[156:159], v[168:171]
    s_mov_b32 s17, 294912
    v_permlane16_swap_b32 v41, v43
    v_fma_f32 v21, v21, v16, v16
    v_mfma_f32_16x16x32_bf16 v[168:171], v[48:51], a[172:175], v[168:171]
    v_rcp_f32 v21, v21
    v_mfma_f32_16x16x32_bf16 v[168:171], v[52:55], a[188:191], v[168:171]
    s_waitcnt lgkmcnt(0)
    v_fma_f32 v22, v22, v16, v16
    v_fma_f32 v23, v23, v16, v16
    v_mfma_f32_16x16x32_bf16 v[168:171], v[60:63], a[204:207], v[168:171]
    buffer_store_dwordx4 v[40:43], v7, s[8:11], s17 offen sc1
    ds_read_b64_tr_b16 v[44:45], v58 offset:43008
    v_mfma_f32_16x16x32_bf16 v[168:171], v[64:67], a[220:223], v[168:171]
    ds_read_b64_tr_b16 v[46:47], v58 offset:52224
    v_mul_f32 v188, v20, v188
    v_mfma_f32_16x16x32_bf16 v[168:171], v[68:71], a[236:239], v[168:171]
    ds_read_b64_tr_b16 v[48:49], v58 offset:44032
    v_mul_f32 v189, v21, v189
    v_mfma_f32_16x16x32_bf16 v[164:167], v[60:63], a[200:203], v[164:167]
    ds_read_b64_tr_b16 v[50:51], v58 offset:53248
    v_mul_f32 v24, v13, v192
    v_mfma_f32_16x16x32_bf16 v[164:167], v[64:67], a[216:219], v[164:167]
    ds_read_b64_tr_b16 v[52:53], v58 offset:45056
    v_mul_f32 v25, v13, v193
    v_mfma_f32_16x16x32_bf16 v[164:167], v[68:71], a[232:235], v[164:167]
    ds_read_b64_tr_b16 v[54:55], v58 offset:54272
    v_mul_f32 v26, v13, v194
    v_mfma_f32_16x16x32_bf16 v[160:163], v[60:63], a[196:199], v[160:163]
    v_rcp_f32 v22, v22
    v_mfma_f32_16x16x32_bf16 v[160:163], v[64:67], a[212:215], v[160:163]
    v_rcp_f32 v23, v23
    v_mfma_f32_16x16x32_bf16 v[160:163], v[68:71], a[228:231], v[160:163]
    v_exp_f32 v24, v24
    v_mfma_f32_16x16x32_bf16 v[156:159], v[60:63], a[192:195], v[156:159]
    v_exp_f32 v25, v25
    v_mfma_f32_16x16x32_bf16 v[156:159], v[64:67], a[208:211], v[156:159]
    v_exp_f32 v26, v26
    v_mfma_f32_16x16x32_bf16 v[156:159], v[68:71], a[224:227], v[156:159]
    s_waitcnt lgkmcnt(0)
    v_mul_f32 v190, v22, v190
    v_mul_f32 v191, v23, v191
    v_mfma_f32_16x16x32_bf16 v[156:159], v[44:47], a[240:243], v[156:159]
    ds_read_b64_tr_b16 v[60:61], v59 offset:36864
    v_mul_f32 v27, v13, v195
    v_mfma_f32_16x16x32_bf16 v[156:159], v[48:51], v[220:223], v[156:159]
    ds_read_b64_tr_b16 v[62:63], v59 offset:46080
    v_fma_f32 v24, v24, v17, v17
    v_mfma_f32_16x16x32_bf16 v[156:159], v[52:55], v[236:239], v[156:159]
    ds_read_b64_tr_b16 v[64:65], v59 offset:37888
    v_fma_f32 v25, v25, v17, v17
    v_mfma_f32_16x16x32_bf16 v[160:163], v[44:47], a[244:247], v[160:163]
    ds_read_b64_tr_b16 v[66:67], v59 offset:47104
    v_fma_f32 v26, v26, v17, v17
    v_mfma_f32_16x16x32_bf16 v[160:163], v[48:51], v[224:227], v[160:163]
    ds_read_b64_tr_b16 v[68:69], v59 offset:38912
    v_mul_f32 v28, v14, v196
    v_mfma_f32_16x16x32_bf16 v[160:163], v[52:55], v[240:243], v[160:163]
    ds_read_b64_tr_b16 v[70:71], v59 offset:48128
    v_mul_f32 v29, v14, v197
    v_mfma_f32_16x16x32_bf16 v[164:167], v[44:47], a[248:251], v[164:167]
    v_exp_f32 v27, v27
    v_mfma_f32_16x16x32_bf16 v[164:167], v[48:51], v[228:231], v[164:167]
    v_rcp_f32 v24, v24
    v_mfma_f32_16x16x32_bf16 v[164:167], v[52:55], v[244:247], v[164:167]
    v_rcp_f32 v25, v25
    v_mfma_f32_16x16x32_bf16 v[168:171], v[44:47], a[252:255], v[168:171]
    v_rcp_f32 v26, v26
    v_mfma_f32_16x16x32_bf16 v[168:171], v[48:51], v[232:235], v[168:171]
    v_exp_f32 v28, v28
    v_mfma_f32_16x16x32_bf16 v[168:171], v[52:55], v[248:251], v[168:171]
    s_waitcnt lgkmcnt(0)
    v_exp_f32 v29, v29
    v_mfma_f32_16x16x32_bf16 v[108:111], v[60:63], a[144:147], v[108:111]
    ds_read_b64_tr_b16 v[44:45], v59 offset:39936
    v_fma_f32 v27, v27, v17, v17
    v_mfma_f32_16x16x32_bf16 v[108:111], v[64:67], a[160:163], v[108:111]
    ds_read_b64_tr_b16 v[46:47], v59 offset:49152
    v_mul_f32 v192, v24, v192
    v_mfma_f32_16x16x32_bf16 v[108:111], v[68:71], a[176:179], v[108:111]
    ds_read_b64_tr_b16 v[48:49], v59 offset:40960
    v_mul_f32 v193, v25, v193
    v_mfma_f32_16x16x32_bf16 v[112:115], v[60:63], a[148:151], v[112:115]
    ds_read_b64_tr_b16 v[50:51], v59 offset:50176
    v_mul_f32 v194, v26, v194
    v_mfma_f32_16x16x32_bf16 v[112:115], v[64:67], a[164:167], v[112:115]
    ds_read_b64_tr_b16 v[52:53], v59 offset:41984
    v_mul_f32 v30, v14, v198
    v_mfma_f32_16x16x32_bf16 v[112:115], v[68:71], a[180:183], v[112:115]
    ds_read_b64_tr_b16 v[54:55], v59 offset:51200
    v_mul_f32 v31, v14, v199
    v_mfma_f32_16x16x32_bf16 v[116:119], v[60:63], a[152:155], v[116:119]
    v_rcp_f32 v27, v27
    v_mfma_f32_16x16x32_bf16 v[116:119], v[64:67], a[168:171], v[116:119]
    v_exp_f32 v30, v30
    v_mfma_f32_16x16x32_bf16 v[116:119], v[68:71], a[184:187], v[116:119]
    v_exp_f32 v31, v31
    v_mfma_f32_16x16x32_bf16 v[120:123], v[60:63], a[156:159], v[120:123]
    v_mul_f32 v195, v27, v195
    v_fma_f32 v28, v28, v18, v18
    v_mfma_f32_16x16x32_bf16 v[120:123], v[64:67], a[172:175], v[120:123]
    v_rcp_f32 v28, v28
    v_mfma_f32_16x16x32_bf16 v[120:123], v[68:71], a[188:191], v[120:123]
    s_waitcnt lgkmcnt(0)
    v_fma_f32 v29, v29, v18, v18
    v_fma_f32 v30, v30, v18, v18
    v_mfma_f32_16x16x32_bf16 v[120:123], v[44:47], a[204:207], v[120:123]
    ds_read_b64_tr_b16 v[60:61], v59 offset:43008
    v_fma_f32 v31, v31, v18, v18
    v_mfma_f32_16x16x32_bf16 v[120:123], v[48:51], a[220:223], v[120:123]
    ds_read_b64_tr_b16 v[62:63], v59 offset:52224
    v_mul_f32 v196, v28, v196
    v_mfma_f32_16x16x32_bf16 v[120:123], v[52:55], a[236:239], v[120:123]
    ds_read_b64_tr_b16 v[64:65], v59 offset:44032
    v_mul_f32 v32, v15, v200
    v_mfma_f32_16x16x32_bf16 v[116:119], v[44:47], a[200:203], v[116:119]
    ds_read_b64_tr_b16 v[66:67], v59 offset:53248
    v_mul_f32 v33, v15, v201
    v_mfma_f32_16x16x32_bf16 v[116:119], v[48:51], a[216:219], v[116:119]
    ds_read_b64_tr_b16 v[68:69], v59 offset:45056
    v_mul_f32 v34, v15, v202
    v_mfma_f32_16x16x32_bf16 v[116:119], v[52:55], a[232:235], v[116:119]
    ds_read_b64_tr_b16 v[70:71], v59 offset:54272
    v_mul_f32 v35, v15, v203
    v_mfma_f32_16x16x32_bf16 v[112:115], v[44:47], a[196:199], v[112:115]
    v_rcp_f32 v29, v29
    v_mfma_f32_16x16x32_bf16 v[112:115], v[48:51], a[212:215], v[112:115]
    v_rcp_f32 v30, v30
    v_mfma_f32_16x16x32_bf16 v[112:115], v[52:55], a[228:231], v[112:115]
    v_rcp_f32 v31, v31
    v_mfma_f32_16x16x32_bf16 v[108:111], v[44:47], a[192:195], v[108:111]
    v_exp_f32 v32, v32
    v_mfma_f32_16x16x32_bf16 v[108:111], v[48:51], a[208:211], v[108:111]
    v_exp_f32 v33, v33
    v_mfma_f32_16x16x32_bf16 v[108:111], v[52:55], a[224:227], v[108:111]
    s_waitcnt lgkmcnt(0)
    v_exp_f32 v34, v34
    v_mfma_f32_16x16x32_bf16 v[108:111], v[60:63], a[240:243], v[108:111]
    s_waitcnt vmcnt(2)
    s_barrier
    s_add_u32 m0, s12, 110592
    v_mfma_f32_16x16x32_bf16 v[108:111], v[64:67], v[220:223], v[108:111]
    s_add_u32 s15, s13, 0
    v_add_u32 v56, 4294930432, v56
    ds_read_b64_tr_b16 v[44:45], v56 offset:0
    v_mfma_f32_16x16x32_bf16 v[108:111], v[68:71], v[236:239], v[108:111]
    buffer_load_dwordx4 v1, s[8:11], s15 offen offset:0 sc1 lds
    ds_read_b64_tr_b16 v[46:47], v56 offset:9216
    v_mfma_f32_16x16x32_bf16 v[112:115], v[60:63], a[244:247], v[112:115]
    ds_read_b64_tr_b16 v[48:49], v56 offset:1024
    ds_read_b64_tr_b16 v[50:51], v56 offset:10240
    v_mfma_f32_16x16x32_bf16 v[112:115], v[64:67], v[224:227], v[112:115]
    ds_read_b64_tr_b16 v[52:53], v56 offset:2048
    ds_read_b64_tr_b16 v[54:55], v56 offset:11264
    v_mfma_f32_16x16x32_bf16 v[112:115], v[68:71], v[240:243], v[112:115]
    v_or_b32 v10, s38, v1
    v_and_b32 v6, 0xffff, v9
    v_mfma_f32_16x16x32_bf16 v[116:119], v[60:63], a[248:251], v[116:119]
    ds_read_b64_tr_b16 v[72:73], v6 offset:0
    v_mul_f32 v197, v29, v197
    v_mfma_f32_16x16x32_bf16 v[116:119], v[64:67], v[228:231], v[116:119]
    buffer_load_dwordx4 v1, s[8:11], s15 offen offset:1024 sc1 lds
    ds_read_b64_tr_b16 v[74:75], v6 offset:9216
    v_mfma_f32_16x16x32_bf16 v[116:119], v[68:71], v[244:247], v[116:119]
    v_exp_f32 v35, v35
    v_mfma_f32_16x16x32_bf16 v[120:123], v[60:63], a[252:255], v[120:123]
    v_mul_f32 v198, v30, v198
    v_mul_f32 v199, v31, v199
    v_mfma_f32_16x16x32_bf16 v[120:123], v[64:67], v[232:235], v[120:123]
    v_fma_f32 v32, v32, v19, v19
    v_fma_f32 v33, v33, v19, v19
    v_mfma_f32_16x16x32_bf16 v[120:123], v[68:71], v[248:251], v[120:123]
    s_waitcnt lgkmcnt(2)
    v_rcp_f32 v32, v32
    v_mfma_f32_16x16x32_bf16 v[76:79], v[44:47], a[0:3], 0
    ds_read_b64_tr_b16 v[60:61], v56 offset:3072
    v_fma_f32 v34, v34, v19, v19
    v_mfma_f32_16x16x32_bf16 v[76:79], v[48:51], a[16:19], v[76:79]
    buffer_load_dwordx4 v1, s[8:11], s15 offen offset:2048 sc1 lds
    ds_read_b64_tr_b16 v[62:63], v56 offset:12288
    v_mfma_f32_16x16x32_bf16 v[76:79], v[52:55], a[32:35], v[76:79]
    ds_read_b64_tr_b16 v[64:65], v56 offset:4096
    v_fma_f32 v35, v35, v19, v19
    v_mfma_f32_16x16x32_bf16 v[80:83], v[44:47], a[4:7], 0
    ds_read_b64_tr_b16 v[66:67], v56 offset:13312
    v_mul_f32 v200, v32, v200
    v_mfma_f32_16x16x32_bf16 v[80:83], v[48:51], a[20:23], v[80:83]
    s_waitcnt lgkmcnt(4)
    ds_read_b64_tr_b16 v[68:69], v56 offset:5120
    v_mul_f32 v20, v12, v204
    v_mfma_f32_16x16x32_bf16 v[80:83], v[52:55], a[36:39], v[80:83]
    s_add_u32 s23, s23, s39
    ds_read_b64_tr_b16 v[70:71], v56 offset:14336
    v_mul_f32 v21, v12, v205
    v_mfma_f32_16x16x32_bf16 v[84:87], v[44:47], a[8:11], 0
    v_rcp_f32 v33, v33
    v_mfma_f32_16x16x32_bf16 v[84:87], v[48:51], a[24:27], v[84:87]
    buffer_store_dwordx4 v[72:75], v10, s[8:11], s23 offen sc1
    v_mul_f32 v201, v33, v201
    v_mfma_f32_16x16x32_bf16 v[84:87], v[52:55], a[40:43], v[84:87]
    v_rcp_f32 v34, v34
    v_mfma_f32_16x16x32_bf16 v[88:91], v[44:47], a[12:15], 0
    v_rcp_f32 v35, v35
    v_mfma_f32_16x16x32_bf16 v[88:91], v[48:51], a[28:31], v[88:91]
    v_exp_f32 v20, v20
    v_mfma_f32_16x16x32_bf16 v[88:91], v[52:55], a[44:47], v[88:91]
    s_waitcnt lgkmcnt(0)
    v_exp_f32 v21, v21
    v_mfma_f32_16x16x32_bf16 v[88:91], v[60:63], a[60:63], v[88:91]
    buffer_load_dwordx4 v1, s[8:11], s15 offen offset:3072 sc1 lds
    ds_read_b64_tr_b16 v[44:45], v56 offset:6144
    v_mfma_f32_16x16x32_bf16 v[88:91], v[64:67], a[76:79], v[88:91]
    s_add_u32 m0, s12, 114688
    ds_read_b64_tr_b16 v[46:47], v56 offset:15360
    ds_read_b64_tr_b16 v[48:49], v56 offset:7168
    v_mfma_f32_16x16x32_bf16 v[88:91], v[68:71], a[92:95], v[88:91]
    s_add_u32 s15, s13, 4096
    ds_read_b64_tr_b16 v[50:51], v56 offset:16384
    v_mul_f32 v202, v34, v202
    v_mfma_f32_16x16x32_bf16 v[84:87], v[60:63], a[56:59], v[84:87]
    ds_read_b64_tr_b16 v[52:53], v56 offset:8192
    v_mul_f32 v203, v35, v203
    v_mfma_f32_16x16x32_bf16 v[84:87], v[64:67], a[72:75], v[84:87]
    s_mov_b32 s17, 1024
    ds_read_b64_tr_b16 v[54:55], v56 offset:17408
    v_mul_f32 v188, v188, v124
    v_mfma_f32_16x16x32_bf16 v[84:87], v[68:71], a[88:91], v[84:87]
    v_and_b32 v6, 0xffff, v2
    v_mul_f32 v189, v189, v125
    v_mfma_f32_16x16x32_bf16 v[80:83], v[60:63], a[52:55], v[80:83]
    buffer_load_dwordx4 v1, s[8:11], s15 offen offset:0 sc1 lds
    ds_read_b64_tr_b16 v[72:73], v6 offset:0
    v_mfma_f32_16x16x32_bf16 v[80:83], v[64:67], a[68:71], v[80:83]
    ds_read_b64_tr_b16 v[74:75], v6 offset:9216
    v_mul_f32 v190, v190, v126
    v_mfma_f32_16x16x32_bf16 v[80:83], v[68:71], a[84:87], v[80:83]
    v_mul_f32 v191, v191, v127
    v_mul_f32 v192, v192, v128
    v_mfma_f32_16x16x32_bf16 v[76:79], v[60:63], a[48:51], v[76:79]
    v_mul_f32 v193, v193, v129
    v_mul_f32 v194, v194, v130
    v_mfma_f32_16x16x32_bf16 v[76:79], v[64:67], a[64:67], v[76:79]
    v_mul_f32 v195, v195, v131
    v_cvt_pk_bf16_f32 v36, v188, v189
    v_mfma_f32_16x16x32_bf16 v[76:79], v[68:71], a[80:83], v[76:79]
    s_waitcnt lgkmcnt(2)
    v_cvt_pk_bf16_f32 v37, v190, v191
    v_cvt_pk_bf16_f32 v38, v192, v193
    v_mfma_f32_16x16x32_bf16 v[76:79], v[44:47], a[96:99], v[76:79]
    buffer_load_dwordx4 v1, s[8:11], s15 offen offset:1024 sc1 lds
    ds_read_b64_tr_b16 v[60:61], v56 offset:36864
    v_mfma_f32_16x16x32_bf16 v[76:79], v[48:51], a[112:115], v[76:79]
    ds_read_b64_tr_b16 v[62:63], v56 offset:46080
    v_cvt_pk_bf16_f32 v39, v194, v195
    v_mfma_f32_16x16x32_bf16 v[76:79], v[52:55], a[128:131], v[76:79]
    ds_read_b64_tr_b16 v[64:65], v56 offset:37888
    v_mul_f32 v196, v196, v132
    v_mfma_f32_16x16x32_bf16 v[80:83], v[44:47], a[100:103], v[80:83]
    ds_read_b64_tr_b16 v[66:67], v56 offset:47104
    v_mul_f32 v197, v197, v133
    v_mfma_f32_16x16x32_bf16 v[80:83], v[48:51], a[116:119], v[80:83]
    s_waitcnt lgkmcnt(4)
    ds_read_b64_tr_b16 v[68:69], v56 offset:38912
    v_mul_f32 v198, v198, v134
    v_mfma_f32_16x16x32_bf16 v[80:83], v[52:55], a[132:135], v[80:83]
    s_add_u32 s23, s23, s39
    ds_read_b64_tr_b16 v[70:71], v56 offset:48128
    v_mul_f32 v199, v199, v135
    v_mfma_f32_16x16x32_bf16 v[84:87], v[44:47], a[104:107], v[84:87]
    buffer_store_dwordx4 v[72:75], v10, s[8:11], s23 offen sc1
    v_mul_f32 v200, v200, v136
    v_mfma_f32_16x16x32_bf16 v[84:87], v[48:51], a[120:123], v[84:87]
    v_mul_f32 v201, v201, v137
    v_mul_f32 v202, v202, v138
    v_mfma_f32_16x16x32_bf16 v[84:87], v[52:55], a[136:139], v[84:87]
    v_mul_f32 v203, v203, v139
    v_cvt_pk_bf16_f32 v40, v196, v197
    v_mfma_f32_16x16x32_bf16 v[88:91], v[44:47], a[108:111], v[88:91]
    v_cvt_pk_bf16_f32 v41, v198, v199
    v_cvt_pk_bf16_f32 v42, v200, v201
    v_mfma_f32_16x16x32_bf16 v[88:91], v[48:51], a[124:127], v[88:91]
    v_cvt_pk_bf16_f32 v43, v202, v203
    v_permlane16_swap_b32 v36, v38
    v_mfma_f32_16x16x32_bf16 v[88:91], v[52:55], a[140:143], v[88:91]
    s_waitcnt lgkmcnt(0)
    v_permlane16_swap_b32 v37, v39
    v_permlane16_swap_b32 v40, v42
    v_mfma_f32_16x16x32_bf16 v[88:91], v[60:63], a[156:159], v[88:91]
    buffer_store_dwordx4 v[36:39], v7, s[8:11], s17 offen sc1
    ds_read_b64_tr_b16 v[44:45], v56 offset:39936
    v_mfma_f32_16x16x32_bf16 v[88:91], v[64:67], a[172:175], v[88:91]
    s_mov_b32 s17, 295936
    ds_read_b64_tr_b16 v[46:47], v56 offset:49152
    ds_read_b64_tr_b16 v[48:49], v56 offset:40960
    v_mfma_f32_16x16x32_bf16 v[88:91], v[68:71], a[188:191], v[88:91]
    ds_read_b64_tr_b16 v[50:51], v56 offset:50176
    v_permlane16_swap_b32 v41, v43
    v_mfma_f32_16x16x32_bf16 v[84:87], v[60:63], a[152:155], v[84:87]
    ds_read_b64_tr_b16 v[52:53], v56 offset:41984
    v_mul_f32 v22, v12, v206
    v_mfma_f32_16x16x32_bf16 v[84:87], v[64:67], a[168:171], v[84:87]
    buffer_store_dwordx4 v[40:43], v7, s[8:11], s17 offen sc1
    ds_read_b64_tr_b16 v[54:55], v56 offset:51200
    v_mfma_f32_16x16x32_bf16 v[84:87], v[68:71], a[184:187], v[84:87]
    v_lshrrev_b32 v6, 16, v2
    v_mul_f32 v23, v12, v207
    v_mfma_f32_16x16x32_bf16 v[80:83], v[60:63], a[148:151], v[80:83]
    ds_read_b64_tr_b16 v[72:73], v6 offset:0
    v_fma_f32 v20, v20, v16, v16
    v_mfma_f32_16x16x32_bf16 v[80:83], v[64:67], a[164:167], v[80:83]
    ds_read_b64_tr_b16 v[74:75], v6 offset:9216
    v_fma_f32 v21, v21, v16, v16
    v_mfma_f32_16x16x32_bf16 v[80:83], v[68:71], a[180:183], v[80:83]
    v_exp_f32 v22, v22
    v_mfma_f32_16x16x32_bf16 v[76:79], v[60:63], a[144:147], v[76:79]
    buffer_load_dwordx4 v1, s[8:11], s15 offen offset:2048 sc1 lds
    v_fma_f32 v22, v22, v16, v16
    v_mfma_f32_16x16x32_bf16 v[76:79], v[64:67], a[160:163], v[76:79]
    v_exp_f32 v23, v23
    v_mfma_f32_16x16x32_bf16 v[76:79], v[68:71], a[176:179], v[76:79]
    s_waitcnt lgkmcnt(2)
    v_rcp_f32 v20, v20
    v_mfma_f32_16x16x32_bf16 v[76:79], v[44:47], a[192:195], v[76:79]
    ds_read_b64_tr_b16 v[60:61], v56 offset:43008
    v_fma_f32 v23, v23, v16, v16
    v_mfma_f32_16x16x32_bf16 v[76:79], v[48:51], a[208:211], v[76:79]
    ds_read_b64_tr_b16 v[62:63], v56 offset:52224
    v_mul_f32 v204, v20, v204
    v_mfma_f32_16x16x32_bf16 v[76:79], v[52:55], a[224:227], v[76:79]
L_pad_c1_2:
    s_cbranch_execz L_pad_c1_6
    ds_read_b64_tr_b16 v[64:65], v56 offset:44032
    v_mul_f32 v24, v13, v208
    v_mfma_f32_16x16x32_bf16 v[80:83], v[44:47], a[196:199], v[80:83]
    buffer_load_dwordx4 v1, s[8:11], s15 offen offset:3072 sc1 lds
    ds_read_b64_tr_b16 v[66:67], v56 offset:53248
    v_mfma_f32_16x16x32_bf16 v[80:83], v[48:51], a[212:215], v[80:83]
    s_waitcnt lgkmcnt(4)
    ds_read_b64_tr_b16 v[68:69], v56 offset:45056
    v_mul_f32 v25, v13, v209
    v_mfma_f32_16x16x32_bf16 v[80:83], v[52:55], a[228:231], v[80:83]
    s_add_u32 s23, s23, s39
    ds_read_b64_tr_b16 v[70:71], v56 offset:54272
    v_mul_f32 v26, v13, v210
    v_mfma_f32_16x16x32_bf16 v[84:87], v[44:47], a[200:203], v[84:87]
    s_add_u32 m0, s12, 118784
    v_rcp_f32 v21, v21
    v_mfma_f32_16x16x32_bf16 v[84:87], v[48:51], a[216:219], v[84:87]
    s_add_u32 s15, s13, 8192
    v_rcp_f32 v22, v22
    v_mfma_f32_16x16x32_bf16 v[84:87], v[52:55], a[232:235], v[84:87]
    v_rcp_f32 v23, v23
    v_mfma_f32_16x16x32_bf16 v[88:91], v[44:47], a[204:207], v[88:91]
    buffer_store_dwordx4 v[72:75], v10, s[8:11], s23 offen sc1
    v_mul_f32 v205, v21, v205
    v_mfma_f32_16x16x32_bf16 v[88:91], v[48:51], a[220:223], v[88:91]
    v_exp_f32 v24, v24
    v_mfma_f32_16x16x32_bf16 v[88:91], v[52:55], a[236:239], v[88:91]
    s_waitcnt lgkmcnt(0)
    v_exp_f32 v25, v25
    v_mfma_f32_16x16x32_bf16 v[88:91], v[60:63], a[252:255], v[88:91]
    v_add_u32 v57, 4294930432, v57
    v_mul_f32 v206, v22, v206
    v_mfma_f32_16x16x32_bf16 v[88:91], v[64:67], v[232:235], v[88:91]
    ds_read_b64_tr_b16 v[44:45], v57 offset:0
    v_mul_f32 v207, v23, v207
    v_mfma_f32_16x16x32_bf16 v[88:91], v[68:71], v[248:251], v[88:91]
    buffer_load_dwordx4 v1, s[8:11], s15 offen offset:0 sc1 lds
    ds_read_b64_tr_b16 v[46:47], v57 offset:9216
    v_mfma_f32_16x16x32_bf16 v[84:87], v[60:63], a[248:251], v[84:87]
    ds_read_b64_tr_b16 v[48:49], v57 offset:1024
    ds_read_b64_tr_b16 v[50:51], v57 offset:10240
    v_mfma_f32_16x16x32_bf16 v[84:87], v[64:67], v[228:231], v[84:87]
    ds_read_b64_tr_b16 v[52:53], v57 offset:2048
    ds_read_b64_tr_b16 v[54:55], v57 offset:11264
    v_mfma_f32_16x16x32_bf16 v[84:87], v[68:71], v[244:247], v[84:87]
    v_and_b32 v6, 0xffff, v3
    v_mul_f32 v27, v13, v211
    v_mfma_f32_16x16x32_bf16 v[80:83], v[60:63], a[244:247], v[80:83]
    ds_read_b64_tr_b16 v[72:73], v6 offset:0
    v_fma_f32 v24, v24, v17, v17
    v_mfma_f32_16x16x32_bf16 v[80:83], v[64:67], v[224:227], v[80:83]
    ds_read_b64_tr_b16 v[74:75], v6 offset:9216
    v_fma_f32 v25, v25, v17, v17
    v_mfma_f32_16x16x32_bf16 v[80:83], v[68:71], v[240:243], v[80:83]
    v_exp_f32 v26, v26
    v_mfma_f32_16x16x32_bf16 v[76:79], v[60:63], a[240:243], v[76:79]
    v_exp_f32 v27, v27
    v_mfma_f32_16x16x32_bf16 v[76:79], v[64:67], v[220:223], v[76:79]
    v_rcp_f32 v24, v24
    v_mfma_f32_16x16x32_bf16 v[76:79], v[68:71], v[236:239], v[76:79]
    s_waitcnt lgkmcnt(2)
    v_rcp_f32 v25, v25
    v_mfma_f32_16x16x32_bf16 v[140:143], v[44:47], a[0:3], 0
    ds_read_b64_tr_b16 v[60:61], v57 offset:3072
    v_fma_f32 v26, v26, v17, v17
    v_mfma_f32_16x16x32_bf16 v[140:143], v[48:51], a[16:19], v[140:143]
    ds_read_b64_tr_b16 v[62:63], v57 offset:12288
    v_fma_f32 v27, v27, v17, v17
    v_mfma_f32_16x16x32_bf16 v[140:143], v[52:55], a[32:35], v[140:143]
    ds_read_b64_tr_b16 v[64:65], v57 offset:4096
    v_mul_f32 v208, v24, v208
    v_mfma_f32_16x16x32_bf16 v[144:147], v[44:47], a[4:7], 0
    ds_read_b64_tr_b16 v[66:67], v57 offset:13312
    v_mul_f32 v209, v25, v209
    v_mfma_f32_16x16x32_bf16 v[144:147], v[48:51], a[20:23], v[144:147]
    s_waitcnt lgkmcnt(4)
    s_add_u32 s23, s23, s39
    ds_read_b64_tr_b16 v[68:69], v57 offset:5120
    v_mfma_f32_16x16x32_bf16 v[144:147], v[52:55], a[36:39], v[144:147]
    buffer_store_dwordx4 v[72:75], v10, s[8:11], s23 offen sc1
    ds_read_b64_tr_b16 v[70:71], v57 offset:14336
    v_mfma_f32_16x16x32_bf16 v[148:151], v[44:47], a[8:11], 0
    v_rcp_f32 v26, v26
    v_mfma_f32_16x16x32_bf16 v[148:151], v[48:51], a[24:27], v[148:151]
    v_rcp_f32 v27, v27
    v_mfma_f32_16x16x32_bf16 v[148:151], v[52:55], a[40:43], v[148:151]
    v_mul_f32 v210, v26, v210
    v_mul_f32 v211, v27, v211
    v_mfma_f32_16x16x32_bf16 v[152:155], v[44:47], a[12:15], 0
    v_mul_f32 v28, v14, v212
    v_mul_f32 v29, v14, v213
    v_mfma_f32_16x16x32_bf16 v[152:155], v[48:51], a[28:31], v[152:155]
    v_exp_f32 v28, v28
    v_mfma_f32_16x16x32_bf16 v[152:155], v[52:55], a[44:47], v[152:155]
    s_waitcnt lgkmcnt(0)
    v_exp_f32 v29, v29
    v_mfma_f32_16x16x32_bf16 v[152:155], v[60:63], a[60:63], v[152:155]
    ds_read_b64_tr_b16 v[44:45], v57 offset:6144
    ds_read_b64_tr_b16 v[46:47], v57 offset:15360
    v_mfma_f32_16x16x32_bf16 v[152:155], v[64:67], a[76:79], v[152:155]
    ds_read_b64_tr_b16 v[48:49], v57 offset:7168
    v_mul_f32 v30, v14, v214
    v_mfma_f32_16x16x32_bf16 v[152:155], v[68:71], a[92:95], v[152:155]
    ds_read_b64_tr_b16 v[50:51], v57 offset:16384
    v_mul_f32 v31, v14, v215
    v_mfma_f32_16x16x32_bf16 v[148:151], v[60:63], a[56:59], v[148:151]
    ds_read_b64_tr_b16 v[52:53], v57 offset:8192
    v_fma_f32 v28, v28, v18, v18
    v_mfma_f32_16x16x32_bf16 v[148:151], v[64:67], a[72:75], v[148:151]
    ds_read_b64_tr_b16 v[54:55], v57 offset:17408
    v_fma_f32 v29, v29, v18, v18
    v_mfma_f32_16x16x32_bf16 v[148:151], v[68:71], a[88:91], v[148:151]
    v_lshrrev_b32 v6, 16, v3
    v_mul_f32 v32, v15, v216
    v_mfma_f32_16x16x32_bf16 v[144:147], v[60:63], a[52:55], v[144:147]
    ds_read_b64_tr_b16 v[72:73], v6 offset:0
    v_mul_f32 v33, v15, v217
    v_mfma_f32_16x16x32_bf16 v[144:147], v[64:67], a[68:71], v[144:147]
    ds_read_b64_tr_b16 v[74:75], v6 offset:9216
    v_mul_f32 v34, v15, v218
    v_mfma_f32_16x16x32_bf16 v[144:147], v[68:71], a[84:87], v[144:147]
    v_exp_f32 v30, v30
    v_mfma_f32_16x16x32_bf16 v[140:143], v[60:63], a[48:51], v[140:143]
    v_exp_f32 v31, v31
    v_mfma_f32_16x16x32_bf16 v[140:143], v[64:67], a[64:67], v[140:143]
    v_rcp_f32 v28, v28
    v_mfma_f32_16x16x32_bf16 v[140:143], v[68:71], a[80:83], v[140:143]
    s_waitcnt lgkmcnt(2)
    v_rcp_f32 v29, v29
    v_mfma_f32_16x16x32_bf16 v[140:143], v[44:47], a[96:99], v[140:143]
    ds_read_b64_tr_b16 v[60:61], v57 offset:36864
    v_fma_f32 v30, v30, v18, v18
    v_mfma_f32_16x16x32_bf16 v[140:143], v[48:51], a[112:115], v[140:143]
    ds_read_b64_tr_b16 v[62:63], v57 offset:46080
    v_fma_f32 v31, v31, v18, v18
    v_mfma_f32_16x16x32_bf16 v[140:143], v[52:55], a[128:131], v[140:143]
    ds_read_b64_tr_b16 v[64:65], v57 offset:37888
    v_mul_f32 v212, v28, v212
    v_mfma_f32_16x16x32_bf16 v[144:147], v[44:47], a[100:103], v[144:147]
    ds_read_b64_tr_b16 v[66:67], v57 offset:47104
    v_mul_f32 v213, v29, v213
    v_mfma_f32_16x16x32_bf16 v[144:147], v[48:51], a[116:119], v[144:147]
    s_waitcnt lgkmcnt(4)
    s_add_u32 s23, s23, s39
    ds_read_b64_tr_b16 v[68:69], v57 offset:38912
    v_mfma_f32_16x16x32_bf16 v[144:147], v[52:55], a[132:135], v[144:147]
    buffer_store_dwordx4 v[72:75], v10, s[8:11], s23 offen sc1
    ds_read_b64_tr_b16 v[70:71], v57 offset:48128
    v_mfma_f32_16x16x32_bf16 v[148:151], v[44:47], a[104:107], v[148:151]
    v_rcp_f32 v30, v30
    v_mfma_f32_16x16x32_bf16 v[148:151], v[48:51], a[120:123], v[148:151]
    v_rcp_f32 v31, v31
    v_mfma_f32_16x16x32_bf16 v[148:151], v[52:55], a[136:139], v[148:151]
    v_exp_f32 v32, v32
    v_mfma_f32_16x16x32_bf16 v[152:155], v[44:47], a[108:111], v[152:155]
    v_exp_f32 v33, v33
    v_mfma_f32_16x16x32_bf16 v[152:155], v[48:51], a[124:127], v[152:155]
    v_exp_f32 v34, v34
    v_mfma_f32_16x16x32_bf16 v[152:155], v[52:55], a[140:143], v[152:155]
    s_waitcnt lgkmcnt(0)
    v_mul_f32 v214, v30, v214
    v_mul_f32 v215, v31, v215
    v_mfma_f32_16x16x32_bf16 v[152:155], v[60:63], a[156:159], v[152:155]
    ds_read_b64_tr_b16 v[44:45], v57 offset:39936
    ds_read_b64_tr_b16 v[46:47], v57 offset:49152
    v_mfma_f32_16x16x32_bf16 v[152:155], v[64:67], a[172:175], v[152:155]
    ds_read_b64_tr_b16 v[48:49], v57 offset:40960
    v_mul_f32 v35, v15, v219
    v_mfma_f32_16x16x32_bf16 v[152:155], v[68:71], a[188:191], v[152:155]
    ds_read_b64_tr_b16 v[50:51], v57 offset:50176
    v_fma_f32 v32, v32, v19, v19
    v_mfma_f32_16x16x32_bf16 v[148:151], v[60:63], a[152:155], v[148:151]
    ds_read_b64_tr_b16 v[52:53], v57 offset:41984
    v_fma_f32 v33, v33, v19, v19
    v_mfma_f32_16x16x32_bf16 v[148:151], v[64:67], a[168:171], v[148:151]
    ds_read_b64_tr_b16 v[54:55], v57 offset:51200
    v_fma_f32 v34, v34, v19, v19
    v_mfma_f32_16x16x32_bf16 v[148:151], v[68:71], a[184:187], v[148:151]
    v_and_b32 v6, 0xffff, v4
    v_mul_f32 v20, v12, v172
    v_mfma_f32_16x16x32_bf16 v[144:147], v[60:63], a[148:151], v[144:147]
    ds_read_b64_tr_b16 v[72:73], v6 offset:0
    v_mul_f32 v21, v12, v173
    v_mfma_f32_16x16x32_bf16 v[144:147], v[64:67], a[164:167], v[144:147]
    ds_read_b64_tr_b16 v[74:75], v6 offset:9216
    v_mul_f32 v22, v12, v174
    v_mfma_f32_16x16x32_bf16 v[144:147], v[68:71], a[180:183], v[144:147]
    v_exp_f32 v35, v35
    v_mfma_f32_16x16x32_bf16 v[140:143], v[60:63], a[144:147], v[140:143]
    v_rcp_f32 v32, v32
    v_mfma_f32_16x16x32_bf16 v[140:143], v[64:67], a[160:163], v[140:143]
    v_rcp_f32 v33, v33
    v_mfma_f32_16x16x32_bf16 v[140:143], v[68:71], a[176:179], v[140:143]
    s_waitcnt lgkmcnt(2)
    v_rcp_f32 v34, v34
    v_mfma_f32_16x16x32_bf16 v[140:143], v[44:47], a[192:195], v[140:143]
    ds_read_b64_tr_b16 v[60:61], v57 offset:43008
    v_fma_f32 v35, v35, v19, v19
    v_mfma_f32_16x16x32_bf16 v[140:143], v[48:51], a[208:211], v[140:143]
    ds_read_b64_tr_b16 v[62:63], v57 offset:52224
    v_mul_f32 v216, v32, v216
    v_mfma_f32_16x16x32_bf16 v[140:143], v[52:55], a[224:227], v[140:143]
    ds_read_b64_tr_b16 v[64:65], v57 offset:44032
    v_mul_f32 v217, v33, v217
    v_mfma_f32_16x16x32_bf16 v[144:147], v[44:47], a[196:199], v[144:147]
    ds_read_b64_tr_b16 v[66:67], v57 offset:53248
    v_mul_f32 v218, v34, v218
    v_mfma_f32_16x16x32_bf16 v[144:147], v[48:51], a[212:215], v[144:147]
    s_waitcnt lgkmcnt(4)
    s_add_u32 s23, s23, s39
    ds_read_b64_tr_b16 v[68:69], v57 offset:45056
    v_mfma_f32_16x16x32_bf16 v[144:147], v[52:55], a[228:231], v[144:147]
    buffer_store_dwordx4 v[72:75], v10, s[8:11], s23 offen sc1
    ds_read_b64_tr_b16 v[70:71], v57 offset:54272
    v_mfma_f32_16x16x32_bf16 v[148:151], v[44:47], a[200:203], v[148:151]
    v_rcp_f32 v35, v35
    v_mfma_f32_16x16x32_bf16 v[148:151], v[48:51], a[216:219], v[148:151]
    v_exp_f32 v20, v20
    v_mfma_f32_16x16x32_bf16 v[148:151], v[52:55], a[232:235], v[148:151]
    v_exp_f32 v21, v21
    v_mfma_f32_16x16x32_bf16 v[152:155], v[44:47], a[204:207], v[152:155]
    v_exp_f32 v22, v22
    v_mfma_f32_16x16x32_bf16 v[152:155], v[48:51], a[220:223], v[152:155]
    v_mul_f32 v219, v35, v219
    v_mul_f32 v23, v12, v175
    v_mfma_f32_16x16x32_bf16 v[152:155], v[52:55], a[236:239], v[152:155]
    s_waitcnt lgkmcnt(0)
    v_mul_f32 v204, v204, v156
    v_mul_f32 v205, v205, v157
    v_mfma_f32_16x16x32_bf16 v[152:155], v[60:63], a[252:255], v[152:155]
    s_mov_b32 s17, 2048
    v_add_u32 v58, 4294930432, v58
    ds_read_b64_tr_b16 v[44:45], v58 offset:0
    v_mfma_f32_16x16x32_bf16 v[152:155], v[64:67], v[232:235], v[152:155]
    ds_read_b64_tr_b16 v[46:47], v58 offset:9216
    ds_read_b64_tr_b16 v[48:49], v58 offset:1024
    v_mfma_f32_16x16x32_bf16 v[152:155], v[68:71], v[248:251], v[152:155]
    ds_read_b64_tr_b16 v[50:51], v58 offset:10240
    v_mul_f32 v206, v206, v158
    v_mfma_f32_16x16x32_bf16 v[148:151], v[60:63], a[248:251], v[148:151]
    ds_read_b64_tr_b16 v[52:53], v58 offset:2048
    v_mul_f32 v207, v207, v159
    v_mfma_f32_16x16x32_bf16 v[148:151], v[64:67], v[228:231], v[148:151]
    ds_read_b64_tr_b16 v[54:55], v58 offset:11264
    v_mul_f32 v208, v208, v160
    v_mfma_f32_16x16x32_bf16 v[148:151], v[68:71], v[244:247], v[148:151]
    v_lshrrev_b32 v6, 16, v4
    v_mul_f32 v209, v209, v161
    v_mfma_f32_16x16x32_bf16 v[144:147], v[60:63], a[244:247], v[144:147]
    ds_read_b64_tr_b16 v[72:73], v6 offset:0
    v_mul_f32 v210, v210, v162
    v_mfma_f32_16x16x32_bf16 v[144:147], v[64:67], v[224:227], v[144:147]
    ds_read_b64_tr_b16 v[74:75], v6 offset:9216
    v_mul_f32 v211, v211, v163
    v_mfma_f32_16x16x32_bf16 v[144:147], v[68:71], v[240:243], v[144:147]
    v_cvt_pk_bf16_f32 v36, v204, v205
    v_cvt_pk_bf16_f32 v37, v206, v207
    v_mfma_f32_16x16x32_bf16 v[140:143], v[60:63], a[240:243], v[140:143]
    v_cvt_pk_bf16_f32 v38, v208, v209
    v_cvt_pk_bf16_f32 v39, v210, v211
    v_mfma_f32_16x16x32_bf16 v[140:143], v[64:67], v[220:223], v[140:143]
    v_exp_f32 v23, v23
    v_mfma_f32_16x16x32_bf16 v[140:143], v[68:71], v[236:239], v[140:143]
    s_waitcnt lgkmcnt(2)
    v_mul_f32 v212, v212, v164
    v_mul_f32 v213, v213, v165
    v_mfma_f32_16x16x32_bf16 v[92:95], v[44:47], a[0:3], 0
    ds_read_b64_tr_b16 v[60:61], v58 offset:3072
    v_mul_f32 v214, v214, v166
    v_mfma_f32_16x16x32_bf16 v[92:95], v[48:51], a[16:19], v[92:95]
    ds_read_b64_tr_b16 v[62:63], v58 offset:12288
    v_mul_f32 v215, v215, v167
    v_mfma_f32_16x16x32_bf16 v[92:95], v[52:55], a[32:35], v[92:95]
    ds_read_b64_tr_b16 v[64:65], v58 offset:4096
    v_mul_f32 v216, v216, v168
    v_mfma_f32_16x16x32_bf16 v[96:99], v[44:47], a[4:7], 0
    ds_read_b64_tr_b16 v[66:67], v58 offset:13312
    v_mul_f32 v217, v217, v169
    v_mfma_f32_16x16x32_bf16 v[96:99], v[48:51], a[20:23], v[96:99]
    s_waitcnt lgkmcnt(4)
    s_add_u32 s23, s23, s39
    ds_read_b64_tr_b16 v[68:69], v58 offset:5120
    v_mfma_f32_16x16x32_bf16 v[96:99], v[52:55], a[36:39], v[96:99]
    buffer_store_dwordx4 v[72:75], v10, s[8:11], s23 offen sc1
    ds_read_b64_tr_b16 v[70:71], v58 offset:14336
    v_mfma_f32_16x16x32_bf16 v[100:103], v[44:47], a[8:11], 0
    v_mul_f32 v218, v218, v170
    v_mul_f32 v219, v219, v171
    v_mfma_f32_16x16x32_bf16 v[100:103], v[48:51], a[24:27], v[100:103]
    v_cvt_pk_bf16_f32 v40, v212, v213
    v_cvt_pk_bf16_f32 v41, v214, v215
    v_mfma_f32_16x16x32_bf16 v[100:103], v[52:55], a[40:43], v[100:103]
    v_cvt_pk_bf16_f32 v42, v216, v217
    v_cvt_pk_bf16_f32 v43, v218, v219
    v_mfma_f32_16x16x32_bf16 v[104:107], v[44:47], a[12:15], 0
    v_permlane16_swap_b32 v36, v38
    v_permlane16_swap_b32 v37, v39
    v_mfma_f32_16x16x32_bf16 v[104:107], v[48:51], a[28:31], v[104:107]
    buffer_store_dwordx4 v[36:39], v7, s[8:11], s17 offen sc1
    v_permlane16_swap_b32 v40, v42
    v_mfma_f32_16x16x32_bf16 v[104:107], v[52:55], a[44:47], v[104:107]
    s_waitcnt lgkmcnt(0)
    v_permlane16_swap_b32 v41, v43
    v_fma_f32 v20, v20, v16, v16
    v_mfma_f32_16x16x32_bf16 v[104:107], v[60:63], a[60:63], v[104:107]
    s_mov_b32 s17, 296960
    ds_read_b64_tr_b16 v[44:45], v58 offset:6144
    ds_read_b64_tr_b16 v[46:47], v58 offset:15360
    v_mfma_f32_16x16x32_bf16 v[104:107], v[64:67], a[76:79], v[104:107]
    ds_read_b64_tr_b16 v[48:49], v58 offset:7168
    v_fma_f32 v21, v21, v16, v16
    v_mfma_f32_16x16x32_bf16 v[104:107], v[68:71], a[92:95], v[104:107]
    buffer_store_dwordx4 v[40:43], v7, s[8:11], s17 offen sc1
    ds_read_b64_tr_b16 v[50:51], v58 offset:16384
    v_mfma_f32_16x16x32_bf16 v[100:103], v[60:63], a[56:59], v[100:103]
    ds_read_b64_tr_b16 v[52:53], v58 offset:8192
    v_fma_f32 v22, v22, v16, v16
    v_mfma_f32_16x16x32_bf16 v[100:103], v[64:67], a[72:75], v[100:103]
    ds_read_b64_tr_b16 v[54:55], v58 offset:17408
    v_fma_f32 v23, v23, v16, v16
    v_mfma_f32_16x16x32_bf16 v[100:103], v[68:71], a[88:91], v[100:103]
    v_and_b32 v6, 0xffff, v5
    v_mul_f32 v24, v13, v176
    v_mfma_f32_16x16x32_bf16 v[96:99], v[60:63], a[52:55], v[96:99]
    ds_read_b64_tr_b16 v[72:73], v6 offset:0
    v_mul_f32 v25, v13, v177
    v_mfma_f32_16x16x32_bf16 v[96:99], v[64:67], a[68:71], v[96:99]
    ds_read_b64_tr_b16 v[74:75], v6 offset:9216
    v_mul_f32 v26, v13, v178
    v_mfma_f32_16x16x32_bf16 v[96:99], v[68:71], a[84:87], v[96:99]
    v_rcp_f32 v20, v20
    v_mfma_f32_16x16x32_bf16 v[92:95], v[60:63], a[48:51], v[92:95]
    v_rcp_f32 v21, v21
    v_mfma_f32_16x16x32_bf16 v[92:95], v[64:67], a[64:67], v[92:95]
    v_rcp_f32 v22, v22
    v_mfma_f32_16x16x32_bf16 v[92:95], v[68:71], a[80:83], v[92:95]
    s_waitcnt lgkmcnt(2)
    v_rcp_f32 v23, v23
    v_mfma_f32_16x16x32_bf16 v[92:95], v[44:47], a[96:99], v[92:95]
    ds_read_b64_tr_b16 v[60:61], v58 offset:36864
    v_mul_f32 v172, v20, v172
    v_mfma_f32_16x16x32_bf16 v[92:95], v[48:51], a[112:115], v[92:95]
    ds_read_b64_tr_b16 v[62:63], v58 offset:46080
    v_mul_f32 v173, v21, v173
    v_mfma_f32_16x16x32_bf16 v[92:95], v[52:55], a[128:131], v[92:95]
    ds_read_b64_tr_b16 v[64:65], v58 offset:37888
    v_mul_f32 v174, v22, v174
    v_mfma_f32_16x16x32_bf16 v[96:99], v[44:47], a[100:103], v[96:99]
    ds_read_b64_tr_b16 v[66:67], v58 offset:47104
    v_mul_f32 v175, v23, v175
    v_mfma_f32_16x16x32_bf16 v[96:99], v[48:51], a[116:119], v[96:99]
    s_waitcnt lgkmcnt(4)
    s_add_u32 s23, s23, s39
    ds_read_b64_tr_b16 v[68:69], v58 offset:38912
    v_mfma_f32_16x16x32_bf16 v[96:99], v[52:55], a[132:135], v[96:99]
    buffer_store_dwordx4 v[72:75], v10, s[8:11], s23 offen sc1
    ds_read_b64_tr_b16 v[70:71], v58 offset:48128
    v_mfma_f32_16x16x32_bf16 v[100:103], v[44:47], a[104:107], v[100:103]
    v_exp_f32 v24, v24
    v_mfma_f32_16x16x32_bf16 v[100:103], v[48:51], a[120:123], v[100:103]
    v_exp_f32 v25, v25
    v_mfma_f32_16x16x32_bf16 v[100:103], v[52:55], a[136:139], v[100:103]
    v_exp_f32 v26, v26
    v_mfma_f32_16x16x32_bf16 v[104:107], v[44:47], a[108:111], v[104:107]
    v_mul_f32 v27, v13, v179
    v_fma_f32 v24, v24, v17, v17
    v_mfma_f32_16x16x32_bf16 v[104:107], v[48:51], a[124:127], v[104:107]
    v_exp_f32 v27, v27
    v_mfma_f32_16x16x32_bf16 v[104:107], v[52:55], a[140:143], v[104:107]
    s_waitcnt lgkmcnt(0)
    v_rcp_f32 v24, v24
    v_mfma_f32_16x16x32_bf16 v[104:107], v[60:63], a[156:159], v[104:107]
    ds_read_b64_tr_b16 v[44:45], v58 offset:39936
    ds_read_b64_tr_b16 v[46:47], v58 offset:49152
    v_mfma_f32_16x16x32_bf16 v[104:107], v[64:67], a[172:175], v[104:107]
    ds_read_b64_tr_b16 v[48:49], v58 offset:40960
    v_fma_f32 v25, v25, v17, v17
    v_mfma_f32_16x16x32_bf16 v[104:107], v[68:71], a[188:191], v[104:107]
    ds_read_b64_tr_b16 v[50:51], v58 offset:50176
    v_fma_f32 v26, v26, v17, v17
    v_mfma_f32_16x16x32_bf16 v[100:103], v[60:63], a[152:155], v[100:103]
    ds_read_b64_tr_b16 v[52:53], v58 offset:41984
    v_fma_f32 v27, v27, v17, v17
    v_mfma_f32_16x16x32_bf16 v[100:103], v[64:67], a[168:171], v[100:103]
    ds_read_b64_tr_b16 v[54:55], v58 offset:51200
    v_mul_f32 v176, v24, v176
    v_mfma_f32_16x16x32_bf16 v[100:103], v[68:71], a[184:187], v[100:103]
    v_lshrrev_b32 v6, 16, v5
    v_mul_f32 v28, v14, v180
    v_mfma_f32_16x16x32_bf16 v[96:99], v[60:63], a[148:151], v[96:99]
    ds_read_b64_tr_b16 v[72:73], v6 offset:0
    v_mul_f32 v29, v14, v181
    v_mfma_f32_16x16x32_bf16 v[96:99], v[64:67], a[164:167], v[96:99]
    ds_read_b64_tr_b16 v[74:75], v6 offset:9216
    v_mul_f32 v30, v14, v182
    v_mfma_f32_16x16x32_bf16 v[96:99], v[68:71], a[180:183], v[96:99]
    v_rcp_f32 v25, v25
    v_mfma_f32_16x16x32_bf16 v[92:95], v[60:63], a[144:147], v[92:95]
    v_rcp_f32 v26, v26
    v_mfma_f32_16x16x32_bf16 v[92:95], v[64:67], a[160:163], v[92:95]
    v_rcp_f32 v27, v27
    v_mfma_f32_16x16x32_bf16 v[92:95], v[68:71], a[176:179], v[92:95]
    s_waitcnt lgkmcnt(2)
    v_exp_f32 v28, v28
    v_mfma_f32_16x16x32_bf16 v[92:95], v[44:47], a[192:195], v[92:95]
    ds_read_b64_tr_b16 v[60:61], v58 offset:43008
    v_mul_f32 v177, v25, v177
    v_mfma_f32_16x16x32_bf16 v[92:95], v[48:51], a[208:211], v[92:95]
    ds_read_b64_tr_b16 v[62:63], v58 offset:52224
    v_mul_f32 v178, v26, v178
    v_mfma_f32_16x16x32_bf16 v[92:95], v[52:55], a[224:227], v[92:95]
    ds_read_b64_tr_b16 v[64:65], v58 offset:44032
    v_mul_f32 v179, v27, v179
    v_mfma_f32_16x16x32_bf16 v[96:99], v[44:47], a[196:199], v[96:99]
    ds_read_b64_tr_b16 v[66:67], v58 offset:53248
    v_mul_f32 v31, v14, v183
    v_mfma_f32_16x16x32_bf16 v[96:99], v[48:51], a[212:215], v[96:99]
    s_waitcnt lgkmcnt(4)
    s_add_u32 s23, s23, s39
    ds_read_b64_tr_b16 v[68:69], v58 offset:45056
    v_mfma_f32_16x16x32_bf16 v[96:99], v[52:55], a[228:231], v[96:99]
    buffer_store_dwordx4 v[72:75], v10, s[8:11], s23 offen sc1
    ds_read_b64_tr_b16 v[70:71], v58 offset:54272
    v_mfma_f32_16x16x32_bf16 v[100:103], v[44:47], a[200:203], v[100:103]
    v_exp_f32 v29, v29
    v_mfma_f32_16x16x32_bf16 v[100:103], v[48:51], a[216:219], v[100:103]
    v_exp_f32 v30, v30
    v_mfma_f32_16x16x32_bf16 v[100:103], v[52:55], a[232:235], v[100:103]
    v_exp_f32 v31, v31
    v_mfma_f32_16x16x32_bf16 v[104:107], v[44:47], a[204:207], v[104:107]
    v_fma_f32 v28, v28, v18, v18
    v_fma_f32 v29, v29, v18, v18
    v_mfma_f32_16x16x32_bf16 v[104:107], v[48:51], a[220:223], v[104:107]
    v_rcp_f32 v28, v28
    v_mfma_f32_16x16x32_bf16 v[104:107], v[52:55], a[236:239], v[104:107]
    s_waitcnt lgkmcnt(0)
    v_rcp_f32 v29, v29
    v_mfma_f32_16x16x32_bf16 v[104:107], v[60:63], a[252:255], v[104:107]
    v_add_u32 v59, 4294930432, v59
    v_fma_f32 v30, v30, v18, v18
    v_mfma_f32_16x16x32_bf16 v[104:107], v[64:67], v[232:235], v[104:107]
    ds_read_b64_tr_b16 v[44:45], v59 offset:0
    v_fma_f32 v31, v31, v18, v18
    v_mfma_f32_16x16x32_bf16 v[104:107], v[68:71], v[248:251], v[104:107]
    ds_read_b64_tr_b16 v[46:47], v59 offset:9216
    v_mul_f32 v180, v28, v180
    v_mfma_f32_16x16x32_bf16 v[100:103], v[60:63], a[248:251], v[100:103]
    ds_read_b64_tr_b16 v[48:49], v59 offset:1024
    v_mul_f32 v181, v29, v181
    v_mfma_f32_16x16x32_bf16 v[100:103], v[64:67], v[228:231], v[100:103]
    ds_read_b64_tr_b16 v[50:51], v59 offset:10240
    v_mul_f32 v32, v15, v184
    v_mfma_f32_16x16x32_bf16 v[100:103], v[68:71], v[244:247], v[100:103]
    ds_read_b64_tr_b16 v[52:53], v59 offset:2048
    v_mul_f32 v33, v15, v185
    v_mfma_f32_16x16x32_bf16 v[96:99], v[60:63], a[244:247], v[96:99]
    ds_read_b64_tr_b16 v[54:55], v59 offset:11264
    v_mul_f32 v34, v15, v186
    v_mfma_f32_16x16x32_bf16 v[96:99], v[64:67], v[224:227], v[96:99]
    v_rcp_f32 v30, v30
    v_mfma_f32_16x16x32_bf16 v[96:99], v[68:71], v[240:243], v[96:99]
    v_rcp_f32 v31, v31
    v_mfma_f32_16x16x32_bf16 v[92:95], v[60:63], a[240:243], v[92:95]
    v_exp_f32 v32, v32
    v_mfma_f32_16x16x32_bf16 v[92:95], v[64:67], v[220:223], v[92:95]
    v_exp_f32 v33, v33
    v_mfma_f32_16x16x32_bf16 v[92:95], v[68:71], v[236:239], v[92:95]
    s_waitcnt lgkmcnt(0)
    v_exp_f32 v34, v34
    v_mfma_f32_16x16x32_bf16 v[188:191], v[44:47], a[0:3], 0
    ds_read_b64_tr_b16 v[60:61], v59 offset:3072
    v_mul_f32 v182, v30, v182
    v_mfma_f32_16x16x32_bf16 v[188:191], v[48:51], a[16:19], v[188:191]
    ds_read_b64_tr_b16 v[62:63], v59 offset:12288
    v_mul_f32 v183, v31, v183
    v_mfma_f32_16x16x32_bf16 v[188:191], v[52:55], a[32:35], v[188:191]
    v_mov_b32 v255, 1
    ds_read_b64_tr_b16 v[64:65], v59 offset:4096
    v_mfma_f32_16x16x32_bf16 v[192:195], v[44:47], a[4:7], 0
    ds_read_b64_tr_b16 v[66:67], v59 offset:13312
    v_mul_f32 v35, v15, v187
    v_mfma_f32_16x16x32_bf16 v[192:195], v[48:51], a[20:23], v[192:195]
    s_waitcnt vmcnt(2)
    ds_read_b64_tr_b16 v[68:69], v59 offset:5120
    v_fma_f32 v32, v32, v19, v19
    v_mfma_f32_16x16x32_bf16 v[192:195], v[52:55], a[36:39], v[192:195]
    buffer_store_dword v255, v252, s[8:11], 0 offen sc1
    ds_read_b64_tr_b16 v[70:71], v59 offset:14336
    v_mfma_f32_16x16x32_bf16 v[196:199], v[44:47], a[8:11], 0
    v_exp_f32 v35, v35
    v_mfma_f32_16x16x32_bf16 v[196:199], v[48:51], a[24:27], v[196:199]
    v_rcp_f32 v32, v32
    v_mfma_f32_16x16x32_bf16 v[196:199], v[52:55], a[40:43], v[196:199]
    v_fma_f32 v33, v33, v19, v19
    v_fma_f32 v34, v34, v19, v19
    v_mfma_f32_16x16x32_bf16 v[200:203], v[44:47], a[12:15], 0
    v_rcp_f32 v33, v33
    v_mfma_f32_16x16x32_bf16 v[200:203], v[48:51], a[28:31], v[200:203]
    v_rcp_f32 v34, v34
    v_mfma_f32_16x16x32_bf16 v[200:203], v[52:55], a[44:47], v[200:203]
    s_waitcnt lgkmcnt(0)
    v_fma_f32 v35, v35, v19, v19
    v_mul_f32 v184, v32, v184
    v_mfma_f32_16x16x32_bf16 v[200:203], v[60:63], a[60:63], v[200:203]
    ds_read_b64_tr_b16 v[44:45], v59 offset:6144
    v_mul_f32 v185, v33, v185
    v_mfma_f32_16x16x32_bf16 v[200:203], v[64:67], a[76:79], v[200:203]
    ds_read_b64_tr_b16 v[46:47], v59 offset:15360
    v_mul_f32 v186, v34, v186
    v_mfma_f32_16x16x32_bf16 v[200:203], v[68:71], a[92:95], v[200:203]
    ds_read_b64_tr_b16 v[48:49], v59 offset:7168
    v_mul_f32 v20, v12, v76
    v_mfma_f32_16x16x32_bf16 v[196:199], v[60:63], a[56:59], v[196:199]
    ds_read_b64_tr_b16 v[50:51], v59 offset:16384
    v_mul_f32 v21, v12, v77
    v_mfma_f32_16x16x32_bf16 v[196:199], v[64:67], a[72:75], v[196:199]
    ds_read_b64_tr_b16 v[52:53], v59 offset:8192
    v_mul_f32 v22, v12, v78
    v_mfma_f32_16x16x32_bf16 v[196:199], v[68:71], a[88:91], v[196:199]
    ds_read_b64_tr_b16 v[54:55], v59 offset:17408
    v_mul_f32 v23, v12, v79
    v_mfma_f32_16x16x32_bf16 v[192:195], v[60:63], a[52:55], v[192:195]
    v_rcp_f32 v35, v35
    v_mfma_f32_16x16x32_bf16 v[192:195], v[64:67], a[68:71], v[192:195]
    v_exp_f32 v20, v20
    v_mfma_f32_16x16x32_bf16 v[192:195], v[68:71], a[84:87], v[192:195]
    v_exp_f32 v21, v21
    v_mfma_f32_16x16x32_bf16 v[188:191], v[60:63], a[48:51], v[188:191]
    v_exp_f32 v22, v22
    v_mfma_f32_16x16x32_bf16 v[188:191], v[64:67], a[64:67], v[188:191]
    v_exp_f32 v23, v23
    v_mfma_f32_16x16x32_bf16 v[188:191], v[68:71], a[80:83], v[188:191]
    s_waitcnt lgkmcnt(0)
    v_mul_f32 v187, v35, v187
    v_fma_f32 v20, v20, v16, v16
    v_mfma_f32_16x16x32_bf16 v[188:191], v[44:47], a[96:99], v[188:191]
    s_mov_b32 s17, 3072
    ds_read_b64_tr_b16 v[60:61], v59 offset:36864
    v_mul_f32 v172, v172, v108
    v_mfma_f32_16x16x32_bf16 v[188:191], v[48:51], a[112:115], v[188:191]
    ds_read_b64_tr_b16 v[62:63], v59 offset:46080
    v_mul_f32 v173, v173, v109
    v_mfma_f32_16x16x32_bf16 v[188:191], v[52:55], a[128:131], v[188:191]
    ds_read_b64_tr_b16 v[64:65], v59 offset:37888
    v_mul_f32 v174, v174, v110
    v_mfma_f32_16x16x32_bf16 v[192:195], v[44:47], a[100:103], v[192:195]
    ds_read_b64_tr_b16 v[66:67], v59 offset:47104
    v_mul_f32 v175, v175, v111
    v_mfma_f32_16x16x32_bf16 v[192:195], v[48:51], a[116:119], v[192:195]
    ds_read_b64_tr_b16 v[68:69], v59 offset:38912
    v_mul_f32 v176, v176, v112
    v_mfma_f32_16x16x32_bf16 v[192:195], v[52:55], a[132:135], v[192:195]
    ds_read_b64_tr_b16 v[70:71], v59 offset:48128
    v_mul_f32 v177, v177, v113
    v_mfma_f32_16x16x32_bf16 v[196:199], v[44:47], a[104:107], v[196:199]
    v_mul_f32 v178, v178, v114
    v_mul_f32 v179, v179, v115
    v_mfma_f32_16x16x32_bf16 v[196:199], v[48:51], a[120:123], v[196:199]
    v_cvt_pk_bf16_f32 v36, v172, v173
    v_cvt_pk_bf16_f32 v37, v174, v175
    v_mfma_f32_16x16x32_bf16 v[196:199], v[52:55], a[136:139], v[196:199]
    v_cvt_pk_bf16_f32 v38, v176, v177
    v_cvt_pk_bf16_f32 v39, v178, v179
    v_mfma_f32_16x16x32_bf16 v[200:203], v[44:47], a[108:111], v[200:203]
    v_mul_f32 v180, v180, v116
    v_mul_f32 v181, v181, v117
    v_mfma_f32_16x16x32_bf16 v[200:203], v[48:51], a[124:127], v[200:203]
    v_mul_f32 v182, v182, v118
    v_mul_f32 v183, v183, v119
    v_mfma_f32_16x16x32_bf16 v[200:203], v[52:55], a[140:143], v[200:203]
    s_waitcnt lgkmcnt(0)
    v_mul_f32 v184, v184, v120
    v_mul_f32 v185, v185, v121
    v_mfma_f32_16x16x32_bf16 v[200:203], v[60:63], a[156:159], v[200:203]
    ds_read_b64_tr_b16 v[44:45], v59 offset:39936
    v_mul_f32 v186, v186, v122
    v_mfma_f32_16x16x32_bf16 v[200:203], v[64:67], a[172:175], v[200:203]
    ds_read_b64_tr_b16 v[46:47], v59 offset:49152
    v_mul_f32 v187, v187, v123
    v_mfma_f32_16x16x32_bf16 v[200:203], v[68:71], a[188:191], v[200:203]
    ds_read_b64_tr_b16 v[48:49], v59 offset:40960
    v_cvt_pk_bf16_f32 v40, v180, v181
    v_mfma_f32_16x16x32_bf16 v[196:199], v[60:63], a[152:155], v[196:199]
    ds_read_b64_tr_b16 v[50:51], v59 offset:50176
    v_cvt_pk_bf16_f32 v41, v182, v183
    v_mfma_f32_16x16x32_bf16 v[196:199], v[64:67], a[168:171], v[196:199]
    ds_read_b64_tr_b16 v[52:53], v59 offset:41984
    v_cvt_pk_bf16_f32 v42, v184, v185
    v_mfma_f32_16x16x32_bf16 v[196:199], v[68:71], a[184:187], v[196:199]
    s_waitcnt vmcnt(1)
    ds_read_b64_tr_b16 v[54:55], v59 offset:51200
    v_cvt_pk_bf16_f32 v43, v186, v187
    v_mfma_f32_16x16x32_bf16 v[192:195], v[60:63], a[148:151], v[192:195]
    buffer_store_dword v252, v252, s[8:11], s44 offen sc1
    v_permlane16_swap_b32 v36, v38
    v_mfma_f32_16x16x32_bf16 v[192:195], v[64:67], a[164:167], v[192:195]
    v_permlane16_swap_b32 v37, v39
    v_permlane16_swap_b32 v40, v42
    v_mfma_f32_16x16x32_bf16 v[192:195], v[68:71], a[180:183], v[192:195]
    buffer_store_dwordx4 v[36:39], v7, s[8:11], s17 offen sc1
    v_permlane16_swap_b32 v41, v43
    v_mfma_f32_16x16x32_bf16 v[188:191], v[60:63], a[144:147], v[188:191]
    s_mov_b32 s17, 297984
    v_rcp_f32 v20, v20
    v_mfma_f32_16x16x32_bf16 v[188:191], v[64:67], a[160:163], v[188:191]
    v_add_u32 v2, 0, v1
    v_add_u32 v3, 36864, v1
    v_mfma_f32_16x16x32_bf16 v[188:191], v[68:71], a[176:179], v[188:191]
    s_waitcnt lgkmcnt(0)
    v_add_u32 v4, 73728, v1
    v_add_u32 v5, 110592, v1
    v_mfma_f32_16x16x32_bf16 v[188:191], v[44:47], a[192:195], v[188:191]
    buffer_store_dwordx4 v[40:43], v7, s[8:11], s17 offen sc1
    ds_read_b64_tr_b16 v[60:61], v59 offset:43008
    v_mfma_f32_16x16x32_bf16 v[188:191], v[48:51], a[208:211], v[188:191]
L_pad_c1_3:
    s_cbranch_execz L_pad_c1_7
    ds_read_b64_tr_b16 v[62:63], v59 offset:52224
    v_fma_f32 v21, v21, v16, v16
    v_mfma_f32_16x16x32_bf16 v[188:191], v[52:55], a[224:227], v[188:191]
    ds_read_b64_tr_b16 v[64:65], v59 offset:44032
    v_fma_f32 v22, v22, v16, v16
    v_mfma_f32_16x16x32_bf16 v[192:195], v[44:47], a[196:199], v[192:195]
    ds_read_b64_tr_b16 v[66:67], v59 offset:53248
    v_fma_f32 v23, v23, v16, v16
    v_mfma_f32_16x16x32_bf16 v[192:195], v[48:51], a[212:215], v[192:195]
    ds_read_b64_tr_b16 v[68:69], v59 offset:45056
    v_mul_f32 v76, v20, v76
    v_mfma_f32_16x16x32_bf16 v[192:195], v[52:55], a[228:231], v[192:195]
    ds_read_b64_tr_b16 v[70:71], v59 offset:54272
    v_mul_f32 v24, v13, v80
    v_mfma_f32_16x16x32_bf16 v[196:199], v[44:47], a[200:203], v[196:199]
    v_rcp_f32 v21, v21
    v_mfma_f32_16x16x32_bf16 v[196:199], v[48:51], a[216:219], v[196:199]
    v_rcp_f32 v22, v22
    v_mfma_f32_16x16x32_bf16 v[196:199], v[52:55], a[232:235], v[196:199]
    v_rcp_f32 v23, v23
    v_mfma_f32_16x16x32_bf16 v[200:203], v[44:47], a[204:207], v[200:203]
    v_exp_f32 v24, v24
    v_mfma_f32_16x16x32_bf16 v[200:203], v[48:51], a[220:223], v[200:203]
    v_mul_f32 v77, v21, v77
    v_mul_f32 v78, v22, v78
    v_mfma_f32_16x16x32_bf16 v[200:203], v[52:55], a[236:239], v[200:203]
    s_waitcnt lgkmcnt(0)
    v_mul_f32 v79, v23, v79
    v_mul_f32 v25, v13, v81
    v_mfma_f32_16x16x32_bf16 v[200:203], v[60:63], a[252:255], v[200:203]
    s_barrier
    s_add_u32 m0, s12, 0
    ds_read_b128 v[44:47], v5 offset:0
    v_mfma_f32_16x16x32_bf16 v[200:203], v[64:67], v[232:235], v[200:203]
    s_mov_b64 s[40:41], s[50:51]
    s_add_u32 s15, s18, 4096
    ds_read_b128 v[48:51], v5 offset:1024
    v_mfma_f32_16x16x32_bf16 v[200:203], v[68:71], v[248:251], v[200:203]
    buffer_load_dwordx4 v11, s[40:43], s15 offen  lds
    ds_read_b128 v[52:55], v5 offset:2048
    v_mfma_f32_16x16x32_bf16 v[196:199], v[60:63], a[248:251], v[196:199]
    s_add_u32 m0, s12, 1024
    v_exp_f32 v25, v25
    v_mfma_f32_16x16x32_bf16 v[196:199], v[64:67], v[228:231], v[196:199]
    s_add_u32 s15, s15, s19
    v_mul_f32 v26, v13, v82
    v_mul_f32 v27, v13, v83
    v_mfma_f32_16x16x32_bf16 v[196:199], v[68:71], v[244:247], v[196:199]
    v_exp_f32 v26, v26
    v_mfma_f32_16x16x32_bf16 v[192:195], v[60:63], a[244:247], v[192:195]
    v_exp_f32 v27, v27
    v_mfma_f32_16x16x32_bf16 v[192:195], v[64:67], v[224:227], v[192:195]
    buffer_load_dwordx4 v11, s[40:43], s15 offen  lds
    v_fma_f32 v24, v24, v17, v17
    v_mfma_f32_16x16x32_bf16 v[192:195], v[68:71], v[240:243], v[192:195]
    s_add_u32 m0, s12, 2048
    v_rcp_f32 v24, v24
    v_mfma_f32_16x16x32_bf16 v[188:191], v[60:63], a[240:243], v[188:191]
    s_add_u32 s15, s15, s19
    v_fma_f32 v25, v25, v17, v17
    v_fma_f32 v26, v26, v17, v17
    v_mfma_f32_16x16x32_bf16 v[188:191], v[64:67], v[220:223], v[188:191]
    v_rcp_f32 v25, v25
    v_mfma_f32_16x16x32_bf16 v[188:191], v[68:71], v[236:239], v[188:191]
    s_waitcnt lgkmcnt(0)
    v_rcp_f32 v26, v26
    v_mfma_f32_16x16x32_bf16 v[124:127], v[44:47], a[0:3], 0
    ds_read_b128 v[60:63], v5 offset:3072
    v_fma_f32 v27, v27, v17, v17
    v_mfma_f32_16x16x32_bf16 v[124:127], v[48:51], a[16:19], v[124:127]
    buffer_load_dwordx4 v11, s[40:43], s15 offen  lds
    ds_read_b128 v[64:67], v5 offset:4096
    v_mfma_f32_16x16x32_bf16 v[124:127], v[52:55], a[32:35], v[124:127]
    s_add_u32 m0, s12, 3072
    ds_read_b128 v[68:71], v5 offset:5120
    v_mul_f32 v80, v24, v80
    v_mfma_f32_16x16x32_bf16 v[128:131], v[44:47], a[4:7], 0
    s_add_u32 s15, s15, s19
    v_rcp_f32 v27, v27
    v_mfma_f32_16x16x32_bf16 v[128:131], v[48:51], a[20:23], v[128:131]
    v_mul_f32 v81, v25, v81
    v_mul_f32 v82, v26, v82
    v_mfma_f32_16x16x32_bf16 v[128:131], v[52:55], a[36:39], v[128:131]
    v_mul_f32 v83, v27, v83
    v_mul_f32 v28, v14, v84
    v_mfma_f32_16x16x32_bf16 v[132:135], v[44:47], a[8:11], 0
    v_exp_f32 v28, v28
    v_mfma_f32_16x16x32_bf16 v[132:135], v[48:51], a[24:27], v[132:135]
    buffer_load_dword v254, v253, s[8:11], 0 offen sc1
    v_mul_f32 v29, v14, v85
    v_mfma_f32_16x16x32_bf16 v[132:135], v[52:55], a[40:43], v[132:135]
    buffer_load_dwordx4 v11, s[40:43], s15 offen  lds
    v_mul_f32 v30, v14, v86
    v_mfma_f32_16x16x32_bf16 v[136:139], v[44:47], a[12:15], 0
    s_add_u32 m0, s12, 4096
    v_exp_f32 v29, v29
    v_mfma_f32_16x16x32_bf16 v[136:139], v[48:51], a[28:31], v[136:139]
    s_add_u32 s15, s15, s19
    v_exp_f32 v30, v30
    v_mfma_f32_16x16x32_bf16 v[136:139], v[52:55], a[44:47], v[136:139]
    s_waitcnt lgkmcnt(0)
    v_mul_f32 v31, v14, v87
    v_fma_f32 v28, v28, v18, v18
    v_mfma_f32_16x16x32_bf16 v[136:139], v[60:63], a[60:63], v[136:139]
    ds_read_b128 v[44:47], v5 offset:6144
    v_fma_f32 v29, v29, v18, v18
    v_mfma_f32_16x16x32_bf16 v[136:139], v[64:67], a[76:79], v[136:139]
    ds_read_b128 v[48:51], v5 offset:7168
    v_fma_f32 v30, v30, v18, v18
    v_mfma_f32_16x16x32_bf16 v[136:139], v[68:71], a[92:95], v[136:139]
    buffer_load_dwordx4 v11, s[40:43], s15 offen  lds
    ds_read_b128 v[52:55], v5 offset:8192
    v_mfma_f32_16x16x32_bf16 v[132:135], v[60:63], a[56:59], v[132:135]
    s_add_u32 m0, s12, 5120
    v_exp_f32 v31, v31
    v_mfma_f32_16x16x32_bf16 v[132:135], v[64:67], a[72:75], v[132:135]
    s_add_u32 s15, s15, s19
    v_rcp_f32 v28, v28
    v_mfma_f32_16x16x32_bf16 v[132:135], v[68:71], a[88:91], v[132:135]
    v_rcp_f32 v29, v29
    v_mfma_f32_16x16x32_bf16 v[128:131], v[60:63], a[52:55], v[128:131]
    v_rcp_f32 v30, v30
    v_mfma_f32_16x16x32_bf16 v[128:131], v[64:67], a[68:71], v[128:131]
    v_fma_f32 v31, v31, v18, v18
    v_mul_f32 v84, v28, v84
    v_mfma_f32_16x16x32_bf16 v[128:131], v[68:71], a[84:87], v[128:131]
    buffer_load_dwordx4 v11, s[40:43], s15 offen  lds
    v_mul_f32 v85, v29, v85
    v_mfma_f32_16x16x32_bf16 v[124:127], v[60:63], a[48:51], v[124:127]
    s_add_u32 m0, s12, 6144
    v_rcp_f32 v31, v31
    v_mfma_f32_16x16x32_bf16 v[124:127], v[64:67], a[64:67], v[124:127]
    s_add_u32 s15, s15, s19
    v_mul_f32 v86, v30, v86
    v_mul_f32 v87, v31, v87
    v_mfma_f32_16x16x32_bf16 v[124:127], v[68:71], a[80:83], v[124:127]
    s_waitcnt lgkmcnt(0)
    v_mul_f32 v32, v15, v88
    v_mul_f32 v33, v15, v89
    v_mfma_f32_16x16x32_bf16 v[124:127], v[44:47], a[96:99], v[124:127]
    ds_read_b128 v[60:63], v5 offset:9216
    v_mul_f32 v34, v15, v90
    v_mfma_f32_16x16x32_bf16 v[124:127], v[48:51], a[112:115], v[124:127]
    ds_read_b128 v[64:67], v5 offset:10240
    v_mul_f32 v35, v15, v91
    v_mfma_f32_16x16x32_bf16 v[124:127], v[52:55], a[128:131], v[124:127]
    buffer_load_dwordx4 v11, s[40:43], s15 offen  lds
    ds_read_b128 v[68:71], v5 offset:11264
    v_mfma_f32_16x16x32_bf16 v[128:131], v[44:47], a[100:103], v[128:131]
    s_add_u32 m0, s12, 7168
    v_exp_f32 v32, v32
    v_mfma_f32_16x16x32_bf16 v[128:131], v[48:51], a[116:119], v[128:131]
    s_add_u32 s15, s15, s19
    v_exp_f32 v33, v33
    v_mfma_f32_16x16x32_bf16 v[128:131], v[52:55], a[132:135], v[128:131]
    v_exp_f32 v34, v34
    v_mfma_f32_16x16x32_bf16 v[132:135], v[44:47], a[104:107], v[132:135]
    v_exp_f32 v35, v35
    v_mfma_f32_16x16x32_bf16 v[132:135], v[48:51], a[120:123], v[132:135]
    v_fma_f32 v32, v32, v19, v19
    v_fma_f32 v33, v33, v19, v19
    v_mfma_f32_16x16x32_bf16 v[132:135], v[52:55], a[136:139], v[132:135]
    buffer_load_dwordx4 v11, s[40:43], s15 offen  lds
    v_fma_f32 v34, v34, v19, v19
    v_mfma_f32_16x16x32_bf16 v[136:139], v[44:47], a[108:111], v[136:139]
    s_add_u32 m0, s12, 8192
    v_rcp_f32 v32, v32
    v_mfma_f32_16x16x32_bf16 v[136:139], v[48:51], a[124:127], v[136:139]
    s_add_u32 s15, s15, s19
    v_rcp_f32 v33, v33
    v_mfma_f32_16x16x32_bf16 v[136:139], v[52:55], a[140:143], v[136:139]
    s_waitcnt lgkmcnt(0)
    v_rcp_f32 v34, v34
    v_mfma_f32_16x16x32_bf16 v[136:139], v[60:63], a[156:159], v[136:139]
    ds_read_b128 v[44:47], v5 offset:12288
    v_fma_f32 v35, v35, v19, v19
    v_mfma_f32_16x16x32_bf16 v[136:139], v[64:67], a[172:175], v[136:139]
    ds_read_b128 v[48:51], v5 offset:13312
    v_mul_f32 v88, v32, v88
    v_mfma_f32_16x16x32_bf16 v[136:139], v[68:71], a[188:191], v[136:139]
    buffer_load_dwordx4 v11, s[40:43], s15 offen  lds
    ds_read_b128 v[52:55], v5 offset:14336
    v_mfma_f32_16x16x32_bf16 v[132:135], v[60:63], a[152:155], v[132:135]
    s_add_u32 m0, s12, 36864
    v_rcp_f32 v35, v35
    v_mfma_f32_16x16x32_bf16 v[132:135], v[64:67], a[168:171], v[132:135]
    s_mov_b64 s[40:41], s[50:51]
    v_mul_f32 v89, v33, v89
    v_mul_f32 v90, v34, v90
    v_mfma_f32_16x16x32_bf16 v[132:135], v[68:71], a[184:187], v[132:135]
    s_mul_i32 s15, s19, 9
    v_mul_f32 v91, v35, v91
    v_mul_f32 v20, v12, v140
    v_mfma_f32_16x16x32_bf16 v[128:131], v[60:63], a[148:151], v[128:131]
    s_add_u32 s15, s15, s18
    v_exp_f32 v20, v20
    v_mfma_f32_16x16x32_bf16 v[128:131], v[64:67], a[164:167], v[128:131]
    s_add_u32 s15, s15, 4096
    v_mul_f32 v21, v12, v141
    v_mul_f32 v22, v12, v142
    v_mfma_f32_16x16x32_bf16 v[128:131], v[68:71], a[180:183], v[128:131]
    buffer_load_dwordx4 v11, s[40:43], s15 offen  lds
    v_mul_f32 v23, v12, v143
    v_mfma_f32_16x16x32_bf16 v[124:127], v[60:63], a[144:147], v[124:127]
    s_add_u32 m0, s12, 37888
    v_exp_f32 v21, v21
    v_mfma_f32_16x16x32_bf16 v[124:127], v[64:67], a[160:163], v[124:127]
    s_add_u32 s15, s15, s19
    v_exp_f32 v22, v22
    v_mfma_f32_16x16x32_bf16 v[124:127], v[68:71], a[176:179], v[124:127]
    s_waitcnt lgkmcnt(0)
    v_exp_f32 v23, v23
    v_mfma_f32_16x16x32_bf16 v[124:127], v[44:47], a[192:195], v[124:127]
    ds_read_b128 v[60:63], v5 offset:15360
    v_fma_f32 v20, v20, v16, v16
    v_mfma_f32_16x16x32_bf16 v[124:127], v[48:51], a[208:211], v[124:127]
    ds_read_b128 v[64:67], v5 offset:16384
    v_fma_f32 v21, v21, v16, v16
    v_mfma_f32_16x16x32_bf16 v[124:127], v[52:55], a[224:227], v[124:127]
    buffer_load_dwordx4 v11, s[40:43], s15 offen  lds
    ds_read_b128 v[68:71], v5 offset:17408
    v_mfma_f32_16x16x32_bf16 v[128:131], v[44:47], a[196:199], v[128:131]
    s_add_u32 m0, s12, 38912
    v_rcp_f32 v20, v20
    v_mfma_f32_16x16x32_bf16 v[128:131], v[48:51], a[212:215], v[128:131]
    s_add_u32 s15, s15, s19
    v_rcp_f32 v21, v21
    v_mfma_f32_16x16x32_bf16 v[128:131], v[52:55], a[228:231], v[128:131]
    v_fma_f32 v22, v22, v16, v16
    v_fma_f32 v23, v23, v16, v16
    v_mfma_f32_16x16x32_bf16 v[132:135], v[44:47], a[200:203], v[132:135]
    v_rcp_f32 v22, v22
    v_mfma_f32_16x16x32_bf16 v[132:135], v[48:51], a[216:219], v[132:135]
    v_rcp_f32 v23, v23
    v_mfma_f32_16x16x32_bf16 v[132:135], v[52:55], a[232:235], v[132:135]
    buffer_load_dwordx4 v11, s[40:43], s15 offen  lds
    v_mul_f32 v140, v20, v140
    v_mfma_f32_16x16x32_bf16 v[136:139], v[44:47], a[204:207], v[136:139]
    s_add_u32 m0, s12, 39936
    v_mul_f32 v141, v21, v141
    v_mul_f32 v142, v22, v142
    v_mfma_f32_16x16x32_bf16 v[136:139], v[48:51], a[220:223], v[136:139]
    s_add_u32 s15, s15, s19
    v_mul_f32 v143, v23, v143
    v_mul_f32 v24, v13, v144
    v_mfma_f32_16x16x32_bf16 v[136:139], v[52:55], a[236:239], v[136:139]
    s_waitcnt lgkmcnt(0)
    v_exp_f32 v24, v24
    v_mfma_f32_16x16x32_bf16 v[136:139], v[60:63], a[252:255], v[136:139]
    ds_read_b128 v[44:47], v5 offset:18432
    v_mul_f32 v25, v13, v145
    v_mfma_f32_16x16x32_bf16 v[136:139], v[64:67], v[232:235], v[136:139]
    ds_read_b128 v[48:51], v5 offset:19456
    v_mul_f32 v26, v13, v146
    v_mfma_f32_16x16x32_bf16 v[136:139], v[68:71], v[248:251], v[136:139]
    buffer_load_dwordx4 v11, s[40:43], s15 offen  lds
    ds_read_b128 v[52:55], v5 offset:20480
    v_mfma_f32_16x16x32_bf16 v[132:135], v[60:63], a[248:251], v[132:135]
    s_add_u32 m0, s12, 40960
    v_exp_f32 v25, v25
    v_mfma_f32_16x16x32_bf16 v[132:135], v[64:67], v[228:231], v[132:135]
    s_add_u32 s15, s15, s19
    v_exp_f32 v26, v26
    v_mfma_f32_16x16x32_bf16 v[132:135], v[68:71], v[244:247], v[132:135]
    v_mul_f32 v27, v13, v147
    v_fma_f32 v24, v24, v17, v17
    v_mfma_f32_16x16x32_bf16 v[128:131], v[60:63], a[244:247], v[128:131]
    v_exp_f32 v27, v27
    v_mfma_f32_16x16x32_bf16 v[128:131], v[64:67], v[224:227], v[128:131]
    s_waitcnt vmcnt(10)
    v_cmp_gt_u32 s[46:47], 1, v254
    v_fma_f32 v25, v25, v17, v17
    v_mfma_f32_16x16x32_bf16 v[128:131], v[68:71], v[240:243], v[128:131]
    buffer_load_dwordx4 v11, s[40:43], s15 offen  lds
    v_fma_f32 v26, v26, v17, v17
    v_mfma_f32_16x16x32_bf16 v[124:127], v[60:63], a[240:243], v[124:127]
    s_cmp_lg_u64 s[46:47], 0
    s_cbranch_scc1 L_slow12
L_slow12_ret:
    v_fma_f32 v27, v27, v17, v17
    v_mfma_f32_16x16x32_bf16 v[124:127], v[64:67], v[220:223], v[124:127]
    s_add_u32 m0, s12, 41984
    v_rcp_f32 v24, v24
    v_mfma_f32_16x16x32_bf16 v[124:127], v[68:71], v[236:239], v[124:127]
    s_waitcnt lgkmcnt(0)
    v_rcp_f32 v25, v25
    v_mfma_f32_16x16x32_bf16 v[204:207], v[44:47], a[0:3], 0
    s_add_u32 s15, s15, s19
    ds_read_b128 v[60:63], v5 offset:21504
    v_mul_f32 v144, v24, v144
    v_mfma_f32_16x16x32_bf16 v[204:207], v[48:51], a[16:19], v[204:207]
    ds_read_b128 v[64:67], v5 offset:22528
    v_mul_f32 v145, v25, v145
    v_mfma_f32_16x16x32_bf16 v[204:207], v[52:55], a[32:35], v[204:207]
    buffer_load_dword v254, v8, s[8:11], 0 offen sc1
    ds_read_b128 v[68:71], v5 offset:23552
    v_mfma_f32_16x16x32_bf16 v[208:211], v[44:47], a[4:7], 0
    buffer_load_dwordx4 v11, s[40:43], s15 offen  lds
    v_mul_f32 v28, v14, v148
    v_mfma_f32_16x16x32_bf16 v[208:211], v[48:51], a[20:23], v[208:211]
    s_add_u32 m0, s12, 43008
    v_rcp_f32 v26, v26
    v_mfma_f32_16x16x32_bf16 v[208:211], v[52:55], a[36:39], v[208:211]
    s_add_u32 s15, s15, s19
    v_rcp_f32 v27, v27
    v_mfma_f32_16x16x32_bf16 v[212:215], v[44:47], a[8:11], 0
    v_exp_f32 v28, v28
    v_mfma_f32_16x16x32_bf16 v[212:215], v[48:51], a[24:27], v[212:215]
    v_mul_f32 v146, v26, v146
    v_mul_f32 v147, v27, v147
    v_mfma_f32_16x16x32_bf16 v[212:215], v[52:55], a[40:43], v[212:215]
    v_mul_f32 v29, v14, v149
    v_mul_f32 v30, v14, v150
    v_mfma_f32_16x16x32_bf16 v[216:219], v[44:47], a[12:15], 0
    buffer_load_dwordx4 v11, s[40:43], s15 offen  lds
    v_mul_f32 v31, v14, v151
    v_mfma_f32_16x16x32_bf16 v[216:219], v[48:51], a[28:31], v[216:219]
    s_add_u32 m0, s12, 44032
    v_exp_f32 v29, v29
    v_mfma_f32_16x16x32_bf16 v[216:219], v[52:55], a[44:47], v[216:219]
    s_waitcnt lgkmcnt(0)
    v_exp_f32 v30, v30
    v_mfma_f32_16x16x32_bf16 v[216:219], v[60:63], a[60:63], v[216:219]
    s_add_u32 s15, s15, s19
    ds_read_b128 v[44:47], v5 offset:24576
    v_fma_f32 v28, v28, v18, v18
    v_mfma_f32_16x16x32_bf16 v[216:219], v[64:67], a[76:79], v[216:219]
    ds_read_b128 v[48:51], v5 offset:25600
    v_fma_f32 v29, v29, v18, v18
    v_mfma_f32_16x16x32_bf16 v[216:219], v[68:71], a[92:95], v[216:219]
    ds_read_b128 v[52:55], v5 offset:26624
    v_fma_f32 v30, v30, v18, v18
    v_mfma_f32_16x16x32_bf16 v[212:215], v[60:63], a[56:59], v[212:215]
    buffer_load_dwordx4 v11, s[40:43], s15 offen  lds
    v_mul_f32 v32, v12, v124
    v_mfma_f32_16x16x32_bf16 v[212:215], v[64:67], a[72:75], v[212:215]
    s_add_u32 m0, s12, 45056
    v_exp_f32 v31, v31
    v_mfma_f32_16x16x32_bf16 v[212:215], v[68:71], a[88:91], v[212:215]
    s_add_u32 s15, s15, s19
    v_rcp_f32 v28, v28
    v_mfma_f32_16x16x32_bf16 v[208:211], v[60:63], a[52:55], v[208:211]
    v_rcp_f32 v29, v29
    v_mfma_f32_16x16x32_bf16 v[208:211], v[64:67], a[68:71], v[208:211]
    v_rcp_f32 v30, v30
    v_mfma_f32_16x16x32_bf16 v[208:211], v[68:71], a[84:87], v[208:211]
    v_exp_f32 v32, v32
    v_mfma_f32_16x16x32_bf16 v[204:207], v[60:63], a[48:51], v[204:207]
    buffer_load_dwordx4 v11, s[40:43], s15 offen  lds
    v_fma_f32 v31, v31, v18, v18
    v_mfma_f32_16x16x32_bf16 v[204:207], v[64:67], a[64:67], v[204:207]
    v_rcp_f32 v31, v31
    v_mfma_f32_16x16x32_bf16 v[204:207], v[68:71], a[80:83], v[204:207]
    s_waitcnt lgkmcnt(0)
    v_mul_f32 v148, v28, v148
    v_mul_f32 v149, v29, v149
    v_mfma_f32_16x16x32_bf16 v[204:207], v[44:47], a[96:99], v[204:207]
    ds_read_b128 v[60:63], v5 offset:27648
    v_mul_f32 v150, v30, v150
    v_mfma_f32_16x16x32_bf16 v[204:207], v[48:51], a[112:115], v[204:207]
    ds_read_b128 v[64:67], v5 offset:28672
    v_mul_f32 v151, v31, v151
    v_mfma_f32_16x16x32_bf16 v[204:207], v[52:55], a[128:131], v[204:207]
    ds_read_b128 v[68:71], v5 offset:29696
    v_mul_f32 v33, v12, v125
    v_mfma_f32_16x16x32_bf16 v[208:211], v[44:47], a[100:103], v[208:211]
    v_exp_f32 v33, v33
    v_mfma_f32_16x16x32_bf16 v[208:211], v[48:51], a[116:119], v[208:211]
    v_mul_f32 v34, v12, v126
    v_mul_f32 v35, v12, v127
    v_mfma_f32_16x16x32_bf16 v[208:211], v[52:55], a[132:135], v[208:211]
    v_exp_f32 v34, v34
    v_mfma_f32_16x16x32_bf16 v[212:215], v[44:47], a[104:107], v[212:215]
    v_exp_f32 v35, v35
    v_mfma_f32_16x16x32_bf16 v[212:215], v[48:51], a[120:123], v[212:215]
    v_fma_f32 v32, v32, v16, v16
    v_fma_f32 v33, v33, v16, v16
    v_mfma_f32_16x16x32_bf16 v[212:215], v[52:55], a[136:139], v[212:215]
    v_rcp_f32 v32, v32
    v_mfma_f32_16x16x32_bf16 v[216:219], v[44:47], a[108:111], v[216:219]
    v_rcp_f32 v33, v33
    v_mfma_f32_16x16x32_bf16 v[216:219], v[48:51], a[124:127], v[216:219]
    v_fma_f32 v34, v34, v16, v16
    v_fma_f32 v35, v35, v16, v16
    v_mfma_f32_16x16x32_bf16 v[216:219], v[52:55], a[140:143], v[216:219]
    s_waitcnt lgkmcnt(0)
    v_rcp_f32 v34, v34
    v_mfma_f32_16x16x32_bf16 v[216:219], v[60:63], a[156:159], v[216:219]
    ds_read_b128 v[44:47], v5 offset:30720
    v_mul_f32 v124, v32, v124
    v_mfma_f32_16x16x32_bf16 v[216:219], v[64:67], a[172:175], v[216:219]
    ds_read_b128 v[48:51], v5 offset:31744
    v_mul_f32 v125, v33, v125
    v_mfma_f32_16x16x32_bf16 v[216:219], v[68:71], a[188:191], v[216:219]
    ds_read_b128 v[52:55], v5 offset:32768
    v_mul_f32 v126, v34, v126
    v_mfma_f32_16x16x32_bf16 v[212:215], v[60:63], a[152:155], v[212:215]
    v_rcp_f32 v35, v35
    v_mfma_f32_16x16x32_bf16 v[212:215], v[64:67], a[168:171], v[212:215]
    v_mul_f32 v127, v35, v127
    v_mul_f32 v20, v13, v128
    v_mfma_f32_16x16x32_bf16 v[212:215], v[68:71], a[184:187], v[212:215]
    v_exp_f32 v20, v20
    v_mfma_f32_16x16x32_bf16 v[208:211], v[60:63], a[148:151], v[208:211]
    v_mul_f32 v21, v13, v129
    v_mul_f32 v22, v13, v130
    v_mfma_f32_16x16x32_bf16 v[208:211], v[64:67], a[164:167], v[208:211]
    v_exp_f32 v21, v21
    v_mfma_f32_16x16x32_bf16 v[208:211], v[68:71], a[180:183], v[208:211]
    v_exp_f32 v22, v22
    v_mfma_f32_16x16x32_bf16 v[204:207], v[60:63], a[144:147], v[204:207]
    v_mul_f32 v23, v13, v131
    v_fma_f32 v20, v20, v17, v17
    v_mfma_f32_16x16x32_bf16 v[204:207], v[64:67], a[160:163], v[204:207]
    v_exp_f32 v23, v23
    v_mfma_f32_16x16x32_bf16 v[204:207], v[68:71], a[176:179], v[204:207]
    s_waitcnt lgkmcnt(0)
    v_rcp_f32 v20, v20
    v_mfma_f32_16x16x32_bf16 v[204:207], v[44:47], a[192:195], v[204:207]
    ds_read_b128 v[60:63], v5 offset:33792
    v_fma_f32 v21, v21, v17, v17
    v_mfma_f32_16x16x32_bf16 v[204:207], v[48:51], a[208:211], v[204:207]
    ds_read_b128 v[64:67], v5 offset:34816
    v_fma_f32 v22, v22, v17, v17
    v_mfma_f32_16x16x32_bf16 v[204:207], v[52:55], a[224:227], v[204:207]
    ds_read_b128 v[68:71], v5 offset:35840
    v_fma_f32 v23, v23, v17, v17
    v_mfma_f32_16x16x32_bf16 v[208:211], v[44:47], a[196:199], v[208:211]
    v_rcp_f32 v21, v21
    v_mfma_f32_16x16x32_bf16 v[208:211], v[48:51], a[212:215], v[208:211]
    s_waitcnt vmcnt(4)
    v_cmp_gt_u32 s[46:47], 1, v254
    v_mul_f32 v128, v20, v128
    v_mfma_f32_16x16x32_bf16 v[208:211], v[52:55], a[228:231], v[208:211]
    v_rcp_f32 v22, v22
    v_mfma_f32_16x16x32_bf16 v[212:215], v[44:47], a[200:203], v[212:215]
    s_cmp_lg_u64 s[46:47], 0
    s_cbranch_scc1 L_slow13
L_slow13_ret:
    s_add_u32 m0, s12, 73728
    v_mfma_f32_16x16x32_bf16 v[212:215], v[48:51], a[216:219], v[212:215]
    s_add_u32 s15, s14, 0
    s_and_b32 s20, s2, 1
    s_lshl_b32 s20, s20, 2
    v_mfma_f32_16x16x32_bf16 v[212:215], v[52:55], a[232:235], v[212:215]
    buffer_load_dwordx4 v1, s[8:11], s15 offen offset:0 sc1 lds
    s_lshr_b32 s21, s2, 6
    v_mfma_f32_16x16x32_bf16 v[216:219], v[44:47], a[204:207], v[216:219]
    s_add_u32 s20, s20, s21
    s_bfe_u32 s21, s2, 0x20001
    s_bfe_u32 s22, s2, 0x30003
    v_mfma_f32_16x16x32_bf16 v[216:219], v[48:51], a[220:223], v[216:219]
    s_and_b32 s24, s22, 3
    v_and_b32 v72, 0xf0, v1
    v_bfe_u32 v73, v0, 4, 1
    v_mfma_f32_16x16x32_bf16 v[216:219], v[52:55], a[236:239], v[216:219]
    s_waitcnt lgkmcnt(0)
    v_rcp_f32 v23, v23
    v_mfma_f32_16x16x32_bf16 v[216:219], v[60:63], a[252:255], v[216:219]
    s_barrier
    v_add_u32 v56, 4294930432, v56
    v_bfe_u32 v74, v0, 5, 1
    v_mfma_f32_16x16x32_bf16 v[216:219], v[64:67], v[232:235], v[216:219]
    buffer_load_dwordx4 v1, s[8:11], s15 offen offset:1024 sc1 lds
    ds_read_b64_tr_b16 v[44:45], v56 offset:0
    v_mfma_f32_16x16x32_bf16 v[216:219], v[68:71], v[248:251], v[216:219]
    s_lshr_b32 s25, s22, 2
    ds_read_b64_tr_b16 v[46:47], v56 offset:9216
    s_lshl_b32 s26, s20, 1
    v_mfma_f32_16x16x32_bf16 v[212:215], v[60:63], a[248:251], v[212:215]
    s_add_u32 s26, s26, s25
    ds_read_b64_tr_b16 v[48:49], v56 offset:1024
    s_lshl_b32 s26, s26, 2
    v_mfma_f32_16x16x32_bf16 v[212:215], v[64:67], v[228:231], v[212:215]
    s_add_u32 s26, s26, s3
    ds_read_b64_tr_b16 v[50:51], v56 offset:10240
    s_mul_i32 s27, s26, 294912
    v_mfma_f32_16x16x32_bf16 v[212:215], v[68:71], v[244:247], v[212:215]
    s_mul_i32 s28, s21, 73728
    ds_read_b64_tr_b16 v[52:53], v56 offset:2048
    s_add_u32 s27, s27, s28
    v_mfma_f32_16x16x32_bf16 v[208:211], v[60:63], a[244:247], v[208:211]
    s_add_u32 s27, s27, 37748736
    ds_read_b64_tr_b16 v[54:55], v56 offset:11264
    v_mul_u32_u24 v75, 9216, v74
    v_mfma_f32_16x16x32_bf16 v[208:211], v[64:67], v[224:227], v[208:211]
    buffer_load_dwordx4 v1, s[8:11], s15 offen offset:2048 sc1 lds
    v_lshl_add_u32 v75, v73, 9, v75
    v_mfma_f32_16x16x32_bf16 v[208:211], v[68:71], v[240:243], v[208:211]
    s_mul_i32 s28, s24, 589824
    v_add3_u32 v8, v75, v72, s27
    s_mul_i32 s27, s21, 2359296
    v_mfma_f32_16x16x32_bf16 v[204:207], v[60:63], a[240:243], v[204:207]
    s_add_u32 s27, s27, s28
    s_lshl_b32 s28, s26, 9
    s_add_u32 s27, s27, s28
    v_mfma_f32_16x16x32_bf16 v[204:207], v[64:67], v[220:223], v[204:207]
    s_add_u32 s27, s27, 27262976
    v_lshl_add_u32 v72, v73, 15, v72
    v_mul_f32 v129, v21, v129
    v_mfma_f32_16x16x32_bf16 v[204:207], v[68:71], v[236:239], v[204:207]
    s_waitcnt lgkmcnt(0)
    v_add_u32 v72, s27, v72
    v_mul_f32 v130, v22, v130
    v_mfma_f32_16x16x32_bf16 v[156:159], v[44:47], a[0:3], 0
    v_add_u32 v57, 4294930432, v57
    v_lshl_add_u32 v9, v74, 16, v72
    v_mfma_f32_16x16x32_bf16 v[156:159], v[48:51], a[16:19], v[156:159]
    buffer_load_dwordx4 v1, s[8:11], s15 offen offset:3072 sc1 lds
    ds_read_b64_tr_b16 v[60:61], v57 offset:0
    v_mfma_f32_16x16x32_bf16 v[156:159], v[52:55], a[32:35], v[156:159]
    s_add_u32 m0, s12, 77824
    ds_read_b64_tr_b16 v[62:63], v57 offset:9216
    v_lshl_add_u32 v72, v74, 8, v72
    v_mfma_f32_16x16x32_bf16 v[160:163], v[44:47], a[4:7], 0
    s_add_u32 s15, s14, 4096
    ds_read_b64_tr_b16 v[64:65], v57 offset:1024
    v_add_u32 v10, 524288, v72
    v_mfma_f32_16x16x32_bf16 v[160:163], v[48:51], a[20:23], v[160:163]
    ds_read_b64_tr_b16 v[66:67], v57 offset:10240
    v_mul_f32 v131, v23, v131
    v_mfma_f32_16x16x32_bf16 v[160:163], v[52:55], a[36:39], v[160:163]
    ds_read_b64_tr_b16 v[68:69], v57 offset:2048
    v_mul_f32 v24, v14, v132
    v_mfma_f32_16x16x32_bf16 v[164:167], v[44:47], a[8:11], 0
    buffer_load_dwordx4 v1, s[8:11], s15 offen offset:0 sc1 lds
    ds_read_b64_tr_b16 v[70:71], v57 offset:11264
    v_mfma_f32_16x16x32_bf16 v[164:167], v[48:51], a[24:27], v[164:167]
    v_exp_f32 v24, v24
    v_mfma_f32_16x16x32_bf16 v[164:167], v[52:55], a[40:43], v[164:167]
    v_mul_f32 v25, v14, v133
    v_mul_f32 v26, v14, v134
    v_mfma_f32_16x16x32_bf16 v[168:171], v[44:47], a[12:15], 0
    v_exp_f32 v25, v25
    v_mfma_f32_16x16x32_bf16 v[168:171], v[48:51], a[28:31], v[168:171]
    v_exp_f32 v26, v26
    v_mfma_f32_16x16x32_bf16 v[168:171], v[52:55], a[44:47], v[168:171]
    s_waitcnt lgkmcnt(0)
    v_mul_f32 v27, v14, v135
    v_fma_f32 v24, v24, v18, v18
    v_mfma_f32_16x16x32_bf16 v[172:175], v[60:63], a[0:3], 0
    buffer_load_dwordx4 v1, s[8:11], s15 offen offset:1024 sc1 lds
    v_add_u32 v58, 4294930432, v58
    v_mfma_f32_16x16x32_bf16 v[172:175], v[64:67], a[16:19], v[172:175]
    ds_read_b64_tr_b16 v[44:45], v58 offset:0
    v_fma_f32 v25, v25, v18, v18
    v_mfma_f32_16x16x32_bf16 v[172:175], v[68:71], a[32:35], v[172:175]
    ds_read_b64_tr_b16 v[46:47], v58 offset:9216
    v_fma_f32 v26, v26, v18, v18
    v_mfma_f32_16x16x32_bf16 v[176:179], v[60:63], a[4:7], 0
    ds_read_b64_tr_b16 v[48:49], v58 offset:1024
    v_mul_f32 v28, v15, v136
    v_mfma_f32_16x16x32_bf16 v[176:179], v[64:67], a[20:23], v[176:179]
    buffer_load_dwordx4 v1, s[8:11], s15 offen offset:2048 sc1 lds
    ds_read_b64_tr_b16 v[50:51], v58 offset:10240
    v_mfma_f32_16x16x32_bf16 v[176:179], v[68:71], a[36:39], v[176:179]
    ds_read_b64_tr_b16 v[52:53], v58 offset:2048
    v_mul_f32 v29, v15, v137
    v_mfma_f32_16x16x32_bf16 v[180:183], v[60:63], a[8:11], 0
    ds_read_b64_tr_b16 v[54:55], v58 offset:11264
    v_mul_f32 v30, v15, v138
    v_mfma_f32_16x16x32_bf16 v[180:183], v[64:67], a[24:27], v[180:183]
    v_exp_f32 v27, v27
    v_mfma_f32_16x16x32_bf16 v[180:183], v[68:71], a[40:43], v[180:183]
    v_rcp_f32 v24, v24
    v_mfma_f32_16x16x32_bf16 v[184:187], v[60:63], a[12:15], 0
    buffer_load_dwordx4 v1, s[8:11], s15 offen offset:3072 sc1 lds
    v_fma_f32 v27, v27, v18, v18
    v_mfma_f32_16x16x32_bf16 v[184:187], v[64:67], a[28:31], v[184:187]
    s_add_u32 m0, s12, 81920
    v_rcp_f32 v25, v25
    v_mfma_f32_16x16x32_bf16 v[184:187], v[68:71], a[44:47], v[184:187]
    s_waitcnt lgkmcnt(0)
    v_rcp_f32 v26, v26
    v_mfma_f32_16x16x32_bf16 v[108:111], v[44:47], a[0:3], 0
    s_add_u32 s15, s14, 8192
    v_add_u32 v59, 4294930432, v59
    v_mul_f32 v132, v24, v132
    v_mfma_f32_16x16x32_bf16 v[108:111], v[48:51], a[16:19], v[108:111]
    ds_read_b64_tr_b16 v[60:61], v59 offset:0
    v_mul_f32 v133, v25, v133
    v_mfma_f32_16x16x32_bf16 v[108:111], v[52:55], a[32:35], v[108:111]
    buffer_load_dwordx4 v1, s[8:11], s15 offen offset:0 sc1 lds
    ds_read_b64_tr_b16 v[62:63], v59 offset:9216
    v_mfma_f32_16x16x32_bf16 v[112:115], v[44:47], a[4:7], 0
    s_add_u32 m0, s12, 110592
    ds_read_b64_tr_b16 v[64:65], v59 offset:1024
    v_mul_f32 v134, v26, v134
    v_mfma_f32_16x16x32_bf16 v[112:115], v[48:51], a[20:23], v[112:115]
    s_add_u32 s15, s14, 36864
    ds_read_b64_tr_b16 v[66:67], v59 offset:10240
    v_mul_f32 v31, v15, v139
    v_mfma_f32_16x16x32_bf16 v[112:115], v[52:55], a[36:39], v[112:115]
    ds_read_b64_tr_b16 v[68:69], v59 offset:2048
    ds_read_b64_tr_b16 v[70:71], v59 offset:11264
    v_mfma_f32_16x16x32_bf16 v[116:119], v[44:47], a[8:11], 0
    v_rcp_f32 v27, v27
    v_mfma_f32_16x16x32_bf16 v[116:119], v[48:51], a[24:27], v[116:119]
    buffer_load_dwordx4 v1, s[8:11], s15 offen offset:0 sc1 lds
    v_mul_f32 v135, v27, v135
    v_mfma_f32_16x16x32_bf16 v[116:119], v[52:55], a[40:43], v[116:119]
    v_exp_f32 v28, v28
    v_mfma_f32_16x16x32_bf16 v[120:123], v[44:47], a[12:15], 0
    v_exp_f32 v29, v29
    v_mfma_f32_16x16x32_bf16 v[120:123], v[48:51], a[28:31], v[120:123]
    v_exp_f32 v30, v30
    v_mfma_f32_16x16x32_bf16 v[120:123], v[52:55], a[44:47], v[120:123]
    s_waitcnt lgkmcnt(0)
    v_exp_f32 v31, v31
    v_mul_f32 v124, v124, v204
    v_mul_f32 v125, v125, v205
    v_mul_f32 v126, v126, v206
    v_mul_f32 v127, v127, v207
    v_mfma_f32_16x16x32_bf16 v[204:207], v[60:63], a[0:3], 0
    buffer_load_dwordx4 v1, s[8:11], s15 offen offset:1024 sc1 lds
    ds_read_b64_tr_b16 v[44:45], v56 offset:3072
    v_mfma_f32_16x16x32_bf16 v[204:207], v[64:67], a[16:19], v[204:207]
    s_mov_b32 s17, 4096
    ds_read_b64_tr_b16 v[46:47], v56 offset:12288
    v_fma_f32 v28, v28, v19, v19
    v_mfma_f32_16x16x32_bf16 v[204:207], v[68:71], a[32:35], v[204:207]
    ds_read_b64_tr_b16 v[48:49], v56 offset:4096
    v_fma_f32 v29, v29, v19, v19
    v_mul_f32 v128, v128, v208
    v_mul_f32 v129, v129, v209
    v_mul_f32 v130, v130, v210
    v_mul_f32 v131, v131, v211
    v_mfma_f32_16x16x32_bf16 v[208:211], v[60:63], a[4:7], 0
L_pad_c1_4:
    s_cbranch_execz L_pad_c1_8
    ds_read_b64_tr_b16 v[50:51], v56 offset:13312
    v_fma_f32 v30, v30, v19, v19
    v_mfma_f32_16x16x32_bf16 v[208:211], v[64:67], a[20:23], v[208:211]
    ds_read_b64_tr_b16 v[52:53], v56 offset:5120
    v_fma_f32 v31, v31, v19, v19
    v_mfma_f32_16x16x32_bf16 v[208:211], v[68:71], a[36:39], v[208:211]
    buffer_load_dwordx4 v1, s[8:11], s15 offen offset:2048 sc1 lds
    ds_read_b64_tr_b16 v[54:55], v56 offset:14336
    v_mul_f32 v132, v132, v212
    v_mul_f32 v133, v133, v213
    v_mul_f32 v134, v134, v214
    v_mul_f32 v135, v135, v215
    v_mfma_f32_16x16x32_bf16 v[212:215], v[60:63], a[8:11], 0
    v_rcp_f32 v28, v28
    v_mfma_f32_16x16x32_bf16 v[212:215], v[64:67], a[24:27], v[212:215]
    v_rcp_f32 v29, v29
    v_mfma_f32_16x16x32_bf16 v[212:215], v[68:71], a[40:43], v[212:215]
    v_rcp_f32 v30, v30
    v_mul_f32 v136, v28, v136
    v_mul_f32 v136, v136, v216
    v_mul_f32 v137, v29, v137
    v_mul_f32 v137, v137, v217
    v_mul_f32 v138, v30, v138
    v_mul_f32 v138, v138, v218
    v_rcp_f32 v31, v31
    s_nop 0
    v_mul_f32 v139, v31, v139
    v_mul_f32 v139, v139, v219
    v_mfma_f32_16x16x32_bf16 v[216:219], v[60:63], a[12:15], 0
    v_mul_f32 v32, v15, v152
    v_mul_f32 v33, v15, v153
    v_mfma_f32_16x16x32_bf16 v[216:219], v[64:67], a[28:31], v[216:219]
    buffer_load_dwordx4 v1, s[8:11], s15 offen offset:3072 sc1 lds
    v_mul_f32 v34, v15, v154
    v_mfma_f32_16x16x32_bf16 v[216:219], v[68:71], a[44:47], v[216:219]
    s_waitcnt lgkmcnt(0)
    v_exp_f32 v32, v32
    v_mfma_f32_16x16x32_bf16 v[156:159], v[44:47], a[48:51], v[156:159]
    s_mov_b32 s16, 0
    ds_read_b64_tr_b16 v[60:61], v57 offset:3072
    v_mul_f32 v35, v15, v155
    v_mfma_f32_16x16x32_bf16 v[156:159], v[48:51], a[64:67], v[156:159]
    s_add_u32 m0, s12, 114688
    ds_read_b64_tr_b16 v[62:63], v57 offset:12288
    v_fma_f32 v32, v32, v19, v19
    v_mfma_f32_16x16x32_bf16 v[156:159], v[52:55], a[80:83], v[156:159]
    s_add_u32 s15, s14, 40960
    ds_read_b64_tr_b16 v[64:65], v57 offset:4096
    v_cvt_pk_bf16_f32 v36, v124, v125
    v_mfma_f32_16x16x32_bf16 v[160:163], v[44:47], a[52:55], v[160:163]
    buffer_load_dwordx4 a[0:3], v8, s[8:11], s16 offen offset:0 sc1
    ds_read_b64_tr_b16 v[66:67], v57 offset:13312
    v_mfma_f32_16x16x32_bf16 v[160:163], v[48:51], a[68:71], v[160:163]
    ds_read_b64_tr_b16 v[68:69], v57 offset:5120
    v_cvt_pk_bf16_f32 v37, v126, v127
    v_mfma_f32_16x16x32_bf16 v[160:163], v[52:55], a[84:87], v[160:163]
    ds_read_b64_tr_b16 v[70:71], v57 offset:14336
    v_cvt_pk_bf16_f32 v38, v128, v129
    v_mfma_f32_16x16x32_bf16 v[164:167], v[44:47], a[56:59], v[164:167]
    v_exp_f32 v33, v33
    v_mfma_f32_16x16x32_bf16 v[164:167], v[48:51], a[72:75], v[164:167]
    v_exp_f32 v34, v34
    v_mfma_f32_16x16x32_bf16 v[164:167], v[52:55], a[88:91], v[164:167]
    buffer_load_dwordx4 a[4:7], v8, s[8:11], s16 offen offset:256 sc1
    v_fma_f32 v33, v33, v19, v19
    v_mfma_f32_16x16x32_bf16 v[168:171], v[44:47], a[60:63], v[168:171]
    s_mov_b32 s16, 18432
    v_exp_f32 v35, v35
    v_mfma_f32_16x16x32_bf16 v[168:171], v[48:51], a[76:79], v[168:171]
    v_rcp_f32 v32, v32
    v_mfma_f32_16x16x32_bf16 v[168:171], v[52:55], a[92:95], v[168:171]
    s_waitcnt lgkmcnt(0)
    v_rcp_f32 v33, v33
    v_mfma_f32_16x16x32_bf16 v[172:175], v[60:63], a[48:51], v[172:175]
    ds_read_b64_tr_b16 v[44:45], v58 offset:3072
    v_fma_f32 v34, v34, v19, v19
    v_mfma_f32_16x16x32_bf16 v[172:175], v[64:67], a[64:67], v[172:175]
    buffer_load_dwordx4 a[8:11], v8, s[8:11], s16 offen offset:0 sc1
    ds_read_b64_tr_b16 v[46:47], v58 offset:12288
    v_mfma_f32_16x16x32_bf16 v[172:175], v[68:71], a[80:83], v[172:175]
    ds_read_b64_tr_b16 v[48:49], v58 offset:4096
    v_fma_f32 v35, v35, v19, v19
    v_mfma_f32_16x16x32_bf16 v[176:179], v[60:63], a[52:55], v[176:179]
    ds_read_b64_tr_b16 v[50:51], v58 offset:13312
    v_mul_f32 v152, v32, v152
    v_mfma_f32_16x16x32_bf16 v[176:179], v[64:67], a[68:71], v[176:179]
    ds_read_b64_tr_b16 v[52:53], v58 offset:5120
    v_mul_f32 v153, v33, v153
    v_mfma_f32_16x16x32_bf16 v[176:179], v[68:71], a[84:87], v[176:179]
    ds_read_b64_tr_b16 v[54:55], v58 offset:14336
    v_cvt_pk_bf16_f32 v39, v130, v131
    v_mfma_f32_16x16x32_bf16 v[180:183], v[60:63], a[56:59], v[180:183]
    buffer_load_dwordx4 a[12:15], v8, s[8:11], s16 offen offset:256 sc1
    v_cvt_pk_bf16_f32 v40, v132, v133
    v_mfma_f32_16x16x32_bf16 v[180:183], v[64:67], a[72:75], v[180:183]
    s_mov_b32 s16, 36864
    v_rcp_f32 v34, v34
    v_mfma_f32_16x16x32_bf16 v[180:183], v[68:71], a[88:91], v[180:183]
    v_rcp_f32 v35, v35
    v_mfma_f32_16x16x32_bf16 v[184:187], v[60:63], a[60:63], v[184:187]
    v_mul_f32 v154, v34, v154
    v_mul_f32 v155, v35, v155
    v_mfma_f32_16x16x32_bf16 v[184:187], v[64:67], a[76:79], v[184:187]
    v_cvt_pk_bf16_f32 v41, v134, v135
    v_cvt_pk_bf16_f32 v42, v136, v137
    v_mfma_f32_16x16x32_bf16 v[184:187], v[68:71], a[92:95], v[184:187]
    s_waitcnt lgkmcnt(0)
    v_cvt_pk_bf16_f32 v43, v138, v139
    v_permlane16_swap_b32 v36, v38
    v_mfma_f32_16x16x32_bf16 v[108:111], v[44:47], a[48:51], v[108:111]
    buffer_load_dwordx4 a[16:19], v8, s[8:11], s16 offen offset:0 sc1
    ds_read_b64_tr_b16 v[60:61], v59 offset:3072
    v_mfma_f32_16x16x32_bf16 v[108:111], v[48:51], a[64:67], v[108:111]
    ds_read_b64_tr_b16 v[62:63], v59 offset:12288
    v_permlane16_swap_b32 v37, v39
    v_mfma_f32_16x16x32_bf16 v[108:111], v[52:55], a[80:83], v[108:111]
    ds_read_b64_tr_b16 v[64:65], v59 offset:4096
    v_permlane16_swap_b32 v40, v42
    v_mfma_f32_16x16x32_bf16 v[112:115], v[44:47], a[52:55], v[112:115]
    ds_read_b64_tr_b16 v[66:67], v59 offset:13312
    v_permlane16_swap_b32 v41, v43
    v_mfma_f32_16x16x32_bf16 v[112:115], v[48:51], a[68:71], v[112:115]
    buffer_store_dwordx4 v[36:39], v7, s[8:11], s17 offen sc1
    ds_read_b64_tr_b16 v[68:69], v59 offset:5120
    v_mfma_f32_16x16x32_bf16 v[112:115], v[52:55], a[84:87], v[112:115]
    s_mov_b32 s17, 299008
    ds_read_b64_tr_b16 v[70:71], v59 offset:14336
    v_mul_f32 v20, v12, v92
    v_mfma_f32_16x16x32_bf16 v[116:119], v[44:47], a[56:59], v[116:119]
    v_exp_f32 v20, v20
    v_mfma_f32_16x16x32_bf16 v[116:119], v[48:51], a[72:75], v[116:119]
    v_mul_f32 v21, v12, v93
    v_mul_f32 v22, v12, v94
    v_mfma_f32_16x16x32_bf16 v[116:119], v[52:55], a[88:91], v[116:119]
    v_exp_f32 v21, v21
    v_mfma_f32_16x16x32_bf16 v[120:123], v[44:47], a[60:63], v[120:123]
    buffer_store_dwordx4 v[40:43], v7, s[8:11], s17 offen sc1
    v_mul_f32 v23, v12, v95
    v_mfma_f32_16x16x32_bf16 v[120:123], v[48:51], a[76:79], v[120:123]
    v_exp_f32 v22, v22
    v_mfma_f32_16x16x32_bf16 v[120:123], v[52:55], a[92:95], v[120:123]
    s_waitcnt lgkmcnt(0)
    v_exp_f32 v23, v23
    v_mfma_f32_16x16x32_bf16 v[204:207], v[60:63], a[48:51], v[204:207]
    ds_read_b64_tr_b16 v[44:45], v56 offset:6144
    v_fma_f32 v20, v20, v16, v16
    v_mfma_f32_16x16x32_bf16 v[204:207], v[64:67], a[64:67], v[204:207]
    ds_read_b64_tr_b16 v[46:47], v56 offset:15360
    v_fma_f32 v21, v21, v16, v16
    v_mfma_f32_16x16x32_bf16 v[204:207], v[68:71], a[80:83], v[204:207]
    buffer_load_dwordx4 a[20:23], v8, s[8:11], s16 offen offset:256 sc1
    ds_read_b64_tr_b16 v[48:49], v56 offset:7168
    v_mfma_f32_16x16x32_bf16 v[208:211], v[60:63], a[52:55], v[208:211]
    s_mov_b32 s16, 55296
    ds_read_b64_tr_b16 v[50:51], v56 offset:16384
    v_fma_f32 v22, v22, v16, v16
    v_mfma_f32_16x16x32_bf16 v[208:211], v[64:67], a[68:71], v[208:211]
    ds_read_b64_tr_b16 v[52:53], v56 offset:8192
    v_fma_f32 v23, v23, v16, v16
    v_mfma_f32_16x16x32_bf16 v[208:211], v[68:71], a[84:87], v[208:211]
    ds_read_b64_tr_b16 v[54:55], v56 offset:17408
    v_mul_f32 v24, v13, v96
    v_mfma_f32_16x16x32_bf16 v[212:215], v[60:63], a[56:59], v[212:215]
    v_rcp_f32 v20, v20
    v_mfma_f32_16x16x32_bf16 v[212:215], v[64:67], a[72:75], v[212:215]
    buffer_load_dwordx4 a[24:27], v8, s[8:11], s16 offen offset:0 sc1
    v_mul_f32 v92, v20, v92
    v_mfma_f32_16x16x32_bf16 v[212:215], v[68:71], a[88:91], v[212:215]
    v_rcp_f32 v21, v21
    v_mfma_f32_16x16x32_bf16 v[216:219], v[60:63], a[60:63], v[216:219]
    v_rcp_f32 v22, v22
    v_mfma_f32_16x16x32_bf16 v[216:219], v[64:67], a[76:79], v[216:219]
    v_rcp_f32 v23, v23
    v_mfma_f32_16x16x32_bf16 v[216:219], v[68:71], a[92:95], v[216:219]
    s_waitcnt lgkmcnt(0)
    v_exp_f32 v24, v24
    v_mfma_f32_16x16x32_bf16 v[156:159], v[44:47], a[96:99], v[156:159]
    buffer_load_dwordx4 a[28:31], v8, s[8:11], s16 offen offset:256 sc1
    ds_read_b64_tr_b16 v[60:61], v57 offset:6144
    v_mfma_f32_16x16x32_bf16 v[156:159], v[48:51], a[112:115], v[156:159]
    s_mov_b32 s16, 1024
    ds_read_b64_tr_b16 v[62:63], v57 offset:15360
    v_mul_f32 v93, v21, v93
    v_mfma_f32_16x16x32_bf16 v[156:159], v[52:55], a[128:131], v[156:159]
    ds_read_b64_tr_b16 v[64:65], v57 offset:7168
    v_mul_f32 v94, v22, v94
    v_mfma_f32_16x16x32_bf16 v[160:163], v[44:47], a[100:103], v[160:163]
    ds_read_b64_tr_b16 v[66:67], v57 offset:16384
    v_mul_f32 v95, v23, v95
    v_mfma_f32_16x16x32_bf16 v[160:163], v[48:51], a[116:119], v[160:163]
    ds_read_b64_tr_b16 v[68:69], v57 offset:8192
    v_mul_f32 v25, v13, v97
    v_mfma_f32_16x16x32_bf16 v[160:163], v[52:55], a[132:135], v[160:163]
    buffer_load_dwordx4 v1, s[8:11], s15 offen offset:0 sc1 lds
    ds_read_b64_tr_b16 v[70:71], v57 offset:17408
    v_mfma_f32_16x16x32_bf16 v[164:167], v[44:47], a[104:107], v[164:167]
    v_exp_f32 v25, v25
    v_mfma_f32_16x16x32_bf16 v[164:167], v[48:51], a[120:123], v[164:167]
    v_mul_f32 v26, v13, v98
    v_mul_f32 v27, v13, v99
    v_mfma_f32_16x16x32_bf16 v[164:167], v[52:55], a[136:139], v[164:167]
    v_exp_f32 v26, v26
    v_mfma_f32_16x16x32_bf16 v[168:171], v[44:47], a[108:111], v[168:171]
    v_exp_f32 v27, v27
    v_mfma_f32_16x16x32_bf16 v[168:171], v[48:51], a[124:127], v[168:171]
    buffer_load_dwordx4 v1, s[8:11], s15 offen offset:1024 sc1 lds
    v_mfma_f32_16x16x32_bf16 v[168:171], v[52:55], a[140:143], v[168:171]
    s_waitcnt lgkmcnt(0)
    v_fma_f32 v24, v24, v17, v17
    v_fma_f32 v25, v25, v17, v17
    v_mfma_f32_16x16x32_bf16 v[172:175], v[60:63], a[96:99], v[172:175]
    ds_read_b64_tr_b16 v[44:45], v58 offset:6144
    v_fma_f32 v26, v26, v17, v17
    v_mfma_f32_16x16x32_bf16 v[172:175], v[64:67], a[112:115], v[172:175]
    ds_read_b64_tr_b16 v[46:47], v58 offset:15360
    v_fma_f32 v27, v27, v17, v17
    v_mfma_f32_16x16x32_bf16 v[172:175], v[68:71], a[128:131], v[172:175]
    ds_read_b64_tr_b16 v[48:49], v58 offset:7168
    v_mul_f32 v28, v14, v100
    v_mfma_f32_16x16x32_bf16 v[176:179], v[60:63], a[100:103], v[176:179]
    buffer_load_dwordx4 v1, s[8:11], s15 offen offset:2048 sc1 lds
    v_mfma_f32_16x16x32_bf16 v[176:179], v[64:67], a[116:119], v[176:179]
    ds_read_b64_tr_b16 v[50:51], v58 offset:16384
    v_mul_f32 v29, v14, v101
    v_mfma_f32_16x16x32_bf16 v[176:179], v[68:71], a[132:135], v[176:179]
    ds_read_b64_tr_b16 v[52:53], v58 offset:8192
    v_mul_f32 v30, v14, v102
    v_mfma_f32_16x16x32_bf16 v[180:183], v[60:63], a[104:107], v[180:183]
    ds_read_b64_tr_b16 v[54:55], v58 offset:17408
    v_mul_f32 v31, v14, v103
    v_mfma_f32_16x16x32_bf16 v[180:183], v[64:67], a[120:123], v[180:183]
    v_rcp_f32 v24, v24
    v_mfma_f32_16x16x32_bf16 v[180:183], v[68:71], a[136:139], v[180:183]
    buffer_load_dwordx4 v1, s[8:11], s15 offen offset:3072 sc1 lds
    v_mfma_f32_16x16x32_bf16 v[184:187], v[60:63], a[108:111], v[184:187]
    s_add_u32 m0, s12, 118784
    v_rcp_f32 v25, v25
    v_mfma_f32_16x16x32_bf16 v[184:187], v[64:67], a[124:127], v[184:187]
    s_add_u32 s15, s14, 45056
    v_rcp_f32 v26, v26
    v_mfma_f32_16x16x32_bf16 v[184:187], v[68:71], a[140:143], v[184:187]
    s_waitcnt lgkmcnt(0)
    v_rcp_f32 v27, v27
    v_mfma_f32_16x16x32_bf16 v[108:111], v[44:47], a[96:99], v[108:111]
    ds_read_b64_tr_b16 v[60:61], v59 offset:6144
    v_mul_f32 v96, v24, v96
    v_mfma_f32_16x16x32_bf16 v[108:111], v[48:51], a[112:115], v[108:111]
    buffer_load_dwordx4 v1, s[8:11], s15 offen offset:0 sc1 lds
    v_mfma_f32_16x16x32_bf16 v[108:111], v[52:55], a[128:131], v[108:111]
    ds_read_b64_tr_b16 v[62:63], v59 offset:15360
    v_mul_f32 v97, v25, v97
    v_mfma_f32_16x16x32_bf16 v[112:115], v[44:47], a[100:103], v[112:115]
    ds_read_b64_tr_b16 v[64:65], v59 offset:7168
    v_mul_f32 v98, v26, v98
    v_mfma_f32_16x16x32_bf16 v[112:115], v[48:51], a[116:119], v[112:115]
    ds_read_b64_tr_b16 v[66:67], v59 offset:16384
    v_mul_f32 v99, v27, v99
    v_mfma_f32_16x16x32_bf16 v[112:115], v[52:55], a[132:135], v[112:115]
    ds_read_b64_tr_b16 v[68:69], v59 offset:8192
    ds_read_b64_tr_b16 v[70:71], v59 offset:17408
    v_mfma_f32_16x16x32_bf16 v[116:119], v[44:47], a[104:107], v[116:119]
    buffer_load_dwordx4 a[32:35], v8, s[8:11], s16 offen offset:0 sc1
    v_mfma_f32_16x16x32_bf16 v[116:119], v[48:51], a[120:123], v[116:119]
    v_exp_f32 v28, v28
    v_mfma_f32_16x16x32_bf16 v[116:119], v[52:55], a[136:139], v[116:119]
    v_exp_f32 v29, v29
    v_mfma_f32_16x16x32_bf16 v[120:123], v[44:47], a[108:111], v[120:123]
    v_exp_f32 v30, v30
    v_mfma_f32_16x16x32_bf16 v[120:123], v[48:51], a[124:127], v[120:123]
    v_exp_f32 v31, v31
    v_mfma_f32_16x16x32_bf16 v[120:123], v[52:55], a[140:143], v[120:123]
    s_waitcnt lgkmcnt(0)
    v_fma_f32 v28, v28, v18, v18
    v_fma_f32 v29, v29, v18, v18
    v_mfma_f32_16x16x32_bf16 v[204:207], v[60:63], a[96:99], v[204:207]
    s_waitcnt vmcnt(29)
    s_barrier
    ds_read_b64_tr_b16 v[44:45], v56 offset:36864
    v_mfma_f32_16x16x32_bf16 v[204:207], v[64:67], a[112:115], v[204:207]
    buffer_load_dwordx4 a[36:39], v8, s[8:11], s16 offen offset:256 sc1
    v_mfma_f32_16x16x32_bf16 v[204:207], v[68:71], a[128:131], v[204:207]
    s_mov_b32 s16, 19456
    ds_read_b64_tr_b16 v[46:47], v56 offset:46080
    v_fma_f32 v30, v30, v18, v18
    v_mfma_f32_16x16x32_bf16 v[208:211], v[60:63], a[100:103], v[208:211]
    s_add_u32 m0, s12, 0
    ds_read_b64_tr_b16 v[48:49], v56 offset:37888
    v_fma_f32 v31, v31, v18, v18
    v_mfma_f32_16x16x32_bf16 v[208:211], v[64:67], a[116:119], v[208:211]
    s_add_u32 s15, s14, 73728
    ds_read_b64_tr_b16 v[50:51], v56 offset:47104
    v_mul_f32 v32, v15, v104
    v_mfma_f32_16x16x32_bf16 v[208:211], v[68:71], a[132:135], v[208:211]
    buffer_load_dwordx4 a[40:43], v8, s[8:11], s16 offen offset:0 sc1
    v_mfma_f32_16x16x32_bf16 v[212:215], v[60:63], a[104:107], v[212:215]
    ds_read_b64_tr_b16 v[52:53], v56 offset:38912
    v_mul_f32 v33, v15, v105
    v_mfma_f32_16x16x32_bf16 v[212:215], v[64:67], a[120:123], v[212:215]
    ds_read_b64_tr_b16 v[54:55], v56 offset:48128
    v_mul_f32 v34, v15, v106
    v_mfma_f32_16x16x32_bf16 v[212:215], v[68:71], a[136:139], v[212:215]
    v_rcp_f32 v28, v28
    v_mfma_f32_16x16x32_bf16 v[216:219], v[60:63], a[108:111], v[216:219]
    v_mov_b32 v255, 2
    v_mul_f32 v100, v28, v100
    v_mfma_f32_16x16x32_bf16 v[216:219], v[64:67], a[124:127], v[216:219]
    buffer_load_dwordx4 a[44:47], v8, s[8:11], s16 offen offset:256 sc1
    v_mfma_f32_16x16x32_bf16 v[216:219], v[68:71], a[140:143], v[216:219]
    s_waitcnt lgkmcnt(0)
    v_rcp_f32 v29, v29
    v_mfma_f32_16x16x32_bf16 v[156:159], v[44:47], a[144:147], v[156:159]
    s_waitcnt vmcnt(12)
    ds_read_b64_tr_b16 v[60:61], v56 offset:39936
    v_mul_f32 v101, v29, v101
    v_mfma_f32_16x16x32_bf16 v[156:159], v[48:51], a[160:163], v[156:159]
    s_mov_b32 s16, 37888
    ds_read_b64_tr_b16 v[62:63], v56 offset:49152
    v_mul_f32 v35, v15, v107
    v_mfma_f32_16x16x32_bf16 v[156:159], v[52:55], a[176:179], v[156:159]
    ds_read_b64_tr_b16 v[64:65], v56 offset:40960
    ds_read_b64_tr_b16 v[66:67], v56 offset:50176
    v_mfma_f32_16x16x32_bf16 v[160:163], v[44:47], a[148:151], v[160:163]
    buffer_store_dword v255, v252, s[8:11], 0 offen sc1
    v_mfma_f32_16x16x32_bf16 v[160:163], v[48:51], a[164:167], v[160:163]
    buffer_load_dwordx4 a[48:51], v8, s[8:11], s16 offen offset:0 sc1
    v_mfma_f32_16x16x32_bf16 v[160:163], v[52:55], a[180:183], v[160:163]
    ds_read_b64_tr_b16 v[68:69], v56 offset:41984
    ds_read_b64_tr_b16 v[70:71], v56 offset:51200
    v_mfma_f32_16x16x32_bf16 v[164:167], v[44:47], a[152:155], v[164:167]
    v_rcp_f32 v30, v30
    v_mfma_f32_16x16x32_bf16 v[164:167], v[48:51], a[168:171], v[164:167]
    v_rcp_f32 v31, v31
    v_mfma_f32_16x16x32_bf16 v[164:167], v[52:55], a[184:187], v[164:167]
    v_exp_f32 v32, v32
    v_mfma_f32_16x16x32_bf16 v[168:171], v[44:47], a[156:159], v[168:171]
    buffer_load_dwordx4 a[52:55], v8, s[8:11], s16 offen offset:256 sc1
    v_mfma_f32_16x16x32_bf16 v[168:171], v[48:51], a[172:175], v[168:171]
    s_mov_b32 s16, 56320
    v_exp_f32 v33, v33
    v_mfma_f32_16x16x32_bf16 v[168:171], v[52:55], a[188:191], v[168:171]
    s_waitcnt lgkmcnt(0)
    v_exp_f32 v34, v34
    v_mfma_f32_16x16x32_bf16 v[168:171], v[60:63], a[204:207], v[168:171]
    ds_read_b64_tr_b16 v[44:45], v56 offset:43008
    v_mul_f32 v102, v30, v102
    v_mfma_f32_16x16x32_bf16 v[168:171], v[64:67], a[220:223], v[168:171]
    ds_read_b64_tr_b16 v[46:47], v56 offset:52224
    v_mul_f32 v103, v31, v103
    v_mfma_f32_16x16x32_bf16 v[168:171], v[68:71], a[236:239], v[168:171]
    buffer_load_dwordx4 a[56:59], v8, s[8:11], s16 offen offset:0 sc1
    v_mfma_f32_16x16x32_bf16 v[164:167], v[60:63], a[200:203], v[164:167]
    ds_read_b64_tr_b16 v[48:49], v56 offset:44032
    v_fma_f32 v32, v32, v19, v19
    v_mfma_f32_16x16x32_bf16 v[164:167], v[64:67], a[216:219], v[164:167]
    ds_read_b64_tr_b16 v[50:51], v56 offset:53248
    v_fma_f32 v33, v33, v19, v19
    v_mfma_f32_16x16x32_bf16 v[164:167], v[68:71], a[232:235], v[164:167]
    ds_read_b64_tr_b16 v[52:53], v56 offset:45056
    v_fma_f32 v34, v34, v19, v19
    v_mfma_f32_16x16x32_bf16 v[160:163], v[60:63], a[196:199], v[160:163]
    ds_read_b64_tr_b16 v[54:55], v56 offset:54272
    v_mul_f32 v20, v12, v188
    v_mfma_f32_16x16x32_bf16 v[160:163], v[64:67], a[212:215], v[160:163]
    buffer_load_dwordx4 a[60:63], v8, s[8:11], s16 offen offset:256 sc1
    v_mfma_f32_16x16x32_bf16 v[160:163], v[68:71], a[228:231], v[160:163]
    s_mov_b32 s16, 2048
    v_exp_f32 v35, v35
    v_mfma_f32_16x16x32_bf16 v[156:159], v[60:63], a[192:195], v[156:159]
    v_rcp_f32 v32, v32
    v_mfma_f32_16x16x32_bf16 v[156:159], v[64:67], a[208:211], v[156:159]
    v_rcp_f32 v33, v33
    v_mfma_f32_16x16x32_bf16 v[156:159], v[68:71], a[224:227], v[156:159]
    s_waitcnt lgkmcnt(0)
    v_rcp_f32 v34, v34
    v_mfma_f32_16x16x32_bf16 v[156:159], v[44:47], a[240:243], v[156:159]
    buffer_load_dwordx4 v1, s[8:11], s15 offen offset:0 sc1 lds
    v_mfma_f32_16x16x32_bf16 v[156:159], v[48:51], v[220:223], v[156:159]
    ds_read_b64_tr_b16 v[60:61], v57 offset:36864
    v_fma_f32 v35, v35, v19, v19
    v_mfma_f32_16x16x32_bf16 v[156:159], v[52:55], v[236:239], v[156:159]
    ds_read_b64_tr_b16 v[62:63], v57 offset:46080
    v_mul_f32 v104, v32, v104
    v_mfma_f32_16x16x32_bf16 v[160:163], v[44:47], a[244:247], v[160:163]
    ds_read_b64_tr_b16 v[64:65], v57 offset:37888
    v_mul_f32 v105, v33, v105
    v_mfma_f32_16x16x32_bf16 v[160:163], v[48:51], v[224:227], v[160:163]
    ds_read_b64_tr_b16 v[66:67], v57 offset:47104
    v_mul_f32 v106, v34, v106
    v_mfma_f32_16x16x32_bf16 v[160:163], v[52:55], v[240:243], v[160:163]
    buffer_load_dwordx4 v1, s[8:11], s15 offen offset:1024 sc1 lds
    v_mfma_f32_16x16x32_bf16 v[164:167], v[44:47], a[248:251], v[164:167]
    ds_read_b64_tr_b16 v[68:69], v57 offset:38912
    v_mul_f32 v21, v12, v189
    v_mfma_f32_16x16x32_bf16 v[164:167], v[48:51], v[228:231], v[164:167]
    ds_read_b64_tr_b16 v[70:71], v57 offset:48128
    v_mul_f32 v22, v12, v190
    v_mfma_f32_16x16x32_bf16 v[164:167], v[52:55], v[244:247], v[164:167]
    v_rcp_f32 v35, v35
    v_mfma_f32_16x16x32_bf16 v[168:171], v[44:47], a[252:255], v[168:171]
    v_exp_f32 v20, v20
    v_mfma_f32_16x16x32_bf16 v[168:171], v[48:51], v[232:235], v[168:171]
    buffer_load_dwordx4 v1, s[8:11], s15 offen offset:2048 sc1 lds
    v_mfma_f32_16x16x32_bf16 v[168:171], v[52:55], v[248:251], v[168:171]
    s_waitcnt lgkmcnt(0)
    v_exp_f32 v21, v21
    v_mfma_f32_16x16x32_bf16 v[172:175], v[60:63], a[144:147], v[172:175]
    s_mov_b32 s17, 5120
    ds_read_b64_tr_b16 v[44:45], v57 offset:39936
    ds_read_b64_tr_b16 v[46:47], v57 offset:49152
    v_mfma_f32_16x16x32_bf16 v[172:175], v[64:67], a[160:163], v[172:175]
    ds_read_b64_tr_b16 v[48:49], v57 offset:40960
    ds_read_b64_tr_b16 v[50:51], v57 offset:50176
    v_mfma_f32_16x16x32_bf16 v[172:175], v[68:71], a[176:179], v[172:175]
    ds_read_b64_tr_b16 v[52:53], v57 offset:41984
    ds_read_b64_tr_b16 v[54:55], v57 offset:51200
    v_mfma_f32_16x16x32_bf16 v[176:179], v[60:63], a[148:151], v[176:179]
    buffer_load_dwordx4 v1, s[8:11], s15 offen offset:3072 sc1 lds
    v_mfma_f32_16x16x32_bf16 v[176:179], v[64:67], a[164:167], v[176:179]
    s_add_u32 m0, s12, 4096
    v_mul_f32 v76, v76, v156
    v_mul_f32 v77, v77, v157
    v_mfma_f32_16x16x32_bf16 v[176:179], v[68:71], a[180:183], v[176:179]
    s_add_u32 s15, s14, 77824
    v_mul_f32 v78, v78, v158
    v_mul_f32 v79, v79, v159
    v_mfma_f32_16x16x32_bf16 v[180:183], v[60:63], a[152:155], v[180:183]
    v_mul_f32 v80, v80, v160
    v_mul_f32 v81, v81, v161
    v_mfma_f32_16x16x32_bf16 v[180:183], v[64:67], a[168:171], v[180:183]
    v_mul_f32 v82, v82, v162
    v_mul_f32 v83, v83, v163
    v_mfma_f32_16x16x32_bf16 v[180:183], v[68:71], a[184:187], v[180:183]
    buffer_load_dwordx4 v1, s[8:11], s15 offen offset:0 sc1 lds
    v_mfma_f32_16x16x32_bf16 v[184:187], v[60:63], a[156:159], v[184:187]
    v_cvt_pk_bf16_f32 v36, v76, v77
    v_cvt_pk_bf16_f32 v37, v78, v79
    v_mfma_f32_16x16x32_bf16 v[184:187], v[64:67], a[172:175], v[184:187]
    v_cvt_pk_bf16_f32 v38, v80, v81
    v_cvt_pk_bf16_f32 v39, v82, v83
    v_mfma_f32_16x16x32_bf16 v[184:187], v[68:71], a[188:191], v[184:187]
    s_waitcnt lgkmcnt(0)
    v_mul_f32 v84, v84, v164
    v_mul_f32 v85, v85, v165
    v_mfma_f32_16x16x32_bf16 v[184:187], v[44:47], a[204:207], v[184:187]
    ds_read_b64_tr_b16 v[60:61], v57 offset:43008
    v_mul_f32 v86, v86, v166
    v_mfma_f32_16x16x32_bf16 v[184:187], v[48:51], a[220:223], v[184:187]
    buffer_load_dwordx4 v1, s[8:11], s15 offen offset:1024 sc1 lds
    v_mfma_f32_16x16x32_bf16 v[184:187], v[52:55], a[236:239], v[184:187]
    ds_read_b64_tr_b16 v[62:63], v57 offset:52224
    v_mul_f32 v87, v87, v167
    v_mfma_f32_16x16x32_bf16 v[180:183], v[44:47], a[200:203], v[180:183]
    ds_read_b64_tr_b16 v[64:65], v57 offset:44032
    v_mul_f32 v88, v88, v168
    v_mfma_f32_16x16x32_bf16 v[180:183], v[48:51], a[216:219], v[180:183]
    ds_read_b64_tr_b16 v[66:67], v57 offset:53248
    v_mul_f32 v89, v89, v169
    v_mfma_f32_16x16x32_bf16 v[180:183], v[52:55], a[232:235], v[180:183]
    ds_read_b64_tr_b16 v[68:69], v57 offset:45056
    v_mul_f32 v90, v90, v170
    v_mfma_f32_16x16x32_bf16 v[176:179], v[44:47], a[196:199], v[176:179]
    buffer_load_dwordx4 v1, s[8:11], s15 offen offset:2048 sc1 lds
    v_mfma_f32_16x16x32_bf16 v[176:179], v[48:51], a[212:215], v[176:179]
    ds_read_b64_tr_b16 v[70:71], v57 offset:54272
    v_mul_f32 v91, v91, v171
    v_mfma_f32_16x16x32_bf16 v[176:179], v[52:55], a[228:231], v[176:179]
    v_cvt_pk_bf16_f32 v40, v84, v85
    v_cvt_pk_bf16_f32 v41, v86, v87
    v_mfma_f32_16x16x32_bf16 v[172:175], v[44:47], a[192:195], v[172:175]
    v_cvt_pk_bf16_f32 v42, v88, v89
    v_cvt_pk_bf16_f32 v43, v90, v91
    v_mfma_f32_16x16x32_bf16 v[172:175], v[48:51], a[208:211], v[172:175]
    v_exp_f32 v22, v22
    v_mfma_f32_16x16x32_bf16 v[172:175], v[52:55], a[224:227], v[172:175]
    s_waitcnt lgkmcnt(0)
    v_permlane16_swap_b32 v36, v38
    v_permlane16_swap_b32 v37, v39
    v_mfma_f32_16x16x32_bf16 v[172:175], v[60:63], a[240:243], v[172:175]
    buffer_store_dwordx4 v[36:39], v7, s[8:11], s17 offen sc1
    v_mfma_f32_16x16x32_bf16 v[172:175], v[64:67], v[220:223], v[172:175]
    s_mov_b32 s17, 300032
    ds_read_b64_tr_b16 v[44:45], v58 offset:36864
    v_permlane16_swap_b32 v40, v42
    v_mfma_f32_16x16x32_bf16 v[172:175], v[68:71], v[236:239], v[172:175]
    ds_read_b64_tr_b16 v[46:47], v58 offset:46080
    v_permlane16_swap_b32 v41, v43
    v_mfma_f32_16x16x32_bf16 v[176:179], v[60:63], a[244:247], v[176:179]
    ds_read_b64_tr_b16 v[48:49], v58 offset:37888
    v_mul_f32 v107, v35, v107
    v_mfma_f32_16x16x32_bf16 v[176:179], v[64:67], v[224:227], v[176:179]
    buffer_store_dwordx4 v[40:43], v7, s[8:11], s17 offen sc1
    v_mfma_f32_16x16x32_bf16 v[176:179], v[68:71], v[240:243], v[176:179]
    ds_read_b64_tr_b16 v[50:51], v58 offset:47104
    v_mul_f32 v23, v12, v191
    v_mfma_f32_16x16x32_bf16 v[180:183], v[60:63], a[248:251], v[180:183]
    ds_read_b64_tr_b16 v[52:53], v58 offset:38912
    v_fma_f32 v20, v20, v16, v16
    v_mfma_f32_16x16x32_bf16 v[180:183], v[64:67], v[228:231], v[180:183]
    ds_read_b64_tr_b16 v[54:55], v58 offset:48128
    v_fma_f32 v21, v21, v16, v16
    v_mfma_f32_16x16x32_bf16 v[180:183], v[68:71], v[244:247], v[180:183]
    v_exp_f32 v23, v23
    v_mfma_f32_16x16x32_bf16 v[184:187], v[60:63], a[252:255], v[184:187]
    buffer_load_dwordx4 v1, s[8:11], s15 offen offset:3072 sc1 lds
    v_mfma_f32_16x16x32_bf16 v[184:187], v[64:67], v[232:235], v[184:187]
    s_add_u32 m0, s12, 8192
    v_rcp_f32 v20, v20
    v_mfma_f32_16x16x32_bf16 v[184:187], v[68:71], v[248:251], v[184:187]
    s_waitcnt lgkmcnt(0)
    v_rcp_f32 v21, v21
    v_mfma_f32_16x16x32_bf16 v[108:111], v[44:47], a[144:147], v[108:111]
    s_add_u32 s15, s14, 81920
    ds_read_b64_tr_b16 v[60:61], v58 offset:39936
    ds_read_b64_tr_b16 v[62:63], v58 offset:49152
    v_mfma_f32_16x16x32_bf16 v[108:111], v[48:51], a[160:163], v[108:111]
    s_mov_b32 s17, 6144
    ds_read_b64_tr_b16 v[64:65], v58 offset:40960
    ds_read_b64_tr_b16 v[66:67], v58 offset:50176
    v_mfma_f32_16x16x32_bf16 v[108:111], v[52:55], a[176:179], v[108:111]
    buffer_load_dword v254, v253, s[8:11], 0 offen sc1
    v_mfma_f32_16x16x32_bf16 v[112:115], v[44:47], a[148:151], v[112:115]
    buffer_load_dwordx4 v1, s[8:11], s15 offen offset:0 sc1 lds
    v_mfma_f32_16x16x32_bf16 v[112:115], v[48:51], a[164:167], v[112:115]
    ds_read_b64_tr_b16 v[68:69], v58 offset:41984
    v_mul_f32 v140, v140, v172
    v_mfma_f32_16x16x32_bf16 v[112:115], v[52:55], a[180:183], v[112:115]
    ds_read_b64_tr_b16 v[70:71], v58 offset:51200
    v_mul_f32 v141, v141, v173
    v_mfma_f32_16x16x32_bf16 v[116:119], v[44:47], a[152:155], v[116:119]
    v_mul_f32 v142, v142, v174
    v_mul_f32 v143, v143, v175
    v_mfma_f32_16x16x32_bf16 v[116:119], v[48:51], a[168:171], v[116:119]
    v_mul_f32 v144, v144, v176
    v_mul_f32 v145, v145, v177
    v_mfma_f32_16x16x32_bf16 v[116:119], v[52:55], a[184:187], v[116:119]
    buffer_load_dwordx4 a[64:67], v8, s[8:11], s16 offen offset:0 sc1
    v_mfma_f32_16x16x32_bf16 v[120:123], v[44:47], a[156:159], v[120:123]
    v_mul_f32 v146, v146, v178
    v_mul_f32 v147, v147, v179
    v_mfma_f32_16x16x32_bf16 v[120:123], v[48:51], a[172:175], v[120:123]
    v_cvt_pk_bf16_f32 v36, v140, v141
    v_cvt_pk_bf16_f32 v37, v142, v143
    v_mfma_f32_16x16x32_bf16 v[120:123], v[52:55], a[188:191], v[120:123]
    s_waitcnt lgkmcnt(0)
    v_cvt_pk_bf16_f32 v38, v144, v145
    v_cvt_pk_bf16_f32 v39, v146, v147
    v_mfma_f32_16x16x32_bf16 v[120:123], v[60:63], a[204:207], v[120:123]
    ds_read_b64_tr_b16 v[44:45], v58 offset:43008
    v_mul_f32 v148, v148, v180
    v_mfma_f32_16x16x32_bf16 v[120:123], v[64:67], a[220:223], v[120:123]
    buffer_load_dwordx4 a[68:71], v8, s[8:11], s16 offen offset:256 sc1
    v_mfma_f32_16x16x32_bf16 v[120:123], v[68:71], a[236:239], v[120:123]
    s_mov_b32 s16, 20480
    ds_read_b64_tr_b16 v[46:47], v58 offset:52224
    v_mul_f32 v149, v149, v181
    v_mfma_f32_16x16x32_bf16 v[116:119], v[60:63], a[200:203], v[116:119]
    ds_read_b64_tr_b16 v[48:49], v58 offset:44032
    v_mul_f32 v150, v150, v182
    v_mfma_f32_16x16x32_bf16 v[116:119], v[64:67], a[216:219], v[116:119]
    ds_read_b64_tr_b16 v[50:51], v58 offset:53248
    v_mul_f32 v151, v151, v183
    v_mfma_f32_16x16x32_bf16 v[116:119], v[68:71], a[232:235], v[116:119]
    ds_read_b64_tr_b16 v[52:53], v58 offset:45056
    v_mul_f32 v152, v152, v184
    v_mfma_f32_16x16x32_bf16 v[112:115], v[60:63], a[196:199], v[112:115]
    buffer_load_dwordx4 a[72:75], v8, s[8:11], s16 offen offset:0 sc1
    v_mfma_f32_16x16x32_bf16 v[112:115], v[64:67], a[212:215], v[112:115]
    ds_read_b64_tr_b16 v[54:55], v58 offset:54272
    v_mul_f32 v153, v153, v185
    v_mfma_f32_16x16x32_bf16 v[112:115], v[68:71], a[228:231], v[112:115]
    v_mul_f32 v154, v154, v186
    v_mul_f32 v155, v155, v187
    v_mfma_f32_16x16x32_bf16 v[108:111], v[60:63], a[192:195], v[108:111]
    v_cvt_pk_bf16_f32 v40, v148, v149
    v_cvt_pk_bf16_f32 v41, v150, v151
    v_mfma_f32_16x16x32_bf16 v[108:111], v[64:67], a[208:211], v[108:111]
    v_cvt_pk_bf16_f32 v42, v152, v153
    v_cvt_pk_bf16_f32 v43, v154, v155
    v_mfma_f32_16x16x32_bf16 v[108:111], v[68:71], a[224:227], v[108:111]
    s_waitcnt lgkmcnt(0)
    v_permlane16_swap_b32 v36, v38
    v_permlane16_swap_b32 v37, v39
    v_mfma_f32_16x16x32_bf16 v[108:111], v[44:47], a[240:243], v[108:111]
    buffer_store_dwordx4 v[36:39], v7, s[8:11], s17 offen sc1
    v_mfma_f32_16x16x32_bf16 v[108:111], v[48:51], v[220:223], v[108:111]
    s_mov_b32 s17, 301056
    ds_read_b64_tr_b16 v[60:61], v59 offset:36864
    v_permlane16_swap_b32 v40, v42
    v_mfma_f32_16x16x32_bf16 v[108:111], v[52:55], v[236:239], v[108:111]
    ds_read_b64_tr_b16 v[62:63], v59 offset:46080
    v_permlane16_swap_b32 v41, v43
    v_mfma_f32_16x16x32_bf16 v[112:115], v[44:47], a[244:247], v[112:115]
    ds_read_b64_tr_b16 v[64:65], v59 offset:37888
    v_fma_f32 v22, v22, v16, v16
    v_mfma_f32_16x16x32_bf16 v[112:115], v[48:51], v[224:227], v[112:115]
    buffer_store_dwordx4 v[40:43], v7, s[8:11], s17 offen sc1
    v_mfma_f32_16x16x32_bf16 v[112:115], v[52:55], v[240:243], v[112:115]
L_pad_c1_5:
    s_cbranch_execz L_hopret_c1
    ds_read_b64_tr_b16 v[66:67], v59 offset:47104
    v_fma_f32 v23, v23, v16, v16
    v_mfma_f32_16x16x32_bf16 v[116:119], v[44:47], a[248:251], v[116:119]
    ds_read_b64_tr_b16 v[68:69], v59 offset:38912
    v_mul_f32 v188, v20, v188
    v_mfma_f32_16x16x32_bf16 v[116:119], v[48:51], v[228:231], v[116:119]
    ds_read_b64_tr_b16 v[70:71], v59 offset:48128
    v_mul_f32 v189, v21, v189
    v_mfma_f32_16x16x32_bf16 v[116:119], v[52:55], v[244:247], v[116:119]
    v_rcp_f32 v22, v22
    v_mfma_f32_16x16x32_bf16 v[120:123], v[44:47], a[252:255], v[120:123]
    buffer_load_dwordx4 a[76:79], v8, s[8:11], s16 offen offset:256 sc1
    v_mfma_f32_16x16x32_bf16 v[120:123], v[48:51], v[232:235], v[120:123]
    s_mov_b32 s16, 38912
    v_rcp_f32 v23, v23
    v_mfma_f32_16x16x32_bf16 v[120:123], v[52:55], v[248:251], v[120:123]
    s_waitcnt lgkmcnt(0)
    v_mul_f32 v190, v22, v190
    v_mul_f32 v191, v23, v191
    v_mfma_f32_16x16x32_bf16 v[204:207], v[60:63], a[144:147], v[204:207]
    s_mov_b32 s17, 7168
    ds_read_b64_tr_b16 v[44:45], v59 offset:39936
    ds_read_b64_tr_b16 v[46:47], v59 offset:49152
    v_mfma_f32_16x16x32_bf16 v[204:207], v[64:67], a[160:163], v[204:207]
    ds_read_b64_tr_b16 v[48:49], v59 offset:40960
    ds_read_b64_tr_b16 v[50:51], v59 offset:50176
    v_mfma_f32_16x16x32_bf16 v[204:207], v[68:71], a[176:179], v[204:207]
    buffer_load_dwordx4 a[80:83], v8, s[8:11], s16 offen offset:0 sc1
    v_mfma_f32_16x16x32_bf16 v[208:211], v[60:63], a[148:151], v[208:211]
    ds_read_b64_tr_b16 v[52:53], v59 offset:41984
    v_mul_f32 v92, v92, v108
    v_mfma_f32_16x16x32_bf16 v[208:211], v[64:67], a[164:167], v[208:211]
    ds_read_b64_tr_b16 v[54:55], v59 offset:51200
    v_mul_f32 v93, v93, v109
    v_mfma_f32_16x16x32_bf16 v[208:211], v[68:71], a[180:183], v[208:211]
    v_mul_f32 v94, v94, v110
    v_mul_f32 v95, v95, v111
    v_mfma_f32_16x16x32_bf16 v[212:215], v[60:63], a[152:155], v[212:215]
    v_mul_f32 v96, v96, v112
    v_mul_f32 v97, v97, v113
    v_mfma_f32_16x16x32_bf16 v[212:215], v[64:67], a[168:171], v[212:215]
    buffer_load_dwordx4 a[84:87], v8, s[8:11], s16 offen offset:256 sc1
    v_mfma_f32_16x16x32_bf16 v[212:215], v[68:71], a[184:187], v[212:215]
    s_mov_b32 s16, 57344
    v_mul_f32 v98, v98, v114
    v_mul_f32 v99, v99, v115
    v_mfma_f32_16x16x32_bf16 v[216:219], v[60:63], a[156:159], v[216:219]
    v_cvt_pk_bf16_f32 v36, v92, v93
    v_cvt_pk_bf16_f32 v37, v94, v95
    v_mfma_f32_16x16x32_bf16 v[216:219], v[64:67], a[172:175], v[216:219]
    v_cvt_pk_bf16_f32 v38, v96, v97
    v_cvt_pk_bf16_f32 v39, v98, v99
    v_mfma_f32_16x16x32_bf16 v[216:219], v[68:71], a[188:191], v[216:219]
    s_waitcnt lgkmcnt(0)
    v_mul_f32 v100, v100, v116
    v_mul_f32 v101, v101, v117
    v_mfma_f32_16x16x32_bf16 v[216:219], v[44:47], a[204:207], v[216:219]
    buffer_load_dwordx4 a[88:91], v8, s[8:11], s16 offen offset:0 sc1
    v_mfma_f32_16x16x32_bf16 v[216:219], v[48:51], a[220:223], v[216:219]
    ds_read_b64_tr_b16 v[60:61], v59 offset:43008
    v_mul_f32 v102, v102, v118
    v_mfma_f32_16x16x32_bf16 v[216:219], v[52:55], a[236:239], v[216:219]
    ds_read_b64_tr_b16 v[62:63], v59 offset:52224
    v_mul_f32 v103, v103, v119
    v_mfma_f32_16x16x32_bf16 v[212:215], v[44:47], a[200:203], v[212:215]
    ds_read_b64_tr_b16 v[64:65], v59 offset:44032
    v_mul_f32 v104, v104, v120
    v_mfma_f32_16x16x32_bf16 v[212:215], v[48:51], a[216:219], v[212:215]
    ds_read_b64_tr_b16 v[66:67], v59 offset:53248
    v_mul_f32 v105, v105, v121
    v_mfma_f32_16x16x32_bf16 v[212:215], v[52:55], a[232:235], v[212:215]
    buffer_load_dwordx4 a[92:95], v8, s[8:11], s16 offen offset:256 sc1
    v_mfma_f32_16x16x32_bf16 v[208:211], v[44:47], a[196:199], v[208:211]
    ds_read_b64_tr_b16 v[68:69], v59 offset:45056
    v_mul_f32 v106, v106, v122
    v_mfma_f32_16x16x32_bf16 v[208:211], v[48:51], a[212:215], v[208:211]
    ds_read_b64_tr_b16 v[70:71], v59 offset:54272
    v_mul_f32 v107, v107, v123
    v_mfma_f32_16x16x32_bf16 v[208:211], v[52:55], a[228:231], v[208:211]
    v_cvt_pk_bf16_f32 v40, v100, v101
    v_cvt_pk_bf16_f32 v41, v102, v103
    v_mfma_f32_16x16x32_bf16 v[204:207], v[44:47], a[192:195], v[204:207]
    v_cvt_pk_bf16_f32 v42, v104, v105
    v_cvt_pk_bf16_f32 v43, v106, v107
    v_mfma_f32_16x16x32_bf16 v[204:207], v[48:51], a[208:211], v[204:207]
    v_permlane16_swap_b32 v36, v38
    v_permlane16_swap_b32 v37, v39
    v_mfma_f32_16x16x32_bf16 v[204:207], v[52:55], a[224:227], v[204:207]
    s_waitcnt lgkmcnt(0)
    v_permlane16_swap_b32 v40, v42
    v_permlane16_swap_b32 v41, v43
    v_mfma_f32_16x16x32_bf16 v[204:207], v[60:63], a[240:243], v[204:207]
    s_waitcnt vmcnt(36)
    s_barrier
    s_add_u32 m0, s12, 36864
    v_mfma_f32_16x16x32_bf16 v[204:207], v[64:67], v[220:223], v[204:207]
    buffer_store_dwordx4 v[36:39], v7, s[8:11], s17 offen sc1
    v_mfma_f32_16x16x32_bf16 v[204:207], v[68:71], v[236:239], v[204:207]
    s_waitcnt vmcnt(12)
    v_cmp_gt_u32 s[46:47], 2, v254
    ds_read_b128 v[44:47], v4 offset:0
    v_mfma_f32_16x16x32_bf16 v[208:211], v[60:63], a[244:247], v[208:211]
    s_add_u32 s15, s14, 110592
    ds_read_b128 v[48:51], v4 offset:1024
    v_mul_f32 v24, v13, v192
    v_mfma_f32_16x16x32_bf16 v[208:211], v[64:67], v[224:227], v[208:211]
    s_cmp_lg_u64 s[46:47], 0
    s_cbranch_scc1 L_slow14
L_slow14_ret:
    ds_read_b128 v[52:55], v4 offset:2048
    v_mfma_f32_16x16x32_bf16 v[208:211], v[68:71], v[240:243], v[208:211]
    buffer_load_dwordx4 v1, s[8:11], s15 offen offset:0 sc1 lds
    v_mfma_f32_16x16x32_bf16 v[212:215], v[60:63], a[248:251], v[212:215]
    s_mov_b32 s16, 3072
    ds_read_b128 v[56:59], v4 offset:3072
    v_mul_f32 v25, v13, v193
    v_mfma_f32_16x16x32_bf16 v[212:215], v[64:67], v[228:231], v[212:215]
    s_mov_b32 s17, 302080
    v_exp_f32 v24, v24
    v_mfma_f32_16x16x32_bf16 v[212:215], v[68:71], v[244:247], v[212:215]
    v_exp_f32 v25, v25
    v_mfma_f32_16x16x32_bf16 v[216:219], v[60:63], a[252:255], v[216:219]
    v_mul_f32 v26, v13, v194
    v_mul_f32 v27, v13, v195
    v_mfma_f32_16x16x32_bf16 v[216:219], v[64:67], v[232:235], v[216:219]
    buffer_store_dwordx4 v[40:43], v7, s[8:11], s17 offen sc1
    v_mfma_f32_16x16x32_bf16 v[216:219], v[68:71], v[248:251], v[216:219]
    s_waitcnt lgkmcnt(0)
    v_exp_f32 v26, v26
    v_mfma_f32_16x16x32_bf16 v[124:127], v[44:47], a[0:3], 0
    ds_read_b128 v[60:63], v4 offset:4096
    v_fma_f32 v24, v24, v17, v17
    v_mfma_f32_16x16x32_bf16 v[124:127], v[48:51], a[8:11], v[124:127]
    ds_read_b128 v[64:67], v4 offset:5120
    v_fma_f32 v25, v25, v17, v17
    v_mfma_f32_16x16x32_bf16 v[124:127], v[52:55], a[16:19], v[124:127]
    ds_read_b128 v[68:71], v4 offset:6144
    v_fma_f32 v26, v26, v17, v17
    v_mfma_f32_16x16x32_bf16 v[124:127], v[56:59], a[24:27], v[124:127]
    buffer_load_dwordx4 v1, s[8:11], s15 offen offset:1024 sc1 lds
    v_mfma_f32_16x16x32_bf16 v[128:131], v[44:47], a[4:7], 0
    ds_read_b128 v[72:75], v4 offset:7168
    v_mul_f32 v28, v14, v196
    v_mfma_f32_16x16x32_bf16 v[128:131], v[48:51], a[12:15], v[128:131]
    v_exp_f32 v27, v27
    v_mfma_f32_16x16x32_bf16 v[128:131], v[52:55], a[20:23], v[128:131]
    v_rcp_f32 v24, v24
    v_mfma_f32_16x16x32_bf16 v[128:131], v[56:59], a[28:31], v[128:131]
    s_waitcnt lgkmcnt(0)
    v_rcp_f32 v25, v25
    v_mfma_f32_16x16x32_bf16 v[132:135], v[60:63], a[0:3], 0
    buffer_load_dwordx4 v1, s[8:11], s15 offen offset:2048 sc1 lds
    v_mfma_f32_16x16x32_bf16 v[132:135], v[64:67], a[8:11], v[132:135]
    ds_read_b128 v[44:47], v4 offset:8192
    ds_read_b128 v[48:51], v4 offset:9216
    v_mfma_f32_16x16x32_bf16 v[132:135], v[68:71], a[16:19], v[132:135]
    ds_read_b128 v[52:55], v4 offset:10240
    v_fma_f32 v27, v27, v17, v17
    v_mfma_f32_16x16x32_bf16 v[132:135], v[72:75], a[24:27], v[132:135]
    ds_read_b128 v[56:59], v4 offset:11264
    v_mul_f32 v192, v24, v192
    v_mfma_f32_16x16x32_bf16 v[136:139], v[60:63], a[4:7], 0
    v_rcp_f32 v26, v26
    v_mfma_f32_16x16x32_bf16 v[136:139], v[64:67], a[12:15], v[136:139]
    buffer_load_dwordx4 v1, s[8:11], s15 offen offset:3072 sc1 lds
    v_mfma_f32_16x16x32_bf16 v[136:139], v[68:71], a[20:23], v[136:139]
    s_add_u32 m0, s12, 40960
    v_rcp_f32 v27, v27
    v_mfma_f32_16x16x32_bf16 v[136:139], v[72:75], a[28:31], v[136:139]
    s_waitcnt lgkmcnt(0)
    v_exp_f32 v28, v28
    v_mfma_f32_16x16x32_bf16 v[76:79], v[44:47], a[0:3], 0
    v_mov_b32 v255, 3
    ds_read_b128 v[60:63], v4 offset:12288
    v_mfma_f32_16x16x32_bf16 v[76:79], v[48:51], a[8:11], v[76:79]
    s_add_u32 s15, s14, 114688
    ds_read_b128 v[64:67], v4 offset:13312
    v_mul_f32 v193, v25, v193
    v_mfma_f32_16x16x32_bf16 v[76:79], v[52:55], a[16:19], v[76:79]
    buffer_load_dwordx4 v1, s[8:11], s15 offen offset:0 sc1 lds
    v_mfma_f32_16x16x32_bf16 v[76:79], v[56:59], a[24:27], v[76:79]
    s_waitcnt vmcnt(12)
    ds_read_b128 v[68:71], v4 offset:14336
    ds_read_b128 v[72:75], v4 offset:15360
    v_mfma_f32_16x16x32_bf16 v[80:83], v[44:47], a[4:7], 0
    v_mul_f32 v194, v26, v194
    v_mul_f32 v195, v27, v195
    v_mfma_f32_16x16x32_bf16 v[80:83], v[48:51], a[12:15], v[80:83]
    v_mul_f32 v29, v14, v197
    v_mul_f32 v30, v14, v198
    v_mfma_f32_16x16x32_bf16 v[80:83], v[52:55], a[20:23], v[80:83]
    v_exp_f32 v29, v29
    v_mfma_f32_16x16x32_bf16 v[80:83], v[56:59], a[28:31], v[80:83]
    s_waitcnt lgkmcnt(0)
    v_exp_f32 v30, v30
    v_mfma_f32_16x16x32_bf16 v[156:159], v[60:63], a[0:3], 0
    buffer_store_dword v255, v252, s[8:11], 0 offen sc1
    v_mfma_f32_16x16x32_bf16 v[156:159], v[64:67], a[8:11], v[156:159]
    buffer_load_dwordx4 v1, s[8:11], s15 offen offset:1024 sc1 lds
    v_mfma_f32_16x16x32_bf16 v[156:159], v[68:71], a[16:19], v[156:159]
    ds_read_b128 v[44:47], v4 offset:16384
    ds_read_b128 v[48:51], v4 offset:17408
    v_mfma_f32_16x16x32_bf16 v[156:159], v[72:75], a[24:27], v[156:159]
    ds_read_b128 v[52:55], v4 offset:18432
    ds_read_b128 v[56:59], v4 offset:19456
    v_mfma_f32_16x16x32_bf16 v[160:163], v[60:63], a[4:7], 0
    v_mul_f32 v31, v14, v199
    v_fma_f32 v28, v28, v18, v18
    v_mfma_f32_16x16x32_bf16 v[160:163], v[64:67], a[12:15], v[160:163]
    buffer_load_dwordx4 v1, s[8:11], s15 offen offset:2048 sc1 lds
    v_mfma_f32_16x16x32_bf16 v[160:163], v[68:71], a[20:23], v[160:163]
    v_exp_f32 v31, v31
    v_mfma_f32_16x16x32_bf16 v[160:163], v[72:75], a[28:31], v[160:163]
    s_waitcnt lgkmcnt(0)
    v_rcp_f32 v28, v28
    v_mfma_f32_16x16x32_bf16 v[164:167], v[44:47], a[0:3], 0
    ds_read_b128 v[60:63], v4 offset:20480
    v_fma_f32 v29, v29, v18, v18
    v_mfma_f32_16x16x32_bf16 v[164:167], v[48:51], a[8:11], v[164:167]
    ds_read_b128 v[64:67], v4 offset:21504
    v_fma_f32 v30, v30, v18, v18
    v_mfma_f32_16x16x32_bf16 v[164:167], v[52:55], a[16:19], v[164:167]
    buffer_load_dwordx4 v1, s[8:11], s15 offen offset:3072 sc1 lds
    v_mfma_f32_16x16x32_bf16 v[164:167], v[56:59], a[24:27], v[164:167]
    s_add_u32 m0, s12, 45056
    ds_read_b128 v[68:71], v4 offset:22528
    ds_read_b128 v[72:75], v4 offset:23552
    v_mfma_f32_16x16x32_bf16 v[168:171], v[44:47], a[4:7], 0
    s_add_u32 s15, s14, 118784
    v_rcp_f32 v29, v29
    v_mfma_f32_16x16x32_bf16 v[168:171], v[48:51], a[12:15], v[168:171]
    v_rcp_f32 v30, v30
    v_mfma_f32_16x16x32_bf16 v[168:171], v[52:55], a[20:23], v[168:171]
    v_fma_f32 v31, v31, v18, v18
    v_mul_f32 v196, v28, v196
    v_mfma_f32_16x16x32_bf16 v[168:171], v[56:59], a[28:31], v[168:171]
    s_waitcnt lgkmcnt(0)
    v_rcp_f32 v31, v31
    v_mfma_f32_16x16x32_bf16 v[140:143], v[60:63], a[0:3], 0
    buffer_load_dwordx4 v1, s[8:11], s15 offen offset:0 sc1 lds
    v_mfma_f32_16x16x32_bf16 v[140:143], v[64:67], a[8:11], v[140:143]
    ds_read_b128 v[44:47], v4 offset:24576
    ds_read_b128 v[48:51], v4 offset:25600
    v_mfma_f32_16x16x32_bf16 v[140:143], v[68:71], a[16:19], v[140:143]
    ds_read_b128 v[52:55], v4 offset:26624
    v_mul_f32 v197, v29, v197
    v_mfma_f32_16x16x32_bf16 v[140:143], v[72:75], a[24:27], v[140:143]
    ds_read_b128 v[56:59], v4 offset:27648
    v_mul_f32 v198, v30, v198
    v_mfma_f32_16x16x32_bf16 v[144:147], v[60:63], a[4:7], 0
    buffer_load_dwordx4 a[96:99], v8, s[8:11], s16 offen offset:0 sc1
    v_mfma_f32_16x16x32_bf16 v[144:147], v[64:67], a[12:15], v[144:147]
    v_mul_f32 v199, v31, v199
    v_mul_f32 v32, v15, v200
    v_mfma_f32_16x16x32_bf16 v[144:147], v[68:71], a[20:23], v[144:147]
    v_exp_f32 v32, v32
    v_mfma_f32_16x16x32_bf16 v[144:147], v[72:75], a[28:31], v[144:147]
    s_waitcnt lgkmcnt(0)
    v_mul_f32 v33, v15, v201
    v_mul_f32 v34, v15, v202
    v_mfma_f32_16x16x32_bf16 v[148:151], v[44:47], a[0:3], 0
    ds_read_b128 v[60:63], v4 offset:28672
    v_mul_f32 v35, v15, v203
    v_mfma_f32_16x16x32_bf16 v[148:151], v[48:51], a[8:11], v[148:151]
    buffer_load_dwordx4 a[100:103], v8, s[8:11], s16 offen offset:256 sc1
    v_mfma_f32_16x16x32_bf16 v[148:151], v[52:55], a[16:19], v[148:151]
    s_mov_b32 s16, 21504
    ds_read_b128 v[64:67], v4 offset:29696
    ds_read_b128 v[68:71], v4 offset:30720
    v_mfma_f32_16x16x32_bf16 v[148:151], v[56:59], a[24:27], v[148:151]
    ds_read_b128 v[72:75], v4 offset:31744
    v_fma_f32 v32, v32, v19, v19
    v_mfma_f32_16x16x32_bf16 v[152:155], v[44:47], a[4:7], 0
    v_exp_f32 v33, v33
    v_mfma_f32_16x16x32_bf16 v[152:155], v[48:51], a[12:15], v[152:155]
    v_exp_f32 v34, v34
    v_mfma_f32_16x16x32_bf16 v[152:155], v[52:55], a[20:23], v[152:155]
    buffer_load_dwordx4 a[104:107], v8, s[8:11], s16 offen offset:0 sc1
    v_mfma_f32_16x16x32_bf16 v[152:155], v[56:59], a[28:31], v[152:155]
    s_waitcnt lgkmcnt(0)
    v_exp_f32 v35, v35
    v_mfma_f32_16x16x32_bf16 v[172:175], v[60:63], a[0:3], 0
    ds_read_b128 v[44:47], v4 offset:32768
    v_fma_f32 v33, v33, v19, v19
    v_mfma_f32_16x16x32_bf16 v[172:175], v[64:67], a[8:11], v[172:175]
    ds_read_b128 v[48:51], v4 offset:33792
    v_fma_f32 v34, v34, v19, v19
    v_mfma_f32_16x16x32_bf16 v[172:175], v[68:71], a[16:19], v[172:175]
    ds_read_b128 v[52:55], v4 offset:34816
    v_fma_f32 v35, v35, v19, v19
    v_mfma_f32_16x16x32_bf16 v[172:175], v[72:75], a[24:27], v[172:175]
    buffer_load_dwordx4 a[108:111], v8, s[8:11], s16 offen offset:256 sc1
    v_mfma_f32_16x16x32_bf16 v[176:179], v[60:63], a[4:7], 0
    s_mov_b32 s16, 39936
    ds_read_b128 v[56:59], v4 offset:35840
    v_mfma_f32_16x16x32_bf16 v[176:179], v[64:67], a[12:15], v[176:179]
    v_rcp_f32 v32, v32
    v_mfma_f32_16x16x32_bf16 v[176:179], v[68:71], a[20:23], v[176:179]
    v_rcp_f32 v33, v33
    v_mfma_f32_16x16x32_bf16 v[176:179], v[72:75], a[28:31], v[176:179]
    s_waitcnt lgkmcnt(0)
    v_rcp_f32 v34, v34
    v_mfma_f32_16x16x32_bf16 v[180:183], v[44:47], a[0:3], 0
    s_barrier
    ds_read_b128 v[60:63], v5 offset:0
    v_mul_f32 v200, v32, v200
    v_mfma_f32_16x16x32_bf16 v[180:183], v[48:51], a[8:11], v[180:183]
    buffer_load_dwordx4 a[112:115], v8, s[8:11], s16 offen offset:0 sc1
    v_mfma_f32_16x16x32_bf16 v[180:183], v[52:55], a[16:19], v[180:183]
    s_add_u32 m0, s12, 73728
    ds_read_b128 v[64:67], v5 offset:1024
    ds_read_b128 v[68:71], v5 offset:2048
    v_mfma_f32_16x16x32_bf16 v[180:183], v[56:59], a[24:27], v[180:183]
    s_add_u32 s15, s14, 147456
    ds_read_b128 v[72:75], v5 offset:3072
    v_mul_f32 v201, v33, v201
    v_mfma_f32_16x16x32_bf16 v[184:187], v[44:47], a[4:7], 0
    v_rcp_f32 v35, v35
    v_mfma_f32_16x16x32_bf16 v[184:187], v[48:51], a[12:15], v[184:187]
    buffer_load_dwordx4 a[116:119], v8, s[8:11], s16 offen offset:256 sc1
    v_mfma_f32_16x16x32_bf16 v[184:187], v[52:55], a[20:23], v[184:187]
    s_mov_b32 s16, 58368
    v_mul_f32 v202, v34, v202
    v_mul_f32 v203, v35, v203
    v_mfma_f32_16x16x32_bf16 v[184:187], v[56:59], a[28:31], v[184:187]
    s_waitcnt lgkmcnt(0)
    v_mul_f32 v188, v188, v204
    v_mul_f32 v189, v189, v205
    v_mfma_f32_16x16x32_bf16 v[124:127], v[60:63], a[32:35], v[124:127]
    s_mov_b32 s17, 8192
    ds_read_b128 v[44:47], v5 offset:4096
    v_mul_f32 v190, v190, v206
    v_mfma_f32_16x16x32_bf16 v[124:127], v[64:67], a[40:43], v[124:127]
    ds_read_b128 v[48:51], v5 offset:5120
    v_mul_f32 v191, v191, v207
    v_mfma_f32_16x16x32_bf16 v[124:127], v[68:71], a[48:51], v[124:127]
    buffer_load_dwordx4 a[120:123], v8, s[8:11], s16 offen offset:0 sc1
    v_mfma_f32_16x16x32_bf16 v[124:127], v[72:75], a[56:59], v[124:127]
    ds_read_b128 v[52:55], v5 offset:6144
    ds_read_b128 v[56:59], v5 offset:7168
    v_mfma_f32_16x16x32_bf16 v[128:131], v[60:63], a[36:39], v[128:131]
    v_mul_f32 v192, v192, v208
    v_mul_f32 v193, v193, v209
    v_mfma_f32_16x16x32_bf16 v[128:131], v[64:67], a[44:47], v[128:131]
    s_lshl_b32 s24, s7, 5
    v_mul_f32 v194, v194, v210
    v_mul_f32 v195, v195, v211
    v_mfma_f32_16x16x32_bf16 v[128:131], v[68:71], a[52:55], v[128:131]
    s_lshl_b32 s25, s4, 3
    v_cvt_pk_bf16_f32 v36, v188, v189
    v_cvt_pk_bf16_f32 v37, v190, v191
    v_mfma_f32_16x16x32_bf16 v[128:131], v[72:75], a[60:63], v[128:131]
    s_waitcnt lgkmcnt(0)
    v_cvt_pk_bf16_f32 v38, v192, v193
    v_cvt_pk_bf16_f32 v39, v194, v195
    v_mfma_f32_16x16x32_bf16 v[132:135], v[44:47], a[32:35], v[132:135]
    buffer_load_dwordx4 a[124:127], v8, s[8:11], s16 offen offset:256 sc1
    v_mfma_f32_16x16x32_bf16 v[132:135], v[48:51], a[40:43], v[132:135]
    s_mov_b32 s16, 4096
    ds_read_b128 v[60:63], v5 offset:8192
    ds_read_b128 v[64:67], v5 offset:9216
    v_mfma_f32_16x16x32_bf16 v[132:135], v[52:55], a[48:51], v[132:135]
    s_add_u32 s24, s24, s25
    ds_read_b128 v[68:71], v5 offset:10240
    v_mul_f32 v196, v196, v212
    v_mfma_f32_16x16x32_bf16 v[132:135], v[56:59], a[56:59], v[132:135]
    s_mul_i32 s26, s3, 18
    ds_read_b128 v[72:75], v5 offset:11264
    v_mul_f32 v197, v197, v213
    v_mfma_f32_16x16x32_bf16 v[136:139], v[44:47], a[36:39], v[136:139]
    buffer_load_dwordx4 v1, s[8:11], s15 offen offset:0 sc1 lds
    v_mfma_f32_16x16x32_bf16 v[136:139], v[48:51], a[44:47], v[136:139]
    v_mul_f32 v198, v198, v214
    v_mul_f32 v199, v199, v215
    v_mfma_f32_16x16x32_bf16 v[136:139], v[52:55], a[52:55], v[136:139]
    v_mul_f32 v200, v200, v216
    v_mul_f32 v201, v201, v217
    v_mfma_f32_16x16x32_bf16 v[136:139], v[56:59], a[60:63], v[136:139]
    s_waitcnt lgkmcnt(0)
    v_mul_f32 v202, v202, v218
    v_mul_f32 v203, v203, v219
    v_mfma_f32_16x16x32_bf16 v[76:79], v[60:63], a[32:35], v[76:79]
    ds_read_b128 v[44:47], v5 offset:12288
    v_cvt_pk_bf16_f32 v40, v196, v197
    v_mfma_f32_16x16x32_bf16 v[76:79], v[64:67], a[40:43], v[76:79]
    buffer_load_dwordx4 v1, s[8:11], s15 offen offset:1024 sc1 lds
    v_mfma_f32_16x16x32_bf16 v[76:79], v[68:71], a[48:51], v[76:79]
    s_bfe_u32 s27, s7, 0x20003
    ds_read_b128 v[48:51], v5 offset:13312
    ds_read_b128 v[52:55], v5 offset:14336
    v_mfma_f32_16x16x32_bf16 v[76:79], v[72:75], a[56:59], v[76:79]
    s_lshl_b32 s27, s27, 6
    ds_read_b128 v[56:59], v5 offset:15360
    v_cvt_pk_bf16_f32 v41, v198, v199
    v_mfma_f32_16x16x32_bf16 v[80:83], v[60:63], a[36:39], v[80:83]
    v_cvt_pk_bf16_f32 v42, v200, v201
    v_cvt_pk_bf16_f32 v43, v202, v203
    v_mfma_f32_16x16x32_bf16 v[80:83], v[64:67], a[44:47], v[80:83]
    v_permlane16_swap_b32 v36, v38
    v_permlane16_swap_b32 v37, v39
    v_mfma_f32_16x16x32_bf16 v[80:83], v[68:71], a[52:55], v[80:83]
    buffer_store_dwordx4 v[36:39], v7, s[8:11], s17 offen sc1
    v_mfma_f32_16x16x32_bf16 v[80:83], v[72:75], a[60:63], v[80:83]
    s_waitcnt lgkmcnt(0)
    v_permlane16_swap_b32 v40, v42
    v_permlane16_swap_b32 v41, v43
    v_mfma_f32_16x16x32_bf16 v[156:159], v[44:47], a[32:35], v[156:159]
    s_mov_b32 s17, 303104
    ds_read_b128 v[60:63], v5 offset:16384
    v_and_b32 v217, 7, v0
    v_mfma_f32_16x16x32_bf16 v[156:159], v[48:51], a[40:43], v[156:159]
    ds_read_b128 v[64:67], v5 offset:17408
    v_bfe_u32 v36, v0, 3, 3
    v_mfma_f32_16x16x32_bf16 v[156:159], v[52:55], a[48:51], v[156:159]
    ds_read_b128 v[68:71], v5 offset:18432
    v_add_u32 v215, s26, v36
    v_mfma_f32_16x16x32_bf16 v[156:159], v[56:59], a[56:59], v[156:159]
    buffer_store_dwordx4 v[40:43], v7, s[8:11], s17 offen sc1
    v_mfma_f32_16x16x32_bf16 v[160:163], v[44:47], a[36:39], v[160:163]
    ds_read_b128 v[72:75], v5 offset:19456
    v_and_b32 v37, 1, v36
    v_mfma_f32_16x16x32_bf16 v[160:163], v[48:51], a[44:47], v[160:163]
    v_add3_u32 v37, v37, s26, 16
    v_lshrrev_b32 v38, 1, v36
    v_mfma_f32_16x16x32_bf16 v[160:163], v[52:55], a[52:55], v[160:163]
    s_lshr_b32 s26, s7, 5
    v_add_u32 v216, s24, v217
    v_cmp_gt_u32 vcc, 2, v38
    v_mfma_f32_16x16x32_bf16 v[160:163], v[56:59], a[60:63], v[160:163]
    s_waitcnt lgkmcnt(0)
    v_lshl_add_u32 v208, v215, 11, v216
    v_lshl_add_u32 v209, v37, 11, v216
    v_mfma_f32_16x16x32_bf16 v[164:167], v[60:63], a[32:35], v[164:167]
    buffer_load_dword v254, v253, s[8:11], 0 offen sc1
    v_mfma_f32_16x16x32_bf16 v[164:167], v[64:67], a[40:43], v[164:167]
    buffer_load_dwordx4 v1, s[8:11], s15 offen offset:2048 sc1 lds
    v_mfma_f32_16x16x32_bf16 v[164:167], v[68:71], a[48:51], v[164:167]
    s_add_u32 s26, s26, s27
    ds_read_b128 v[44:47], v5 offset:20480
    ds_read_b128 v[48:51], v5 offset:21504
    v_mfma_f32_16x16x32_bf16 v[164:167], v[72:75], a[56:59], v[164:167]
    s_bfe_u32 s27, s7, 0x10002
    ds_read_b128 v[52:55], v5 offset:22528
    ds_read_b128 v[56:59], v5 offset:23552
    v_mfma_f32_16x16x32_bf16 v[168:171], v[60:63], a[36:39], v[168:171]
    s_lshl_b32 s27, s27, 5
    v_lshlrev_b32 v208, 4, v208
    v_lshl_add_u32 v209, v209, 2, v38
    v_mfma_f32_16x16x32_bf16 v[168:171], v[64:67], a[44:47], v[168:171]
    s_add_u32 s26, s26, s27
    v_lshlrev_b32 v209, 2, v209
    v_lshlrev_b32 v39, 2, v37
    v_mfma_f32_16x16x32_bf16 v[168:171], v[68:71], a[52:55], v[168:171]
    buffer_load_dwordx4 v1, s[8:11], s15 offen offset:3072 sc1 lds
    v_mfma_f32_16x16x32_bf16 v[168:171], v[72:75], a[60:63], v[168:171]
    s_waitcnt lgkmcnt(0)
    v_sub_u32 v40, 568, v39
    s_lshl_b32 s26, s26, 2
    v_mfma_f32_16x16x32_bf16 v[140:143], v[44:47], a[32:35], v[140:143]
    s_add_u32 m0, s12, 77824
    ds_read_b128 v[60:63], v5 offset:24576
    v_cndmask_b32 v39, v40, v39, vcc
    v_mfma_f32_16x16x32_bf16 v[140:143], v[48:51], a[40:43], v[140:143]
    s_add_u32 s15, s14, 151552
    ds_read_b128 v[64:67], v5 offset:25600
    v_lshl_add_u32 v214, v38, 1, v39
    v_mfma_f32_16x16x32_bf16 v[140:143], v[52:55], a[48:51], v[140:143]
    s_and_b32 s27, s7, 3
    ds_read_b128 v[68:71], v5 offset:26624
    s_add_u32 s26, s26, s27
    v_mfma_f32_16x16x32_bf16 v[140:143], v[56:59], a[56:59], v[140:143]
    buffer_load_dwordx4 v1, s[8:11], s15 offen offset:0 sc1 lds
    v_mfma_f32_16x16x32_bf16 v[144:147], v[44:47], a[36:39], v[144:147]
    s_lshl_b32 s26, s26, 7
    ds_read_b128 v[72:75], v5 offset:27648
    s_add_u32 s26, s26, 58720256
    v_mfma_f32_16x16x32_bf16 v[144:147], v[48:51], a[44:47], v[144:147]
    s_lshl_b32 s27, s3, 12
    s_add_u32 s26, s26, s27
    v_and_b32 v210, 3, v0
    v_mfma_f32_16x16x32_bf16 v[144:147], v[52:55], a[52:55], v[144:147]
    s_movk_i32 s27, 192
    v_lshl_add_u32 v210, v210, 10, s26
    v_mul_u32_u24 v36, 1760, v217
    v_mfma_f32_16x16x32_bf16 v[144:147], v[56:59], a[60:63], v[144:147]
    s_waitcnt lgkmcnt(0)
    v_add_u32 v36, 36864, v36
    v_lshlrev_b32 v37, 2, v215
    v_mfma_f32_16x16x32_bf16 v[148:151], v[60:63], a[32:35], v[148:151]
    buffer_load_dwordx4 v1, s[8:11], s15 offen offset:1024 sc1 lds
    v_mfma_f32_16x16x32_bf16 v[148:151], v[64:67], a[40:43], v[148:151]
    ds_read_b128 v[44:47], v5 offset:28672
    ds_read_b128 v[48:51], v5 offset:29696
    v_mfma_f32_16x16x32_bf16 v[148:151], v[68:71], a[48:51], v[148:151]
    ds_read_b128 v[52:55], v5 offset:30720
    v_sub_u32 v38, 572, v37
    v_mfma_f32_16x16x32_bf16 v[148:151], v[72:75], a[56:59], v[148:151]
    ds_read_b128 v[56:59], v5 offset:31744
    v_add_u32 v39, 32, v37
    v_mfma_f32_16x16x32_bf16 v[152:155], v[60:63], a[36:39], v[152:155]
    v_subrev_u32 v40, 32, v38
    v_mul_u32_u24 v41, 7282, v37
    v_mfma_f32_16x16x32_bf16 v[152:155], v[64:67], a[44:47], v[152:155]
    buffer_load_dwordx4 v1, s[8:11], s15 offen offset:2048 sc1 lds
    v_mfma_f32_16x16x32_bf16 v[152:155], v[68:71], a[52:55], v[152:155]
    v_lshrrev_b32 v41, 16, v41
    v_and_b32 v42, 63, v37
    v_mfma_f32_16x16x32_bf16 v[152:155], v[72:75], a[60:63], v[152:155]
    s_waitcnt lgkmcnt(0)
    v_mad_i32_i24 v41, v41, -9, v37
    v_lshl_add_u32 v42, v42, 1, v36
    v_mfma_f32_16x16x32_bf16 v[172:175], v[44:47], a[32:35], v[172:175]
    ds_read_b128 v[60:63], v5 offset:32768
    v_mad_u32_u24 v84, v41, s27, v42
    v_mfma_f32_16x16x32_bf16 v[172:175], v[48:51], a[40:43], v[172:175]
    ds_read_b128 v[64:67], v5 offset:33792
    v_add_u32 v43, 1, v41
    v_mfma_f32_16x16x32_bf16 v[172:175], v[52:55], a[48:51], v[172:175]
    buffer_load_dwordx4 v1, s[8:11], s15 offen offset:3072 sc1 lds
    v_mfma_f32_16x16x32_bf16 v[172:175], v[56:59], a[56:59], v[172:175]
    s_add_u32 m0, s12, 81920
    ds_read_b128 v[68:71], v5 offset:34816
    ds_read_b128 v[72:75], v5 offset:35840
    v_mfma_f32_16x16x32_bf16 v[176:179], v[44:47], a[36:39], v[176:179]
    s_add_u32 s15, s14, 155648
    v_add_u32 v218, -8, v41
    v_mul_u32_u24 v219, 7282, v38
    v_mfma_f32_16x16x32_bf16 v[176:179], v[48:51], a[44:47], v[176:179]
    v_min_u32 v43, v43, v218
    v_add_u32 v218, -7, v41
    v_mfma_f32_16x16x32_bf16 v[176:179], v[52:55], a[52:55], v[176:179]
    v_mad_u32_u24 v85, v43, s27, v42
    v_add_u32 v43, 2, v41
    v_mfma_f32_16x16x32_bf16 v[176:179], v[56:59], a[60:63], v[176:179]
    s_waitcnt lgkmcnt(0)
    v_min_u32 v43, v43, v218
    v_add_u32 v218, -6, v41
    v_mfma_f32_16x16x32_bf16 v[180:183], v[60:63], a[32:35], v[180:183]
    s_waitcnt vmcnt(31)
    s_barrier
    ds_read_b128 v[44:47], v2 offset:0
    v_mfma_f32_16x16x32_bf16 v[180:183], v[64:67], a[40:43], v[180:183]
    buffer_load_dwordx4 v1, s[8:11], s15 offen offset:0 sc1 lds
    v_mfma_f32_16x16x32_bf16 v[180:183], v[68:71], a[48:51], v[180:183]
    s_add_u32 m0, s12, 110592
    ds_read_b128 v[48:51], v2 offset:1024
    ds_read_b128 v[52:55], v2 offset:2048
    v_mfma_f32_16x16x32_bf16 v[180:183], v[72:75], a[56:59], v[180:183]
    s_add_u32 s15, s14, 184320
    ds_read_b128 v[56:59], v2 offset:3072
    v_mad_u32_u24 v86, v43, s27, v42
    v_mfma_f32_16x16x32_bf16 v[184:187], v[60:63], a[36:39], v[184:187]
    v_add_u32 v43, 3, v41
    v_lshrrev_b32 v219, 16, v219
    v_mfma_f32_16x16x32_bf16 v[184:187], v[64:67], a[44:47], v[184:187]
    buffer_load_dwordx4 a[128:131], v8, s[8:11], s16 offen offset:0 sc1
    v_mfma_f32_16x16x32_bf16 v[184:187], v[68:71], a[52:55], v[184:187]
    v_min_u32 v43, v43, v218
    v_mad_i32_i24 v219, v219, -9, v38
    v_mfma_f32_16x16x32_bf16 v[184:187], v[72:75], a[60:63], v[184:187]
    s_waitcnt lgkmcnt(0)
    v_mad_u32_u24 v87, v43, s27, v42
    v_and_b32 v12, 63, v38
    v_mfma_f32_16x16x32_bf16 v[124:127], v[44:47], a[64:67], v[124:127]
    ds_read_b128 v[60:63], v2 offset:4096
    v_lshl_add_u32 v12, v12, 1, v36
    v_mfma_f32_16x16x32_bf16 v[124:127], v[48:51], a[72:75], v[124:127]
    ds_read_b128 v[64:67], v2 offset:5120
    v_mad_u32_u24 v88, v219, s27, v12
    v_mfma_f32_16x16x32_bf16 v[124:127], v[52:55], a[80:83], v[124:127]
    buffer_load_dwordx4 a[132:135], v8, s[8:11], s16 offen offset:256 sc1
    v_mfma_f32_16x16x32_bf16 v[124:127], v[56:59], a[88:91], v[124:127]
    s_mov_b32 s16, 22528
    ds_read_b128 v[68:71], v2 offset:6144
    ds_read_b128 v[72:75], v2 offset:7168
    v_mfma_f32_16x16x32_bf16 v[128:131], v[44:47], a[68:71], v[128:131]
    v_add_u32 v13, 1, v219
    v_add_u32 v14, -8, v219
    v_mfma_f32_16x16x32_bf16 v[128:131], v[48:51], a[76:79], v[128:131]
    v_min_u32 v13, v13, v14
    v_add_u32 v14, -7, v219
    v_mfma_f32_16x16x32_bf16 v[128:131], v[52:55], a[84:87], v[128:131]
    v_mad_u32_u24 v89, v13, s27, v12
    v_add_u32 v13, 2, v219
    v_mfma_f32_16x16x32_bf16 v[128:131], v[56:59], a[92:95], v[128:131]
    s_waitcnt lgkmcnt(0)
    v_min_u32 v13, v13, v14
    v_add_u32 v14, -6, v219
    v_mfma_f32_16x16x32_bf16 v[132:135], v[60:63], a[64:67], v[132:135]
    buffer_load_dwordx4 a[136:139], v8, s[8:11], s16 offen offset:0 sc1
    v_mfma_f32_16x16x32_bf16 v[132:135], v[64:67], a[72:75], v[132:135]
    ds_read_b128 v[44:47], v2 offset:8192
    ds_read_b128 v[48:51], v2 offset:9216
    v_mfma_f32_16x16x32_bf16 v[132:135], v[68:71], a[80:83], v[132:135]
    ds_read_b128 v[52:55], v2 offset:10240
    v_mad_u32_u24 v90, v13, s27, v12
    v_mfma_f32_16x16x32_bf16 v[132:135], v[72:75], a[88:91], v[132:135]
    ds_read_b128 v[56:59], v2 offset:11264
    v_add_u32 v13, 3, v219
    v_mfma_f32_16x16x32_bf16 v[136:139], v[60:63], a[68:71], v[136:139]
    buffer_load_dwordx4 a[140:143], v8, s[8:11], s16 offen offset:256 sc1
    v_mfma_f32_16x16x32_bf16 v[136:139], v[64:67], a[76:79], v[136:139]
L_pad_c1_6:
    s_cbranch_execz L_hopret_c1
    s_mov_b32 s16, 40960
    v_min_u32 v13, v13, v14
    v_mul_u32_u24 v41, 7282, v39
    v_mfma_f32_16x16x32_bf16 v[136:139], v[68:71], a[84:87], v[136:139]
    v_mad_u32_u24 v91, v13, s27, v12
    v_lshrrev_b32 v41, 16, v41
    v_mfma_f32_16x16x32_bf16 v[136:139], v[72:75], a[92:95], v[136:139]
    s_waitcnt lgkmcnt(0)
    v_mad_i32_i24 v41, v41, -9, v39
    v_and_b32 v42, 63, v39
    v_mfma_f32_16x16x32_bf16 v[76:79], v[44:47], a[64:67], v[76:79]
    v_mov_b32 v255, 4
    ds_read_b128 v[60:63], v2 offset:12288
    v_mfma_f32_16x16x32_bf16 v[76:79], v[48:51], a[72:75], v[76:79]
    buffer_load_dwordx4 a[144:147], v8, s[8:11], s16 offen offset:0 sc1
    v_mfma_f32_16x16x32_bf16 v[76:79], v[52:55], a[80:83], v[76:79]
    s_waitcnt vmcnt(13)
    ds_read_b128 v[64:67], v2 offset:13312
    ds_read_b128 v[68:71], v2 offset:14336
    v_mfma_f32_16x16x32_bf16 v[76:79], v[56:59], a[88:91], v[76:79]
    ds_read_b128 v[72:75], v2 offset:15360
    v_lshl_add_u32 v42, v42, 1, v36
    v_mfma_f32_16x16x32_bf16 v[80:83], v[44:47], a[68:71], v[80:83]
    s_waitcnt vmcnt(12)
    v_cmp_gt_u32 s[46:47], 3, v254
    v_mad_u32_u24 v92, v41, s27, v42
    v_mfma_f32_16x16x32_bf16 v[80:83], v[48:51], a[76:79], v[80:83]
    v_add_u32 v43, 1, v41
    v_add_u32 v218, -8, v41
    v_mfma_f32_16x16x32_bf16 v[80:83], v[52:55], a[84:87], v[80:83]
    buffer_store_dword v255, v252, s[8:11], 0 offen sc1
    v_mfma_f32_16x16x32_bf16 v[80:83], v[56:59], a[92:95], v[80:83]
    s_waitcnt lgkmcnt(0)
    v_min_u32 v43, v43, v218
    v_add_u32 v218, -7, v41
    v_mfma_f32_16x16x32_bf16 v[156:159], v[60:63], a[64:67], v[156:159]
    buffer_load_dwordx4 a[148:151], v8, s[8:11], s16 offen offset:256 sc1
    v_mfma_f32_16x16x32_bf16 v[156:159], v[64:67], a[72:75], v[156:159]
    s_cmp_lg_u64 s[46:47], 0
    s_cbranch_scc1 L_slow15
L_slow15_ret:
    ds_read_b128 v[44:47], v2 offset:16384
    v_mfma_f32_16x16x32_bf16 v[156:159], v[68:71], a[80:83], v[156:159]
    s_mov_b32 s16, 59392
    ds_read_b128 v[48:51], v2 offset:17408
    ds_read_b128 v[52:55], v2 offset:18432
    v_mfma_f32_16x16x32_bf16 v[156:159], v[72:75], a[88:91], v[156:159]
    ds_read_b128 v[56:59], v2 offset:19456
    v_mad_u32_u24 v93, v43, s27, v42
    v_mfma_f32_16x16x32_bf16 v[160:163], v[60:63], a[68:71], v[160:163]
    buffer_load_dwordx4 a[152:155], v8, s[8:11], s16 offen offset:0 sc1
    v_mfma_f32_16x16x32_bf16 v[160:163], v[64:67], a[76:79], v[160:163]
    v_add_u32 v43, 2, v41
    v_mul_u32_u24 v219, 7282, v40
    v_mfma_f32_16x16x32_bf16 v[160:163], v[68:71], a[84:87], v[160:163]
    v_min_u32 v43, v43, v218
    v_add_u32 v218, -6, v41
    v_mfma_f32_16x16x32_bf16 v[160:163], v[72:75], a[92:95], v[160:163]
    s_waitcnt lgkmcnt(0)
    v_mad_u32_u24 v94, v43, s27, v42
    v_add_u32 v43, 3, v41
    v_mfma_f32_16x16x32_bf16 v[164:167], v[44:47], a[64:67], v[164:167]
    ds_read_b128 v[60:63], v2 offset:20480
    v_min_u32 v43, v43, v218
    v_mfma_f32_16x16x32_bf16 v[164:167], v[48:51], a[72:75], v[164:167]
    buffer_load_dwordx4 a[156:159], v8, s[8:11], s16 offen offset:256 sc1
    v_mfma_f32_16x16x32_bf16 v[164:167], v[52:55], a[80:83], v[164:167]
    s_mov_b32 s16, 5120
    ds_read_b128 v[64:67], v2 offset:21504
    ds_read_b128 v[68:71], v2 offset:22528
    v_mfma_f32_16x16x32_bf16 v[164:167], v[56:59], a[88:91], v[164:167]
    ds_read_b128 v[72:75], v2 offset:23552
    v_mad_u32_u24 v95, v43, s27, v42
    v_mfma_f32_16x16x32_bf16 v[168:171], v[44:47], a[68:71], v[168:171]
    v_lshrrev_b32 v219, 16, v219
    v_and_b32 v12, 63, v40
    v_mfma_f32_16x16x32_bf16 v[168:171], v[48:51], a[76:79], v[168:171]
    v_mad_i32_i24 v219, v219, -9, v40
    v_lshl_add_u32 v12, v12, 1, v36
    v_mfma_f32_16x16x32_bf16 v[168:171], v[52:55], a[84:87], v[168:171]
    buffer_load_dwordx4 v1, s[8:11], s15 offen offset:0 sc1 lds
    v_mfma_f32_16x16x32_bf16 v[168:171], v[56:59], a[92:95], v[168:171]
    s_waitcnt lgkmcnt(0)
    v_mad_u32_u24 v96, v219, s27, v12
    v_add_u32 v13, 1, v219
    v_mfma_f32_16x16x32_bf16 v[140:143], v[60:63], a[64:67], v[140:143]
    s_lshl_b32 s26, s3, 3
    ds_read_b128 v[44:47], v2 offset:24576
    v_add_u32 v14, -8, v219
    v_mfma_f32_16x16x32_bf16 v[140:143], v[64:67], a[72:75], v[140:143]
    ds_read_b128 v[48:51], v2 offset:25600
    v_min_u32 v13, v13, v14
    v_mfma_f32_16x16x32_bf16 v[140:143], v[68:71], a[80:83], v[140:143]
    ds_read_b128 v[52:55], v2 offset:26624
    v_mad_u32_u24 v97, v13, s27, v12
    v_mfma_f32_16x16x32_bf16 v[140:143], v[72:75], a[88:91], v[140:143]
    buffer_load_dwordx4 v1, s[8:11], s15 offen offset:1024 sc1 lds
    v_mfma_f32_16x16x32_bf16 v[144:147], v[60:63], a[68:71], v[144:147]
    ds_read_b128 v[56:59], v2 offset:27648
    v_add_u32 v13, 2, v219
    v_mfma_f32_16x16x32_bf16 v[144:147], v[64:67], a[76:79], v[144:147]
    s_lshr_b32 s29, s3, 1
    v_add_u32 v14, -7, v219
    v_mul_u32_u24 v41, 7282, v214
    v_mfma_f32_16x16x32_bf16 v[144:147], v[68:71], a[84:87], v[144:147]
    s_lshl_b32 s29, s29, 4
    v_min_u32 v13, v13, v14
    v_add_u32 v14, -6, v219
    v_mfma_f32_16x16x32_bf16 v[144:147], v[72:75], a[92:95], v[144:147]
    s_waitcnt lgkmcnt(0)
    v_mad_u32_u24 v98, v13, s27, v12
    v_add_u32 v13, 3, v219
    v_mfma_f32_16x16x32_bf16 v[148:151], v[44:47], a[64:67], v[148:151]
    buffer_load_dwordx4 v1, s[8:11], s15 offen offset:2048 sc1 lds
    v_mfma_f32_16x16x32_bf16 v[148:151], v[48:51], a[72:75], v[148:151]
    ds_read_b128 v[60:63], v2 offset:28672
    ds_read_b128 v[64:67], v2 offset:29696
    v_mfma_f32_16x16x32_bf16 v[148:151], v[52:55], a[80:83], v[148:151]
    ds_read_b128 v[68:71], v2 offset:30720
    v_min_u32 v13, v13, v14
    v_mfma_f32_16x16x32_bf16 v[148:151], v[56:59], a[88:91], v[148:151]
    ds_read_b128 v[72:75], v2 offset:31744
    v_mad_u32_u24 v99, v13, s27, v12
    v_mfma_f32_16x16x32_bf16 v[152:155], v[44:47], a[68:71], v[152:155]
    v_lshrrev_b32 v41, 16, v41
    v_and_b32 v42, 63, v214
    v_mfma_f32_16x16x32_bf16 v[152:155], v[48:51], a[76:79], v[152:155]
    buffer_load_dwordx4 v1, s[8:11], s15 offen offset:3072 sc1 lds
    v_mfma_f32_16x16x32_bf16 v[152:155], v[52:55], a[84:87], v[152:155]
    s_add_u32 m0, s12, 114688
    v_mad_i32_i24 v41, v41, -9, v214
    v_lshl_add_u32 v42, v42, 1, v36
    v_mfma_f32_16x16x32_bf16 v[152:155], v[56:59], a[92:95], v[152:155]
    s_waitcnt lgkmcnt(0)
    v_mad_u32_u24 v100, v41, s27, v42
    v_add_u32 v43, 1, v41
    v_mfma_f32_16x16x32_bf16 v[172:175], v[60:63], a[64:67], v[172:175]
    s_add_u32 s15, s14, 188416
    ds_read_b128 v[44:47], v2 offset:32768
    v_add_u32 v218, -8, v41
    v_mfma_f32_16x16x32_bf16 v[172:175], v[64:67], a[72:75], v[172:175]
    ds_read_b128 v[48:51], v2 offset:33792
    v_min_u32 v43, v43, v218
    v_mfma_f32_16x16x32_bf16 v[172:175], v[68:71], a[80:83], v[172:175]
    buffer_load_dwordx4 v1, s[8:11], s15 offen offset:0 sc1 lds
    v_mfma_f32_16x16x32_bf16 v[172:175], v[72:75], a[88:91], v[172:175]
    ds_read_b128 v[52:55], v2 offset:34816
    ds_read_b128 v[56:59], v2 offset:35840
    v_mfma_f32_16x16x32_bf16 v[176:179], v[60:63], a[68:71], v[176:179]
    v_mad_u32_u24 v101, v43, s27, v42
    v_cmp_ne_u32 s[30:31], 0, v215
    v_mfma_f32_16x16x32_bf16 v[176:179], v[64:67], a[76:79], v[176:179]
    v_mov_b32 v213, 0xffff0000
    v_lshlrev_b32 v120, 5, v217
    v_mfma_f32_16x16x32_bf16 v[176:179], v[68:71], a[84:87], v[176:179]
    v_add_u32 v120, 51200, v120
    v_cndmask_b32 v213, v213, -1, s[30:31]
    v_mfma_f32_16x16x32_bf16 v[176:179], v[72:75], a[92:95], v[176:179]
    s_waitcnt lgkmcnt(0)
    v_add_u32 v119, s26, v120
    v_and_b32 v36, 15, v0
    v_mfma_f32_16x16x32_bf16 v[180:183], v[44:47], a[64:67], v[180:183]
    s_barrier
    ds_read_b128 v[60:63], v3 offset:0
    v_bfe_u32 v37, v0, 4, 2
    v_mfma_f32_16x16x32_bf16 v[180:183], v[48:51], a[72:75], v[180:183]
    buffer_load_dwordx4 v1, s[8:11], s15 offen offset:1024 sc1 lds
    v_mfma_f32_16x16x32_bf16 v[180:183], v[52:55], a[80:83], v[180:183]
    s_and_b32 s26, s3, 1
    ds_read_b128 v[64:67], v3 offset:1024
    ds_read_b128 v[68:71], v3 offset:2048
    v_mfma_f32_16x16x32_bf16 v[180:183], v[56:59], a[88:91], v[180:183]
    s_lshl_b32 s26, s26, 1
    ds_read_b128 v[72:75], v3 offset:3072
    v_add_u32 v38, s29, v36
    v_mfma_f32_16x16x32_bf16 v[184:187], v[44:47], a[68:71], v[184:187]
    v_cmp_eq_u32 s[32:33], 0, v38
    v_cvt_f32_u32 v39, v38
    v_mfma_f32_16x16x32_bf16 v[184:187], v[48:51], a[76:79], v[184:187]
    buffer_load_dwordx4 v1, s[8:11], s15 offen offset:2048 sc1 lds
    v_mfma_f32_16x16x32_bf16 v[184:187], v[52:55], a[84:87], v[184:187]
    v_mul_f32 v39, 0x3c800000, v39
    v_lshlrev_b32 v40, 3, v37
    v_mfma_f32_16x16x32_bf16 v[184:187], v[56:59], a[92:95], v[184:187]
    s_waitcnt lgkmcnt(0)
    v_cvt_f32_u32 v40, v40
    v_mov_b32 v13, 0x3f003f00
    v_mfma_f32_16x16x32_bf16 v[124:127], v[60:63], a[96:99], v[124:127]
    ds_read_b128 v[44:47], v3 offset:4096
    v_mul_f32 v40, v40, v39
    v_mfma_f32_16x16x32_bf16 v[124:127], v[64:67], a[104:107], v[124:127]
    ds_read_b128 v[48:51], v3 offset:5120
    v_mov_b32 v14, 0xbf003f00
    v_mfma_f32_16x16x32_bf16 v[124:127], v[68:71], a[112:115], v[124:127]
    buffer_load_dwordx4 v1, s[8:11], s15 offen offset:3072 sc1 lds
    v_mfma_f32_16x16x32_bf16 v[124:127], v[72:75], a[120:123], v[124:127]
    s_add_u32 m0, s12, 118784
    ds_read_b128 v[52:55], v3 offset:6144
    ds_read_b128 v[56:59], v3 offset:7168
    v_mfma_f32_16x16x32_bf16 v[128:131], v[60:63], a[100:103], v[128:131]
    s_add_u32 s15, s14, 192512
    v_bfe_i32 v15, v0, 0, 1
    v_fmamk_f32 v41, v39, 0x00000000, v40
    v_mfma_f32_16x16x32_bf16 v[128:131], v[64:67], a[108:111], v[128:131]
    v_cos_f32 v102, v41
    v_mfma_f32_16x16x32_bf16 v[128:131], v[68:71], a[116:119], v[128:131]
    v_sin_f32 v41, v41
    v_mfma_f32_16x16x32_bf16 v[128:131], v[72:75], a[124:127], v[128:131]
    s_waitcnt lgkmcnt(0)
    v_and_b32 v15, 0x80008000, v15
    v_fmamk_f32 v42, v39, 0x3f800000, v40
    v_mfma_f32_16x16x32_bf16 v[132:135], v[44:47], a[96:99], v[132:135]
    buffer_load_dwordx4 v1, s[8:11], s15 offen offset:0 sc1 lds
    v_mfma_f32_16x16x32_bf16 v[132:135], v[48:51], a[104:107], v[132:135]
    s_add_u32 m0, s12, 0
    ds_read_b128 v[60:63], v3 offset:8192
    ds_read_b128 v[64:67], v3 offset:9216
    v_mfma_f32_16x16x32_bf16 v[132:135], v[52:55], a[112:115], v[132:135]
    s_add_u32 s15, s14, 221184
    ds_read_b128 v[68:71], v3 offset:10240
    v_fmamk_f32 v43, v39, 0x40000000, v40
    v_mfma_f32_16x16x32_bf16 v[132:135], v[56:59], a[120:123], v[132:135]
    ds_read_b128 v[72:75], v3 offset:11264
    v_fmamk_f32 v218, v39, 0x40400000, v40
    v_mfma_f32_16x16x32_bf16 v[136:139], v[44:47], a[100:103], v[136:139]
    buffer_load_dwordx4 a[160:163], v8, s[8:11], s16 offen offset:0 sc1
    v_mfma_f32_16x16x32_bf16 v[136:139], v[48:51], a[108:111], v[136:139]
    v_cos_f32 v219, v42
    v_mfma_f32_16x16x32_bf16 v[136:139], v[52:55], a[116:119], v[136:139]
    v_sin_f32 v42, v42
    v_mfma_f32_16x16x32_bf16 v[136:139], v[56:59], a[124:127], v[136:139]
    s_waitcnt lgkmcnt(0)
    v_cos_f32 v103, v43
    v_mfma_f32_16x16x32_bf16 v[76:79], v[60:63], a[96:99], v[76:79]
    ds_read_b128 v[44:47], v3 offset:12288
    v_cvt_pk_bf16_f32 v102, v102, v219
    v_mfma_f32_16x16x32_bf16 v[76:79], v[64:67], a[104:107], v[76:79]
    buffer_load_dwordx4 a[164:167], v8, s[8:11], s16 offen offset:256 sc1
    v_mfma_f32_16x16x32_bf16 v[76:79], v[68:71], a[112:115], v[76:79]
    s_mov_b32 s16, 23552
    ds_read_b128 v[48:51], v3 offset:13312
    ds_read_b128 v[52:55], v3 offset:14336
    v_mfma_f32_16x16x32_bf16 v[76:79], v[72:75], a[120:123], v[76:79]
    ds_read_b128 v[56:59], v3 offset:15360
    v_cvt_pk_bf16_f32 v106, -v41, -v42
    v_mfma_f32_16x16x32_bf16 v[80:83], v[60:63], a[100:103], v[80:83]
    v_cos_f32 v12, v218
    v_mfma_f32_16x16x32_bf16 v[80:83], v[64:67], a[108:111], v[80:83]
    v_sin_f32 v43, v43
    v_mfma_f32_16x16x32_bf16 v[80:83], v[68:71], a[116:119], v[80:83]
    buffer_load_dword v254, v253, s[8:11], 0 offen sc1
    v_mfma_f32_16x16x32_bf16 v[80:83], v[72:75], a[124:127], v[80:83]
    s_waitcnt lgkmcnt(0)
    v_sin_f32 v218, v218
    v_mfma_f32_16x16x32_bf16 v[156:159], v[44:47], a[96:99], v[156:159]
    buffer_load_dwordx4 a[168:171], v8, s[8:11], s16 offen offset:0 sc1
    v_mfma_f32_16x16x32_bf16 v[156:159], v[48:51], a[104:107], v[156:159]
    ds_read_b128 v[60:63], v3 offset:16384
    ds_read_b128 v[64:67], v3 offset:17408
    v_mfma_f32_16x16x32_bf16 v[156:159], v[52:55], a[112:115], v[156:159]
    ds_read_b128 v[68:71], v3 offset:18432
    v_cndmask_b32 v102, v102, v13, s[32:33]
    v_mfma_f32_16x16x32_bf16 v[156:159], v[56:59], a[120:123], v[156:159]
    ds_read_b128 v[72:75], v3 offset:19456
    v_cndmask_b32 v106, v106, v14, s[32:33]
    v_mfma_f32_16x16x32_bf16 v[160:163], v[44:47], a[100:103], v[160:163]
    buffer_load_dwordx4 a[172:175], v8, s[8:11], s16 offen offset:256 sc1
    v_mfma_f32_16x16x32_bf16 v[160:163], v[48:51], a[108:111], v[160:163]
    s_mov_b32 s16, 41984
    v_xor_b32 v110, v15, v102
    v_xor_b32 v114, v15, v106
    v_mfma_f32_16x16x32_bf16 v[160:163], v[52:55], a[116:119], v[160:163]
    v_cvt_pk_bf16_f32 v103, v103, v12
    v_cvt_pk_bf16_f32 v107, -v43, -v218
    v_mfma_f32_16x16x32_bf16 v[160:163], v[56:59], a[124:127], v[160:163]
    s_waitcnt lgkmcnt(0)
    v_cndmask_b32 v103, v103, v13, s[32:33]
    v_cndmask_b32 v107, v107, v14, s[32:33]
    v_mfma_f32_16x16x32_bf16 v[164:167], v[60:63], a[96:99], v[164:167]
    ds_read_b128 v[44:47], v3 offset:20480
    v_xor_b32 v111, v15, v103
    v_mfma_f32_16x16x32_bf16 v[164:167], v[64:67], a[104:107], v[164:167]
    buffer_load_dwordx4 a[176:179], v8, s[8:11], s16 offen offset:0 sc1
    v_mfma_f32_16x16x32_bf16 v[164:167], v[68:71], a[112:115], v[164:167]
    ds_read_b128 v[48:51], v3 offset:21504
    ds_read_b128 v[52:55], v3 offset:22528
    v_mfma_f32_16x16x32_bf16 v[164:167], v[72:75], a[120:123], v[164:167]
    ds_read_b128 v[56:59], v3 offset:23552
    v_xor_b32 v115, v15, v107
    v_mfma_f32_16x16x32_bf16 v[168:171], v[60:63], a[100:103], v[168:171]
    v_fmamk_f32 v41, v39, 0x40800000, v40
    v_fmamk_f32 v42, v39, 0x40a00000, v40
    v_mfma_f32_16x16x32_bf16 v[168:171], v[64:67], a[108:111], v[168:171]
    v_cos_f32 v104, v41
    v_mfma_f32_16x16x32_bf16 v[168:171], v[68:71], a[116:119], v[168:171]
    buffer_load_dwordx4 a[180:183], v8, s[8:11], s16 offen offset:256 sc1
    v_mfma_f32_16x16x32_bf16 v[168:171], v[72:75], a[124:127], v[168:171]
    s_waitcnt lgkmcnt(0)
    v_cos_f32 v219, v42
    v_mfma_f32_16x16x32_bf16 v[140:143], v[44:47], a[96:99], v[140:143]
    s_mov_b32 s16, 60416
    ds_read_b128 v[60:63], v3 offset:24576
    v_cvt_pk_bf16_f32 v104, v104, v219
    v_mfma_f32_16x16x32_bf16 v[140:143], v[48:51], a[104:107], v[140:143]
    s_mov_b32 s29, 36864
    ds_read_b128 v[64:67], v3 offset:25600
    v_cndmask_b32 v104, v104, v13, s[32:33]
    v_mfma_f32_16x16x32_bf16 v[140:143], v[52:55], a[112:115], v[140:143]
    ds_read_b128 v[68:71], v3 offset:26624
    v_xor_b32 v112, v15, v104
    v_mfma_f32_16x16x32_bf16 v[140:143], v[56:59], a[120:123], v[140:143]
    buffer_load_dwordx4 a[184:187], v8, s[8:11], s16 offen offset:0 sc1
    v_mfma_f32_16x16x32_bf16 v[144:147], v[44:47], a[100:103], v[144:147]
    ds_read_b128 v[72:75], v3 offset:27648
    v_fmamk_f32 v43, v39, 0x40c00000, v40
    v_mfma_f32_16x16x32_bf16 v[144:147], v[48:51], a[108:111], v[144:147]
    v_sin_f32 v41, v41
    v_mfma_f32_16x16x32_bf16 v[144:147], v[52:55], a[116:119], v[144:147]
    v_sin_f32 v42, v42
    v_mfma_f32_16x16x32_bf16 v[144:147], v[56:59], a[124:127], v[144:147]
    s_waitcnt lgkmcnt(0)
    v_cos_f32 v105, v43
    v_mfma_f32_16x16x32_bf16 v[148:151], v[60:63], a[96:99], v[148:151]
    buffer_load_dwordx4 a[188:191], v8, s[8:11], s16 offen offset:256 sc1
    v_mfma_f32_16x16x32_bf16 v[148:151], v[64:67], a[104:107], v[148:151]
    s_mov_b32 s16, 6144
    ds_read_b128 v[44:47], v3 offset:28672
    ds_read_b128 v[48:51], v3 offset:29696
    v_mfma_f32_16x16x32_bf16 v[148:151], v[68:71], a[112:115], v[148:151]
    ds_read_b128 v[52:55], v3 offset:30720
    v_cvt_pk_bf16_f32 v108, -v41, -v42
    v_mfma_f32_16x16x32_bf16 v[148:151], v[72:75], a[120:123], v[148:151]
    ds_read_b128 v[56:59], v3 offset:31744
    v_cndmask_b32 v108, v108, v14, s[32:33]
    v_mfma_f32_16x16x32_bf16 v[152:155], v[60:63], a[100:103], v[152:155]
    v_sin_f32 v43, v43
    v_mfma_f32_16x16x32_bf16 v[152:155], v[64:67], a[108:111], v[152:155]
    buffer_load_dwordx4 v1, s[8:11], s15 offen offset:0 sc1 lds
    v_mfma_f32_16x16x32_bf16 v[152:155], v[68:71], a[116:119], v[152:155]
    v_xor_b32 v116, v15, v108
    v_fmamk_f32 v218, v39, 0x40e00000, v40
    v_mfma_f32_16x16x32_bf16 v[152:155], v[72:75], a[124:127], v[152:155]
    s_waitcnt lgkmcnt(0)
    v_cos_f32 v12, v218
    v_mfma_f32_16x16x32_bf16 v[172:175], v[44:47], a[96:99], v[172:175]
    ds_read_b128 v[60:63], v3 offset:32768
    v_cvt_pk_bf16_f32 v105, v105, v12
    v_mfma_f32_16x16x32_bf16 v[172:175], v[48:51], a[104:107], v[172:175]
    ds_read_b128 v[64:67], v3 offset:33792
    v_cndmask_b32 v105, v105, v13, s[32:33]
    v_mfma_f32_16x16x32_bf16 v[172:175], v[52:55], a[112:115], v[172:175]
    buffer_load_dwordx4 v1, s[8:11], s15 offen offset:1024 sc1 lds
    v_mfma_f32_16x16x32_bf16 v[172:175], v[56:59], a[120:123], v[172:175]
    ds_read_b128 v[68:71], v3 offset:34816
    ds_read_b128 v[72:75], v3 offset:35840
    v_mfma_f32_16x16x32_bf16 v[176:179], v[44:47], a[100:103], v[176:179]
    v_sin_f32 v218, v218
    v_mfma_f32_16x16x32_bf16 v[176:179], v[48:51], a[108:111], v[176:179]
    v_cvt_pk_bf16_f32 v109, -v43, -v218
    v_xor_b32 v113, v15, v105
    v_mfma_f32_16x16x32_bf16 v[176:179], v[52:55], a[116:119], v[176:179]
    v_cndmask_b32 v109, v109, v14, s[32:33]
    v_lshrrev_b32 v39, 2, v36
    v_mfma_f32_16x16x32_bf16 v[176:179], v[56:59], a[124:127], v[176:179]
    s_waitcnt lgkmcnt(0)
    v_xor_b32 v117, v15, v109
    v_and_b32 v41, 2, v39
    v_mfma_f32_16x16x32_bf16 v[180:183], v[60:63], a[96:99], v[180:183]
    s_waitcnt vmcnt(20)
    s_barrier
    ds_read_b128 v[44:47], v4 offset:0
    v_mfma_f32_16x16x32_bf16 v[180:183], v[64:67], a[104:107], v[180:183]
    buffer_load_dwordx4 v1, s[8:11], s15 offen offset:2048 sc1 lds
    v_mfma_f32_16x16x32_bf16 v[180:183], v[68:71], a[112:115], v[180:183]
    ds_read_b128 v[48:51], v4 offset:1024
    ds_read_b128 v[52:55], v4 offset:2048
    v_mfma_f32_16x16x32_bf16 v[180:183], v[72:75], a[120:123], v[180:183]
    ds_read_b128 v[56:59], v4 offset:3072
    v_add3_u32 v39, v39, v41, s26
    v_mfma_f32_16x16x32_bf16 v[184:187], v[60:63], a[100:103], v[184:187]
    v_mul_u32_u24 v39, 1760, v39
    v_and_b32 v41, 3, v36
    v_mfma_f32_16x16x32_bf16 v[184:187], v[64:67], a[108:111], v[184:187]
    buffer_load_dwordx4 v1, s[8:11], s15 offen offset:3072 sc1 lds
    v_mfma_f32_16x16x32_bf16 v[184:187], v[68:71], a[116:119], v[184:187]
    s_add_u32 m0, s12, 4096
    v_mul_u32_u24 v41, 192, v41
    v_lshl_add_u32 v39, v37, 4, v39
    v_mfma_f32_16x16x32_bf16 v[184:187], v[72:75], a[124:127], v[184:187]
    s_waitcnt lgkmcnt(0)
    v_add3_u32 v118, v39, v41, s29
    v_and_b32 v41, 2, v37
    v_mfma_f32_16x16x32_bf16 v[124:127], v[44:47], a[128:131], v[124:127]
    s_add_u32 s15, s14, 225280
    ds_read_b128 v[60:63], v4 offset:4096
    v_add3_u32 v37, v37, v41, s26
    v_mfma_f32_16x16x32_bf16 v[124:127], v[48:51], a[136:139], v[124:127]
    ds_read_b128 v[64:67], v4 offset:5120
    v_lshlrev_b32 v211, 5, v37
    v_mfma_f32_16x16x32_bf16 v[124:127], v[52:55], a[144:147], v[124:127]
    buffer_load_dwordx4 v1, s[8:11], s15 offen offset:0 sc1 lds
    v_mfma_f32_16x16x32_bf16 v[124:127], v[56:59], a[152:155], v[124:127]
    ds_read_b128 v[68:71], v4 offset:6144
    ds_read_b128 v[72:75], v4 offset:7168
    v_mfma_f32_16x16x32_bf16 v[128:131], v[44:47], a[132:135], v[128:131]
    v_add_u32 v211, 51200, v211
    v_cndmask_b32 v212, 0, 0.5, s[32:33]
    v_mfma_f32_16x16x32_bf16 v[128:131], v[48:51], a[140:143], v[128:131]
    v_mul_u32_u24 v39, 432, v38
    v_and_b32 v197, 3, v37
    v_mfma_f32_16x16x32_bf16 v[128:131], v[52:55], a[148:151], v[128:131]
    v_lshlrev_b32 v197, 2, v197
    v_mov_b32 v13, 13824
    v_mfma_f32_16x16x32_bf16 v[128:131], v[56:59], a[156:159], v[128:131]
    s_waitcnt lgkmcnt(0)
    v_add_u32 v197, 51856, v197
    v_cndmask_b32 v14, v39, v13, s[32:33]
    v_mfma_f32_16x16x32_bf16 v[132:135], v[60:63], a[128:131], v[132:135]
    buffer_load_dwordx4 v1, s[8:11], s15 offen offset:1024 sc1 lds
    v_mfma_f32_16x16x32_bf16 v[132:135], v[64:67], a[136:139], v[132:135]
    ds_read_b128 v[44:47], v4 offset:8192
    ds_read_b128 v[48:51], v4 offset:9216
    v_mfma_f32_16x16x32_bf16 v[132:135], v[68:71], a[144:147], v[132:135]
    s_waitcnt vmcnt(12)
    v_cmp_gt_u32 s[46:47], 4, v254
    ds_read_b128 v[52:55], v4 offset:10240
    v_mfma_f32_16x16x32_bf16 v[132:135], v[72:75], a[152:155], v[132:135]
    ds_read_b128 v[56:59], v4 offset:11264
    v_sad_u32 v188, v39, v13, v197
    v_mfma_f32_16x16x32_bf16 v[136:139], v[60:63], a[132:135], v[136:139]
    buffer_load_dwordx4 v1, s[8:11], s15 offen offset:2048 sc1 lds
    v_mfma_f32_16x16x32_bf16 v[136:139], v[64:67], a[140:143], v[136:139]
    s_cmp_lg_u64 s[46:47], 0
    s_cbranch_scc1 L_slow16
L_slow16_ret:
    v_sub_u32 v198, v13, v39
    v_mfma_f32_16x16x32_bf16 v[136:139], v[68:71], a[148:151], v[136:139]
    v_add_u32 v43, 3072, v39
    v_add_u32 v41, 6144, v39
    v_mfma_f32_16x16x32_bf16 v[136:139], v[72:75], a[156:159], v[136:139]
    s_waitcnt lgkmcnt(0)
    v_sad_u32 v189, v43, v13, v197
    v_sub_u32 v199, v13, v43
    v_mfma_f32_16x16x32_bf16 v[76:79], v[44:47], a[128:131], v[76:79]
    ds_read_b128 v[60:63], v4 offset:12288
    v_sad_u32 v190, v41, v13, v197
    v_mfma_f32_16x16x32_bf16 v[76:79], v[48:51], a[136:139], v[76:79]
    buffer_load_dwordx4 v1, s[8:11], s15 offen offset:3072 sc1 lds
    v_mfma_f32_16x16x32_bf16 v[76:79], v[52:55], a[144:147], v[76:79]
    s_add_u32 m0, s12, 8192
    ds_read_b128 v[64:67], v4 offset:13312
    ds_read_b128 v[68:71], v4 offset:14336
    v_mfma_f32_16x16x32_bf16 v[76:79], v[56:59], a[152:155], v[76:79]
    s_add_u32 s15, s14, 229376
    ds_read_b128 v[72:75], v4 offset:15360
    v_sub_u32 v200, v13, v41
    v_mfma_f32_16x16x32_bf16 v[80:83], v[44:47], a[132:135], v[80:83]
    v_add_u32 v43, 9216, v39
    v_add_u32 v41, 12288, v39
    v_mfma_f32_16x16x32_bf16 v[80:83], v[48:51], a[140:143], v[80:83]
    v_sad_u32 v191, v43, v13, v197
    v_sub_u32 v201, v13, v43
    v_mfma_f32_16x16x32_bf16 v[80:83], v[52:55], a[148:151], v[80:83]
    buffer_load_dwordx4 v1, s[8:11], s15 offen offset:0 sc1 lds
    v_mfma_f32_16x16x32_bf16 v[80:83], v[56:59], a[156:159], v[80:83]
    s_waitcnt lgkmcnt(0)
    v_sad_u32 v192, v41, v13, v197
    v_sub_u32 v202, v13, v41
    v_mfma_f32_16x16x32_bf16 v[156:159], v[60:63], a[128:131], v[156:159]
    s_add_u32 m0, s12, 36864
    ds_read_b128 v[44:47], v4 offset:16384
    v_add_u32 v43, 15360, v14
    v_mfma_f32_16x16x32_bf16 v[156:159], v[64:67], a[136:139], v[156:159]
    s_add_u32 s15, s14, 258048
    ds_read_b128 v[48:51], v4 offset:17408
    v_add_u32 v218, 4294955008, v14
    v_mfma_f32_16x16x32_bf16 v[156:159], v[68:71], a[144:147], v[156:159]
    ds_read_b128 v[52:55], v4 offset:18432
    v_min_u32 v43, v43, v218
    v_mfma_f32_16x16x32_bf16 v[156:159], v[72:75], a[152:155], v[156:159]
    buffer_load_dwordx4 a[192:195], v8, s[8:11], s16 offen offset:0 sc1
    v_mfma_f32_16x16x32_bf16 v[160:163], v[60:63], a[132:135], v[160:163]
    ds_read_b128 v[56:59], v4 offset:19456
    v_sad_u32 v193, v43, v13, v197
    v_mfma_f32_16x16x32_bf16 v[160:163], v[64:67], a[140:143], v[160:163]
    v_sub_u32 v203, v13, v43
    v_add_u32 v41, 18432, v14
    v_mfma_f32_16x16x32_bf16 v[160:163], v[68:71], a[148:151], v[160:163]
    v_add_u32 v42, 4294958080, v14
    v_add_u32 v43, 21504, v14
    v_mfma_f32_16x16x32_bf16 v[160:163], v[72:75], a[156:159], v[160:163]
    s_waitcnt lgkmcnt(0)
    v_min_u32 v41, v41, v42
    v_add_u32 v218, 4294961152, v14
    v_mfma_f32_16x16x32_bf16 v[164:167], v[44:47], a[128:131], v[164:167]
    buffer_load_dwordx4 a[196:199], v8, s[8:11], s16 offen offset:256 sc1
    v_mfma_f32_16x16x32_bf16 v[164:167], v[48:51], a[136:139], v[164:167]
    s_mov_b32 s16, 24576
    ds_read_b128 v[60:63], v4 offset:20480
    ds_read_b128 v[64:67], v4 offset:21504
    v_mfma_f32_16x16x32_bf16 v[164:167], v[52:55], a[144:147], v[164:167]
    s_lshl_b32 s26, s5, 12
    ds_read_b128 v[68:71], v4 offset:22528
    v_sad_u32 v194, v41, v13, v197
    v_mfma_f32_16x16x32_bf16 v[164:167], v[56:59], a[152:155], v[164:167]
    s_lshl_b32 s29, s4, 10
    ds_read_b128 v[72:75], v4 offset:23552
    v_sub_u32 v204, v13, v41
    v_mfma_f32_16x16x32_bf16 v[168:171], v[44:47], a[132:135], v[168:171]
    s_add_u32 s26, s26, s29
    v_min_u32 v43, v43, v218
    v_add_u32 v41, 24576, v14
    v_mfma_f32_16x16x32_bf16 v[168:171], v[48:51], a[140:143], v[168:171]
    buffer_load_dwordx4 a[200:203], v8, s[8:11], s16 offen offset:0 sc1
    v_mfma_f32_16x16x32_bf16 v[168:171], v[52:55], a[148:151], v[168:171]
    s_lshl_b32 s29, s6, 6
    v_sad_u32 v195, v43, v13, v197
    v_sub_u32 v205, v13, v43
    v_mfma_f32_16x16x32_bf16 v[168:171], v[56:59], a[156:159], v[168:171]
    s_waitcnt lgkmcnt(0)
    v_add_u32 v42, 4294964224, v14
    v_cmp_gt_u32 vcc, 512, v1
    v_mfma_f32_16x16x32_bf16 v[140:143], v[60:63], a[128:131], v[140:143]
    s_add_u32 s26, s26, s29
    ds_read_b128 v[44:47], v4 offset:24576
    v_min_u32 v41, v41, v42
    v_mfma_f32_16x16x32_bf16 v[140:143], v[64:67], a[136:139], v[140:143]
    ds_read_b128 v[48:51], v4 offset:25600
    v_sad_u32 v196, v41, v13, v197
    v_mfma_f32_16x16x32_bf16 v[140:143], v[68:71], a[144:147], v[140:143]
    buffer_load_dwordx4 a[204:207], v8, s[8:11], s16 offen offset:256 sc1
    v_mfma_f32_16x16x32_bf16 v[140:143], v[72:75], a[152:155], v[140:143]
    s_mov_b32 s16, 43008
    ds_read_b128 v[52:55], v4 offset:26624
    ds_read_b128 v[56:59], v4 offset:27648
    v_mfma_f32_16x16x32_bf16 v[144:147], v[60:63], a[132:135], v[144:147]
    v_sub_u32 v206, v13, v41
    v_subrev_u32 v41, 144, v197
    v_mfma_f32_16x16x32_bf16 v[144:147], v[64:67], a[140:143], v[144:147]
    v_cndmask_b32 v197, v41, v197, s[32:33]
    v_cndmask_b32 v188, v189, v188, vcc
    v_mfma_f32_16x16x32_bf16 v[144:147], v[68:71], a[148:151], v[144:147]
    v_cndmask_b32 v190, v191, v190, vcc
    v_cndmask_b32 v192, v193, v192, vcc
    v_mfma_f32_16x16x32_bf16 v[144:147], v[72:75], a[156:159], v[144:147]
    s_waitcnt lgkmcnt(0)
    v_cndmask_b32 v194, v195, v194, vcc
    v_cndmask_b32 v196, v197, v196, vcc
    v_mfma_f32_16x16x32_bf16 v[148:151], v[44:47], a[128:131], v[148:151]
    buffer_load_dwordx4 a[208:211], v8, s[8:11], s16 offen offset:0 sc1
    v_mfma_f32_16x16x32_bf16 v[148:151], v[48:51], a[136:139], v[148:151]
    ds_read_b128 v[60:63], v4 offset:28672
    ds_read_b128 v[64:67], v4 offset:29696
    v_mfma_f32_16x16x32_bf16 v[148:151], v[52:55], a[144:147], v[148:151]
    ds_read_b128 v[68:71], v4 offset:30720
    v_lshlrev_b32 v207, 3, v216
    v_mfma_f32_16x16x32_bf16 v[148:151], v[56:59], a[152:155], v[148:151]
    ds_read_b128 v[72:75], v4 offset:31744
    v_cndmask_b32 v207, v207, -2.0, s[30:31]
    v_mfma_f32_16x16x32_bf16 v[152:155], v[44:47], a[132:135], v[152:155]
    buffer_load_dwordx4 a[212:215], v8, s[8:11], s16 offen offset:256 sc1
    v_mfma_f32_16x16x32_bf16 v[152:155], v[48:51], a[140:143], v[152:155]
    s_mov_b32 s16, 61440
    v_lshrrev_b32 v43, 3, v0
    v_and_b32 v42, 3, v0
    v_mfma_f32_16x16x32_bf16 v[152:155], v[52:55], a[148:151], v[152:155]
    v_bfe_u32 v218, v0, 2, 1
    v_lshl_add_u32 v121, v43, 2, v42
    v_mfma_f32_16x16x32_bf16 v[152:155], v[56:59], a[156:159], v[152:155]
    s_waitcnt lgkmcnt(0)
    v_mul_u32_u24 v121, 48, v121
    v_cmp_gt_u32 vcc, 72, v0
    v_mfma_f32_16x16x32_bf16 v[172:175], v[60:63], a[128:131], v[172:175]
    ds_read_b128 v[44:47], v4 offset:32768
    v_sub_u32 v121, 53392, v121
    v_mfma_f32_16x16x32_bf16 v[172:175], v[64:67], a[136:139], v[172:175]
    buffer_load_dwordx4 a[216:219], v8, s[8:11], s16 offen offset:0 sc1
    v_mfma_f32_16x16x32_bf16 v[172:175], v[68:71], a[144:147], v[172:175]
    ds_read_b128 v[48:51], v4 offset:33792
    ds_read_b128 v[52:55], v4 offset:34816
    v_mfma_f32_16x16x32_bf16 v[172:175], v[72:75], a[152:155], v[172:175]
L_pad_c1_7:
    s_cbranch_execz L_hopret_c1
    ds_read_b128 v[56:59], v4 offset:35840
    v_lshl_add_u32 v121, v218, 4, v121
    v_mfma_f32_16x16x32_bf16 v[176:179], v[60:63], a[132:135], v[176:179]
    v_mul_u32_u24 v218, 1196032, v218
    v_mfma_f32_16x16x32_bf16 v[176:179], v[64:67], a[140:143], v[176:179]
    v_lshl_add_u32 v43, v43, 14, v218
    v_mfma_f32_16x16x32_bf16 v[176:179], v[68:71], a[148:151], v[176:179]
    buffer_load_dwordx4 a[220:223], v8, s[8:11], s16 offen offset:256 sc1
    v_mfma_f32_16x16x32_bf16 v[176:179], v[72:75], a[156:159], v[176:179]
    s_waitcnt lgkmcnt(0)
    v_lshl_add_u32 v43, v42, 4, v43
    v_mfma_f32_16x16x32_bf16 v[180:183], v[44:47], a[128:131], v[180:183]
    s_waitcnt vmcnt(17)
    s_barrier
    ds_read_b128 v[60:63], v5 offset:0
    v_mfma_f32_16x16x32_bf16 v[180:183], v[48:51], a[136:139], v[180:183]
    s_mov_b32 s16, 7168
    ds_read_b128 v[64:67], v5 offset:1024
    v_add_u32 v122, s26, v43
    v_mfma_f32_16x16x32_bf16 v[180:183], v[52:55], a[144:147], v[180:183]
    ds_read_b128 v[68:71], v5 offset:2048
    v_cndmask_b32 v123, -2.0, v122, vcc
    v_mfma_f32_16x16x32_bf16 v[180:183], v[56:59], a[152:155], v[180:183]
    buffer_load_dwordx4 v1, s[8:11], s15 offen offset:0 sc1 lds
    v_mfma_f32_16x16x32_bf16 v[184:187], v[44:47], a[132:135], v[184:187]
    ds_read_b128 v[72:75], v5 offset:3072
    v_mfma_f32_16x16x32_bf16 v[184:187], v[48:51], a[140:143], v[184:187]
    v_mfma_f32_16x16x32_bf16 v[184:187], v[52:55], a[148:151], v[184:187]
    v_mfma_f32_16x16x32_bf16 v[184:187], v[56:59], a[156:159], v[184:187]
    s_waitcnt lgkmcnt(0)
    v_mfma_f32_16x16x32_bf16 v[124:127], v[60:63], a[160:163], v[124:127]
    buffer_load_dwordx4 v1, s[8:11], s15 offen offset:1024 sc1 lds
    v_mfma_f32_16x16x32_bf16 v[124:127], v[64:67], a[168:171], v[124:127]
    ds_read_b128 v[44:47], v5 offset:4096
    ds_read_b128 v[48:51], v5 offset:5120
    v_mfma_f32_16x16x32_bf16 v[124:127], v[68:71], a[176:179], v[124:127]
    ds_read_b128 v[52:55], v5 offset:6144
    v_mfma_f32_16x16x32_bf16 v[124:127], v[72:75], a[184:187], v[124:127]
    ds_read_b128 v[56:59], v5 offset:7168
    v_mfma_f32_16x16x32_bf16 v[128:131], v[60:63], a[164:167], v[128:131]
    v_mfma_f32_16x16x32_bf16 v[128:131], v[64:67], a[172:175], v[128:131]
    buffer_load_dwordx4 v1, s[8:11], s15 offen offset:2048 sc1 lds
    v_mfma_f32_16x16x32_bf16 v[128:131], v[68:71], a[180:183], v[128:131]
    v_mfma_f32_16x16x32_bf16 v[128:131], v[72:75], a[188:191], v[128:131]
    s_waitcnt lgkmcnt(0)
    v_mfma_f32_16x16x32_bf16 v[132:135], v[44:47], a[160:163], v[132:135]
    ds_read_b128 v[60:63], v5 offset:8192
    v_mfma_f32_16x16x32_bf16 v[132:135], v[48:51], a[168:171], v[132:135]
    ds_read_b128 v[64:67], v5 offset:9216
    v_mfma_f32_16x16x32_bf16 v[132:135], v[52:55], a[176:179], v[132:135]
    buffer_load_dwordx4 v1, s[8:11], s15 offen offset:3072 sc1 lds
    v_mfma_f32_16x16x32_bf16 v[132:135], v[56:59], a[184:187], v[132:135]
    s_add_u32 m0, s12, 40960
    ds_read_b128 v[68:71], v5 offset:10240
    ds_read_b128 v[72:75], v5 offset:11264
    v_mfma_f32_16x16x32_bf16 v[136:139], v[44:47], a[164:167], v[136:139]
    s_add_u32 s15, s14, 262144
    v_mfma_f32_16x16x32_bf16 v[136:139], v[48:51], a[172:175], v[136:139]
    v_mfma_f32_16x16x32_bf16 v[136:139], v[52:55], a[180:183], v[136:139]
    v_mfma_f32_16x16x32_bf16 v[136:139], v[56:59], a[188:191], v[136:139]
    s_waitcnt lgkmcnt(0)
    v_mfma_f32_16x16x32_bf16 v[76:79], v[60:63], a[160:163], v[76:79]
    buffer_load_dwordx4 v1, s[8:11], s15 offen offset:0 sc1 lds
    v_mfma_f32_16x16x32_bf16 v[76:79], v[64:67], a[168:171], v[76:79]
    ds_read_b128 v[44:47], v5 offset:12288
    ds_read_b128 v[48:51], v5 offset:13312
    v_mfma_f32_16x16x32_bf16 v[76:79], v[68:71], a[176:179], v[76:79]
    ds_read_b128 v[52:55], v5 offset:14336
    v_mfma_f32_16x16x32_bf16 v[76:79], v[72:75], a[184:187], v[76:79]
    ds_read_b128 v[56:59], v5 offset:15360
    v_mfma_f32_16x16x32_bf16 v[80:83], v[60:63], a[164:167], v[80:83]
    buffer_load_dwordx4 v1, s[8:11], s15 offen offset:1024 sc1 lds
    v_mfma_f32_16x16x32_bf16 v[80:83], v[64:67], a[172:175], v[80:83]
    v_mfma_f32_16x16x32_bf16 v[80:83], v[68:71], a[180:183], v[80:83]
    v_mfma_f32_16x16x32_bf16 v[80:83], v[72:75], a[188:191], v[80:83]
    s_waitcnt lgkmcnt(0)
    v_mfma_f32_16x16x32_bf16 v[156:159], v[44:47], a[160:163], v[156:159]
    ds_read_b128 v[60:63], v5 offset:16384
    v_mfma_f32_16x16x32_bf16 v[156:159], v[48:51], a[168:171], v[156:159]
    buffer_load_dwordx4 v1, s[8:11], s15 offen offset:2048 sc1 lds
    v_mfma_f32_16x16x32_bf16 v[156:159], v[52:55], a[176:179], v[156:159]
    ds_read_b128 v[64:67], v5 offset:17408
    ds_read_b128 v[68:71], v5 offset:18432
    v_mfma_f32_16x16x32_bf16 v[156:159], v[56:59], a[184:187], v[156:159]
    ds_read_b128 v[72:75], v5 offset:19456
    v_mfma_f32_16x16x32_bf16 v[160:163], v[44:47], a[164:167], v[160:163]
    v_mfma_f32_16x16x32_bf16 v[160:163], v[48:51], a[172:175], v[160:163]
    v_mfma_f32_16x16x32_bf16 v[160:163], v[52:55], a[180:183], v[160:163]
    buffer_load_dwordx4 v1, s[8:11], s15 offen offset:3072 sc1 lds
    v_mfma_f32_16x16x32_bf16 v[160:163], v[56:59], a[188:191], v[160:163]
    s_waitcnt lgkmcnt(0)
    v_mfma_f32_16x16x32_bf16 v[164:167], v[60:63], a[160:163], v[164:167]
    s_add_u32 m0, s12, 45056
    ds_read_b128 v[44:47], v5 offset:20480
    v_mfma_f32_16x16x32_bf16 v[164:167], v[64:67], a[168:171], v[164:167]
    s_add_u32 s15, s14, 266240
    ds_read_b128 v[48:51], v5 offset:21504
    v_mfma_f32_16x16x32_bf16 v[164:167], v[68:71], a[176:179], v[164:167]
    ds_read_b128 v[52:55], v5 offset:22528
    v_mfma_f32_16x16x32_bf16 v[164:167], v[72:75], a[184:187], v[164:167]
    buffer_load_dwordx4 v1, s[8:11], s15 offen offset:0 sc1 lds
    v_mfma_f32_16x16x32_bf16 v[168:171], v[60:63], a[164:167], v[168:171]
    s_add_u32 m0, s12, 73728
    ds_read_b128 v[56:59], v5 offset:23552
    v_mfma_f32_16x16x32_bf16 v[168:171], v[64:67], a[172:175], v[168:171]
    s_add_u32 s15, s14, 294912
    v_mfma_f32_16x16x32_bf16 v[168:171], v[68:71], a[180:183], v[168:171]
    v_mfma_f32_16x16x32_bf16 v[168:171], v[72:75], a[188:191], v[168:171]
    s_waitcnt lgkmcnt(0)
    v_mfma_f32_16x16x32_bf16 v[140:143], v[44:47], a[160:163], v[140:143]
    buffer_load_dwordx4 a[224:227], v8, s[8:11], s16 offen offset:0 sc1
    v_mfma_f32_16x16x32_bf16 v[140:143], v[48:51], a[168:171], v[140:143]
    ds_read_b128 v[60:63], v5 offset:24576
    ds_read_b128 v[64:67], v5 offset:25600
    v_mfma_f32_16x16x32_bf16 v[140:143], v[52:55], a[176:179], v[140:143]
    ds_read_b128 v[68:71], v5 offset:26624
    v_mfma_f32_16x16x32_bf16 v[140:143], v[56:59], a[184:187], v[140:143]
    ds_read_b128 v[72:75], v5 offset:27648
    v_mfma_f32_16x16x32_bf16 v[144:147], v[44:47], a[164:167], v[144:147]
    v_mfma_f32_16x16x32_bf16 v[144:147], v[48:51], a[172:175], v[144:147]
    buffer_load_dwordx4 a[228:231], v8, s[8:11], s16 offen offset:256 sc1
    v_mfma_f32_16x16x32_bf16 v[144:147], v[52:55], a[180:183], v[144:147]
    s_mov_b32 s16, 25600
    v_mfma_f32_16x16x32_bf16 v[144:147], v[56:59], a[188:191], v[144:147]
    s_waitcnt lgkmcnt(0)
    v_mfma_f32_16x16x32_bf16 v[148:151], v[60:63], a[160:163], v[148:151]
    ds_read_b128 v[44:47], v5 offset:28672
    v_mfma_f32_16x16x32_bf16 v[148:151], v[64:67], a[168:171], v[148:151]
    ds_read_b128 v[48:51], v5 offset:29696
    v_mfma_f32_16x16x32_bf16 v[148:151], v[68:71], a[176:179], v[148:151]
    buffer_load_dwordx4 a[232:235], v8, s[8:11], s16 offen offset:0 sc1
    v_mfma_f32_16x16x32_bf16 v[148:151], v[72:75], a[184:187], v[148:151]
    ds_read_b128 v[52:55], v5 offset:30720
    ds_read_b128 v[56:59], v5 offset:31744
    v_mfma_f32_16x16x32_bf16 v[152:155], v[60:63], a[164:167], v[152:155]
    v_mfma_f32_16x16x32_bf16 v[152:155], v[64:67], a[172:175], v[152:155]
    v_mfma_f32_16x16x32_bf16 v[152:155], v[68:71], a[180:183], v[152:155]
    v_mfma_f32_16x16x32_bf16 v[152:155], v[72:75], a[188:191], v[152:155]
    s_waitcnt lgkmcnt(0)
    v_mfma_f32_16x16x32_bf16 v[172:175], v[44:47], a[160:163], v[172:175]
    buffer_load_dwordx4 a[236:239], v8, s[8:11], s16 offen offset:256 sc1
    v_mfma_f32_16x16x32_bf16 v[172:175], v[48:51], a[168:171], v[172:175]
    s_mov_b32 s16, 44032
    ds_read_b128 v[60:63], v5 offset:32768
    ds_read_b128 v[64:67], v5 offset:33792
    v_mfma_f32_16x16x32_bf16 v[172:175], v[52:55], a[176:179], v[172:175]
    ds_read_b128 v[68:71], v5 offset:34816
    v_mfma_f32_16x16x32_bf16 v[172:175], v[56:59], a[184:187], v[172:175]
    ds_read_b128 v[72:75], v5 offset:35840
    v_mfma_f32_16x16x32_bf16 v[176:179], v[44:47], a[164:167], v[176:179]
    buffer_load_dwordx4 a[240:243], v8, s[8:11], s16 offen offset:0 sc1
    v_mfma_f32_16x16x32_bf16 v[176:179], v[48:51], a[172:175], v[176:179]
    v_mfma_f32_16x16x32_bf16 v[176:179], v[52:55], a[180:183], v[176:179]
    v_mfma_f32_16x16x32_bf16 v[176:179], v[56:59], a[188:191], v[176:179]
    s_waitcnt lgkmcnt(0)
    v_mfma_f32_16x16x32_bf16 v[180:183], v[60:63], a[160:163], v[180:183]
    s_waitcnt vmcnt(14)
    s_barrier
    ds_read_b128 v[44:47], v2 offset:0
    v_mfma_f32_16x16x32_bf16 v[180:183], v[64:67], a[168:171], v[180:183]
    buffer_load_dwordx4 a[244:247], v8, s[8:11], s16 offen offset:256 sc1
    v_mfma_f32_16x16x32_bf16 v[180:183], v[68:71], a[176:179], v[180:183]
    s_mov_b32 s16, 62464
    ds_read_b128 v[48:51], v2 offset:1024
    ds_read_b128 v[52:55], v2 offset:2048
    v_mfma_f32_16x16x32_bf16 v[180:183], v[72:75], a[184:187], v[180:183]
    ds_read_b128 v[56:59], v2 offset:3072
    v_mfma_f32_16x16x32_bf16 v[184:187], v[60:63], a[164:167], v[184:187]
    v_mfma_f32_16x16x32_bf16 v[184:187], v[64:67], a[172:175], v[184:187]
    v_mfma_f32_16x16x32_bf16 v[184:187], v[68:71], a[180:183], v[184:187]
    buffer_load_dwordx4 a[248:251], v8, s[8:11], s16 offen offset:0 sc1
    v_mfma_f32_16x16x32_bf16 v[184:187], v[72:75], a[188:191], v[184:187]
    s_waitcnt lgkmcnt(0)
    v_mfma_f32_16x16x32_bf16 v[124:127], v[44:47], a[192:195], v[124:127]
    ds_read_b128 v[60:63], v2 offset:4096
    v_mfma_f32_16x16x32_bf16 v[124:127], v[48:51], a[200:203], v[124:127]
    ds_read_b128 v[64:67], v2 offset:5120
    v_mfma_f32_16x16x32_bf16 v[124:127], v[52:55], a[208:211], v[124:127]
    ds_read_b128 v[68:71], v2 offset:6144
    v_mfma_f32_16x16x32_bf16 v[124:127], v[56:59], a[216:219], v[124:127]
    buffer_load_dwordx4 a[252:255], v8, s[8:11], s16 offen offset:256 sc1
    v_mfma_f32_16x16x32_bf16 v[128:131], v[44:47], a[196:199], v[128:131]
    s_mov_b32 s16, 8192
    ds_read_b128 v[72:75], v2 offset:7168
    v_mfma_f32_16x16x32_bf16 v[128:131], v[48:51], a[204:207], v[128:131]
    v_mfma_f32_16x16x32_bf16 v[128:131], v[52:55], a[212:215], v[128:131]
    v_mfma_f32_16x16x32_bf16 v[128:131], v[56:59], a[220:223], v[128:131]
    s_waitcnt lgkmcnt(0)
    v_mfma_f32_16x16x32_bf16 v[132:135], v[60:63], a[192:195], v[132:135]
    buffer_load_dwordx4 v[220:223], v8, s[8:11], s16 offen offset:0 sc1
    v_mfma_f32_16x16x32_bf16 v[132:135], v[64:67], a[200:203], v[132:135]
    ds_read_b128 v[44:47], v2 offset:8192
    ds_read_b128 v[48:51], v2 offset:9216
    v_mfma_f32_16x16x32_bf16 v[132:135], v[68:71], a[208:211], v[132:135]
    ds_read_b128 v[52:55], v2 offset:10240
    v_mfma_f32_16x16x32_bf16 v[132:135], v[72:75], a[216:219], v[132:135]
    ds_read_b128 v[56:59], v2 offset:11264
    v_mfma_f32_16x16x32_bf16 v[136:139], v[60:63], a[196:199], v[136:139]
    v_mfma_f32_16x16x32_bf16 v[136:139], v[64:67], a[204:207], v[136:139]
    buffer_load_dwordx4 v[224:227], v8, s[8:11], s16 offen offset:256 sc1
    v_mfma_f32_16x16x32_bf16 v[136:139], v[68:71], a[212:215], v[136:139]
    s_mov_b32 s16, 26624
    v_mfma_f32_16x16x32_bf16 v[136:139], v[72:75], a[220:223], v[136:139]
    s_waitcnt lgkmcnt(0)
    v_mfma_f32_16x16x32_bf16 v[76:79], v[44:47], a[192:195], v[76:79]
    ds_read_b128 v[60:63], v2 offset:12288
    v_mfma_f32_16x16x32_bf16 v[76:79], v[48:51], a[200:203], v[76:79]
    ds_read_b128 v[64:67], v2 offset:13312
    v_mfma_f32_16x16x32_bf16 v[76:79], v[52:55], a[208:211], v[76:79]
    buffer_load_dwordx4 v[228:231], v8, s[8:11], s16 offen offset:0 sc1
    v_mfma_f32_16x16x32_bf16 v[76:79], v[56:59], a[216:219], v[76:79]
    ds_read_b128 v[68:71], v2 offset:14336
    ds_read_b128 v[72:75], v2 offset:15360
    v_mfma_f32_16x16x32_bf16 v[80:83], v[44:47], a[196:199], v[80:83]
    v_mfma_f32_16x16x32_bf16 v[80:83], v[48:51], a[204:207], v[80:83]
    v_mfma_f32_16x16x32_bf16 v[80:83], v[52:55], a[212:215], v[80:83]
    v_mfma_f32_16x16x32_bf16 v[80:83], v[56:59], a[220:223], v[80:83]
    s_waitcnt lgkmcnt(0)
    v_mfma_f32_16x16x32_bf16 v[156:159], v[60:63], a[192:195], v[156:159]
    buffer_load_dwordx4 v[232:235], v8, s[8:11], s16 offen offset:256 sc1
    v_mfma_f32_16x16x32_bf16 v[156:159], v[64:67], a[200:203], v[156:159]
    s_mov_b32 s16, 45056
    ds_read_b128 v[44:47], v2 offset:16384
    ds_read_b128 v[48:51], v2 offset:17408
    v_mfma_f32_16x16x32_bf16 v[156:159], v[68:71], a[208:211], v[156:159]
    ds_read_b128 v[52:55], v2 offset:18432
    v_mfma_f32_16x16x32_bf16 v[156:159], v[72:75], a[216:219], v[156:159]
    ds_read_b128 v[56:59], v2 offset:19456
    v_mfma_f32_16x16x32_bf16 v[160:163], v[60:63], a[196:199], v[160:163]
    buffer_load_dwordx4 v[236:239], v8, s[8:11], s16 offen offset:0 sc1
    v_mfma_f32_16x16x32_bf16 v[160:163], v[64:67], a[204:207], v[160:163]
    v_mfma_f32_16x16x32_bf16 v[160:163], v[68:71], a[212:215], v[160:163]
    v_mfma_f32_16x16x32_bf16 v[160:163], v[72:75], a[220:223], v[160:163]
    s_waitcnt lgkmcnt(0)
    v_mfma_f32_16x16x32_bf16 v[164:167], v[44:47], a[192:195], v[164:167]
    ds_read_b128 v[60:63], v2 offset:20480
    v_mfma_f32_16x16x32_bf16 v[164:167], v[48:51], a[200:203], v[164:167]
    buffer_load_dwordx4 v[240:243], v8, s[8:11], s16 offen offset:256 sc1
    v_mfma_f32_16x16x32_bf16 v[164:167], v[52:55], a[208:211], v[164:167]
    s_mov_b32 s16, 63488
    ds_read_b128 v[64:67], v2 offset:21504
    ds_read_b128 v[68:71], v2 offset:22528
    v_mfma_f32_16x16x32_bf16 v[164:167], v[56:59], a[216:219], v[164:167]
    ds_read_b128 v[72:75], v2 offset:23552
    v_mfma_f32_16x16x32_bf16 v[168:171], v[44:47], a[196:199], v[168:171]
    v_mfma_f32_16x16x32_bf16 v[168:171], v[48:51], a[204:207], v[168:171]
    v_mfma_f32_16x16x32_bf16 v[168:171], v[52:55], a[212:215], v[168:171]
    buffer_load_dwordx4 v[244:247], v8, s[8:11], s16 offen offset:0 sc1
    v_mfma_f32_16x16x32_bf16 v[168:171], v[56:59], a[220:223], v[168:171]
    s_waitcnt lgkmcnt(0)
    v_mfma_f32_16x16x32_bf16 v[140:143], v[60:63], a[192:195], v[140:143]
    ds_read_b128 v[44:47], v2 offset:24576
    v_mfma_f32_16x16x32_bf16 v[140:143], v[64:67], a[200:203], v[140:143]
    ds_read_b128 v[48:51], v2 offset:25600
    v_mfma_f32_16x16x32_bf16 v[140:143], v[68:71], a[208:211], v[140:143]
    ds_read_b128 v[52:55], v2 offset:26624
    v_mfma_f32_16x16x32_bf16 v[140:143], v[72:75], a[216:219], v[140:143]
    buffer_load_dwordx4 v[248:251], v8, s[8:11], s16 offen offset:256 sc1
    v_mfma_f32_16x16x32_bf16 v[144:147], v[60:63], a[196:199], v[144:147]
    ds_read_b128 v[56:59], v2 offset:27648
    v_mfma_f32_16x16x32_bf16 v[144:147], v[64:67], a[204:207], v[144:147]
    v_mfma_f32_16x16x32_bf16 v[144:147], v[68:71], a[212:215], v[144:147]
    v_mfma_f32_16x16x32_bf16 v[144:147], v[72:75], a[220:223], v[144:147]
    s_waitcnt lgkmcnt(0)
    v_mfma_f32_16x16x32_bf16 v[148:151], v[44:47], a[192:195], v[148:151]
    buffer_load_dwordx4 v1, s[8:11], s15 offen offset:0 sc1 lds
    v_mfma_f32_16x16x32_bf16 v[148:151], v[48:51], a[200:203], v[148:151]
    ds_read_b128 v[60:63], v2 offset:28672
    ds_read_b128 v[64:67], v2 offset:29696
    v_mfma_f32_16x16x32_bf16 v[148:151], v[52:55], a[208:211], v[148:151]
    ds_read_b128 v[68:71], v2 offset:30720
    v_mfma_f32_16x16x32_bf16 v[148:151], v[56:59], a[216:219], v[148:151]
    ds_read_b128 v[72:75], v2 offset:31744
    v_mfma_f32_16x16x32_bf16 v[152:155], v[44:47], a[196:199], v[152:155]
    v_mfma_f32_16x16x32_bf16 v[152:155], v[48:51], a[204:207], v[152:155]
    buffer_load_dwordx4 v1, s[8:11], s15 offen offset:1024 sc1 lds
    v_mfma_f32_16x16x32_bf16 v[152:155], v[52:55], a[212:215], v[152:155]
    v_mfma_f32_16x16x32_bf16 v[152:155], v[56:59], a[220:223], v[152:155]
    s_waitcnt lgkmcnt(0)
    v_mfma_f32_16x16x32_bf16 v[172:175], v[60:63], a[192:195], v[172:175]
    ds_read_b128 v[44:47], v2 offset:32768
    v_mfma_f32_16x16x32_bf16 v[172:175], v[64:67], a[200:203], v[172:175]
    ds_read_b128 v[48:51], v2 offset:33792
    v_mfma_f32_16x16x32_bf16 v[172:175], v[68:71], a[208:211], v[172:175]
    buffer_load_dwordx4 v1, s[8:11], s15 offen offset:2048 sc1 lds
    v_mfma_f32_16x16x32_bf16 v[172:175], v[72:75], a[216:219], v[172:175]
    ds_read_b128 v[52:55], v2 offset:34816
    ds_read_b128 v[56:59], v2 offset:35840
    v_mfma_f32_16x16x32_bf16 v[176:179], v[60:63], a[196:199], v[176:179]
    v_mfma_f32_16x16x32_bf16 v[176:179], v[64:67], a[204:207], v[176:179]
    v_mfma_f32_16x16x32_bf16 v[176:179], v[68:71], a[212:215], v[176:179]
    v_mfma_f32_16x16x32_bf16 v[176:179], v[72:75], a[220:223], v[176:179]
    s_waitcnt lgkmcnt(0)
    v_mfma_f32_16x16x32_bf16 v[180:183], v[44:47], a[192:195], v[180:183]
    s_waitcnt vmcnt(3)
    s_barrier
    ds_read_b128 v[60:63], v3 offset:0
    v_mfma_f32_16x16x32_bf16 v[180:183], v[48:51], a[200:203], v[180:183]
    buffer_load_dwordx4 v1, s[8:11], s15 offen offset:3072 sc1 lds
    v_mfma_f32_16x16x32_bf16 v[180:183], v[52:55], a[208:211], v[180:183]
    s_add_u32 m0, s12, 77824
    ds_read_b128 v[64:67], v3 offset:1024
    ds_read_b128 v[68:71], v3 offset:2048
    v_mfma_f32_16x16x32_bf16 v[180:183], v[56:59], a[216:219], v[180:183]
    s_add_u32 s15, s14, 299008
    ds_read_b128 v[72:75], v3 offset:3072
    v_mfma_f32_16x16x32_bf16 v[184:187], v[44:47], a[196:199], v[184:187]
    v_mfma_f32_16x16x32_bf16 v[184:187], v[48:51], a[204:207], v[184:187]
    buffer_load_dwordx4 v1, s[8:11], s15 offen offset:0 sc1 lds
    v_mfma_f32_16x16x32_bf16 v[184:187], v[52:55], a[212:215], v[184:187]
    v_mfma_f32_16x16x32_bf16 v[184:187], v[56:59], a[220:223], v[184:187]
    s_waitcnt lgkmcnt(0)
    v_mfma_f32_16x16x32_bf16 v[124:127], v[60:63], a[224:227], v[124:127]
    ds_read_b128 v[44:47], v3 offset:4096
    v_mfma_f32_16x16x32_bf16 v[124:127], v[64:67], a[232:235], v[124:127]
    ds_read_b128 v[48:51], v3 offset:5120
    v_mfma_f32_16x16x32_bf16 v[124:127], v[68:71], a[240:243], v[124:127]
    buffer_load_dwordx4 v1, s[8:11], s15 offen offset:1024 sc1 lds
    v_mfma_f32_16x16x32_bf16 v[124:127], v[72:75], a[248:251], v[124:127]
    ds_read_b128 v[52:55], v3 offset:6144
    ds_read_b128 v[56:59], v3 offset:7168
    v_mfma_f32_16x16x32_bf16 v[128:131], v[60:63], a[228:231], v[128:131]
    v_mfma_f32_16x16x32_bf16 v[128:131], v[64:67], a[236:239], v[128:131]
    v_mfma_f32_16x16x32_bf16 v[128:131], v[68:71], a[244:247], v[128:131]
    v_mfma_f32_16x16x32_bf16 v[128:131], v[72:75], a[252:255], v[128:131]
    s_waitcnt lgkmcnt(0)
    v_mfma_f32_16x16x32_bf16 v[128:131], v[44:47], v[224:227], v[128:131]
    buffer_load_dwordx4 v1, s[8:11], s15 offen offset:2048 sc1 lds
    v_mfma_f32_16x16x32_bf16 v[128:131], v[48:51], v[232:235], v[128:131]
    ds_read_b128 v[60:63], v3 offset:8192
    ds_read_b128 v[64:67], v3 offset:9216
    v_mfma_f32_16x16x32_bf16 v[128:131], v[52:55], v[240:243], v[128:131]
    ds_read_b128 v[68:71], v3 offset:10240
    v_mfma_f32_16x16x32_bf16 v[128:131], v[56:59], v[248:251], v[128:131]
    ds_read_b128 v[72:75], v3 offset:11264
    v_mfma_f32_16x16x32_bf16 v[124:127], v[44:47], v[220:223], v[124:127]
    buffer_load_dwordx4 v1, s[8:11], s15 offen offset:3072 sc1 lds
    v_mfma_f32_16x16x32_bf16 v[124:127], v[48:51], v[228:231], v[124:127]
    s_add_u32 m0, s12, 81920
    v_mfma_f32_16x16x32_bf16 v[124:127], v[52:55], v[236:239], v[124:127]
    s_add_u32 s15, s14, 303104
    v_mfma_f32_16x16x32_bf16 v[124:127], v[56:59], v[244:247], v[124:127]
    s_waitcnt lgkmcnt(0)
    v_mfma_f32_16x16x32_bf16 v[132:135], v[60:63], a[224:227], v[132:135]
    ds_read_b128 v[44:47], v3 offset:12288
    v_mfma_f32_16x16x32_bf16 v[132:135], v[64:67], a[232:235], v[132:135]
    buffer_load_dwordx4 v1, s[8:11], s15 offen offset:0 sc1 lds
    v_mfma_f32_16x16x32_bf16 v[132:135], v[68:71], a[240:243], v[132:135]
    ds_read_b128 v[48:51], v3 offset:13312
    ds_read_b128 v[52:55], v3 offset:14336
    v_mfma_f32_16x16x32_bf16 v[132:135], v[72:75], a[248:251], v[132:135]
    ds_read_b128 v[56:59], v3 offset:15360
    v_cvt_pk_bf16_f32 v20, v124, v125
    v_mfma_f32_16x16x32_bf16 v[136:139], v[60:63], a[228:231], v[136:139]
    v_cvt_pk_bf16_f32 v21, v126, v127
    v_cvt_pk_bf16_f32 v22, v128, v129
    v_mfma_f32_16x16x32_bf16 v[136:139], v[64:67], a[236:239], v[136:139]
    v_cvt_pk_bf16_f32 v23, v130, v131
    v_mfma_f32_16x16x32_bf16 v[136:139], v[68:71], a[244:247], v[136:139]
    v_permlane32_swap_b32 v20, v22
    v_mfma_f32_16x16x32_bf16 v[136:139], v[72:75], a[252:255], v[136:139]
    s_waitcnt lgkmcnt(0)
    v_permlane32_swap_b32 v21, v23
    v_mfma_f32_16x16x32_bf16 v[136:139], v[44:47], v[224:227], v[136:139]
    buffer_store_dwordx4 v[20:23], v10, s[8:11], 0 offen sc1
    v_mfma_f32_16x16x32_bf16 v[136:139], v[48:51], v[232:235], v[136:139]
    ds_read_b128 v[60:63], v3 offset:16384
    ds_read_b128 v[64:67], v3 offset:17408
    v_mfma_f32_16x16x32_bf16 v[136:139], v[52:55], v[240:243], v[136:139]
    ds_read_b128 v[68:71], v3 offset:18432
    v_mfma_f32_16x16x32_bf16 v[136:139], v[56:59], v[248:251], v[136:139]
    ds_read_b128 v[72:75], v3 offset:19456
    v_mfma_f32_16x16x32_bf16 v[132:135], v[44:47], v[220:223], v[132:135]
    v_mfma_f32_16x16x32_bf16 v[132:135], v[48:51], v[228:231], v[132:135]
    s_getpc_b64 s[20:21]
L_pc17:
    s_add_u32 s20, s20, L_after0-L_pc17
    s_addc_u32 s21, s21, 0
    v_mfma_f32_16x16x32_bf16 v[132:135], v[52:55], v[236:239], v[132:135]
    v_lshlrev_b32 v7, 7, v0
    v_mfma_f32_16x16x32_bf16 v[132:135], v[56:59], v[244:247], v[132:135]
    s_waitcnt lgkmcnt(0)
    v_min_u32 v7, L_ffn1-L_after0, v7
    v_mfma_f32_16x16x32_bf16 v[76:79], v[60:63], a[224:227], v[76:79]
    ds_read_b128 v[44:47], v3 offset:20480
    v_mfma_f32_16x16x32_bf16 v[76:79], v[64:67], a[232:235], v[76:79]
    global_load_dword v6, v7, s[20:21]
    ds_read_b128 v[48:51], v3 offset:21504
    v_mfma_f32_16x16x32_bf16 v[76:79], v[68:71], a[240:243], v[76:79]
    ds_read_b128 v[52:55], v3 offset:22528
    v_mfma_f32_16x16x32_bf16 v[76:79], v[72:75], a[248:251], v[76:79]
    ds_read_b128 v[56:59], v3 offset:23552
    v_mfma_f32_16x16x32_bf16 v[80:83], v[60:63], a[228:231], v[80:83]
    v_mfma_f32_16x16x32_bf16 v[80:83], v[64:67], a[236:239], v[80:83]
    v_mfma_f32_16x16x32_bf16 v[80:83], v[68:71], a[244:247], v[80:83]
    v_mfma_f32_16x16x32_bf16 v[80:83], v[72:75], a[252:255], v[80:83]
    s_waitcnt lgkmcnt(0)
    v_mfma_f32_16x16x32_bf16 v[80:83], v[44:47], v[224:227], v[80:83]
    ds_read_b128 v[60:63], v3 offset:24576
    v_mfma_f32_16x16x32_bf16 v[80:83], v[48:51], v[232:235], v[80:83]
    ds_read_b128 v[64:67], v3 offset:25600
    v_mfma_f32_16x16x32_bf16 v[80:83], v[52:55], v[240:243], v[80:83]
    ds_read_b128 v[68:71], v3 offset:26624
    v_mfma_f32_16x16x32_bf16 v[80:83], v[56:59], v[248:251], v[80:83]
    ds_read_b128 v[72:75], v3 offset:27648
    v_mfma_f32_16x16x32_bf16 v[76:79], v[44:47], v[220:223], v[76:79]
    v_mfma_f32_16x16x32_bf16 v[76:79], v[48:51], v[228:231], v[76:79]
    v_mfma_f32_16x16x32_bf16 v[76:79], v[52:55], v[236:239], v[76:79]
    v_mfma_f32_16x16x32_bf16 v[76:79], v[56:59], v[244:247], v[76:79]
    s_waitcnt lgkmcnt(0)
    v_mfma_f32_16x16x32_bf16 v[156:159], v[60:63], a[224:227], v[156:159]
    s_mov_b32 s17, 0
    ds_read_b128 v[44:47], v3 offset:28672
    v_mfma_f32_16x16x32_bf16 v[156:159], v[64:67], a[232:235], v[156:159]
    ds_read_b128 v[48:51], v3 offset:29696
    v_mfma_f32_16x16x32_bf16 v[156:159], v[68:71], a[240:243], v[156:159]
    ds_read_b128 v[52:55], v3 offset:30720
    v_mfma_f32_16x16x32_bf16 v[156:159], v[72:75], a[248:251], v[156:159]
    ds_read_b128 v[56:59], v3 offset:31744
    v_cvt_pk_bf16_f32 v20, v132, v133
    v_mfma_f32_16x16x32_bf16 v[160:163], v[60:63], a[228:231], v[160:163]
    v_cvt_pk_bf16_f32 v21, v134, v135
    v_cvt_pk_bf16_f32 v22, v76, v77
    v_mfma_f32_16x16x32_bf16 v[160:163], v[64:67], a[236:239], v[160:163]
    v_cvt_pk_bf16_f32 v23, v78, v79
    v_cvt_pk_bf16_f32 v24, v136, v137
    v_mfma_f32_16x16x32_bf16 v[160:163], v[68:71], a[244:247], v[160:163]
    buffer_store_dwordx4 v[20:23], v9, s[8:11], s17 offen offset:0 sc1
    v_mfma_f32_16x16x32_bf16 v[160:163], v[72:75], a[252:255], v[160:163]
    s_waitcnt lgkmcnt(0)
    v_cvt_pk_bf16_f32 v25, v138, v139
    v_cvt_pk_bf16_f32 v26, v80, v81
    v_mfma_f32_16x16x32_bf16 v[160:163], v[44:47], v[224:227], v[160:163]
    ds_read_b128 v[60:63], v3 offset:32768
    v_cvt_pk_bf16_f32 v27, v82, v83
    v_mfma_f32_16x16x32_bf16 v[160:163], v[48:51], v[232:235], v[160:163]
    ds_read_b128 v[64:67], v3 offset:33792
    v_mfma_f32_16x16x32_bf16 v[160:163], v[52:55], v[240:243], v[160:163]
    buffer_store_dwordx4 v[24:27], v9, s[8:11], s17 offen offset:256 sc1
    v_mfma_f32_16x16x32_bf16 v[160:163], v[56:59], v[248:251], v[160:163]
    ds_read_b128 v[68:71], v3 offset:34816
    ds_read_b128 v[72:75], v3 offset:35840
    v_mfma_f32_16x16x32_bf16 v[156:159], v[44:47], v[220:223], v[156:159]
    v_mfma_f32_16x16x32_bf16 v[156:159], v[48:51], v[228:231], v[156:159]
    v_mfma_f32_16x16x32_bf16 v[156:159], v[52:55], v[236:239], v[156:159]
    v_mfma_f32_16x16x32_bf16 v[156:159], v[56:59], v[244:247], v[156:159]
    s_waitcnt lgkmcnt(0)
    v_mfma_f32_16x16x32_bf16 v[164:167], v[60:63], a[224:227], v[164:167]
    s_waitcnt vmcnt(4)
    s_barrier
    ds_read_b128 v[44:47], v4 offset:0
    v_mfma_f32_16x16x32_bf16 v[164:167], v[64:67], a[232:235], v[164:167]
    ds_read_b128 v[48:51], v4 offset:1024
    v_mfma_f32_16x16x32_bf16 v[164:167], v[68:71], a[240:243], v[164:167]
    ds_read_b128 v[52:55], v4 offset:2048
    v_mfma_f32_16x16x32_bf16 v[164:167], v[72:75], a[248:251], v[164:167]
    ds_read_b128 v[56:59], v4 offset:3072
    v_mfma_f32_16x16x32_bf16 v[168:171], v[60:63], a[228:231], v[168:171]
    v_mfma_f32_16x16x32_bf16 v[168:171], v[64:67], a[236:239], v[168:171]
    v_mfma_f32_16x16x32_bf16 v[168:171], v[68:71], a[244:247], v[168:171]
    v_mfma_f32_16x16x32_bf16 v[168:171], v[72:75], a[252:255], v[168:171]
    s_waitcnt lgkmcnt(0)
    v_mfma_f32_16x16x32_bf16 v[168:171], v[44:47], v[224:227], v[168:171]
    ds_read_b128 v[60:63], v4 offset:4096
    v_mfma_f32_16x16x32_bf16 v[168:171], v[48:51], v[232:235], v[168:171]
    ds_read_b128 v[64:67], v4 offset:5120
    v_mfma_f32_16x16x32_bf16 v[168:171], v[52:55], v[240:243], v[168:171]
    ds_read_b128 v[68:71], v4 offset:6144
    v_mfma_f32_16x16x32_bf16 v[168:171], v[56:59], v[248:251], v[168:171]
    ds_read_b128 v[72:75], v4 offset:7168
    v_mfma_f32_16x16x32_bf16 v[164:167], v[44:47], v[220:223], v[164:167]
    v_mfma_f32_16x16x32_bf16 v[164:167], v[48:51], v[228:231], v[164:167]
    v_mfma_f32_16x16x32_bf16 v[164:167], v[52:55], v[236:239], v[164:167]
    v_mfma_f32_16x16x32_bf16 v[164:167], v[56:59], v[244:247], v[164:167]
    s_waitcnt lgkmcnt(0)
    v_mfma_f32_16x16x32_bf16 v[140:143], v[60:63], a[224:227], v[140:143]
    s_mov_b32 s17, 131072
    ds_read_b128 v[44:47], v4 offset:8192
    v_mfma_f32_16x16x32_bf16 v[140:143], v[64:67], a[232:235], v[140:143]
    ds_read_b128 v[48:51], v4 offset:9216
    v_mfma_f32_16x16x32_bf16 v[140:143], v[68:71], a[240:243], v[140:143]
    ds_read_b128 v[52:55], v4 offset:10240
    v_mfma_f32_16x16x32_bf16 v[140:143], v[72:75], a[248:251], v[140:143]
    ds_read_b128 v[56:59], v4 offset:11264
    v_cvt_pk_bf16_f32 v28, v156, v157
    v_mfma_f32_16x16x32_bf16 v[144:147], v[60:63], a[228:231], v[144:147]
    v_cvt_pk_bf16_f32 v29, v158, v159
    v_cvt_pk_bf16_f32 v30, v164, v165
    v_mfma_f32_16x16x32_bf16 v[144:147], v[64:67], a[236:239], v[144:147]
    v_cvt_pk_bf16_f32 v31, v166, v167
    v_cvt_pk_bf16_f32 v32, v160, v161
    v_mfma_f32_16x16x32_bf16 v[144:147], v[68:71], a[244:247], v[144:147]
    buffer_store_dwordx4 v[28:31], v9, s[8:11], s17 offen offset:0 sc1
    v_mfma_f32_16x16x32_bf16 v[144:147], v[72:75], a[252:255], v[144:147]
    s_waitcnt lgkmcnt(0)
    v_cvt_pk_bf16_f32 v33, v162, v163
    v_cvt_pk_bf16_f32 v34, v168, v169
    v_mfma_f32_16x16x32_bf16 v[144:147], v[44:47], v[224:227], v[144:147]
    ds_read_b128 v[60:63], v4 offset:12288
    v_cvt_pk_bf16_f32 v35, v170, v171
    v_mfma_f32_16x16x32_bf16 v[144:147], v[48:51], v[232:235], v[144:147]
    ds_read_b128 v[64:67], v4 offset:13312
    v_mfma_f32_16x16x32_bf16 v[144:147], v[52:55], v[240:243], v[144:147]
    buffer_store_dwordx4 v[32:35], v9, s[8:11], s17 offen offset:256 sc1
    v_mfma_f32_16x16x32_bf16 v[144:147], v[56:59], v[248:251], v[144:147]
    ds_read_b128 v[68:71], v4 offset:14336
    ds_read_b128 v[72:75], v4 offset:15360
    v_mfma_f32_16x16x32_bf16 v[140:143], v[44:47], v[220:223], v[140:143]
    v_mfma_f32_16x16x32_bf16 v[140:143], v[48:51], v[228:231], v[140:143]
    v_mfma_f32_16x16x32_bf16 v[140:143], v[52:55], v[236:239], v[140:143]
    v_mfma_f32_16x16x32_bf16 v[140:143], v[56:59], v[244:247], v[140:143]
    s_waitcnt lgkmcnt(0)
    v_mfma_f32_16x16x32_bf16 v[148:151], v[60:63], a[224:227], v[148:151]
    ds_read_b128 v[44:47], v4 offset:16384
    v_mfma_f32_16x16x32_bf16 v[148:151], v[64:67], a[232:235], v[148:151]
    ds_read_b128 v[48:51], v4 offset:17408
    v_mfma_f32_16x16x32_bf16 v[148:151], v[68:71], a[240:243], v[148:151]
    ds_read_b128 v[52:55], v4 offset:18432
    v_mfma_f32_16x16x32_bf16 v[148:151], v[72:75], a[248:251], v[148:151]
    ds_read_b128 v[56:59], v4 offset:19456
    v_mfma_f32_16x16x32_bf16 v[152:155], v[60:63], a[228:231], v[152:155]
    v_mfma_f32_16x16x32_bf16 v[152:155], v[64:67], a[236:239], v[152:155]
    v_mfma_f32_16x16x32_bf16 v[152:155], v[68:71], a[244:247], v[152:155]
    v_mfma_f32_16x16x32_bf16 v[152:155], v[72:75], a[252:255], v[152:155]
    s_waitcnt lgkmcnt(0)
    v_mfma_f32_16x16x32_bf16 v[152:155], v[44:47], v[224:227], v[152:155]
    ds_read_b128 v[60:63], v4 offset:20480
    v_mfma_f32_16x16x32_bf16 v[152:155], v[48:51], v[232:235], v[152:155]
    ds_read_b128 v[64:67], v4 offset:21504
    v_mfma_f32_16x16x32_bf16 v[152:155], v[52:55], v[240:243], v[152:155]
    ds_read_b128 v[68:71], v4 offset:22528
    v_mfma_f32_16x16x32_bf16 v[152:155], v[56:59], v[248:251], v[152:155]
    ds_read_b128 v[72:75], v4 offset:23552
    v_mfma_f32_16x16x32_bf16 v[148:151], v[44:47], v[220:223], v[148:151]
    v_mfma_f32_16x16x32_bf16 v[148:151], v[48:51], v[228:231], v[148:151]
    v_mfma_f32_16x16x32_bf16 v[148:151], v[52:55], v[236:239], v[148:151]
L_pad_c1_8:
    s_cbranch_execz L_hopret_c1
    v_mfma_f32_16x16x32_bf16 v[148:151], v[56:59], v[244:247], v[148:151]
    s_waitcnt lgkmcnt(0)
    v_mfma_f32_16x16x32_bf16 v[172:175], v[60:63], a[224:227], v[172:175]
    s_mov_b32 s17, 262144
    ds_read_b128 v[44:47], v4 offset:24576
    v_mfma_f32_16x16x32_bf16 v[172:175], v[64:67], a[232:235], v[172:175]
    ds_read_b128 v[48:51], v4 offset:25600
    v_mfma_f32_16x16x32_bf16 v[172:175], v[68:71], a[240:243], v[172:175]
    ds_read_b128 v[52:55], v4 offset:26624
    v_mfma_f32_16x16x32_bf16 v[172:175], v[72:75], a[248:251], v[172:175]
    ds_read_b128 v[56:59], v4 offset:27648
    v_cvt_pk_bf16_f32 v20, v140, v141
    v_mfma_f32_16x16x32_bf16 v[176:179], v[60:63], a[228:231], v[176:179]
    v_cvt_pk_bf16_f32 v21, v142, v143
    v_cvt_pk_bf16_f32 v22, v148, v149
    v_mfma_f32_16x16x32_bf16 v[176:179], v[64:67], a[236:239], v[176:179]
    v_cvt_pk_bf16_f32 v23, v150, v151
    v_cvt_pk_bf16_f32 v24, v144, v145
    v_mfma_f32_16x16x32_bf16 v[176:179], v[68:71], a[244:247], v[176:179]
    buffer_store_dwordx4 v[20:23], v9, s[8:11], s17 offen offset:0 sc1
    v_mfma_f32_16x16x32_bf16 v[176:179], v[72:75], a[252:255], v[176:179]
    s_waitcnt lgkmcnt(0)
    v_cvt_pk_bf16_f32 v25, v146, v147
    v_cvt_pk_bf16_f32 v26, v152, v153
    v_mfma_f32_16x16x32_bf16 v[176:179], v[44:47], v[224:227], v[176:179]
    ds_read_b128 v[60:63], v4 offset:28672
    v_cvt_pk_bf16_f32 v27, v154, v155
    v_mfma_f32_16x16x32_bf16 v[176:179], v[48:51], v[232:235], v[176:179]
    ds_read_b128 v[64:67], v4 offset:29696
    v_mfma_f32_16x16x32_bf16 v[176:179], v[52:55], v[240:243], v[176:179]
    buffer_store_dwordx4 v[24:27], v9, s[8:11], s17 offen offset:256 sc1
    v_mfma_f32_16x16x32_bf16 v[176:179], v[56:59], v[248:251], v[176:179]
    ds_read_b128 v[68:71], v4 offset:30720
    ds_read_b128 v[72:75], v4 offset:31744
    v_mfma_f32_16x16x32_bf16 v[172:175], v[44:47], v[220:223], v[172:175]
    v_mfma_f32_16x16x32_bf16 v[172:175], v[48:51], v[228:231], v[172:175]
    v_mfma_f32_16x16x32_bf16 v[172:175], v[52:55], v[236:239], v[172:175]
    v_mfma_f32_16x16x32_bf16 v[172:175], v[56:59], v[244:247], v[172:175]
    s_waitcnt lgkmcnt(0)
    v_mfma_f32_16x16x32_bf16 v[180:183], v[60:63], a[224:227], v[180:183]
    ds_read_b128 v[44:47], v4 offset:32768
    v_mfma_f32_16x16x32_bf16 v[180:183], v[64:67], a[232:235], v[180:183]
    ds_read_b128 v[48:51], v4 offset:33792
    v_mfma_f32_16x16x32_bf16 v[180:183], v[68:71], a[240:243], v[180:183]
    ds_read_b128 v[52:55], v4 offset:34816
    v_mfma_f32_16x16x32_bf16 v[180:183], v[72:75], a[248:251], v[180:183]
    ds_read_b128 v[56:59], v4 offset:35840
    v_mfma_f32_16x16x32_bf16 v[184:187], v[60:63], a[228:231], v[184:187]
    v_mfma_f32_16x16x32_bf16 v[184:187], v[64:67], a[236:239], v[184:187]
    v_mfma_f32_16x16x32_bf16 v[184:187], v[68:71], a[244:247], v[184:187]
    v_mfma_f32_16x16x32_bf16 v[184:187], v[72:75], a[252:255], v[184:187]
    s_waitcnt lgkmcnt(0)
    v_mfma_f32_16x16x32_bf16 v[184:187], v[44:47], v[224:227], v[184:187]
    v_mfma_f32_16x16x32_bf16 v[184:187], v[48:51], v[232:235], v[184:187]
    v_mfma_f32_16x16x32_bf16 v[184:187], v[52:55], v[240:243], v[184:187]
    v_mfma_f32_16x16x32_bf16 v[184:187], v[56:59], v[248:251], v[184:187]
    v_mfma_f32_16x16x32_bf16 v[180:183], v[44:47], v[220:223], v[180:183]
    v_mfma_f32_16x16x32_bf16 v[180:183], v[48:51], v[228:231], v[180:183]
    v_mfma_f32_16x16x32_bf16 v[180:183], v[52:55], v[236:239], v[180:183]
    v_mfma_f32_16x16x32_bf16 v[180:183], v[56:59], v[244:247], v[180:183]
    v_mov_b32 v255, 8
    v_cvt_pk_bf16_f32 v28, v172, v173
    v_cvt_pk_bf16_f32 v29, v174, v175
    s_nop 4
    v_cvt_pk_bf16_f32 v30, v180, v181
    v_cvt_pk_bf16_f32 v31, v182, v183
    s_mov_b32 s17, 393216
    buffer_store_dwordx4 v[28:31], v9, s[8:11], s17 offen offset:0 sc1
    v_cvt_pk_bf16_f32 v32, v176, v177
    v_cvt_pk_bf16_f32 v33, v178, v179
    v_cvt_pk_bf16_f32 v34, v184, v185
    v_cvt_pk_bf16_f32 v35, v186, v187
    buffer_store_dwordx4 v[32:35], v9, s[8:11], s17 offen offset:256 sc1
L_after0:
    s_mov_b32 s26, 17825792
    s_mov_b32 s27, 18087936
    buffer_load_dwordx4 v[12:15], v208, s[8:11], s26 offen sc1
    buffer_load_dwordx4 v[16:19], v208, s[8:11], s27 offen sc1
    buffer_load_dword v20, v209, s[8:11], s26 offen sc1
    buffer_load_dword v62, v210, s[8:11], 0 offen sc1
    s_mov_b64 exec, 0
    s_cmp_eq_u32 s3, 0
    s_cbranch_scc1 L_pad_c2_0
    s_cmp_eq_u32 s3, 1
    s_cbranch_scc1 L_pad_c2_1
    s_cmp_eq_u32 s3, 2
    s_cbranch_scc1 L_hopret_c2
    s_branch L_hopret_c2
L_hopret_c2:
    s_mov_b64 exec, -1
    s_mov_b32 s26, 0
    s_waitcnt vmcnt(4)
    buffer_store_dword v255, v252, s[8:11], s26 offen sc1
    s_waitcnt vmcnt(4)
    v_lshlrev_b32 v124, 16, v12
    v_and_b32 v125, 0xffff0000, v12
    v_lshlrev_b32 v126, 16, v13
    v_and_b32 v127, 0xffff0000, v13
    v_lshlrev_b32 v128, 16, v14
    v_and_b32 v129, 0xffff0000, v14
    v_lshlrev_b32 v130, 16, v15
    v_and_b32 v131, 0xffff0000, v15
    s_waitcnt vmcnt(3)
    v_lshlrev_b32 v132, 16, v16
    v_and_b32 v133, 0xffff0000, v16
    v_lshlrev_b32 v134, 16, v17
    v_and_b32 v135, 0xffff0000, v17
    v_lshlrev_b32 v136, 16, v18
    v_and_b32 v137, 0xffff0000, v18
    v_lshlrev_b32 v138, 16, v19
    v_and_b32 v139, 0xffff0000, v19
    s_waitcnt vmcnt(2)
    v_lshlrev_b32 v140, 16, v20
    v_and_b32 v141, 0xffff0000, v20
    s_mov_b32 s24, 0x3f5db3d7
    s_mov_b32 s25, 0xbf000000
    s_mov_b32 s16, 0x3f441b7d
    s_mov_b32 s17, 0x3f248dbb
    s_mov_b32 s28, 0x3e31d0d4
    s_mov_b32 s29, 0x3f7c1c5c
    s_mov_b32 s38, 0xbf708fb2
    s_mov_b32 s39, 0x3eaf1d44
    s_mov_b32 s34, 0
    s_mov_b32 s45, 524288
    s_waitcnt vmcnt(1)
    s_mov_b32 s37, 0
    s_branch L_gp18_f
L_gp18_p0:
    buffer_load_dword v62, v210, s[8:11], 0 offen sc1
    s_sub_u32 s45, s45, 1
    s_cselect_b32 s37, 15, 0
    s_waitcnt vmcnt(0)
L_gp18_f:
    v_cmp_le_u32 s[46:47], 8, v62
    s_nop 0
    s_or_b32 s35, s37, s46
    s_and_b32 s35, s35, 15
    s_lshr_b32 s36, s35, 1
    s_and_b32 s36, s36, s35
    s_and_b32 s36, s36, 5
    s_cbranch_scc0 L_gp18_p0
L_gp18_i0:
    s_ff1_i32_b32 s36, s36
    s_lshl_b32 s34, 3, s36
    s_mul_i32 s26, s36, 2359296
    s_add_u32 s26, s26, 27262976
    s_add_u32 s27, s26, 262144
    buffer_load_dwordx4 v[22:25], v208, s[8:11], s26 offen sc1
    buffer_load_dwordx4 v[26:29], v208, s[8:11], s27 offen sc1
    buffer_load_dword v30, v209, s[8:11], s26 offen sc1
    s_add_u32 s26, s26, 2359296
    s_add_u32 s27, s26, 262144
    buffer_load_dwordx4 v[32:35], v208, s[8:11], s26 offen sc1
    buffer_load_dwordx4 v[36:39], v208, s[8:11], s27 offen sc1
    buffer_load_dword v40, v209, s[8:11], s26 offen sc1
    s_andn2_b32 s36, s35, s34
    s_cbranch_scc1 L_gp18_i2
L_gp18_p2:
    buffer_load_dword v62, v210, s[8:11], 0 offen sc1
    s_sub_u32 s45, s45, 1
    s_cselect_b32 s37, 15, 0
    s_waitcnt vmcnt(0)
    v_cmp_le_u32 s[46:47], 8, v62
    s_nop 0
    s_or_b32 s35, s37, s46
    s_and_b32 s35, s35, 15
    s_andn2_b32 s36, s35, s34
    s_cbranch_scc0 L_gp18_p2
L_gp18_i2:
    s_ff1_i32_b32 s36, s36
    s_bitset1_b32 s34, s36
    s_mul_i32 s26, s36, 2359296
    s_add_u32 s26, s26, 27262976
    s_add_u32 s27, s26, 262144
    buffer_load_dwordx4 v[42:45], v208, s[8:11], s26 offen sc1
    buffer_load_dwordx4 v[46:49], v208, s[8:11], s27 offen sc1
    buffer_load_dword v50, v209, s[8:11], s26 offen sc1
    s_andn2_b32 s36, s35, s34
    s_cbranch_scc1 L_gp18_i3
L_gp18_p3:
    buffer_load_dword v62, v210, s[8:11], 0 offen sc1
    s_sub_u32 s45, s45, 1
    s_cselect_b32 s37, 15, 0
    s_waitcnt vmcnt(0)
    v_cmp_le_u32 s[46:47], 8, v62
    s_nop 0
    s_or_b32 s35, s37, s46
    s_and_b32 s35, s35, 15
    s_andn2_b32 s36, s35, s34
    s_cbranch_scc0 L_gp18_p3
L_gp18_i3:
    s_ff1_i32_b32 s36, s36
    s_bitset1_b32 s34, s36
    s_mul_i32 s26, s36, 2359296
    s_add_u32 s26, s26, 27262976
    s_add_u32 s27, s26, 262144
    buffer_load_dwordx4 v[52:55], v208, s[8:11], s26 offen sc1
    buffer_load_dwordx4 v[56:59], v208, s[8:11], s27 offen sc1
    buffer_load_dword v60, v209, s[8:11], s26 offen sc1
    s_waitcnt vmcnt(11)
    v_lshlrev_b32 v160, 16, v22
    v_and_b32 v161, 0xffff0000, v22
    v_lshlrev_b32 v162, 16, v23
    v_and_b32 v163, 0xffff0000, v23
    v_lshlrev_b32 v164, 16, v24
    v_and_b32 v165, 0xffff0000, v24
    v_lshlrev_b32 v166, 16, v25
    v_and_b32 v167, 0xffff0000, v25
    s_waitcnt vmcnt(10)
    v_lshlrev_b32 v168, 16, v26
    v_and_b32 v169, 0xffff0000, v26
    v_lshlrev_b32 v170, 16, v27
    v_and_b32 v171, 0xffff0000, v27
    v_lshlrev_b32 v172, 16, v28
    v_and_b32 v173, 0xffff0000, v28
    v_lshlrev_b32 v174, 16, v29
    v_and_b32 v175, 0xffff0000, v29
    s_waitcnt vmcnt(9)
    v_lshlrev_b32 v176, 16, v30
    v_and_b32 v177, 0xffff0000, v30
    s_waitcnt vmcnt(8)
    v_lshlrev_b32 v142, 16, v32
    v_and_b32 v143, 0xffff0000, v32
    v_lshlrev_b32 v144, 16, v33
    v_and_b32 v145, 0xffff0000, v33
    v_lshlrev_b32 v146, 16, v34
    v_and_b32 v147, 0xffff0000, v34
    v_lshlrev_b32 v148, 16, v35
    v_and_b32 v149, 0xffff0000, v35
    s_waitcnt vmcnt(7)
    v_lshlrev_b32 v150, 16, v36
    v_and_b32 v151, 0xffff0000, v36
    v_lshlrev_b32 v152, 16, v37
    v_and_b32 v153, 0xffff0000, v37
    v_lshlrev_b32 v154, 16, v38
    v_and_b32 v155, 0xffff0000, v38
    v_lshlrev_b32 v156, 16, v39
    v_and_b32 v157, 0xffff0000, v39
    s_waitcnt vmcnt(6)
    v_lshlrev_b32 v158, 16, v40
    v_and_b32 v159, 0xffff0000, v40
    v_pk_add_f32 v[160:161], v[160:161], v[142:143]
    v_pk_add_f32 v[162:163], v[162:163], v[144:145]
    v_pk_add_f32 v[164:165], v[164:165], v[146:147]
    v_pk_add_f32 v[166:167], v[166:167], v[148:149]
    v_pk_add_f32 v[168:169], v[168:169], v[150:151]
    v_pk_add_f32 v[170:171], v[170:171], v[152:153]
    v_pk_add_f32 v[172:173], v[172:173], v[154:155]
    v_pk_add_f32 v[174:175], v[174:175], v[156:157]
    v_pk_add_f32 v[176:177], v[176:177], v[158:159]
    s_waitcnt vmcnt(5)
    v_lshlrev_b32 v220, 16, v42
    v_and_b32 v221, 0xffff0000, v42
    v_lshlrev_b32 v222, 16, v43
    v_and_b32 v223, 0xffff0000, v43
    v_lshlrev_b32 v224, 16, v44
    v_and_b32 v225, 0xffff0000, v44
    v_lshlrev_b32 v226, 16, v45
    v_and_b32 v227, 0xffff0000, v45
    s_waitcnt vmcnt(4)
    v_lshlrev_b32 v228, 16, v46
    v_and_b32 v229, 0xffff0000, v46
    v_lshlrev_b32 v230, 16, v47
    v_and_b32 v231, 0xffff0000, v47
    v_lshlrev_b32 v232, 16, v48
    v_and_b32 v233, 0xffff0000, v48
    v_lshlrev_b32 v234, 16, v49
    v_and_b32 v235, 0xffff0000, v49
    s_waitcnt vmcnt(3)
    v_lshlrev_b32 v236, 16, v50
    v_and_b32 v237, 0xffff0000, v50
    s_waitcnt vmcnt(2)
    v_lshlrev_b32 v142, 16, v52
    v_and_b32 v143, 0xffff0000, v52
    v_pk_add_f32 v[142:143], v[142:143], v[220:221]
    v_pk_add_f32 v[142:143], v[142:143], v[160:161]
    v_pk_add_f32 v[124:125], v[124:125], v[142:143]
    v_cvt_pk_bf16_f32 v12, v124, v125
    v_and_b32 v12, v213, v12
    ds_write_b16 v84, v12 offset:0
    v_lshlrev_b32 v144, 16, v53
    ds_write_b16_d16_hi v85, v12 offset:2
    v_and_b32 v145, 0xffff0000, v53
    v_pk_add_f32 v[144:145], v[144:145], v[222:223]
    v_pk_add_f32 v[144:145], v[144:145], v[162:163]
    v_pk_add_f32 v[126:127], v[126:127], v[144:145]
    v_cvt_pk_bf16_f32 v13, v126, v127
    ds_write_b16 v86, v13 offset:4
    v_lshlrev_b32 v146, 16, v54
    v_and_b32 v147, 0xffff0000, v54
    ds_write_b16_d16_hi v87, v13 offset:6
    v_pk_add_f32 v[146:147], v[146:147], v[224:225]
    v_pk_add_f32 v[146:147], v[146:147], v[164:165]
    v_pk_add_f32 v[128:129], v[128:129], v[146:147]
    v_cvt_pk_bf16_f32 v14, v128, v129
    ds_write_b16 v88, v14 offset:0
    v_lshlrev_b32 v148, 16, v55
    v_and_b32 v149, 0xffff0000, v55
    ds_write_b16_d16_hi v89, v14 offset:2
    v_pk_add_f32 v[148:149], v[148:149], v[226:227]
    v_pk_add_f32 v[148:149], v[148:149], v[166:167]
    v_pk_add_f32 v[130:131], v[130:131], v[148:149]
    v_cvt_pk_bf16_f32 v15, v130, v131
    ds_write_b16 v90, v15 offset:4
    s_waitcnt vmcnt(1)
    v_lshlrev_b32 v150, 16, v56
    v_and_b32 v151, 0xffff0000, v56
    ds_write_b16_d16_hi v91, v15 offset:6
    v_pk_add_f32 v[150:151], v[150:151], v[228:229]
    v_pk_add_f32 v[150:151], v[150:151], v[168:169]
    v_pk_add_f32 v[132:133], v[132:133], v[150:151]
    v_cvt_pk_bf16_f32 v16, v132, v133
    ds_write_b16 v92, v16 offset:0
    v_lshlrev_b32 v152, 16, v57
    v_and_b32 v153, 0xffff0000, v57
    ds_write_b16_d16_hi v93, v16 offset:2
    v_pk_add_f32 v[152:153], v[152:153], v[230:231]
    v_pk_add_f32 v[152:153], v[152:153], v[170:171]
    v_pk_add_f32 v[134:135], v[134:135], v[152:153]
    v_cvt_pk_bf16_f32 v17, v134, v135
    ds_write_b16 v94, v17 offset:4
    v_lshlrev_b32 v154, 16, v58
    v_and_b32 v155, 0xffff0000, v58
    ds_write_b16_d16_hi v95, v17 offset:6
    v_pk_add_f32 v[154:155], v[154:155], v[232:233]
    v_pk_add_f32 v[154:155], v[154:155], v[172:173]
    v_pk_add_f32 v[136:137], v[136:137], v[154:155]
    v_cvt_pk_bf16_f32 v18, v136, v137
    ds_write_b16 v96, v18 offset:0
    v_lshlrev_b32 v156, 16, v59
    v_and_b32 v157, 0xffff0000, v59
    ds_write_b16_d16_hi v97, v18 offset:2
    v_pk_add_f32 v[156:157], v[156:157], v[234:235]
    v_pk_add_f32 v[156:157], v[156:157], v[174:175]
    v_pk_add_f32 v[138:139], v[138:139], v[156:157]
    v_cvt_pk_bf16_f32 v19, v138, v139
    ds_write_b16 v98, v19 offset:4
    s_waitcnt vmcnt(0)
    v_lshlrev_b32 v158, 16, v60
    v_and_b32 v159, 0xffff0000, v60
    ds_write_b16_d16_hi v99, v19 offset:6
    v_pk_add_f32 v[158:159], v[158:159], v[236:237]
    v_pk_add_f32 v[158:159], v[158:159], v[176:177]
    v_pk_add_f32 v[140:141], v[140:141], v[158:159]
    v_cvt_pk_bf16_f32 v20, v140, v141
    ds_write_b16 v100, v20 offset:0
    v_pk_add_f32 v[62:63], v[124:125], v[126:127]
    v_pk_mul_f32 v[64:65], v[124:125], v[124:125]
    ds_write_b16_d16_hi v101, v20 offset:2
    v_pk_fma_f32 v[64:65], v[126:127], v[126:127], v[64:65]
    v_pk_add_f32 v[62:63], v[62:63], v[128:129]
    v_pk_fma_f32 v[64:65], v[128:129], v[128:129], v[64:65]
    v_pk_add_f32 v[62:63], v[62:63], v[130:131]
    v_pk_fma_f32 v[64:65], v[130:131], v[130:131], v[64:65]
    v_pk_add_f32 v[62:63], v[62:63], v[132:133]
    v_pk_fma_f32 v[64:65], v[132:133], v[132:133], v[64:65]
    v_pk_add_f32 v[62:63], v[62:63], v[134:135]
    v_pk_fma_f32 v[64:65], v[134:135], v[134:135], v[64:65]
    v_pk_add_f32 v[62:63], v[62:63], v[136:137]
    v_pk_fma_f32 v[64:65], v[136:137], v[136:137], v[64:65]
    v_pk_add_f32 v[62:63], v[62:63], v[138:139]
    v_pk_fma_f32 v[64:65], v[138:139], v[138:139], v[64:65]
    v_pk_add_f32 v[62:63], v[62:63], v[140:141]
    v_pk_fma_f32 v[64:65], v[140:141], v[140:141], v[64:65]
    v_add_f32 v62, v62, v63
    v_add_f32 v63, v64, v65
    s_nop 0
    v_add_f32_dpp v62, v62, v62 row_ror:8 row_mask:0xf bank_mask:0xf
    v_add_f32_dpp v63, v63, v63 row_ror:8 row_mask:0xf bank_mask:0xf
    v_mov_b32 v64, v62
    v_mov_b32 v65, v63
    s_nop 0
    v_permlane16_swap_b32 v64, v62
    v_permlane16_swap_b32 v65, v63
    v_pk_add_f32 v[62:63], v[62:63], v[64:65]
    v_mov_b32 v64, v62
    v_mov_b32 v65, v63
    s_nop 0
    v_permlane32_swap_b32 v64, v62
    v_permlane32_swap_b32 v65, v63
    v_pk_add_f32 v[62:63], v[62:63], v[64:65]
    ds_write_b64 v119, v[62:63]
    s_add_u32 m0, s12, 110592
    s_mov_b64 s[40:41], s[48:49]
    s_add_u32 s15, s18, 0
    buffer_load_dwordx4 v11, s[40:43], s15 offen  lds
    s_add_u32 m0, s12, 111616
    s_add_u32 s15, s15, s19
    buffer_load_dwordx4 v11, s[40:43], s15 offen  lds
    s_add_u32 m0, s12, 112640
    s_add_u32 s15, s15, s19
    buffer_load_dwordx4 v11, s[40:43], s15 offen  lds
    s_waitcnt lgkmcnt(0)
    s_barrier
    ds_read_b128 v[16:19], v118 offset:0
    ds_read_b128 v[20:23], v118 offset:64
    ds_read_b128 v[64:67], v211
    ds_read_b128 v[68:71], v211 offset:16
    ds_read_b128 v[24:27], v118 offset:576
    ds_read_b128 v[28:31], v118 offset:640
    ds_read_b128 v[32:35], v118 offset:1152
    ds_read_b128 v[36:39], v118 offset:1216
    ds_read_b128 v[72:75], v120
    ds_read_b128 v[76:79], v120 offset:16
    s_waitcnt lgkmcnt(9)
    v_mfma_f32_16x16x32_bf16 v[160:163], v[16:19], v[102:105], 0
    s_add_u32 m0, s12, 113664
    s_add_u32 s15, s15, s19
    buffer_load_dwordx4 v11, s[40:43], s15 offen  lds
    s_waitcnt lgkmcnt(8)
    v_mfma_f32_16x16x32_bf16 v[160:163], v[20:23], v[110:113], v[160:163]
    s_add_u32 m0, s12, 114688
    s_waitcnt lgkmcnt(7)
    v_add_f32 v64, v64, v66
    v_add_f32 v65, v65, v67
    v_mfma_f32_16x16x32_bf16 v[172:175], v[16:19], v[106:109], 0
    s_add_u32 s15, s15, s19
    s_waitcnt lgkmcnt(6)
    v_add_f32 v68, v68, v70
    v_add_f32 v69, v69, v71
    v_mfma_f32_16x16x32_bf16 v[172:175], v[20:23], v[114:117], v[172:175]
    v_add_f32 v64, v64, v68
    v_add_f32 v65, v65, v69
    s_waitcnt lgkmcnt(5)
    v_mfma_f32_16x16x32_bf16 v[164:167], v[24:27], v[102:105], 0
    buffer_load_dwordx4 v11, s[40:43], s15 offen  lds
    s_waitcnt lgkmcnt(4)
    v_mfma_f32_16x16x32_bf16 v[164:167], v[28:31], v[110:113], v[164:167]
    s_add_u32 m0, s12, 115712
    v_mul_f32 v64, 0x3ae38e39, v64
    v_mul_f32 v65, 0x3ae38e39, v65
    v_mfma_f32_16x16x32_bf16 v[176:179], v[24:27], v[106:109], 0
    s_add_u32 s15, s15, s19
    v_fma_f32 v65, -v64, v64, v65
    v_mul_f32 v67, v212, v64
    v_mfma_f32_16x16x32_bf16 v[176:179], v[28:31], v[114:117], v[176:179]
    v_max_f32 v65, 0, v65
    v_sub_f32 v68, v64, v67
    s_waitcnt lgkmcnt(3)
    v_mfma_f32_16x16x32_bf16 v[168:171], v[32:35], v[102:105], 0
    buffer_load_dwordx4 v11, s[40:43], s15 offen  lds
    s_waitcnt lgkmcnt(2)
    v_mfma_f32_16x16x32_bf16 v[168:171], v[36:39], v[110:113], v[168:171]
    v_add_f32 v65, 0x3727c5ac, v65
    s_waitcnt lgkmcnt(1)
    v_add_f32 v72, v72, v74
    v_mfma_f32_16x16x32_bf16 v[180:183], v[32:35], v[106:109], 0
    s_waitcnt lgkmcnt(0)
    v_add_f32 v76, v76, v78
    v_add_f32 v72, v72, v76
    v_mfma_f32_16x16x32_bf16 v[180:183], v[36:39], v[114:117], v[180:183]
    v_rsq_f32 v66, v65
    v_mul_f32 v72, 0x3ae38e39, v72
    v_add_f32 v160, v160, v68
    v_add_f32 v172, v172, v67
    v_pk_add_f32 v[124:125], v[124:125], v[72:73] op_sel_hi:[1,0] neg_lo:[0,1] neg_hi:[0,1]
    v_pk_add_f32 v[126:127], v[126:127], v[72:73] op_sel_hi:[1,0] neg_lo:[0,1] neg_hi:[0,1]
    v_pk_add_f32 v[128:129], v[128:129], v[72:73] op_sel_hi:[1,0] neg_lo:[0,1] neg_hi:[0,1]
    v_pk_add_f32 v[130:131], v[130:131], v[72:73] op_sel_hi:[1,0] neg_lo:[0,1] neg_hi:[0,1]
    v_pk_add_f32 v[16:17], v[164:165], v[168:169]
    v_add_f32 v18, v166, v170
    v_pk_add_f32 v[24:25], v[164:165], v[168:169] neg_lo:[0,1] neg_hi:[0,1]
    v_sub_f32 v26, v166, v170
    v_pk_fma_f32 v[32:33], v[16:17], s[24:25], v[160:161] op_sel:[0,1,0] op_sel_hi:[1,1,1]
    v_fma_f32 v34, v18, -0.5, v162
    v_pk_add_f32 v[20:21], v[176:177], v[180:181]
    v_add_f32 v22, v178, v182
    v_pk_add_f32 v[28:29], v[176:177], v[180:181] neg_lo:[0,1] neg_hi:[0,1]
    v_sub_f32 v30, v178, v182
    v_pk_fma_f32 v[36:37], v[20:21], s[24:25], v[172:173] op_sel:[0,1,0] op_sel_hi:[1,1,1]
    v_fma_f32 v38, v22, -0.5, v174
    v_fma_f32 v150, v29, s24, v33
    v_fma_f32 v151, -v25, s24, v37
    v_fma_f32 v156, -v29, s24, v33
    v_fma_f32 v157, v25, s24, v37
    v_add_f32 v144, v161, v17
    v_add_f32 v145, v173, v21
    v_fma_f32 v152, v30, s24, v34
    v_fma_f32 v153, -v26, s24, v38
    v_fma_f32 v158, -v30, s24, v34
    v_fma_f32 v159, v26, s24, v38
    v_add_f32 v146, v162, v18
    v_add_f32 v147, v174, v22
    v_fma_f32 v148, v28, s24, v32
    v_fma_f32 v149, -v24, s24, v36
    v_fma_f32 v154, -v28, s24, v32
    v_fma_f32 v155, v24, s24, v36
    v_add_f32 v142, v160, v16
    v_add_f32 v143, v172, v20
    v_pk_mul_f32 v[16:17], v[150:151], s[16:17] op_sel_hi:[1,0]
    v_pk_mul_f32 v[18:19], v[156:157], s[28:29] op_sel_hi:[1,0]
    v_pk_mul_f32 v[20:21], v[152:153], s[28:29] op_sel_hi:[1,0]
    v_pk_mul_f32 v[22:23], v[158:159], s[38:39] op_sel_hi:[1,0]
    v_pk_fma_f32 v[150:151], v[150:151], s[16:17], v[16:17] op_sel:[1,1,0] op_sel_hi:[0,1,1] neg_hi:[1,0,0]
    v_pk_fma_f32 v[156:157], v[156:157], s[28:29], v[18:19] op_sel:[1,1,0] op_sel_hi:[0,1,1] neg_hi:[1,0,0]
    v_pk_fma_f32 v[152:153], v[152:153], s[28:29], v[20:21] op_sel:[1,1,0] op_sel_hi:[0,1,1] neg_hi:[1,0,0]
    v_pk_fma_f32 v[158:159], v[158:159], s[38:39], v[22:23] op_sel:[1,1,0] op_sel_hi:[0,1,1] neg_hi:[1,0,0]
    v_pk_add_f32 v[16:17], v[144:145], v[146:147]
    v_pk_add_f32 v[18:19], v[144:145], v[146:147] neg_lo:[0,1] neg_hi:[0,1]
    v_pk_add_f32 v[22:23], v[150:151], v[152:153]
    v_pk_add_f32 v[24:25], v[150:151], v[152:153] neg_lo:[0,1] neg_hi:[0,1]
    v_pk_add_f32 v[28:29], v[156:157], v[158:159]
    v_pk_add_f32 v[30:31], v[156:157], v[158:159] neg_lo:[0,1] neg_hi:[0,1]
    v_pk_fma_f32 v[20:21], v[16:17], s[24:25], v[142:143] op_sel:[0,1,0] op_sel_hi:[1,1,1]
    v_pk_add_f32 v[142:143], v[142:143], v[16:17]
    v_pk_fma_f32 v[26:27], v[22:23], s[24:25], v[148:149] op_sel:[0,1,0] op_sel_hi:[1,1,1]
    v_pk_add_f32 v[148:149], v[148:149], v[22:23]
    v_pk_fma_f32 v[32:33], v[28:29], s[24:25], v[154:155] op_sel:[0,1,0] op_sel_hi:[1,1,1]
    v_pk_add_f32 v[154:155], v[154:155], v[28:29]
    v_pk_fma_f32 v[144:145], v[18:19], s[24:25], v[20:21] op_sel:[1,0,0] op_sel_hi:[0,0,1] neg_hi:[1,0,0]
    v_pk_fma_f32 v[146:147], v[18:19], s[24:25], v[20:21] op_sel:[1,0,0] op_sel_hi:[0,0,1] neg_lo:[1,0,0]
    v_pk_fma_f32 v[150:151], v[24:25], s[24:25], v[26:27] op_sel:[1,0,0] op_sel_hi:[0,0,1] neg_hi:[1,0,0]
    v_pk_fma_f32 v[152:153], v[24:25], s[24:25], v[26:27] op_sel:[1,0,0] op_sel_hi:[0,0,1] neg_lo:[1,0,0]
    v_pk_fma_f32 v[156:157], v[30:31], s[24:25], v[32:33] op_sel:[1,0,0] op_sel_hi:[0,0,1] neg_hi:[1,0,0]
    v_pk_fma_f32 v[158:159], v[30:31], s[24:25], v[32:33] op_sel:[1,0,0] op_sel_hi:[0,0,1] neg_lo:[1,0,0]
    s_cmp_lt_u32 s3, 2
    s_cbranch_scc0 L_pk19
    s_mov_b64 exec, s[32:33]
    v_pk_add_f32 v[158:159], v[148:149], v[158:159] op_sel:[1,1] op_sel_hi:[0,0] neg_hi:[0,1]
    v_pk_add_f32 v[152:153], v[154:155], v[152:153] op_sel:[1,1] op_sel_hi:[0,0] neg_hi:[0,1]
    v_pk_add_f32 v[146:147], v[144:145], v[146:147] op_sel:[1,1] op_sel_hi:[0,0] neg_hi:[0,1]
    v_pk_add_f32 v[156:157], v[150:151], v[156:157] op_sel:[1,1] op_sel_hi:[0,0] neg_hi:[0,1]
    v_add_f32 v16, v143, v143
    v_fmamk_f32 v142, v64, 0xc3900000, v142
    v_mul_f32 v16, v16, v66
    v_pk_fma_f32 v[148:149], v[148:149], 2.0, v[158:159] op_sel:[0,0,1] op_sel_hi:[1,0,0] neg_lo:[0,0,1] neg_hi:[0,0,1]
    v_pk_fma_f32 v[154:155], v[154:155], 2.0, v[152:153] op_sel:[0,0,1] op_sel_hi:[1,0,0] neg_lo:[0,0,1] neg_hi:[0,0,1]
    v_pk_fma_f32 v[144:145], v[144:145], 2.0, v[146:147] op_sel:[0,0,1] op_sel_hi:[1,0,0] neg_lo:[0,0,1] neg_hi:[0,0,1]
    v_pk_fma_f32 v[150:151], v[150:151], 2.0, v[156:157] op_sel:[0,0,1] op_sel_hi:[1,0,0] neg_lo:[0,0,1] neg_hi:[0,0,1]
    v_add_f32 v142, v142, v142
    v_cvt_pk_f16_f32 v27, v16, 0
    v_mov_b32 v143, 0
    s_mov_b64 exec, -1
L_pk19:
    s_brev_b32 s26, 1
    v_pk_mul_f32 v[142:143], v[142:143], v[66:67] op_sel_hi:[1,0]
    v_pk_mul_f32 v[148:149], v[148:149], v[66:67] op_sel_hi:[1,0]
    v_cvt_pk_f16_f32 v18, v142, v143
    v_pk_mul_f32 v[154:155], v[154:155], v[66:67] op_sel_hi:[1,0]
    v_cvt_pk_f16_f32 v19, v148, v149
    v_bitop3_b32 v18, v18, v198, s26 bitop3:0x78
    v_pk_mul_f32 v[144:145], v[144:145], v[66:67] op_sel_hi:[1,0]
    v_cvt_pk_f16_f32 v20, v154, v155
    v_bitop3_b32 v19, v19, v199, s26 bitop3:0x78
    v_pk_mul_f32 v[150:151], v[150:151], v[66:67] op_sel_hi:[1,0]
    v_cvt_pk_f16_f32 v21, v144, v145
    v_permlane32_swap_b32 v18, v19
    v_bitop3_b32 v20, v20, v200, s26 bitop3:0x78
    v_pk_mul_f32 v[156:157], v[156:157], v[66:67] op_sel_hi:[1,0]
    v_cvt_pk_f16_f32 v22, v150, v151
    v_bitop3_b32 v21, v21, v201, s26 bitop3:0x78
    v_pk_add_f16 v16, v18, v19
    v_pk_add_f16 v19, v18, v19 neg_lo:[0,1] neg_hi:[0,1]
    ds_write2_b32 v188, v16, v19 offset0:0 offset1:4
    v_pk_mul_f32 v[146:147], v[146:147], v[66:67] op_sel_hi:[1,0]
    v_cvt_pk_f16_f32 v23, v156, v157
    v_permlane32_swap_b32 v20, v21
    v_bitop3_b32 v22, v22, v202, s26 bitop3:0x78
    v_pk_mul_f32 v[152:153], v[152:153], v[66:67] op_sel_hi:[1,0]
    v_cvt_pk_f16_f32 v24, v146, v147
    v_bitop3_b32 v23, v23, v203, s26 bitop3:0x78
    v_pk_add_f16 v17, v20, v21
    v_pk_add_f16 v21, v20, v21 neg_lo:[0,1] neg_hi:[0,1]
    ds_write2_b32 v190, v17, v21 offset0:0 offset1:4
    v_pk_mul_f32 v[158:159], v[158:159], v[66:67] op_sel_hi:[1,0]
    v_cvt_pk_f16_f32 v25, v152, v153
    v_permlane32_swap_b32 v22, v23
    v_bitop3_b32 v24, v24, v204, s26 bitop3:0x78
    v_pk_add_f32 v[132:133], v[132:133], v[72:73] op_sel_hi:[1,0] neg_lo:[0,1] neg_hi:[0,1]
    v_cvt_pk_f16_f32 v26, v158, v159
    v_bitop3_b32 v25, v25, v205, s26 bitop3:0x78
    v_pk_add_f16 v16, v22, v23
    v_pk_add_f16 v23, v22, v23 neg_lo:[0,1] neg_hi:[0,1]
    ds_write2_b32 v192, v16, v23 offset0:0 offset1:4
    v_pk_add_f32 v[134:135], v[134:135], v[72:73] op_sel_hi:[1,0] neg_lo:[0,1] neg_hi:[0,1]
    v_pk_add_f32 v[136:137], v[136:137], v[72:73] op_sel_hi:[1,0] neg_lo:[0,1] neg_hi:[0,1]
    v_permlane32_swap_b32 v24, v25
    v_bitop3_b32 v26, v26, v206, s26 bitop3:0x78
    v_pk_add_f32 v[138:139], v[138:139], v[72:73] op_sel_hi:[1,0] neg_lo:[0,1] neg_hi:[0,1]
    v_pk_add_f32 v[140:141], v[140:141], v[72:73] op_sel_hi:[1,0] neg_lo:[0,1] neg_hi:[0,1]
    v_pk_add_f16 v17, v24, v25
    v_pk_add_f16 v25, v24, v25 neg_lo:[0,1] neg_hi:[0,1]
    ds_write2_b32 v194, v17, v25 offset0:0 offset1:4
    v_cvt_pk_bf16_f32 v44, v124, v125
    v_cvt_pk_bf16_f32 v45, v126, v127
    v_permlane32_swap_b32 v26, v27
    v_cvt_pk_bf16_f32 v46, v128, v129
    v_cvt_pk_bf16_f32 v47, v130, v131
    v_pk_add_f16 v16, v26, v27
    v_pk_add_f16 v27, v26, v27 neg_lo:[0,1] neg_hi:[0,1]
    ds_write2_b32 v196, v16, v27 offset0:0 offset1:4
    v_cvt_pk_bf16_f32 v48, v132, v133
    v_cvt_pk_bf16_f32 v49, v134, v135
    v_cvt_pk_bf16_f32 v50, v136, v137
    v_cvt_pk_bf16_f32 v51, v138, v139
    v_cvt_pk_bf16_f32 v52, v140, v141
    s_mov_b32 s27, 88080384
    buffer_store_dwordx4 v[44:47], v208, s[8:11], s27 offen sc1
    buffer_store_dword v52, v209, s[8:11], s27 offen sc1
    s_mov_b32 s27, 88342528
    buffer_store_dwordx4 v[48:51], v208, s[8:11], s27 offen sc1
    s_mov_b32 s27, 57688064
    buffer_store_dwordx2 v[72:73], v207, s[8:11], s27 offen sc1
    s_waitcnt lgkmcnt(0)
    s_barrier
    ds_read_b128 v[28:31], v121 offset:12288
    ds_read_b128 v[32:35], v121 offset:6144
    ds_read_b128 v[36:39], v121 offset:0
    s_mov_b32 s26, 91226112
    s_waitcnt lgkmcnt(2)
    buffer_store_dwordx4 v[28:31], v122, s[8:11], s26 offen sc1
    s_mov_b32 s26, 91750400
    s_waitcnt lgkmcnt(1)
    buffer_store_dwordx4 v[32:35], v122, s[8:11], s26 offen sc1
    s_mov_b32 s26, 92274688
    s_waitcnt lgkmcnt(0)
    buffer_store_dwordx4 v[36:39], v123, s[8:11], s26 offen sc1
    v_add_u32 v12, 147456, v1
    s_lshl_b32 s26, s3, 10
    v_add_u32 v13, s26, v12
    ds_read_b128 v[72:75], v12 offset:0
    ds_read_b128 v[76:79], v12 offset:1024
    ds_read_b128 v[88:91], v12 offset:4096
L_pad_c2_0:
    s_cbranch_execz L_hopret_c2
    ds_read_b128 v[92:95], v12 offset:5120
    ds_read_b128 v[96:99], v12 offset:6144
    ds_read_b128 v[100:103], v12 offset:7168
    ds_read_b128 v[104:107], v13 offset:4096
    ds_read_b128 v[108:111], v12 offset:8192
    ds_read_b128 v[112:115], v12 offset:9216
    ds_read_b128 v[116:119], v12 offset:10240
    ds_read_b128 v[120:123], v12 offset:11264
    ds_read_b128 v[124:127], v13 offset:8192
    ds_read_b128 v[128:131], v12 offset:12288
    ds_read_b128 v[132:135], v12 offset:13312
    ds_read_b128 v[136:139], v12 offset:14336
    ds_read_b128 v[140:143], v12 offset:15360
    ds_read_b128 v[144:147], v13 offset:12288
    s_and_b32 s44, s2, 7
    v_and_b32 v229, 63, v0
    s_mul_i32 s44, s44, 9
    v_and_b32 v230, 15, v0
    s_lshr_b32 s21, s2, 4
    v_bfe_u32 v231, v0, 4, 2
    s_add_u32 s44, s44, s21
    v_lshlrev_b32 v220, 4, v231
    s_bfe_u32 s21, s2, 0x10003
    v_xor_b32 v2, v220, v1
    s_lshl_b32 s25, s44, 15
    v_lshlrev_b32 v220, 6, v230
    s_lshl_b32 s26, s3, 3
    v_lshl_add_u32 v249, v231, 12, v220
    s_add_u32 s26, s26, 0
    v_lshrrev_b32 v220, 2, v230
    s_add_u32 s27, s26, s21
    v_xor_b32 v220, s3, v220
    s_sub_u32 s28, 48, s27
    v_lshlrev_b32 v220, 4, v220
    s_cmp_lt_u32 s26, 16
    s_cselect_b32 s27, s27, s28
    v_lshl_add_u32 v220, v229, 6, v220
    s_cmp_eq_u32 s27, 32
    s_cselect_b32 s36, 16, s27
    v_add_u32 v250, 36864, v220
    s_lshl_b32 s27, s36, 9
    v_and_b32 v221, 0x1f0, v1
    s_add_u32 s32, s27, s25
    s_lshl_b32 s26, s3, 3
    s_add_u32 s26, s26, 2
    s_add_u32 s27, s26, s21
    s_sub_u32 s28, 48, s27
    s_cmp_lt_u32 s26, 16
    s_cselect_b32 s27, s27, s28
    s_cmp_eq_u32 s27, 32
    s_cselect_b32 s37, 16, s27
    s_lshl_b32 s27, s37, 9
    s_add_u32 s33, s27, s25
    s_lshl_b32 s26, s3, 3
    s_add_u32 s26, s26, 4
    s_add_u32 s27, s26, s21
    s_sub_u32 s28, 48, s27
    s_cmp_lt_u32 s26, 16
    s_cselect_b32 s27, s27, s28
    s_cmp_eq_u32 s27, 32
    s_cselect_b32 s38, 16, s27
    s_lshl_b32 s27, s38, 9
    s_add_u32 s34, s27, s25
    s_lshl_b32 s26, s3, 3
    s_add_u32 s26, s26, 6
    s_add_u32 s27, s26, s21
    s_sub_u32 s28, 48, s27
    s_cmp_lt_u32 s26, 16
    s_cselect_b32 s27, s27, s28
    s_cmp_eq_u32 s27, 32
    s_cselect_b32 s39, 16, s27
    s_lshl_b32 s27, s39, 9
    s_add_u32 s35, s27, s25
    s_lshl_b32 s28, s3, 8
    s_add_u32 s28, s28, 53248
    v_lshl_add_u32 v220, v230, 4, s28
    s_lshl_b32 s26, s3, 12
    v_lshl_add_u32 v251, v231, 10, v220
    s_add_u32 s26, s26, 77824
    v_lshrrev_b32 v220, 5, v229
    s_lshl_b32 s27, s3, 11
    v_lshl_add_u32 v3, v220, 14, v221
    s_add_u32 s27, s27, 94208
    v_lshrrev_b32 v220, 3, v229
    s_and_b32 s28, s36, 15
    v_and_b32 v221, 0x70, v1
    v_lshl_add_u32 v220, v220, 9, v221
    v_add_u32 v4, s26, v220
    s_lshl_b32 s26, s3, 10
    v_add_u32 v5, s27, v1
    s_xor_b32 s27, s3, 2
    v_bfe_u32 v220, v0, 3, 2
    s_cmp_eq_u32 s28, 0
    s_cselect_b32 s28, s3, s27
    v_and_b32 v221, 4, v0
    s_add_u32 s26, s26, 77824
    v_add_u32 v220, v220, v221
    s_lshl_b32 s29, s27, 8
    v_and_b32 v229, 35, v0
    s_add_u32 s29, s29, 94208
    v_lshl_add_u32 v229, v220, 2, v229
    s_mul_i32 s24, s21, 1196032
    v_lshl_add_u32 v6, v229, 4, s26
    s_lshl_b32 s26, s27, 10
    v_cmp_gt_u32 vcc, 32, v229
    s_add_u32 s26, s26, 77824
    v_sub_u32 v220, 63, v229
    s_lshl_b32 s22, s44, 14
    v_sub_u32 v221, 32, v229
    s_add_u32 s22, s22, s24
    v_and_b32 v221, 31, v221
    s_lshl_b32 s23, s3, 10
    v_sub_u32 v222, 95, v229
    s_add_u32 s22, s22, s23
    v_cndmask_b32 v221, v222, v221, vcc
    s_cmp_eq_u32 s36, 0
    s_cselect_b64 vcc, -1, 0
    v_cndmask_b32 v221, v220, v221, vcc
    s_add_u32 s22, s22, 91226112
    v_lshl_add_u32 v7, v220, 4, s26
    s_lshl_b32 s26, s28, 10
    v_and_b32 v222, 32, v220
    s_add_u32 s26, s26, 77824
    v_and_b32 v223, 7, v220
    v_lshl_add_u32 v222, v223, 2, v222
    v_lshl_add_u32 v9, v222, 2, s29
    s_lshl_b32 s29, s28, 8
    v_bfe_u32 v222, v220, 3, 1
    s_add_u32 s29, s29, 94208
    v_lshl_add_u32 v10, v222, 10, v9
    v_lshl_or_b32 v189, v222, 31, 1.0
    v_bfe_u32 v222, v220, 4, 1
    v_lshl_or_b32 v191, v222, 31, 1.0
    v_lshl_add_u32 v8, v221, 4, s26
    v_and_b32 v222, 32, v221
    v_and_b32 v223, 7, v221
    v_lshl_add_u32 v222, v223, 2, v222
    v_lshl_add_u32 v252, v222, 2, s29
    v_bfe_u32 v222, v221, 3, 1
    v_lshl_add_u32 v248, v222, 10, v252
    v_lshl_or_b32 v188, v222, 31, 1.0
    v_bfe_u32 v222, v221, 4, 1
    v_lshl_or_b32 v190, v222, 31, 1.0
    s_lshl_b32 s26, s2, 7
    s_add_u32 s26, s26, 60293120
    v_and_b32 v14, 15, v0
    v_lshl_add_u32 v14, v14, 2, s26
    v_cmp_gt_u32 vcc, 64, v0
    v_lshrrev_b32 v15, 4, v0
    v_lshl_add_u32 v14, v15, 15, v14
    v_mov_b32 v15, 1
    v_cndmask_b32 v14, -2.0, v14, vcc
    s_waitcnt vmcnt(0) lgkmcnt(0)
    s_barrier
    buffer_store_dword v15, v14, s[8:11], 0 offen sc1
    s_cmp_ge_u32 s58, 144
    s_cbranch_scc1 L_idle20
    s_add_u32 m0, s12, 116736
    s_add_u32 s15, s15, s19
    buffer_load_dwordx4 v11, s[40:43], s15 offen  lds
    s_add_u32 m0, s12, 117760
    s_add_u32 s15, s15, s19
    buffer_load_dwordx4 v11, s[40:43], s15 offen  lds
    s_add_u32 m0, s12, 118784
    s_add_u32 s15, s15, s19
    buffer_load_dwordx4 v11, s[40:43], s15 offen  lds
    s_add_u32 m0, s12, 0
    s_mov_b64 s[40:41], s[50:51]
    s_add_u32 s15, s18, 0
    buffer_load_dwordx4 v11, s[40:43], s15 offen  lds
    s_add_u32 m0, s12, 1024
    s_add_u32 s15, s15, s19
    buffer_load_dwordx4 v11, s[40:43], s15 offen  lds
    s_add_u32 m0, s12, 2048
    s_add_u32 s15, s15, s19
    buffer_load_dwordx4 v11, s[40:43], s15 offen  lds
    s_add_u32 m0, s12, 3072
    s_add_u32 s15, s15, s19
    buffer_load_dwordx4 v11, s[40:43], s15 offen  lds
    s_add_u32 m0, s12, 4096
    s_add_u32 s15, s15, s19
    buffer_load_dwordx4 v11, s[40:43], s15 offen  lds
    s_add_u32 m0, s12, 5120
    s_add_u32 s15, s15, s19
    buffer_load_dwordx4 v11, s[40:43], s15 offen  lds
    s_add_u32 m0, s12, 6144
    s_add_u32 s15, s15, s19
    buffer_load_dwordx4 v11, s[40:43], s15 offen  lds
    s_add_u32 m0, s12, 7168
    s_add_u32 s15, s15, s19
    buffer_load_dwordx4 v11, s[40:43], s15 offen  lds
    s_add_u32 m0, s12, 8192
    s_add_u32 s15, s15, s19
    buffer_load_dwordx4 v11, s[40:43], s15 offen  lds
    s_and_b32 s27, s2, 3
    s_lshl_b32 s27, s27, 15
    s_add_u32 s27, s27, 60293120
    v_lshl_add_u32 v14, v0, 7, s27
    s_lshl_b32 s26, s3, 8
    s_add_u32 s27, s27, s26
    v_and_b32 v14, 1, v0
    v_lshl_add_u32 v14, v14, 7, s27
    v_bfe_u32 v15, v0, 1, 5
    v_lshl_add_u32 v14, v15, 10, v14
    s_mov_b32 s45, 524288
    s_nop 0
L_spin22:
    buffer_load_dword v15, v14, s[8:11], 0 offen sc1
    s_sub_u32 s45, s45, 1
    s_cbranch_scc1 L_spin22_x
    s_waitcnt vmcnt(0)
    v_cmp_gt_u32 s[46:47], 1, v15
    s_nop 0
    s_and_b64 exec, exec, s[46:47]
    s_cbranch_scc1 L_spin22
L_spin22_x:
    s_mov_b64 exec, -1
    s_waitcnt vmcnt(0)
    s_add_u32 m0, s23, 36864
    s_add_u32 s27, s22, 0
    buffer_load_dwordx4 v2, s[8:11], s27 offen sc1 lds
    s_add_u32 m0, s23, 40960
    s_add_u32 s27, s22, 4096
    buffer_load_dwordx4 v2, s[8:11], s27 offen sc1 lds
    s_add_u32 m0, s23, 45056
    s_add_u32 s27, s22, 8192
    buffer_load_dwordx4 v2, s[8:11], s27 offen sc1 lds
    s_add_u32 m0, s23, 49152
    s_add_u32 s27, s22, 12288
    buffer_load_dwordx4 v2, s[8:11], s27 offen sc1 lds
    s_add_u32 m0, s23, 53248
    s_add_u32 s27, s22, 16384
    buffer_load_dwordx4 v249, s[8:11], s27 offen sc1 lds
    s_barrier
    s_add_u32 s27, s32, 88080384
    buffer_load_dwordx4 v[56:59], v3, s[8:11], s27 offen sc1
    s_add_u32 s27, s33, 88080384
    buffer_load_dwordx4 v[60:63], v3, s[8:11], s27 offen sc1
    s_add_u32 s27, s34, 88080384
    buffer_load_dwordx4 v[64:67], v3, s[8:11], s27 offen sc1
    s_add_u32 s27, s35, 88080384
    buffer_load_dwordx4 v[68:71], v3, s[8:11], s27 offen sc1
    s_waitcnt vmcnt(4)
    s_barrier
    ds_read_b128 v[32:35], v251 offset:0
    ds_read_b128 v[16:19], v250 offset:0
    ds_read_b128 v[24:27], v250 offset:8192
    ds_read_b128 v[20:23], v250 offset:4096
    ds_read_b128 v[28:31], v250 offset:12288
    s_waitcnt lgkmcnt(4)
    v_mfma_f32_16x16x32_f16 v[164:167], v[32:35], v[72:75], 0
    v_mfma_f32_16x16x32_f16 v[184:187], v[32:35], v[76:79], 0
    s_waitcnt lgkmcnt(3)
    v_mfma_f32_16x16x32_f16 v[148:151], v[16:19], v[72:75], 0
    v_mfma_f32_16x16x32_f16 v[168:171], v[16:19], v[76:79], 0
    s_waitcnt lgkmcnt(2)
    v_mfma_f32_16x16x32_f16 v[156:159], v[24:27], v[72:75], 0
    v_mfma_f32_16x16x32_f16 v[176:179], v[24:27], v[76:79], 0
    s_waitcnt lgkmcnt(1)
    v_mfma_f32_16x16x32_f16 v[152:155], v[20:23], v[72:75], 0
    v_mfma_f32_16x16x32_f16 v[172:175], v[20:23], v[76:79], 0
    s_waitcnt lgkmcnt(0)
    v_mfma_f32_16x16x32_f16 v[160:163], v[28:31], v[72:75], 0
    v_mfma_f32_16x16x32_f16 v[180:183], v[28:31], v[76:79], 0
    v_pk_mul_f32 v[224:225], v[164:165], v[104:105]
    v_pk_mul_f32 v[226:227], v[184:185], v[104:105]
    v_pk_fma_f32 v[224:225], v[184:185], v[124:125], v[224:225]
    v_pk_fma_f32 v[226:227], v[164:165], v[124:125], v[226:227] neg_lo:[1,0,0] neg_hi:[1,0,0]
    v_pk_mul_f32 v[228:229], v[166:167], v[106:107]
    v_pk_mul_f32 v[230:231], v[186:187], v[106:107]
    v_pk_fma_f32 v[228:229], v[186:187], v[126:127], v[228:229]
    v_pk_fma_f32 v[230:231], v[166:167], v[126:127], v[230:231] neg_lo:[1,0,0] neg_hi:[1,0,0]
    v_cvt_pk_f16_f32 v208, v224, v225
    v_cvt_pk_f16_f32 v210, v226, v227
    v_cvt_pk_f16_f32 v220, v226, v227
    v_cvt_pk_f16_f32 v222, -v224, -v225
    v_cvt_pk_f16_f32 v209, v228, v229
    v_cvt_pk_f16_f32 v211, v230, v231
    v_cvt_pk_f16_f32 v221, v230, v231
    v_cvt_pk_f16_f32 v223, -v228, -v229
    v_pk_mul_f32 v[224:225], v[148:149], v[88:89]
    v_pk_mul_f32 v[226:227], v[168:169], v[88:89]
    v_pk_fma_f32 v[224:225], v[168:169], v[108:109], v[224:225]
    v_pk_fma_f32 v[226:227], v[148:149], v[108:109], v[226:227] neg_lo:[1,0,0] neg_hi:[1,0,0]
    v_pk_mul_f32 v[228:229], v[150:151], v[90:91]
    v_pk_mul_f32 v[230:231], v[170:171], v[90:91]
    v_pk_fma_f32 v[228:229], v[170:171], v[110:111], v[228:229]
    v_pk_fma_f32 v[230:231], v[150:151], v[110:111], v[230:231] neg_lo:[1,0,0] neg_hi:[1,0,0]
    v_mfma_f32_16x16x32_f16 v[72:75], v[208:211], v[144:147], 0
    v_cvt_pk_f16_f32 v192, v224, v225
    v_cvt_pk_f16_f32 v194, v226, v227
    v_mfma_f32_16x16x32_f16 v[76:79], v[220:223], v[144:147], 0
    v_cvt_pk_f16_f32 v193, v228, v229
    v_cvt_pk_f16_f32 v195, v230, v231
    v_pk_mul_f32 v[224:225], v[156:157], v[96:97]
    v_pk_mul_f32 v[226:227], v[176:177], v[96:97]
    v_pk_fma_f32 v[224:225], v[176:177], v[116:117], v[224:225]
    v_pk_fma_f32 v[226:227], v[156:157], v[116:117], v[226:227] neg_lo:[1,0,0] neg_hi:[1,0,0]
    v_pk_mul_f32 v[228:229], v[158:159], v[98:99]
    v_pk_mul_f32 v[230:231], v[178:179], v[98:99]
    v_pk_fma_f32 v[228:229], v[178:179], v[118:119], v[228:229]
    v_pk_fma_f32 v[230:231], v[158:159], v[118:119], v[230:231] neg_lo:[1,0,0] neg_hi:[1,0,0]
    v_mfma_f32_16x16x32_f16 v[232:235], v[192:195], v[128:131], 0
    ds_write_b128 v5, v[72:75]
    v_cvt_pk_f16_f32 v200, v224, v225
    v_cvt_pk_f16_f32 v202, v226, v227
    v_cvt_pk_f16_f32 v201, v228, v229
    v_cvt_pk_f16_f32 v203, v230, v231
    v_pk_mul_f32 v[224:225], v[152:153], v[92:93]
    v_pk_mul_f32 v[226:227], v[172:173], v[92:93]
    v_pk_fma_f32 v[224:225], v[172:173], v[112:113], v[224:225]
    v_pk_fma_f32 v[226:227], v[152:153], v[112:113], v[226:227] neg_lo:[1,0,0] neg_hi:[1,0,0]
    v_pk_mul_f32 v[228:229], v[154:155], v[94:95]
    v_pk_mul_f32 v[230:231], v[174:175], v[94:95]
    v_pk_fma_f32 v[228:229], v[174:175], v[114:115], v[228:229]
    v_pk_fma_f32 v[230:231], v[154:155], v[114:115], v[230:231] neg_lo:[1,0,0] neg_hi:[1,0,0]
    v_mfma_f32_16x16x32_f16 v[236:239], v[200:203], v[136:139], 0
    ds_write_b128 v5, v[76:79] offset:1024
    v_cvt_pk_f16_f32 v196, v224, v225
    v_cvt_pk_f16_f32 v198, v226, v227
    v_cvt_pk_f16_f32 v212, v226, v227
    v_cvt_pk_f16_f32 v214, -v224, -v225
    v_cvt_pk_f16_f32 v197, v228, v229
    v_cvt_pk_f16_f32 v199, v230, v231
    v_cvt_pk_f16_f32 v213, v230, v231
    v_cvt_pk_f16_f32 v215, -v228, -v229
    v_pk_mul_f32 v[224:225], v[160:161], v[100:101]
    v_pk_mul_f32 v[226:227], v[180:181], v[100:101]
    v_pk_fma_f32 v[224:225], v[180:181], v[120:121], v[224:225]
    v_pk_fma_f32 v[226:227], v[160:161], v[120:121], v[226:227] neg_lo:[1,0,0] neg_hi:[1,0,0]
    v_pk_mul_f32 v[228:229], v[162:163], v[102:103]
    v_pk_mul_f32 v[230:231], v[182:183], v[102:103]
    v_pk_fma_f32 v[228:229], v[182:183], v[122:123], v[228:229]
    v_pk_fma_f32 v[230:231], v[162:163], v[122:123], v[230:231] neg_lo:[1,0,0] neg_hi:[1,0,0]
    v_mfma_f32_16x16x32_f16 v[240:243], v[196:199], v[132:135], 0
    v_cvt_pk_f16_f32 v204, v224, v225
    v_cvt_pk_f16_f32 v206, v226, v227
    v_cvt_pk_f16_f32 v216, -v226, -v227
    v_cvt_pk_f16_f32 v218, v224, v225
    v_mfma_f32_16x16x32_f16 v[244:247], v[212:215], v[132:135], 0
    v_cvt_pk_f16_f32 v205, v228, v229
    v_cvt_pk_f16_f32 v207, v230, v231
    v_cvt_pk_f16_f32 v217, -v230, -v231
    v_cvt_pk_f16_f32 v219, v228, v229
    v_add_f32 v80, v232, v236
    v_sub_f32 v84, v232, v236
    v_mfma_f32_16x16x32_f16 v[240:243], v[204:207], v[140:143], v[240:243]
    v_add_f32 v81, v233, v237
    v_sub_f32 v85, v233, v237
    v_mfma_f32_16x16x32_f16 v[244:247], v[216:219], v[140:143], v[244:247]
    v_add_f32 v82, v234, v238
    v_sub_f32 v86, v234, v238
    v_add_f32 v83, v235, v239
    v_sub_f32 v87, v235, v239
    s_nop 0
    v_pk_add_f32 v[88:89], v[80:81], v[240:241]
    v_pk_add_f32 v[90:91], v[82:83], v[242:243]
    ds_write_b128 v4, v[88:91] offset:0
    v_pk_add_f32 v[96:97], v[80:81], v[240:241] neg_lo:[0,1] neg_hi:[0,1]
    v_pk_add_f32 v[98:99], v[82:83], v[242:243] neg_lo:[0,1] neg_hi:[0,1]
    ds_write_b128 v4, v[96:99] offset:256
    v_pk_add_f32 v[92:93], v[84:85], v[244:245]
    v_pk_add_f32 v[94:95], v[86:87], v[246:247]
    ds_write_b128 v4, v[92:95] offset:128
    v_pk_add_f32 v[100:101], v[84:85], v[244:245] neg_lo:[0,1] neg_hi:[0,1]
    v_pk_add_f32 v[102:103], v[86:87], v[246:247] neg_lo:[0,1] neg_hi:[0,1]
    ds_write_b128 v4, v[100:103] offset:384
    s_waitcnt lgkmcnt(0)
    s_barrier
    ds_read_b128 v[136:139], v9 offset:0
    s_waitcnt vmcnt(3)
    v_lshlrev_b32 v16, 16, v56
    ds_read_b128 v[140:143], v9 offset:4096
    v_and_b32 v20, 0xffff0000, v56
    ds_read_b128 v[144:147], v10 offset:2048
    s_waitcnt vmcnt(2)
    v_lshlrev_b32 v17, 16, v60
    ds_read_b128 v[148:151], v10 offset:6144
    v_and_b32 v21, 0xffff0000, v60
    ds_read_b32 v136, v252 offset:0
    s_waitcnt vmcnt(1)
    v_lshlrev_b32 v18, 16, v64
    ds_read_b32 v140, v252 offset:4096
    v_and_b32 v22, 0xffff0000, v64
    ds_read_b32 v144, v248 offset:2048
    s_waitcnt vmcnt(0)
    v_lshlrev_b32 v19, 16, v68
    ds_read_b32 v148, v248 offset:6144
    v_and_b32 v23, 0xffff0000, v68
    ds_read_b128 v[104:107], v6 offset:0
    v_lshlrev_b32 v24, 16, v57
    ds_read_b128 v[108:111], v6 offset:4096
    v_and_b32 v28, 0xffff0000, v57
    ds_read_b128 v[112:115], v6 offset:8192
    v_lshlrev_b32 v25, 16, v61
    ds_read_b128 v[116:119], v6 offset:12288
    v_and_b32 v29, 0xffff0000, v61
    ds_read_b128 v[124:127], v7 offset:12288
    v_lshlrev_b32 v26, 16, v65
    ds_read_b128 v[128:131], v7 offset:8192
    v_and_b32 v30, 0xffff0000, v65
    ds_read_b128 v[132:135], v7 offset:4096
    v_lshlrev_b32 v27, 16, v69
    ds_read_b32 v124, v8 offset:12288
    v_and_b32 v31, 0xffff0000, v69
    ds_read_b32 v128, v8 offset:8192
    v_lshlrev_b32 v32, 16, v58
    ds_read_b32 v132, v8 offset:4096
    v_and_b32 v36, 0xffff0000, v58
    v_lshlrev_b32 v33, 16, v62
    v_and_b32 v37, 0xffff0000, v62
    v_lshlrev_b32 v34, 16, v66
    v_and_b32 v38, 0xffff0000, v66
    v_lshlrev_b32 v35, 16, v70
    v_and_b32 v39, 0xffff0000, v70
    v_lshlrev_b32 v40, 16, v59
    v_and_b32 v44, 0xffff0000, v59
    v_lshlrev_b32 v41, 16, v63
    v_and_b32 v45, 0xffff0000, v63
    v_lshlrev_b32 v42, 16, v67
    v_and_b32 v46, 0xffff0000, v67
    v_lshlrev_b32 v43, 16, v71
    v_and_b32 v47, 0xffff0000, v71
    s_waitcnt lgkmcnt(12)
    v_pk_fma_f32 v[136:137], v[140:141], v[188:189], v[136:137]
    s_waitcnt lgkmcnt(10)
    v_pk_fma_f32 v[144:145], v[148:149], v[188:189], v[144:145]
    v_pk_fma_f32 v[138:139], v[142:143], v[188:189], v[138:139] op_sel:[0,1,0]
    v_pk_fma_f32 v[146:147], v[150:151], v[188:189], v[146:147] op_sel:[0,1,0]
    v_pk_fma_f32 v[120:121], v[144:145], v[190:191], v[136:137]
    v_pk_fma_f32 v[122:123], v[146:147], v[190:191], v[138:139] op_sel:[0,1,0]
    s_waitcnt lgkmcnt(9)
    v_pk_add_f32 v[18:19], v[18:19], v[106:107]
    s_waitcnt lgkmcnt(8)
    v_pk_add_f32 v[22:23], v[22:23], v[110:111]
    s_waitcnt lgkmcnt(7)
    v_pk_add_f32 v[26:27], v[26:27], v[114:115]
    s_waitcnt lgkmcnt(6)
    v_pk_add_f32 v[30:31], v[30:31], v[118:119]
    v_pk_add_f32 v[34:35], v[34:35], v[122:123]
    s_waitcnt lgkmcnt(5)
    v_pk_add_f32 v[38:39], v[38:39], v[126:127]
    s_waitcnt lgkmcnt(4)
    v_pk_add_f32 v[42:43], v[42:43], v[130:131]
    s_waitcnt lgkmcnt(3)
    v_pk_add_f32 v[46:47], v[46:47], v[134:135]
    v_cvt_pk_bf16_f32 v68, v19, v23
    v_cvt_pk_bf16_f32 v69, v27, v31
    v_cvt_pk_bf16_f32 v70, v35, v39
    v_cvt_pk_bf16_f32 v71, v43, v47
    s_add_u32 s35, s35, 84934656
    v_cvt_pk_bf16_f32 v64, v18, v22
    v_cvt_pk_bf16_f32 v65, v26, v30
    v_cvt_pk_bf16_f32 v66, v34, v38
    v_cvt_pk_bf16_f32 v67, v42, v46
    s_add_u32 s34, s34, 84934656
    v_pk_add_f32 v[16:17], v[16:17], v[104:105]
    v_pk_add_f32 v[20:21], v[20:21], v[108:109]
    v_pk_add_f32 v[24:25], v[24:25], v[112:113]
    v_pk_add_f32 v[28:29], v[28:29], v[116:117]
    v_pk_add_f32 v[32:33], v[32:33], v[120:121]
    s_waitcnt lgkmcnt(2)
    v_pk_add_f32 v[36:37], v[36:37], v[124:125]
    s_waitcnt lgkmcnt(1)
    v_pk_add_f32 v[40:41], v[40:41], v[128:129]
    s_waitcnt lgkmcnt(0)
    v_pk_add_f32 v[44:45], v[44:45], v[132:133]
    v_cvt_pk_bf16_f32 v60, v17, v21
    v_cvt_pk_bf16_f32 v61, v25, v29
    v_cvt_pk_bf16_f32 v62, v33, v37
    v_cvt_pk_bf16_f32 v63, v41, v45
    s_add_u32 s33, s33, 84934656
    v_cvt_pk_bf16_f32 v56, v16, v20
    v_cvt_pk_bf16_f32 v57, v24, v28
    v_cvt_pk_bf16_f32 v58, v32, v36
    v_cvt_pk_bf16_f32 v59, v40, v44
    s_add_u32 s32, s32, 84934656
    buffer_store_dwordx4 v[68:71], v3, s[8:11], s35 offen sc1
    buffer_store_dwordx4 v[64:67], v3, s[8:11], s34 offen sc1
    buffer_store_dwordx4 v[60:63], v3, s[8:11], s33 offen sc1
    buffer_store_dwordx4 v[56:59], v3, s[8:11], s32 offen sc1
    s_cmp_eq_u32 s44, 0
    s_cbranch_scc0 L_nomu23
    v_lshrrev_b32 v3, 2, v3
    s_lshl_b32 s27, s36, 7
    s_add_u32 s27, s27, 57712640
    buffer_store_dword v104, v3, s[8:11], s27 offen sc1
    s_lshl_b32 s27, s37, 7
    s_add_u32 s27, s27, 57712640
    buffer_store_dword v105, v3, s[8:11], s27 offen sc1
    s_lshl_b32 s27, s38, 7
    s_add_u32 s27, s27, 57712640
    buffer_store_dword v106, v3, s[8:11], s27 offen sc1
    s_lshl_b32 s27, s39, 7
    s_add_u32 s27, s27, 57712640
    buffer_store_dword v107, v3, s[8:11], s27 offen sc1
L_nomu23:
    s_branch L_join21
L_idle20:
    s_add_u32 m0, s12, 116736
    s_add_u32 s15, s15, s19
    buffer_load_dwordx4 v11, s[40:43], s15 offen  lds
    s_add_u32 m0, s12, 117760
    s_add_u32 s15, s15, s19
    buffer_load_dwordx4 v11, s[40:43], s15 offen  lds
    s_add_u32 m0, s12, 118784
    s_add_u32 s15, s15, s19
    buffer_load_dwordx4 v11, s[40:43], s15 offen  lds
    s_add_u32 m0, s12, 0
    s_mov_b64 s[40:41], s[50:51]
    s_add_u32 s15, s18, 0
    buffer_load_dwordx4 v11, s[40:43], s15 offen  lds
    s_add_u32 m0, s12, 1024
    s_add_u32 s15, s15, s19
    buffer_load_dwordx4 v11, s[40:43], s15 offen  lds
    s_add_u32 m0, s12, 2048
    s_add_u32 s15, s15, s19
    buffer_load_dwordx4 v11, s[40:43], s15 offen  lds
    s_add_u32 m0, s12, 3072
    s_add_u32 s15, s15, s19
    buffer_load_dwordx4 v11, s[40:43], s15 offen  lds
    s_add_u32 m0, s12, 4096
    s_add_u32 s15, s15, s19
    buffer_load_dwordx4 v11, s[40:43], s15 offen  lds
    s_add_u32 m0, s12, 5120
    s_add_u32 s15, s15, s19
    buffer_load_dwordx4 v11, s[40:43], s15 offen  lds
    s_add_u32 m0, s12, 6144
    s_add_u32 s15, s15, s19
    buffer_load_dwordx4 v11, s[40:43], s15 offen  lds
    s_add_u32 m0, s12, 7168
    s_add_u32 s15, s15, s19
    buffer_load_dwordx4 v11, s[40:43], s15 offen  lds
    s_add_u32 m0, s12, 8192
    s_add_u32 s15, s15, s19
    buffer_load_dwordx4 v11, s[40:43], s15 offen  lds
    s_and_b32 s26, s2, 3
    s_lshl_b32 s26, s26, 15
    s_add_u32 s26, s26, 60293120
    v_lshl_add_u32 v14, v0, 7, s26
    s_mov_b32 s45, 524288
    s_nop 0
L_spin24:
    buffer_load_dword v15, v14, s[8:11], 0 offen sc1
    s_sub_u32 s45, s45, 1
    s_cbranch_scc1 L_spin24_x
    s_waitcnt vmcnt(0)
    v_cmp_gt_u32 s[46:47], 1, v15
    s_nop 0
    s_and_b64 exec, exec, s[46:47]
    s_cbranch_scc1 L_spin24
L_spin24_x:
    s_mov_b64 exec, -1
    s_waitcnt vmcnt(0)
L_join21:
    s_and_b32 s24, s2, 1
    s_lshl_b32 s24, s24, 2
    s_lshr_b32 s25, s2, 6
    s_add_u32 s24, s24, s25
    s_lshl_b32 s24, s24, 2
    s_add_u32 s24, s24, s3
    s_lshl_b32 s25, s24, 10
    s_add_u32 s25, s25, 84934656
    v_bfe_u32 v23, v0, 4, 2
    v_and_b32 v22, 0xf0, v1
    v_lshl_add_u32 v22, v23, 15, v22
    v_add_u32 v6, s25, v22
    v_bfe_u32 v24, v0, 2, 3
    v_bfe_u32 v25, v0, 5, 1
    v_mul_u32_u24 v25, 18432, v25
    v_lshl_add_u32 v25, v24, 7, v25
    v_and_b32 v24, 6, v24
    v_lshl_add_u32 v25, v24, 4, v25
    v_and_b32 v24, 3, v0
    v_lshl_add_u32 v25, v24, 3, v25
    v_add_u32 v25, 110592, v25
    v_xor_b32 v56, 0, v25
    v_xor_b32 v57, 32, v25
    v_xor_b32 v58, 64, v25
    v_xor_b32 v59, 96, v25
    s_lshl_b32 s26, s2, 7
    s_add_u32 s26, s26, 60555264
    v_and_b32 v26, 15, v0
    v_lshl_add_u32 v26, v26, 2, s26
    v_cmp_gt_u32 vcc, 64, v0
    v_lshrrev_b32 v27, 4, v0
    v_lshl_add_u32 v26, v27, 15, v26
    v_mov_b32 v27, 1
    v_cndmask_b32 v26, -2.0, v26, vcc
    s_nop 1
    s_mov_b64 exec, 0
    s_cmp_eq_u32 s3, 0
    s_cbranch_scc1 L_pad_c3_0
    s_cmp_eq_u32 s3, 1
    s_cbranch_scc1 L_pad_c3_1
    s_cmp_eq_u32 s3, 2
    s_cbranch_scc1 L_pad_c3_2
    s_branch L_pad_c3_3
L_hopret_c3:
    s_mov_b64 exec, -1
    s_waitcnt vmcnt(0) lgkmcnt(0)
    s_barrier
    buffer_store_dword v27, v26, s[8:11], 0 offen sc1
    s_add_u32 m0, s12, 36864
    s_mov_b64 s[40:41], s[48:49]
    s_mul_i32 s15, s19, 9
    s_add_u32 s15, s15, s18
    buffer_load_dwordx4 v11, s[40:43], s15 offen  lds
    s_add_u32 m0, s12, 37888
    s_add_u32 s15, s15, s19
    buffer_load_dwordx4 v11, s[40:43], s15 offen  lds
    s_add_u32 m0, s12, 38912
    s_add_u32 s15, s15, s19
    buffer_load_dwordx4 v11, s[40:43], s15 offen  lds
    s_add_u32 m0, s12, 39936
    s_add_u32 s15, s15, s19
    buffer_load_dwordx4 v11, s[40:43], s15 offen  lds
    s_add_u32 m0, s12, 40960
    s_add_u32 s15, s15, s19
    buffer_load_dwordx4 v11, s[40:43], s15 offen  lds
    s_add_u32 m0, s12, 41984
    s_add_u32 s15, s15, s19
    buffer_load_dwordx4 v11, s[40:43], s15 offen  lds
    s_add_u32 m0, s12, 43008
    s_add_u32 s15, s15, s19
    buffer_load_dwordx4 v11, s[40:43], s15 offen  lds
    s_add_u32 m0, s12, 44032
    s_add_u32 s15, s15, s19
    buffer_load_dwordx4 v11, s[40:43], s15 offen  lds
    s_add_u32 m0, s12, 45056
    s_add_u32 s15, s15, s19
    buffer_load_dwordx4 v11, s[40:43], s15 offen  lds
    s_add_u32 m0, s12, 73728
    s_mov_b64 s[40:41], s[50:51]
    s_mul_i32 s15, s19, 9
    s_add_u32 s15, s15, s18
    buffer_load_dwordx4 v11, s[40:43], s15 offen  lds
    s_add_u32 m0, s12, 74752
    s_add_u32 s15, s15, s19
    buffer_load_dwordx4 v11, s[40:43], s15 offen  lds
    s_add_u32 m0, s12, 75776
    s_add_u32 s15, s15, s19
    buffer_load_dwordx4 v11, s[40:43], s15 offen  lds
    s_add_u32 m0, s12, 76800
    s_add_u32 s15, s15, s19
    buffer_load_dwordx4 v11, s[40:43], s15 offen  lds
L_pad_c2_1:
    s_cbranch_execz L_hopret_c2
    s_add_u32 m0, s12, 77824
    s_add_u32 s15, s15, s19
    buffer_load_dwordx4 v11, s[40:43], s15 offen  lds
    s_add_u32 m0, s12, 78848
    s_add_u32 s15, s15, s19
    buffer_load_dwordx4 v11, s[40:43], s15 offen  lds
    s_add_u32 m0, s12, 79872
    s_add_u32 s15, s15, s19
    buffer_load_dwordx4 v11, s[40:43], s15 offen  lds
    s_add_u32 m0, s12, 80896
    s_add_u32 s15, s15, s19
    buffer_load_dwordx4 v11, s[40:43], s15 offen  lds
    s_add_u32 m0, s12, 81920
    s_add_u32 s15, s15, s19
    buffer_load_dwordx4 v11, s[40:43], s15 offen  lds
    s_and_b32 s27, s2, 3
    s_lshl_b32 s27, s27, 15
    s_add_u32 s27, s27, 60555264
    v_lshl_add_u32 v20, v0, 7, s27
    s_cmp_ge_u32 s58, 144
    s_cbranch_scc0 L_pre25
    s_mov_b32 s45, 524288
    s_mov_b64 exec, 1
L_spin26:
    buffer_load_dword v21, v20, s[8:11], 0 offen sc1
    s_sub_u32 s45, s45, 1
    s_cbranch_scc1 L_spin26_x
    s_waitcnt vmcnt(0)
    v_cmp_gt_u32 s[46:47], 1, v21
    s_nop 0
    s_and_b64 exec, exec, s[46:47]
    s_cbranch_scc1 L_spin26
L_spin26_x:
    s_mov_b64 exec, -1
    s_waitcnt vmcnt(0)
L_pre25:
    s_mov_b32 s45, 524288
L_spin27:
    buffer_load_dword v21, v20, s[8:11], 0 offen sc1
    s_sub_u32 s45, s45, 1
    s_cbranch_scc1 L_spin27_x
    s_waitcnt vmcnt(0)
    v_cmp_gt_u32 s[46:47], 1, v21
    s_nop 0
    s_and_b64 exec, exec, s[46:47]
    s_cbranch_scc1 L_spin27
L_spin27_x:
    s_mov_b64 exec, -1
    s_waitcnt vmcnt(0)
    s_barrier
L_ffn1:
    s_mov_b32 s16, 0
    buffer_load_dwordx4 a[0:3], v6, s[8:11], s16 offen offset:0 sc1
    buffer_load_dwordx4 a[4:7], v6, s[8:11], s16 offen offset:256 sc1
    buffer_load_dwordx4 a[8:11], v6, s[8:11], s16 offen offset:512 sc1
    buffer_load_dwordx4 a[12:15], v6, s[8:11], s16 offen offset:768 sc1
    s_mov_b32 s16, 131072
    buffer_load_dwordx4 a[16:19], v6, s[8:11], s16 offen offset:0 sc1
    buffer_load_dwordx4 a[20:23], v6, s[8:11], s16 offen offset:256 sc1
    buffer_load_dwordx4 a[24:27], v6, s[8:11], s16 offen offset:512 sc1
    buffer_load_dwordx4 a[28:31], v6, s[8:11], s16 offen offset:768 sc1
    s_mov_b32 s16, 262144
    buffer_load_dwordx4 a[32:35], v6, s[8:11], s16 offen offset:0 sc1
    buffer_load_dwordx4 a[36:39], v6, s[8:11], s16 offen offset:256 sc1
    buffer_load_dwordx4 a[40:43], v6, s[8:11], s16 offen offset:512 sc1
    ds_read_b64_tr_b16 v[44:45], v56 offset:0
    ds_read_b64_tr_b16 v[46:47], v56 offset:9216
    ds_read_b64_tr_b16 v[48:49], v57 offset:0
    ds_read_b64_tr_b16 v[50:51], v57 offset:9216
    ds_read_b64_tr_b16 v[52:53], v58 offset:0
    ds_read_b64_tr_b16 v[54:55], v58 offset:9216
    s_waitcnt vmcnt(10) lgkmcnt(4)
    v_mfma_f32_16x16x32_bf16 v[140:143], v[44:47], a[0:3], 0
    buffer_load_dwordx4 a[44:47], v6, s[8:11], s16 offen offset:768 sc1
    s_waitcnt lgkmcnt(2)
    v_mfma_f32_16x16x32_bf16 v[188:191], v[48:51], a[0:3], 0
    s_mov_b32 s16, 393216
    ds_read_b64_tr_b16 v[60:61], v59 offset:0
    ds_read_b64_tr_b16 v[62:63], v59 offset:9216
    s_waitcnt lgkmcnt(2)
    v_mfma_f32_16x16x32_bf16 v[204:207], v[52:55], a[0:3], 0
    s_lshl_b32 s30, s7, 2
    v_add_u32 v56, 4294856704, v56
    s_add_u32 s30, s30, s4
    s_waitcnt vmcnt(10)
    v_mfma_f32_16x16x32_bf16 v[144:147], v[44:47], a[4:7], 0
    s_lshl_b32 s31, s30, 7
    ds_read_b64_tr_b16 v[64:65], v56 offset:0
    s_mul_i32 s32, s3, 589824
    v_mfma_f32_16x16x32_bf16 v[192:195], v[48:51], a[4:7], 0
    buffer_load_dwordx4 a[48:51], v6, s[8:11], s16 offen offset:0 sc1
    v_mfma_f32_16x16x32_bf16 v[208:211], v[52:55], a[4:7], 0
    s_add_u32 s31, s31, s32
    ds_read_b64_tr_b16 v[66:67], v56 offset:9216
    v_add_u32 v57, 4294856704, v57
    s_waitcnt vmcnt(10)
    v_mfma_f32_16x16x32_bf16 v[148:151], v[44:47], a[8:11], 0
    s_add_u32 s31, s31, 84934656
    ds_read_b64_tr_b16 v[68:69], v57 offset:0
    v_and_b32 v89, 0x70, v1
    v_mfma_f32_16x16x32_bf16 v[196:199], v[48:51], a[8:11], 0
    s_lshl_b32 s30, s30, 2
    ds_read_b64_tr_b16 v[70:71], v57 offset:9216
    v_add_u32 v89, s31, v89
    v_mfma_f32_16x16x32_bf16 v[212:215], v[52:55], a[8:11], 0
    s_add_u32 s30, s30, s3
    v_bfe_u32 v90, v0, 3, 3
    s_lshl_b32 s30, s30, 6
    s_waitcnt vmcnt(9)
    v_mfma_f32_16x16x32_bf16 v[152:155], v[44:47], a[12:15], 0
    buffer_load_dwordx4 a[52:55], v6, s[8:11], s16 offen offset:256 sc1
    v_mfma_f32_16x16x32_bf16 v[200:203], v[48:51], a[12:15], 0
    s_add_u32 s30, s30, 59441152
    v_lshl_add_u32 v85, v90, 15, v89
    v_and_b32 v91, 1, v90
    v_mfma_f32_16x16x32_bf16 v[216:219], v[52:55], a[12:15], 0
    s_waitcnt lgkmcnt(0)
    v_lshl_add_u32 v89, v91, 15, v89
    v_lshrrev_b32 v90, 1, v90
    v_mfma_f32_16x16x32_bf16 v[172:175], v[60:63], a[0:3], 0
    s_lshr_b32 s31, s2, 6
    v_add_u32 v58, 4294856704, v58
    ds_read_b64_tr_b16 v[44:45], v58 offset:0
    v_mfma_f32_16x16x32_bf16 v[92:95], v[64:67], a[0:3], 0
    s_and_b32 s27, s2, 1
    ds_read_b64_tr_b16 v[46:47], v58 offset:9216
    v_lshl_add_u32 v86, v90, 2, v89
    v_mfma_f32_16x16x32_bf16 v[124:127], v[68:71], a[0:3], 0
    buffer_load_dwordx4 a[56:59], v6, s[8:11], s16 offen offset:512 sc1
    v_mfma_f32_16x16x32_bf16 v[176:179], v[60:63], a[4:7], 0
    s_lshl_b32 s27, s27, 2
    v_add_u32 v59, 4294856704, v59
    ds_read_b64_tr_b16 v[48:49], v59 offset:0
    v_mfma_f32_16x16x32_bf16 v[96:99], v[64:67], a[4:7], 0
    s_lshr_b32 s28, s2, 6
    ds_read_b64_tr_b16 v[50:51], v59 offset:9216
    v_cmp_gt_u32 vcc, 256, v1
    v_mfma_f32_16x16x32_bf16 v[128:131], v[68:71], a[4:7], 0
    s_add_u32 s27, s27, s28
    v_add_u32 v56, 110592, v56
    v_lshrrev_b32 v89, 2, v1
    v_mfma_f32_16x16x32_bf16 v[180:183], v[60:63], a[8:11], 0
    s_bfe_u32 s28, s2, 0x20001
    ds_read_b64_tr_b16 v[52:53], v56 offset:1024
    v_add_u32 v89, s30, v89
    v_mfma_f32_16x16x32_bf16 v[100:103], v[64:67], a[8:11], 0
    buffer_load_dwordx4 a[60:63], v6, s[8:11], s16 offen offset:768 sc1
    v_mfma_f32_16x16x32_bf16 v[132:135], v[68:71], a[8:11], 0
    s_mov_b32 s16, 524288
    ds_read_b64_tr_b16 v[54:55], v56 offset:10240
    v_cndmask_b32 v87, -2.0, v89, vcc
    v_mfma_f32_16x16x32_bf16 v[184:187], v[60:63], a[12:15], 0
    s_and_b32 s30, s2, 1
    s_lshl_b32 s30, s30, 2
    s_add_u32 s30, s30, s31
    v_mfma_f32_16x16x32_bf16 v[104:107], v[64:67], a[12:15], 0
    s_lshl_b32 s30, s30, 2
    s_add_u32 s30, s30, s3
    s_lshl_b32 s30, s30, 11
    v_mfma_f32_16x16x32_bf16 v[136:139], v[68:71], a[12:15], 0
    s_waitcnt lgkmcnt(0)
    s_add_u32 s30, s30, 59441152
    v_and_b32 v89, 7, v0
    v_mfma_f32_16x16x32_bf16 v[156:159], v[44:47], a[0:3], 0
    s_bfe_u32 s29, s2, 0x30003
    v_add_u32 v57, 110592, v57
    ds_read_b64_tr_b16 v[60:61], v57 offset:1024
    v_mfma_f32_16x16x32_bf16 v[108:111], v[48:51], a[0:3], 0
    buffer_load_dwordx4 a[64:67], v6, s[8:11], s16 offen offset:0 sc1
    s_waitcnt vmcnt(12)
    v_mfma_f32_16x16x32_bf16 v[140:143], v[52:55], a[16:19], v[140:143]
    s_lshl_b32 s24, s28, 3
    ds_read_b64_tr_b16 v[62:63], v57 offset:10240
    v_add_u32 v58, 110592, v58
    v_mfma_f32_16x16x32_bf16 v[160:163], v[44:47], a[4:7], 0
    s_add_u32 s24, s24, s29
    ds_read_b64_tr_b16 v[64:65], v58 offset:1024
    v_lshl_add_u32 v89, v89, 2, s30
    v_mfma_f32_16x16x32_bf16 v[112:115], v[48:51], a[4:7], 0
    s_mul_i32 s24, s24, 9216
    ds_read_b64_tr_b16 v[66:67], v58 offset:10240
    v_bfe_u32 v90, v0, 3, 1
    s_waitcnt vmcnt(11)
    v_mfma_f32_16x16x32_bf16 v[144:147], v[52:55], a[20:23], v[144:147]
    s_mov_b32 s33, 262144
    v_add_u32 v59, 110592, v59
    v_lshl_add_u32 v89, v90, 8, v89
    v_mfma_f32_16x16x32_bf16 v[164:167], v[44:47], a[8:11], 0
    buffer_load_dwordx4 v[76:79], v85, s[8:11], 0 offen sc1
    v_mfma_f32_16x16x32_bf16 v[116:119], v[48:51], a[8:11], 0
    s_lshl_b32 s25, s27, 2
    ds_read_b64_tr_b16 v[68:69], v59 offset:1024
    ds_read_b64_tr_b16 v[70:71], v59 offset:10240
    s_waitcnt vmcnt(11)
    v_mfma_f32_16x16x32_bf16 v[148:151], v[52:55], a[24:27], v[148:151]
    s_add_u32 s25, s25, s3
    v_bfe_u32 v90, v0, 4, 2
    v_and_b32 v21, 63, v0
    v_mfma_f32_16x16x32_bf16 v[168:171], v[44:47], a[12:15], 0
    s_mul_i32 s25, s25, 589824
    v_lshl_add_u32 v88, v90, 6, v89
    v_and_b32 v22, 15, v0
    v_mfma_f32_16x16x32_bf16 v[120:123], v[48:51], a[12:15], 0
    s_add_u32 s25, s25, s24
    v_lshrrev_b32 v23, 4, v21
    s_add_u32 s25, s25, 104857600
    s_waitcnt vmcnt(10)
    v_mfma_f32_16x16x32_bf16 v[152:155], v[52:55], a[28:31], v[152:155]
    s_waitcnt lgkmcnt(0)
    v_add_u32 v7, s25, v1
    s_lshl_b32 s26, s2, 2
    v_mfma_f32_16x16x32_bf16 v[188:191], v[60:63], a[16:19], v[188:191]
    buffer_load_dwordx4 v[80:83], v85, s[8:11], s33 offen sc1
    v_mfma_f32_16x16x32_bf16 v[204:207], v[64:67], a[16:19], v[204:207]
    s_mov_b32 s33, 524288
    v_add_u32 v56, 4294856704, v56
    ds_read_b64_tr_b16 v[44:45], v56 offset:1024
    v_mfma_f32_16x16x32_bf16 v[172:175], v[68:71], a[16:19], v[172:175]
    s_add_u32 s26, s26, s3
    ds_read_b64_tr_b16 v[46:47], v56 offset:10240
    v_add_u32 v57, 4294856704, v57
    v_mfma_f32_16x16x32_bf16 v[192:195], v[60:63], a[20:23], v[192:195]
    s_lshl_b32 s26, s26, 7
    ds_read_b64_tr_b16 v[48:49], v57 offset:1024
    s_add_u32 s26, s26, 58720256
    v_mfma_f32_16x16x32_bf16 v[208:211], v[64:67], a[20:23], v[208:211]
    buffer_load_dword v84, v86, s[8:11], s33 offen sc1
    v_mfma_f32_16x16x32_bf16 v[176:179], v[68:71], a[20:23], v[176:179]
    buffer_load_dwordx4 a[68:71], v6, s[8:11], s16 offen offset:256 sc1
    v_mfma_f32_16x16x32_bf16 v[196:199], v[60:63], a[24:27], v[196:199]
    s_lshr_b32 s24, s29, 2
    ds_read_b64_tr_b16 v[50:51], v57 offset:10240
    v_add_u32 v58, 4294856704, v58
    v_mfma_f32_16x16x32_bf16 v[212:215], v[64:67], a[24:27], v[212:215]
    s_lshl_b32 s24, s24, 1
    ds_read_b64_tr_b16 v[52:53], v58 offset:1024
    ds_read_b64_tr_b16 v[54:55], v58 offset:10240
    v_mfma_f32_16x16x32_bf16 v[180:183], v[68:71], a[24:27], v[180:183]
    s_and_b32 s20, s2, 1
    v_cmp_gt_u32 vcc, 16, v21
    v_lshl_add_u32 v24, v21, 2, s26
    v_mfma_f32_16x16x32_bf16 v[200:203], v[60:63], a[28:31], v[200:203]
    s_and_b32 s26, s2, 0xc7
    s_lshl_b32 s26, s26, 2
    s_add_u32 s26, s26, s24
    v_mfma_f32_16x16x32_bf16 v[216:219], v[64:67], a[28:31], v[216:219]
    buffer_load_dwordx4 a[72:75], v6, s[8:11], s16 offen offset:512 sc1
    v_mfma_f32_16x16x32_bf16 v[184:187], v[68:71], a[28:31], v[184:187]
    s_waitcnt lgkmcnt(0)
    v_cndmask_b32 v252, -2.0, v24, vcc
    s_lshr_b32 s24, s3, 1
    v_mfma_f32_16x16x32_bf16 v[92:95], v[44:47], a[16:19], v[92:95]
    s_add_u32 s26, s26, s24
    v_add_u32 v59, 4294856704, v59
    ds_read_b64_tr_b16 v[60:61], v59 offset:1024
    v_mfma_f32_16x16x32_bf16 v[124:127], v[48:51], a[16:19], v[124:127]
    s_lshl_b32 s26, s26, 7
    ds_read_b64_tr_b16 v[62:63], v59 offset:10240
    s_add_u32 s26, s26, 58720256
    v_mfma_f32_16x16x32_bf16 v[156:159], v[52:55], a[16:19], v[156:159]
    s_lshl_b32 s20, s20, 2
    v_add_u32 v56, 110592, v56
    v_and_b32 v24, 7, v21
    v_mfma_f32_16x16x32_bf16 v[96:99], v[44:47], a[20:23], v[96:99]
    s_lshr_b32 s21, s2, 6
    ds_read_b64_tr_b16 v[64:65], v56 offset:2048
    v_lshlrev_b32 v24, 12, v24
    v_mfma_f32_16x16x32_bf16 v[128:131], v[48:51], a[20:23], v[128:131]
    buffer_load_dwordx4 a[76:79], v6, s[8:11], s16 offen offset:768 sc1
    v_mfma_f32_16x16x32_bf16 v[160:163], v[52:55], a[20:23], v[160:163]
    s_mov_b32 s16, 655360
    ds_read_b64_tr_b16 v[66:67], v56 offset:11264
    v_add_u32 v57, 110592, v57
    v_mfma_f32_16x16x32_bf16 v[100:103], v[44:47], a[24:27], v[100:103]
    s_add_u32 s20, s20, s21
    ds_read_b64_tr_b16 v[68:69], v57 offset:2048
    v_add_u32 v253, s26, v24
    v_mfma_f32_16x16x32_bf16 v[132:135], v[48:51], a[24:27], v[132:135]
    s_bfe_u32 s21, s2, 0x20001
    ds_read_b64_tr_b16 v[70:71], v57 offset:11264
    v_add_u32 v2, 0, v1
    v_mfma_f32_16x16x32_bf16 v[164:167], v[52:55], a[24:27], v[164:167]
    s_bfe_u32 s22, s2, 0x30003
    v_add_u32 v3, 36864, v1
    v_add_u32 v4, 73728, v1
    v_mfma_f32_16x16x32_bf16 v[104:107], v[44:47], a[28:31], v[104:107]
    buffer_load_dwordx4 a[80:83], v6, s[8:11], s16 offen offset:0 sc1
    v_mfma_f32_16x16x32_bf16 v[136:139], v[48:51], a[28:31], v[136:139]
    s_and_b32 s24, s22, 3
    v_add_u32 v5, 110592, v1
    v_and_b32 v72, 0xf0, v1
    v_mfma_f32_16x16x32_bf16 v[168:171], v[52:55], a[28:31], v[168:171]
    s_waitcnt lgkmcnt(0)
    v_bfe_u32 v73, v0, 4, 1
    v_bfe_u32 v74, v0, 5, 1
    v_mfma_f32_16x16x32_bf16 v[108:111], v[60:63], a[16:19], v[108:111]
    s_lshr_b32 s25, s22, 2
    v_add_u32 v58, 110592, v58
    ds_read_b64_tr_b16 v[44:45], v58 offset:2048
    s_waitcnt vmcnt(15)
    v_mfma_f32_16x16x32_bf16 v[140:143], v[64:67], a[32:35], v[140:143]
    s_lshl_b32 s26, s20, 1
    ds_read_b64_tr_b16 v[46:47], v58 offset:11264
    s_add_u32 s26, s26, s25
    v_mfma_f32_16x16x32_bf16 v[188:191], v[68:71], a[32:35], v[188:191]
    buffer_load_dwordx4 a[84:87], v6, s[8:11], s16 offen offset:256 sc1
    v_mfma_f32_16x16x32_bf16 v[112:115], v[60:63], a[20:23], v[112:115]
    s_lshl_b32 s26, s26, 2
    v_add_u32 v59, 110592, v59
    ds_read_b64_tr_b16 v[48:49], v59 offset:2048
    s_waitcnt vmcnt(15)
    v_mfma_f32_16x16x32_bf16 v[144:147], v[64:67], a[36:39], v[144:147]
    s_add_u32 s26, s26, s3
    ds_read_b64_tr_b16 v[50:51], v59 offset:11264
    s_mul_i32 s27, s26, 294912
    v_mfma_f32_16x16x32_bf16 v[192:195], v[68:71], a[36:39], v[192:195]
    s_mul_i32 s28, s21, 73728
    v_add_u32 v56, 4294856704, v56
    s_add_u32 s27, s27, s28
    v_mfma_f32_16x16x32_bf16 v[116:119], v[60:63], a[24:27], v[116:119]
    s_add_u32 s27, s27, 104857600
    ds_read_b64_tr_b16 v[52:53], v56 offset:2048
    v_mul_u32_u24 v75, 9216, v74
    s_waitcnt vmcnt(14)
    v_mfma_f32_16x16x32_bf16 v[148:151], v[64:67], a[40:43], v[148:151]
    buffer_load_dwordx4 a[88:91], v6, s[8:11], s16 offen offset:512 sc1
    v_mfma_f32_16x16x32_bf16 v[196:199], v[68:71], a[40:43], v[196:199]
    s_mul_i32 s28, s24, 589824
    ds_read_b64_tr_b16 v[54:55], v56 offset:11264
    v_lshl_add_u32 v75, v73, 9, v75
    v_mfma_f32_16x16x32_bf16 v[120:123], v[60:63], a[28:31], v[120:123]
    v_add3_u32 v8, v75, v72, s27
    s_mul_i32 s27, s21, 2359296
    s_waitcnt vmcnt(14)
    v_mfma_f32_16x16x32_bf16 v[152:155], v[64:67], a[44:47], v[152:155]
    s_add_u32 s27, s27, s28
    s_lshl_b32 s28, s26, 9
    s_add_u32 s27, s27, s28
    v_mfma_f32_16x16x32_bf16 v[200:203], v[68:71], a[44:47], v[200:203]
    s_waitcnt lgkmcnt(0)
    s_add_u32 s27, s27, 94371840
    v_lshl_add_u32 v72, v73, 15, v72
    v_mfma_f32_16x16x32_bf16 v[204:207], v[44:47], a[32:35], v[204:207]
    buffer_load_dwordx4 a[92:95], v6, s[8:11], s16 offen offset:768 sc1
    v_mfma_f32_16x16x32_bf16 v[172:175], v[48:51], a[32:35], v[172:175]
    s_mov_b32 s16, 786432
    v_add_u32 v57, 4294856704, v57
    ds_read_b64_tr_b16 v[60:61], v57 offset:2048
    v_mfma_f32_16x16x32_bf16 v[92:95], v[52:55], a[32:35], v[92:95]
    ds_read_b64_tr_b16 v[62:63], v57 offset:11264
    v_add_u32 v58, 4294856704, v58
    v_mfma_f32_16x16x32_bf16 v[208:211], v[44:47], a[36:39], v[208:211]
    ds_read_b64_tr_b16 v[64:65], v58 offset:2048
    v_add_u32 v72, s27, v72
    v_mfma_f32_16x16x32_bf16 v[176:179], v[48:51], a[36:39], v[176:179]
    ds_read_b64_tr_b16 v[66:67], v58 offset:11264
    v_lshl_add_u32 v9, v74, 16, v72
    v_mfma_f32_16x16x32_bf16 v[96:99], v[52:55], a[36:39], v[96:99]
    v_add_u32 v59, 4294856704, v59
    v_lshl_add_u32 v72, v74, 8, v72
    v_mfma_f32_16x16x32_bf16 v[212:215], v[44:47], a[40:43], v[212:215]
    buffer_load_dwordx4 a[96:99], v6, s[8:11], s16 offen offset:0 sc1
    v_mfma_f32_16x16x32_bf16 v[180:183], v[48:51], a[40:43], v[180:183]
    ds_read_b64_tr_b16 v[68:69], v59 offset:2048
    ds_read_b64_tr_b16 v[70:71], v59 offset:11264
    v_mfma_f32_16x16x32_bf16 v[100:103], v[52:55], a[40:43], v[100:103]
    v_add_u32 v10, 524288, v72
    v_mfma_f32_16x16x32_bf16 v[216:219], v[44:47], a[44:47], v[216:219]
    v_mfma_f32_16x16x32_bf16 v[184:187], v[48:51], a[44:47], v[184:187]
    v_mfma_f32_16x16x32_bf16 v[104:107], v[52:55], a[44:47], v[104:107]
    s_waitcnt lgkmcnt(0)
    v_mfma_f32_16x16x32_bf16 v[124:127], v[60:63], a[32:35], v[124:127]
    buffer_load_dwordx4 a[100:103], v6, s[8:11], s16 offen offset:256 sc1
    v_mfma_f32_16x16x32_bf16 v[156:159], v[64:67], a[32:35], v[156:159]
    v_add_u32 v56, 110592, v56
    v_mfma_f32_16x16x32_bf16 v[108:111], v[68:71], a[32:35], v[108:111]
    ds_read_b64_tr_b16 v[44:45], v56 offset:3072
    v_mfma_f32_16x16x32_bf16 v[128:131], v[60:63], a[36:39], v[128:131]
    ds_read_b64_tr_b16 v[46:47], v56 offset:12288
    v_mfma_f32_16x16x32_bf16 v[160:163], v[64:67], a[36:39], v[160:163]
    buffer_load_dwordx4 a[104:107], v6, s[8:11], s16 offen offset:512 sc1
    v_mfma_f32_16x16x32_bf16 v[112:115], v[68:71], a[36:39], v[112:115]
    ds_read_b64_tr_b16 v[48:49], v56 offset:4096
    ds_read_b64_tr_b16 v[50:51], v56 offset:13312
    v_mfma_f32_16x16x32_bf16 v[132:135], v[60:63], a[40:43], v[132:135]
    ds_read_b64_tr_b16 v[52:53], v56 offset:5120
    v_mfma_f32_16x16x32_bf16 v[164:167], v[64:67], a[40:43], v[164:167]
    ds_read_b64_tr_b16 v[54:55], v56 offset:14336
    v_mfma_f32_16x16x32_bf16 v[116:119], v[68:71], a[40:43], v[116:119]
    v_mfma_f32_16x16x32_bf16 v[136:139], v[60:63], a[44:47], v[136:139]
    buffer_load_dwordx4 a[108:111], v6, s[8:11], s16 offen offset:768 sc1
    v_mfma_f32_16x16x32_bf16 v[168:171], v[64:67], a[44:47], v[168:171]
    s_mov_b32 s16, 917504
    v_mfma_f32_16x16x32_bf16 v[120:123], v[68:71], a[44:47], v[120:123]
    s_waitcnt lgkmcnt(0)
    s_waitcnt vmcnt(18)
    v_mfma_f32_16x16x32_bf16 v[140:143], v[44:47], a[48:51], v[140:143]
    v_add_u32 v57, 110592, v57
    s_waitcnt vmcnt(14)
    v_mfma_f32_16x16x32_bf16 v[140:143], v[48:51], a[64:67], v[140:143]
    ds_read_b64_tr_b16 v[60:61], v57 offset:3072
    s_waitcnt vmcnt(7)
    v_mfma_f32_16x16x32_bf16 v[140:143], v[52:55], a[80:83], v[140:143]
    buffer_load_dwordx4 a[112:115], v6, s[8:11], s16 offen offset:0 sc1
    v_mfma_f32_16x16x32_bf16 v[144:147], v[44:47], a[52:55], v[144:147]
    ds_read_b64_tr_b16 v[62:63], v57 offset:12288
    v_mfma_f32_16x16x32_bf16 v[144:147], v[48:51], a[68:71], v[144:147]
    ds_read_b64_tr_b16 v[64:65], v57 offset:4096
    v_lshlrev_b32 v85, 16, v76
    s_waitcnt vmcnt(7)
    v_mfma_f32_16x16x32_bf16 v[144:147], v[52:55], a[84:87], v[144:147]
    ds_read_b64_tr_b16 v[66:67], v57 offset:13312
    v_and_b32 v76, 0xffff0000, v76
    v_mfma_f32_16x16x32_bf16 v[148:151], v[44:47], a[56:59], v[148:151]
    ds_read_b64_tr_b16 v[68:69], v57 offset:5120
    v_mul_f32 v89, v85, v85
    v_mfma_f32_16x16x32_bf16 v[148:151], v[48:51], a[72:75], v[148:151]
    ds_read_b64_tr_b16 v[70:71], v57 offset:14336
    v_mul_f32 v90, v76, v76
    s_waitcnt vmcnt(6)
    v_mfma_f32_16x16x32_bf16 v[148:151], v[52:55], a[88:91], v[148:151]
    buffer_load_dwordx4 a[116:119], v6, s[8:11], s16 offen offset:256 sc1
    v_mfma_f32_16x16x32_bf16 v[152:155], v[44:47], a[60:63], v[152:155]
    v_lshlrev_b32 v86, 16, v77
    v_and_b32 v77, 0xffff0000, v77
    v_mfma_f32_16x16x32_bf16 v[152:155], v[48:51], a[76:79], v[152:155]
    v_fma_f32 v89, v86, v86, v89
    v_fma_f32 v90, v77, v77, v90
    s_waitcnt vmcnt(6)
    v_mfma_f32_16x16x32_bf16 v[152:155], v[52:55], a[92:95], v[152:155]
    s_waitcnt lgkmcnt(0)
    v_lshlrev_b32 v85, 16, v78
    v_and_b32 v78, 0xffff0000, v78
    v_mfma_f32_16x16x32_bf16 v[188:191], v[60:63], a[48:51], v[188:191]
    v_add_u32 v58, 110592, v58
    v_fma_f32 v89, v85, v85, v89
    v_mfma_f32_16x16x32_bf16 v[188:191], v[64:67], a[64:67], v[188:191]
    buffer_load_dwordx4 a[120:123], v6, s[8:11], s16 offen offset:512 sc1
    v_mfma_f32_16x16x32_bf16 v[188:191], v[68:71], a[80:83], v[188:191]
    ds_read_b64_tr_b16 v[44:45], v58 offset:3072
    v_fma_f32 v90, v78, v78, v90
    v_mfma_f32_16x16x32_bf16 v[192:195], v[60:63], a[52:55], v[192:195]
    ds_read_b64_tr_b16 v[46:47], v58 offset:12288
    v_lshlrev_b32 v86, 16, v79
    v_mfma_f32_16x16x32_bf16 v[192:195], v[64:67], a[68:71], v[192:195]
    ds_read_b64_tr_b16 v[48:49], v58 offset:4096
    v_and_b32 v79, 0xffff0000, v79
    v_mfma_f32_16x16x32_bf16 v[192:195], v[68:71], a[84:87], v[192:195]
    ds_read_b64_tr_b16 v[50:51], v58 offset:13312
    v_fma_f32 v89, v86, v86, v89
    v_mfma_f32_16x16x32_bf16 v[196:199], v[60:63], a[56:59], v[196:199]
    buffer_load_dwordx4 a[124:127], v6, s[8:11], s16 offen offset:768 sc1
    v_mfma_f32_16x16x32_bf16 v[196:199], v[64:67], a[72:75], v[196:199]
    s_mov_b32 s16, 1048576
    ds_read_b64_tr_b16 v[52:53], v58 offset:5120
    ds_read_b64_tr_b16 v[54:55], v58 offset:14336
    v_mfma_f32_16x16x32_bf16 v[196:199], v[68:71], a[88:91], v[196:199]
    v_fma_f32 v90, v79, v79, v90
    v_lshlrev_b32 v85, 16, v80
    v_mfma_f32_16x16x32_bf16 v[200:203], v[60:63], a[60:63], v[200:203]
    v_and_b32 v80, 0xffff0000, v80
    v_fma_f32 v89, v85, v85, v89
    v_mfma_f32_16x16x32_bf16 v[200:203], v[64:67], a[76:79], v[200:203]
    v_fma_f32 v90, v80, v80, v90
    v_lshlrev_b32 v86, 16, v81
    v_mfma_f32_16x16x32_bf16 v[200:203], v[68:71], a[92:95], v[200:203]
    s_waitcnt lgkmcnt(0)
    v_and_b32 v81, 0xffff0000, v81
    v_fma_f32 v89, v86, v86, v89
    v_mfma_f32_16x16x32_bf16 v[204:207], v[44:47], a[48:51], v[204:207]
    buffer_load_dwordx4 a[128:131], v6, s[8:11], s16 offen offset:0 sc1
    v_mfma_f32_16x16x32_bf16 v[204:207], v[48:51], a[64:67], v[204:207]
    v_add_u32 v59, 110592, v59
    v_fma_f32 v90, v81, v81, v90
    v_mfma_f32_16x16x32_bf16 v[204:207], v[52:55], a[80:83], v[204:207]
    ds_read_b64_tr_b16 v[60:61], v59 offset:3072
    v_lshlrev_b32 v85, 16, v82
    v_mfma_f32_16x16x32_bf16 v[208:211], v[44:47], a[52:55], v[208:211]
    ds_read_b64_tr_b16 v[62:63], v59 offset:12288
    v_and_b32 v82, 0xffff0000, v82
    v_mfma_f32_16x16x32_bf16 v[208:211], v[48:51], a[68:71], v[208:211]
    buffer_load_dwordx4 a[132:135], v6, s[8:11], s16 offen offset:256 sc1
    v_mfma_f32_16x16x32_bf16 v[208:211], v[52:55], a[84:87], v[208:211]
    ds_read_b64_tr_b16 v[64:65], v59 offset:4096
    ds_read_b64_tr_b16 v[66:67], v59 offset:13312
    v_mfma_f32_16x16x32_bf16 v[212:215], v[44:47], a[56:59], v[212:215]
    ds_read_b64_tr_b16 v[68:69], v59 offset:5120
    v_fma_f32 v89, v85, v85, v89
    v_mfma_f32_16x16x32_bf16 v[212:215], v[48:51], a[72:75], v[212:215]
    ds_read_b64_tr_b16 v[70:71], v59 offset:14336
    v_fma_f32 v90, v82, v82, v90
    v_mfma_f32_16x16x32_bf16 v[212:215], v[52:55], a[88:91], v[212:215]
    v_lshlrev_b32 v86, 16, v83
    v_and_b32 v83, 0xffff0000, v83
    v_mfma_f32_16x16x32_bf16 v[216:219], v[44:47], a[60:63], v[216:219]
    v_fma_f32 v89, v86, v86, v89
    v_fma_f32 v90, v83, v83, v90
    v_mfma_f32_16x16x32_bf16 v[216:219], v[48:51], a[76:79], v[216:219]
    buffer_load_dwordx4 a[136:139], v6, s[8:11], s16 offen offset:512 sc1
    v_mfma_f32_16x16x32_bf16 v[216:219], v[52:55], a[92:95], v[216:219]
    s_waitcnt lgkmcnt(0)
    v_lshlrev_b32 v85, 16, v84
    v_and_b32 v84, 0xffff0000, v84
    v_mfma_f32_16x16x32_bf16 v[172:175], v[60:63], a[48:51], v[172:175]
    v_add_u32 v56, 4294856704, v56
    v_fma_f32 v89, v85, v85, v89
    v_mfma_f32_16x16x32_bf16 v[172:175], v[64:67], a[64:67], v[172:175]
    ds_read_b64_tr_b16 v[44:45], v56 offset:3072
    v_fma_f32 v90, v84, v84, v90
    v_mfma_f32_16x16x32_bf16 v[172:175], v[68:71], a[80:83], v[172:175]
    ds_read_b64_tr_b16 v[46:47], v56 offset:12288
    v_add_f32 v89, v89, v90
    v_mfma_f32_16x16x32_bf16 v[176:179], v[60:63], a[52:55], v[176:179]
    buffer_load_dwordx4 a[140:143], v6, s[8:11], s16 offen offset:768 sc1
    v_mfma_f32_16x16x32_bf16 v[176:179], v[64:67], a[68:71], v[176:179]
    s_mov_b32 s16, 1179648
    ds_read_b64_tr_b16 v[48:49], v56 offset:4096
    v_add_f32_dpp v89, v89, v89 row_ror:8 row_mask:0xf bank_mask:0xf
    v_mfma_f32_16x16x32_bf16 v[176:179], v[68:71], a[84:87], v[176:179]
    ds_read_b64_tr_b16 v[50:51], v56 offset:13312
    v_mov_b32 v90, v89
    v_mfma_f32_16x16x32_bf16 v[180:183], v[60:63], a[56:59], v[180:183]
    ds_read_b64_tr_b16 v[52:53], v56 offset:5120
    v_mfma_f32_16x16x32_bf16 v[180:183], v[64:67], a[72:75], v[180:183]
    ds_read_b64_tr_b16 v[54:55], v56 offset:14336
    v_permlane16_swap_b32 v90, v89
    v_mfma_f32_16x16x32_bf16 v[180:183], v[68:71], a[88:91], v[180:183]
    buffer_load_dwordx4 a[144:147], v6, s[8:11], s16 offen offset:0 sc1
    v_mfma_f32_16x16x32_bf16 v[184:187], v[60:63], a[60:63], v[184:187]
    v_add_f32 v89, v89, v90
    v_mfma_f32_16x16x32_bf16 v[184:187], v[64:67], a[76:79], v[184:187]
    v_mov_b32 v90, v89
    v_mfma_f32_16x16x32_bf16 v[184:187], v[68:71], a[92:95], v[184:187]
    s_waitcnt lgkmcnt(0)
    v_mfma_f32_16x16x32_bf16 v[92:95], v[44:47], a[48:51], v[92:95]
    v_add_u32 v57, 4294856704, v57
    v_permlane32_swap_b32 v90, v89
    v_mfma_f32_16x16x32_bf16 v[92:95], v[48:51], a[64:67], v[92:95]
    buffer_load_dwordx4 a[148:151], v6, s[8:11], s16 offen offset:256 sc1
    v_mfma_f32_16x16x32_bf16 v[92:95], v[52:55], a[80:83], v[92:95]
    ds_read_b64_tr_b16 v[60:61], v57 offset:3072
    v_add_f32 v89, v89, v90
    v_mfma_f32_16x16x32_bf16 v[96:99], v[44:47], a[52:55], v[96:99]
    ds_read_b64_tr_b16 v[62:63], v57 offset:12288
    v_or_b32 v89, 1, v89
    v_mfma_f32_16x16x32_bf16 v[96:99], v[48:51], a[68:71], v[96:99]
    ds_read_b64_tr_b16 v[64:65], v57 offset:4096
    v_mfma_f32_16x16x32_bf16 v[96:99], v[52:55], a[84:87], v[96:99]
    ds_read_b64_tr_b16 v[66:67], v57 offset:13312
    v_mfma_f32_16x16x32_bf16 v[100:103], v[44:47], a[56:59], v[100:103]
    buffer_store_dword v89, v87, s[8:11], 0 offen sc1
    v_mfma_f32_16x16x32_bf16 v[100:103], v[48:51], a[72:75], v[100:103]
    buffer_load_dwordx4 a[152:155], v6, s[8:11], s16 offen offset:512 sc1
    v_mfma_f32_16x16x32_bf16 v[100:103], v[52:55], a[88:91], v[100:103]
    ds_read_b64_tr_b16 v[68:69], v57 offset:5120
    ds_read_b64_tr_b16 v[70:71], v57 offset:14336
    v_mfma_f32_16x16x32_bf16 v[104:107], v[44:47], a[60:63], v[104:107]
    v_mfma_f32_16x16x32_bf16 v[104:107], v[48:51], a[76:79], v[104:107]
    v_mfma_f32_16x16x32_bf16 v[104:107], v[52:55], a[92:95], v[104:107]
    s_waitcnt lgkmcnt(0)
    v_mfma_f32_16x16x32_bf16 v[124:127], v[60:63], a[48:51], v[124:127]
    v_add_u32 v58, 4294856704, v58
    v_mfma_f32_16x16x32_bf16 v[124:127], v[64:67], a[64:67], v[124:127]
    buffer_load_dwordx4 a[156:159], v6, s[8:11], s16 offen offset:768 sc1
    v_mfma_f32_16x16x32_bf16 v[124:127], v[68:71], a[80:83], v[124:127]
    s_mov_b32 s16, 1310720
    ds_read_b64_tr_b16 v[44:45], v58 offset:3072
    v_mfma_f32_16x16x32_bf16 v[128:131], v[60:63], a[52:55], v[128:131]
    ds_read_b64_tr_b16 v[46:47], v58 offset:12288
    v_mfma_f32_16x16x32_bf16 v[128:131], v[64:67], a[68:71], v[128:131]
    ds_read_b64_tr_b16 v[48:49], v58 offset:4096
    v_mfma_f32_16x16x32_bf16 v[128:131], v[68:71], a[84:87], v[128:131]
    ds_read_b64_tr_b16 v[50:51], v58 offset:13312
    v_mfma_f32_16x16x32_bf16 v[132:135], v[60:63], a[56:59], v[132:135]
    buffer_load_dwordx4 a[160:163], v6, s[8:11], s16 offen offset:0 sc1
    v_mfma_f32_16x16x32_bf16 v[132:135], v[64:67], a[72:75], v[132:135]
    ds_read_b64_tr_b16 v[52:53], v58 offset:5120
    ds_read_b64_tr_b16 v[54:55], v58 offset:14336
    v_mfma_f32_16x16x32_bf16 v[132:135], v[68:71], a[88:91], v[132:135]
    v_mfma_f32_16x16x32_bf16 v[136:139], v[60:63], a[60:63], v[136:139]
    v_mfma_f32_16x16x32_bf16 v[136:139], v[64:67], a[76:79], v[136:139]
    v_mfma_f32_16x16x32_bf16 v[136:139], v[68:71], a[92:95], v[136:139]
    s_waitcnt lgkmcnt(0)
    v_mfma_f32_16x16x32_bf16 v[156:159], v[44:47], a[48:51], v[156:159]
    buffer_load_dwordx4 a[164:167], v6, s[8:11], s16 offen offset:256 sc1
    v_mfma_f32_16x16x32_bf16 v[156:159], v[48:51], a[64:67], v[156:159]
    v_add_u32 v59, 4294856704, v59
    v_mfma_f32_16x16x32_bf16 v[156:159], v[52:55], a[80:83], v[156:159]
    ds_read_b64_tr_b16 v[60:61], v59 offset:3072
    v_mfma_f32_16x16x32_bf16 v[160:163], v[44:47], a[52:55], v[160:163]
L_pad_c3_0:
    s_cbranch_execz L_pad_c3_4
    ds_read_b64_tr_b16 v[62:63], v59 offset:12288
    v_mfma_f32_16x16x32_bf16 v[160:163], v[48:51], a[68:71], v[160:163]
    buffer_load_dwordx4 a[168:171], v6, s[8:11], s16 offen offset:512 sc1
    v_mfma_f32_16x16x32_bf16 v[160:163], v[52:55], a[84:87], v[160:163]
    ds_read_b64_tr_b16 v[64:65], v59 offset:4096
    ds_read_b64_tr_b16 v[66:67], v59 offset:13312
    v_mfma_f32_16x16x32_bf16 v[164:167], v[44:47], a[56:59], v[164:167]
    ds_read_b64_tr_b16 v[68:69], v59 offset:5120
    v_mfma_f32_16x16x32_bf16 v[164:167], v[48:51], a[72:75], v[164:167]
    ds_read_b64_tr_b16 v[70:71], v59 offset:14336
    v_mfma_f32_16x16x32_bf16 v[164:167], v[52:55], a[88:91], v[164:167]
    v_mfma_f32_16x16x32_bf16 v[168:171], v[44:47], a[60:63], v[168:171]
    buffer_load_dwordx4 a[172:175], v6, s[8:11], s16 offen offset:768 sc1
    v_mfma_f32_16x16x32_bf16 v[168:171], v[48:51], a[76:79], v[168:171]
    s_mov_b32 s16, 1441792
    v_mfma_f32_16x16x32_bf16 v[168:171], v[52:55], a[92:95], v[168:171]
    s_waitcnt lgkmcnt(0)
    v_mfma_f32_16x16x32_bf16 v[108:111], v[60:63], a[48:51], v[108:111]
    v_add_u32 v56, 110592, v56
    v_mfma_f32_16x16x32_bf16 v[108:111], v[64:67], a[64:67], v[108:111]
    ds_read_b64_tr_b16 v[44:45], v56 offset:6144
    v_mfma_f32_16x16x32_bf16 v[108:111], v[68:71], a[80:83], v[108:111]
    ds_read_b64_tr_b16 v[46:47], v56 offset:15360
    v_mfma_f32_16x16x32_bf16 v[112:115], v[60:63], a[52:55], v[112:115]
    buffer_load_dwordx4 a[176:179], v6, s[8:11], s16 offen offset:0 sc1
    v_mfma_f32_16x16x32_bf16 v[112:115], v[64:67], a[68:71], v[112:115]
    ds_read_b64_tr_b16 v[48:49], v56 offset:7168
    v_mfma_f32_16x16x32_bf16 v[112:115], v[68:71], a[84:87], v[112:115]
    ds_read_b64_tr_b16 v[50:51], v56 offset:16384
    v_mfma_f32_16x16x32_bf16 v[116:119], v[60:63], a[56:59], v[116:119]
    ds_read_b64_tr_b16 v[52:53], v56 offset:8192
    v_mfma_f32_16x16x32_bf16 v[116:119], v[64:67], a[72:75], v[116:119]
    ds_read_b64_tr_b16 v[54:55], v56 offset:17408
    v_mfma_f32_16x16x32_bf16 v[116:119], v[68:71], a[88:91], v[116:119]
    buffer_load_dwordx4 a[180:183], v6, s[8:11], s16 offen offset:256 sc1
    v_mfma_f32_16x16x32_bf16 v[120:123], v[60:63], a[60:63], v[120:123]
    v_mfma_f32_16x16x32_bf16 v[120:123], v[64:67], a[76:79], v[120:123]
    v_mfma_f32_16x16x32_bf16 v[120:123], v[68:71], a[92:95], v[120:123]
    s_waitcnt lgkmcnt(0)
    s_waitcnt vmcnt(22)
    v_mfma_f32_16x16x32_bf16 v[140:143], v[44:47], a[96:99], v[140:143]
    v_add_u32 v57, 110592, v57
    s_waitcnt vmcnt(18)
    v_mfma_f32_16x16x32_bf16 v[140:143], v[48:51], a[112:115], v[140:143]
    buffer_load_dwordx4 a[184:187], v6, s[8:11], s16 offen offset:512 sc1
    s_waitcnt vmcnt(15)
    v_mfma_f32_16x16x32_bf16 v[140:143], v[52:55], a[128:131], v[140:143]
    ds_read_b64_tr_b16 v[60:61], v57 offset:6144
    v_mfma_f32_16x16x32_bf16 v[144:147], v[44:47], a[100:103], v[144:147]
    ds_read_b64_tr_b16 v[62:63], v57 offset:15360
    v_mfma_f32_16x16x32_bf16 v[144:147], v[48:51], a[116:119], v[144:147]
    ds_read_b64_tr_b16 v[64:65], v57 offset:7168
    s_waitcnt vmcnt(14)
    v_mfma_f32_16x16x32_bf16 v[144:147], v[52:55], a[132:135], v[144:147]
    ds_read_b64_tr_b16 v[66:67], v57 offset:16384
    v_mfma_f32_16x16x32_bf16 v[148:151], v[44:47], a[104:107], v[148:151]
    buffer_load_dwordx4 a[188:191], v6, s[8:11], s16 offen offset:768 sc1
    v_mfma_f32_16x16x32_bf16 v[148:151], v[48:51], a[120:123], v[148:151]
    s_mov_b32 s16, 1572864
    ds_read_b64_tr_b16 v[68:69], v57 offset:8192
    ds_read_b64_tr_b16 v[70:71], v57 offset:17408
    s_waitcnt vmcnt(14)
    v_mfma_f32_16x16x32_bf16 v[148:151], v[52:55], a[136:139], v[148:151]
    v_mfma_f32_16x16x32_bf16 v[152:155], v[44:47], a[108:111], v[152:155]
    v_mfma_f32_16x16x32_bf16 v[152:155], v[48:51], a[124:127], v[152:155]
    s_waitcnt vmcnt(13)
    v_mfma_f32_16x16x32_bf16 v[152:155], v[52:55], a[140:143], v[152:155]
    s_waitcnt lgkmcnt(0)
    v_mfma_f32_16x16x32_bf16 v[188:191], v[60:63], a[96:99], v[188:191]
    buffer_load_dwordx4 a[192:195], v6, s[8:11], s16 offen offset:0 sc1
    v_mfma_f32_16x16x32_bf16 v[188:191], v[64:67], a[112:115], v[188:191]
    v_add_u32 v58, 110592, v58
    v_mfma_f32_16x16x32_bf16 v[188:191], v[68:71], a[128:131], v[188:191]
    ds_read_b64_tr_b16 v[44:45], v58 offset:6144
    v_mfma_f32_16x16x32_bf16 v[192:195], v[60:63], a[100:103], v[192:195]
    ds_read_b64_tr_b16 v[46:47], v58 offset:15360
    v_mfma_f32_16x16x32_bf16 v[192:195], v[64:67], a[116:119], v[192:195]
    ds_read_b64_tr_b16 v[48:49], v58 offset:7168
    v_mfma_f32_16x16x32_bf16 v[192:195], v[68:71], a[132:135], v[192:195]
    buffer_load_dwordx4 a[196:199], v6, s[8:11], s16 offen offset:256 sc1
    v_mfma_f32_16x16x32_bf16 v[196:199], v[60:63], a[104:107], v[196:199]
    ds_read_b64_tr_b16 v[50:51], v58 offset:16384
    ds_read_b64_tr_b16 v[52:53], v58 offset:8192
    v_mfma_f32_16x16x32_bf16 v[196:199], v[64:67], a[120:123], v[196:199]
    ds_read_b64_tr_b16 v[54:55], v58 offset:17408
    v_mfma_f32_16x16x32_bf16 v[196:199], v[68:71], a[136:139], v[196:199]
    v_mfma_f32_16x16x32_bf16 v[200:203], v[60:63], a[108:111], v[200:203]
    v_mfma_f32_16x16x32_bf16 v[200:203], v[64:67], a[124:127], v[200:203]
    buffer_load_dwordx4 a[200:203], v6, s[8:11], s16 offen offset:512 sc1
    v_mfma_f32_16x16x32_bf16 v[200:203], v[68:71], a[140:143], v[200:203]
    s_waitcnt lgkmcnt(0)
    v_mfma_f32_16x16x32_bf16 v[204:207], v[44:47], a[96:99], v[204:207]
    v_add_u32 v59, 110592, v59
    v_mfma_f32_16x16x32_bf16 v[204:207], v[48:51], a[112:115], v[204:207]
    ds_read_b64_tr_b16 v[60:61], v59 offset:6144
    v_mfma_f32_16x16x32_bf16 v[204:207], v[52:55], a[128:131], v[204:207]
    ds_read_b64_tr_b16 v[62:63], v59 offset:15360
    v_mfma_f32_16x16x32_bf16 v[208:211], v[44:47], a[100:103], v[208:211]
    buffer_load_dwordx4 a[204:207], v6, s[8:11], s16 offen offset:768 sc1
    v_mfma_f32_16x16x32_bf16 v[208:211], v[48:51], a[116:119], v[208:211]
    s_mov_b32 s16, 1703936
    ds_read_b64_tr_b16 v[64:65], v59 offset:7168
    v_mfma_f32_16x16x32_bf16 v[208:211], v[52:55], a[132:135], v[208:211]
    ds_read_b64_tr_b16 v[66:67], v59 offset:16384
    v_mfma_f32_16x16x32_bf16 v[212:215], v[44:47], a[104:107], v[212:215]
    ds_read_b64_tr_b16 v[68:69], v59 offset:8192
    v_mfma_f32_16x16x32_bf16 v[212:215], v[48:51], a[120:123], v[212:215]
    ds_read_b64_tr_b16 v[70:71], v59 offset:17408
    v_mfma_f32_16x16x32_bf16 v[212:215], v[52:55], a[136:139], v[212:215]
    buffer_load_dwordx4 a[208:211], v6, s[8:11], s16 offen offset:0 sc1
    v_mfma_f32_16x16x32_bf16 v[216:219], v[44:47], a[108:111], v[216:219]
    v_mfma_f32_16x16x32_bf16 v[216:219], v[48:51], a[124:127], v[216:219]
    v_mfma_f32_16x16x32_bf16 v[216:219], v[52:55], a[140:143], v[216:219]
    s_waitcnt lgkmcnt(0)
    v_mfma_f32_16x16x32_bf16 v[172:175], v[60:63], a[96:99], v[172:175]
    v_add_u32 v56, 4294856704, v56
    v_mfma_f32_16x16x32_bf16 v[172:175], v[64:67], a[112:115], v[172:175]
    buffer_load_dwordx4 a[212:215], v6, s[8:11], s16 offen offset:256 sc1
    v_mfma_f32_16x16x32_bf16 v[172:175], v[68:71], a[128:131], v[172:175]
    ds_read_b64_tr_b16 v[44:45], v56 offset:6144
    v_mfma_f32_16x16x32_bf16 v[176:179], v[60:63], a[100:103], v[176:179]
    ds_read_b64_tr_b16 v[46:47], v56 offset:15360
    v_mfma_f32_16x16x32_bf16 v[176:179], v[64:67], a[116:119], v[176:179]
    ds_read_b64_tr_b16 v[48:49], v56 offset:7168
    v_mfma_f32_16x16x32_bf16 v[176:179], v[68:71], a[132:135], v[176:179]
    ds_read_b64_tr_b16 v[50:51], v56 offset:16384
    v_mfma_f32_16x16x32_bf16 v[180:183], v[60:63], a[104:107], v[180:183]
    ds_read_b64_tr_b16 v[52:53], v56 offset:8192
    v_mfma_f32_16x16x32_bf16 v[180:183], v[64:67], a[120:123], v[180:183]
    buffer_load_dwordx4 a[216:219], v6, s[8:11], s16 offen offset:512 sc1
    v_mfma_f32_16x16x32_bf16 v[180:183], v[68:71], a[136:139], v[180:183]
    ds_read_b64_tr_b16 v[54:55], v56 offset:17408
    v_mfma_f32_16x16x32_bf16 v[184:187], v[60:63], a[108:111], v[184:187]
    v_mfma_f32_16x16x32_bf16 v[184:187], v[64:67], a[124:127], v[184:187]
    v_mfma_f32_16x16x32_bf16 v[184:187], v[68:71], a[140:143], v[184:187]
    s_waitcnt lgkmcnt(0)
    v_mfma_f32_16x16x32_bf16 v[92:95], v[44:47], a[96:99], v[92:95]
    buffer_load_dwordx4 a[220:223], v6, s[8:11], s16 offen offset:768 sc1
    v_mfma_f32_16x16x32_bf16 v[92:95], v[48:51], a[112:115], v[92:95]
    s_mov_b32 s16, 1835008
    v_add_u32 v57, 4294856704, v57
    v_mfma_f32_16x16x32_bf16 v[92:95], v[52:55], a[128:131], v[92:95]
    ds_read_b64_tr_b16 v[60:61], v57 offset:6144
    v_mfma_f32_16x16x32_bf16 v[96:99], v[44:47], a[100:103], v[96:99]
    ds_read_b64_tr_b16 v[62:63], v57 offset:15360
    v_mfma_f32_16x16x32_bf16 v[96:99], v[48:51], a[116:119], v[96:99]
    ds_read_b64_tr_b16 v[64:65], v57 offset:7168
    v_mfma_f32_16x16x32_bf16 v[96:99], v[52:55], a[132:135], v[96:99]
    buffer_load_dwordx4 a[224:227], v6, s[8:11], s16 offen offset:0 sc1
    v_mfma_f32_16x16x32_bf16 v[100:103], v[44:47], a[104:107], v[100:103]
    ds_read_b64_tr_b16 v[66:67], v57 offset:16384
    ds_read_b64_tr_b16 v[68:69], v57 offset:8192
    v_mfma_f32_16x16x32_bf16 v[100:103], v[48:51], a[120:123], v[100:103]
    ds_read_b64_tr_b16 v[70:71], v57 offset:17408
    v_mfma_f32_16x16x32_bf16 v[100:103], v[52:55], a[136:139], v[100:103]
    v_mfma_f32_16x16x32_bf16 v[104:107], v[44:47], a[108:111], v[104:107]
    v_mfma_f32_16x16x32_bf16 v[104:107], v[48:51], a[124:127], v[104:107]
    buffer_load_dwordx4 a[228:231], v6, s[8:11], s16 offen offset:256 sc1
    v_mfma_f32_16x16x32_bf16 v[104:107], v[52:55], a[140:143], v[104:107]
    s_waitcnt lgkmcnt(0)
    v_mfma_f32_16x16x32_bf16 v[124:127], v[60:63], a[96:99], v[124:127]
    v_add_u32 v58, 4294856704, v58
    v_mfma_f32_16x16x32_bf16 v[124:127], v[64:67], a[112:115], v[124:127]
    ds_read_b64_tr_b16 v[44:45], v58 offset:6144
    v_mfma_f32_16x16x32_bf16 v[124:127], v[68:71], a[128:131], v[124:127]
    ds_read_b64_tr_b16 v[46:47], v58 offset:15360
    v_mfma_f32_16x16x32_bf16 v[128:131], v[60:63], a[100:103], v[128:131]
    buffer_load_dwordx4 a[232:235], v6, s[8:11], s16 offen offset:512 sc1
    v_mfma_f32_16x16x32_bf16 v[128:131], v[64:67], a[116:119], v[128:131]
    ds_read_b64_tr_b16 v[48:49], v58 offset:7168
    v_mfma_f32_16x16x32_bf16 v[128:131], v[68:71], a[132:135], v[128:131]
    ds_read_b64_tr_b16 v[50:51], v58 offset:16384
    v_mfma_f32_16x16x32_bf16 v[132:135], v[60:63], a[104:107], v[132:135]
    ds_read_b64_tr_b16 v[52:53], v58 offset:8192
    v_mfma_f32_16x16x32_bf16 v[132:135], v[64:67], a[120:123], v[132:135]
    ds_read_b64_tr_b16 v[54:55], v58 offset:17408
    v_mfma_f32_16x16x32_bf16 v[132:135], v[68:71], a[136:139], v[132:135]
    v_mfma_f32_16x16x32_bf16 v[136:139], v[60:63], a[108:111], v[136:139]
    buffer_load_dword v16, v88, s[8:11], 0 offen offset:0 sc1
    v_mfma_f32_16x16x32_bf16 v[136:139], v[64:67], a[124:127], v[136:139]
    buffer_load_dword v17, v88, s[8:11], 0 offen offset:512 sc1
    v_mfma_f32_16x16x32_bf16 v[136:139], v[68:71], a[140:143], v[136:139]
    s_waitcnt lgkmcnt(0)
    v_mfma_f32_16x16x32_bf16 v[156:159], v[44:47], a[96:99], v[156:159]
    buffer_load_dword v18, v88, s[8:11], 0 offen offset:1024 sc1
    v_mfma_f32_16x16x32_bf16 v[156:159], v[48:51], a[112:115], v[156:159]
    buffer_load_dword v19, v88, s[8:11], 0 offen offset:1536 sc1
    v_mfma_f32_16x16x32_bf16 v[156:159], v[52:55], a[128:131], v[156:159]
    buffer_load_dwordx4 a[236:239], v6, s[8:11], s16 offen offset:768 sc1
    v_mfma_f32_16x16x32_bf16 v[160:163], v[44:47], a[100:103], v[160:163]
    s_mov_b32 s16, 1966080
    v_add_u32 v59, 4294856704, v59
    ds_read_b64_tr_b16 v[60:61], v59 offset:6144
    v_mfma_f32_16x16x32_bf16 v[160:163], v[48:51], a[116:119], v[160:163]
    ds_read_b64_tr_b16 v[62:63], v59 offset:15360
    ds_read_b64_tr_b16 v[64:65], v59 offset:7168
    v_mfma_f32_16x16x32_bf16 v[160:163], v[52:55], a[132:135], v[160:163]
    ds_read_b64_tr_b16 v[66:67], v59 offset:16384
    v_mfma_f32_16x16x32_bf16 v[164:167], v[44:47], a[104:107], v[164:167]
    buffer_load_dwordx4 a[240:243], v6, s[8:11], s16 offen offset:0 sc1
    v_mfma_f32_16x16x32_bf16 v[164:167], v[48:51], a[120:123], v[164:167]
    ds_read_b64_tr_b16 v[68:69], v59 offset:8192
    ds_read_b64_tr_b16 v[70:71], v59 offset:17408
    v_mfma_f32_16x16x32_bf16 v[164:167], v[52:55], a[136:139], v[164:167]
    v_mfma_f32_16x16x32_bf16 v[168:171], v[44:47], a[108:111], v[168:171]
    v_mfma_f32_16x16x32_bf16 v[168:171], v[48:51], a[124:127], v[168:171]
    v_mfma_f32_16x16x32_bf16 v[168:171], v[52:55], a[140:143], v[168:171]
    s_waitcnt lgkmcnt(0)
    v_mfma_f32_16x16x32_bf16 v[108:111], v[60:63], a[96:99], v[108:111]
    s_barrier
    ds_read_b64_tr_b16 v[44:45], v56 offset:36864
    v_mfma_f32_16x16x32_bf16 v[108:111], v[64:67], a[112:115], v[108:111]
    buffer_load_dwordx4 a[244:247], v6, s[8:11], s16 offen offset:256 sc1
    v_mfma_f32_16x16x32_bf16 v[108:111], v[68:71], a[128:131], v[108:111]
    s_add_u32 m0, s12, 110592
    ds_read_b64_tr_b16 v[46:47], v56 offset:46080
    v_mfma_f32_16x16x32_bf16 v[112:115], v[60:63], a[100:103], v[112:115]
    s_mov_b64 s[40:41], s[48:49]
    ds_read_b64_tr_b16 v[48:49], v56 offset:37888
    v_mfma_f32_16x16x32_bf16 v[112:115], v[64:67], a[116:119], v[112:115]
    s_add_u32 s15, s18, 4096
    ds_read_b64_tr_b16 v[50:51], v56 offset:47104
    v_mfma_f32_16x16x32_bf16 v[112:115], v[68:71], a[132:135], v[112:115]
    buffer_load_dwordx4 a[248:251], v6, s[8:11], s16 offen offset:512 sc1
    v_mfma_f32_16x16x32_bf16 v[116:119], v[60:63], a[104:107], v[116:119]
    ds_read_b64_tr_b16 v[52:53], v56 offset:38912
    v_mfma_f32_16x16x32_bf16 v[116:119], v[64:67], a[120:123], v[116:119]
    ds_read_b64_tr_b16 v[54:55], v56 offset:48128
    v_mfma_f32_16x16x32_bf16 v[116:119], v[68:71], a[136:139], v[116:119]
    v_mfma_f32_16x16x32_bf16 v[120:123], v[60:63], a[108:111], v[120:123]
    v_mfma_f32_16x16x32_bf16 v[120:123], v[64:67], a[124:127], v[120:123]
    buffer_load_dwordx4 a[252:255], v6, s[8:11], s16 offen offset:768 sc1
    v_mfma_f32_16x16x32_bf16 v[120:123], v[68:71], a[140:143], v[120:123]
    s_waitcnt lgkmcnt(0)
    s_waitcnt vmcnt(32)
    v_mfma_f32_16x16x32_bf16 v[140:143], v[44:47], a[144:147], v[140:143]
    s_mov_b32 s16, 2097152
    ds_read_b64_tr_b16 v[60:61], v57 offset:36864
    s_waitcnt vmcnt(27)
    v_mfma_f32_16x16x32_bf16 v[140:143], v[48:51], a[160:163], v[140:143]
    ds_read_b64_tr_b16 v[62:63], v57 offset:46080
    s_waitcnt vmcnt(23)
    v_mfma_f32_16x16x32_bf16 v[140:143], v[52:55], a[176:179], v[140:143]
    ds_read_b64_tr_b16 v[64:65], v57 offset:37888
    v_mfma_f32_16x16x32_bf16 v[144:147], v[44:47], a[148:151], v[144:147]
    buffer_load_dwordx4 v[220:223], v6, s[8:11], s16 offen offset:0 sc1
    v_mfma_f32_16x16x32_bf16 v[144:147], v[48:51], a[164:167], v[144:147]
    ds_read_b64_tr_b16 v[66:67], v57 offset:47104
    s_waitcnt vmcnt(23)
    v_mfma_f32_16x16x32_bf16 v[144:147], v[52:55], a[180:183], v[144:147]
    ds_read_b64_tr_b16 v[68:69], v57 offset:38912
    v_mfma_f32_16x16x32_bf16 v[148:151], v[44:47], a[152:155], v[148:151]
    ds_read_b64_tr_b16 v[70:71], v57 offset:48128
    v_mfma_f32_16x16x32_bf16 v[148:151], v[48:51], a[168:171], v[148:151]
    s_waitcnt vmcnt(22)
    v_mfma_f32_16x16x32_bf16 v[148:151], v[52:55], a[184:187], v[148:151]
    buffer_load_dwordx4 v[224:227], v6, s[8:11], s16 offen offset:256 sc1
    v_mfma_f32_16x16x32_bf16 v[152:155], v[44:47], a[156:159], v[152:155]
    v_mfma_f32_16x16x32_bf16 v[152:155], v[48:51], a[172:175], v[152:155]
    s_waitcnt vmcnt(22)
    v_mfma_f32_16x16x32_bf16 v[152:155], v[52:55], a[188:191], v[152:155]
    s_waitcnt lgkmcnt(0)
    v_mfma_f32_16x16x32_bf16 v[188:191], v[60:63], a[144:147], v[188:191]
    ds_read_b64_tr_b16 v[44:45], v58 offset:36864
    v_mfma_f32_16x16x32_bf16 v[188:191], v[64:67], a[160:163], v[188:191]
    ds_read_b64_tr_b16 v[46:47], v58 offset:46080
    v_mfma_f32_16x16x32_bf16 v[188:191], v[68:71], a[176:179], v[188:191]
    buffer_load_dwordx4 v[228:231], v6, s[8:11], s16 offen offset:512 sc1
    v_mfma_f32_16x16x32_bf16 v[192:195], v[60:63], a[148:151], v[192:195]
    ds_read_b64_tr_b16 v[48:49], v58 offset:37888
    v_mfma_f32_16x16x32_bf16 v[192:195], v[64:67], a[164:167], v[192:195]
    ds_read_b64_tr_b16 v[50:51], v58 offset:47104
    v_mfma_f32_16x16x32_bf16 v[192:195], v[68:71], a[180:183], v[192:195]
    ds_read_b64_tr_b16 v[52:53], v58 offset:38912
    v_mfma_f32_16x16x32_bf16 v[196:199], v[60:63], a[152:155], v[196:199]
    ds_read_b64_tr_b16 v[54:55], v58 offset:48128
    v_mfma_f32_16x16x32_bf16 v[196:199], v[64:67], a[168:171], v[196:199]
    buffer_load_dwordx4 v[232:235], v6, s[8:11], s16 offen offset:768 sc1
    v_mfma_f32_16x16x32_bf16 v[196:199], v[68:71], a[184:187], v[196:199]
    s_mov_b32 s16, 2228224
    v_mfma_f32_16x16x32_bf16 v[200:203], v[60:63], a[156:159], v[200:203]
    v_mfma_f32_16x16x32_bf16 v[200:203], v[64:67], a[172:175], v[200:203]
    v_mfma_f32_16x16x32_bf16 v[200:203], v[68:71], a[188:191], v[200:203]
    s_waitcnt lgkmcnt(0)
    v_mfma_f32_16x16x32_bf16 v[204:207], v[44:47], a[144:147], v[204:207]
    buffer_load_dwordx4 v[236:239], v6, s[8:11], s16 offen offset:0 sc1
    v_mfma_f32_16x16x32_bf16 v[204:207], v[48:51], a[160:163], v[204:207]
    ds_read_b64_tr_b16 v[60:61], v59 offset:36864
    v_mfma_f32_16x16x32_bf16 v[204:207], v[52:55], a[176:179], v[204:207]
    ds_read_b64_tr_b16 v[62:63], v59 offset:46080
    v_mfma_f32_16x16x32_bf16 v[208:211], v[44:47], a[148:151], v[208:211]
    ds_read_b64_tr_b16 v[64:65], v59 offset:37888
    v_mfma_f32_16x16x32_bf16 v[208:211], v[48:51], a[164:167], v[208:211]
    ds_read_b64_tr_b16 v[66:67], v59 offset:47104
    v_mfma_f32_16x16x32_bf16 v[208:211], v[52:55], a[180:183], v[208:211]
    buffer_load_dwordx4 v[240:243], v6, s[8:11], s16 offen offset:256 sc1
    v_mfma_f32_16x16x32_bf16 v[212:215], v[44:47], a[152:155], v[212:215]
    ds_read_b64_tr_b16 v[68:69], v59 offset:38912
    v_mfma_f32_16x16x32_bf16 v[212:215], v[48:51], a[168:171], v[212:215]
    ds_read_b64_tr_b16 v[70:71], v59 offset:48128
    v_mfma_f32_16x16x32_bf16 v[212:215], v[52:55], a[184:187], v[212:215]
    v_mfma_f32_16x16x32_bf16 v[216:219], v[44:47], a[156:159], v[216:219]
    v_mfma_f32_16x16x32_bf16 v[216:219], v[48:51], a[172:175], v[216:219]
    buffer_load_dwordx4 v[244:247], v6, s[8:11], s16 offen offset:512 sc1
    v_mfma_f32_16x16x32_bf16 v[216:219], v[52:55], a[188:191], v[216:219]
    s_waitcnt lgkmcnt(0)
    v_mfma_f32_16x16x32_bf16 v[172:175], v[60:63], a[144:147], v[172:175]
    ds_read_b64_tr_b16 v[44:45], v56 offset:39936
    v_mfma_f32_16x16x32_bf16 v[172:175], v[64:67], a[160:163], v[172:175]
    s_waitcnt vmcnt(12)
    ds_read_b64_tr_b16 v[46:47], v56 offset:49152
    v_min3_u32 v91, v16, v17, v18
    v_mfma_f32_16x16x32_bf16 v[172:175], v[68:71], a[176:179], v[172:175]
    ds_read_b64_tr_b16 v[48:49], v56 offset:40960
    v_min_u32 v91, v91, v19
    v_mfma_f32_16x16x32_bf16 v[176:179], v[60:63], a[148:151], v[176:179]
    ds_read_b64_tr_b16 v[50:51], v56 offset:50176
    v_cmp_eq_u32 s[46:47], 0, v91
    v_mfma_f32_16x16x32_bf16 v[176:179], v[64:67], a[164:167], v[176:179]
    buffer_load_dwordx4 v[248:251], v6, s[8:11], s16 offen offset:768 sc1
    v_mfma_f32_16x16x32_bf16 v[176:179], v[68:71], a[180:183], v[176:179]
    s_cmp_lg_u64 s[46:47], 0
    s_cbranch_scc1 L_slow28
L_slow28_ret:
    ds_read_b64_tr_b16 v[52:53], v56 offset:41984
    v_mfma_f32_16x16x32_bf16 v[180:183], v[60:63], a[152:155], v[180:183]
    ds_read_b64_tr_b16 v[54:55], v56 offset:51200
    v_mov_b32 v12, v16
    v_mfma_f32_16x16x32_bf16 v[180:183], v[64:67], a[168:171], v[180:183]
    v_mov_b32 v13, v17
    v_mov_b32 v14, v18
    v_mfma_f32_16x16x32_bf16 v[180:183], v[68:71], a[184:187], v[180:183]
    v_mov_b32 v15, v19
    v_permlane16_swap_b32 v12, v16
    v_mfma_f32_16x16x32_bf16 v[184:187], v[60:63], a[156:159], v[184:187]
    buffer_load_dwordx4 v11, s[40:43], s15 offen  lds
    v_mfma_f32_16x16x32_bf16 v[184:187], v[64:67], a[172:175], v[184:187]
    s_add_u32 m0, s12, 111616
    v_permlane16_swap_b32 v13, v17
    v_permlane16_swap_b32 v14, v18
    v_mfma_f32_16x16x32_bf16 v[184:187], v[68:71], a[188:191], v[184:187]
    s_waitcnt lgkmcnt(0)
    v_permlane16_swap_b32 v15, v19
    v_add_f32 v16, v16, v12
    v_mfma_f32_16x16x32_bf16 v[140:143], v[44:47], a[192:195], v[140:143]
    s_add_u32 s15, s15, s19
    ds_read_b64_tr_b16 v[60:61], v57 offset:39936
    v_add_f32 v17, v17, v13
    v_mfma_f32_16x16x32_bf16 v[140:143], v[48:51], a[208:211], v[140:143]
    ds_read_b64_tr_b16 v[62:63], v57 offset:49152
    v_add_f32 v18, v18, v14
    v_mfma_f32_16x16x32_bf16 v[140:143], v[52:55], a[224:227], v[140:143]
    buffer_load_dwordx4 v11, s[40:43], s15 offen  lds
    v_mfma_f32_16x16x32_bf16 v[144:147], v[44:47], a[196:199], v[144:147]
    s_add_u32 m0, s12, 112640
    ds_read_b64_tr_b16 v[64:65], v57 offset:40960
    v_add_f32 v19, v19, v15
    v_mfma_f32_16x16x32_bf16 v[144:147], v[48:51], a[212:215], v[144:147]
    s_add_u32 s15, s15, s19
    ds_read_b64_tr_b16 v[66:67], v57 offset:50176
    v_mov_b32 v12, v16
    v_mfma_f32_16x16x32_bf16 v[144:147], v[52:55], a[228:231], v[144:147]
    ds_read_b64_tr_b16 v[68:69], v57 offset:41984
    v_mov_b32 v13, v17
    v_mfma_f32_16x16x32_bf16 v[148:151], v[44:47], a[200:203], v[148:151]
    ds_read_b64_tr_b16 v[70:71], v57 offset:51200
    v_mov_b32 v14, v18
    v_mfma_f32_16x16x32_bf16 v[148:151], v[48:51], a[216:219], v[148:151]
    buffer_load_dwordx4 v11, s[40:43], s15 offen  lds
    v_mfma_f32_16x16x32_bf16 v[148:151], v[52:55], a[232:235], v[148:151]
    s_add_u32 m0, s12, 113664
    v_mov_b32 v15, v19
    v_permlane32_swap_b32 v12, v16
    v_mfma_f32_16x16x32_bf16 v[152:155], v[44:47], a[204:207], v[152:155]
    s_add_u32 s15, s15, s19
    v_permlane32_swap_b32 v13, v17
    v_permlane32_swap_b32 v14, v18
    v_mfma_f32_16x16x32_bf16 v[152:155], v[48:51], a[220:223], v[152:155]
    v_permlane32_swap_b32 v15, v19
    v_add_f32 v16, v16, v12
    s_waitcnt vmcnt(15)
    v_mfma_f32_16x16x32_bf16 v[152:155], v[52:55], a[236:239], v[152:155]
    s_waitcnt lgkmcnt(0)
    v_add_f32 v17, v17, v13
    v_add_f32 v18, v18, v14
    v_mfma_f32_16x16x32_bf16 v[188:191], v[60:63], a[192:195], v[188:191]
    buffer_load_dwordx4 v11, s[40:43], s15 offen  lds
    v_mfma_f32_16x16x32_bf16 v[188:191], v[64:67], a[208:211], v[188:191]
    s_add_u32 m0, s12, 114688
    ds_read_b64_tr_b16 v[44:45], v58 offset:39936
    v_add_f32 v19, v19, v15
    v_mfma_f32_16x16x32_bf16 v[188:191], v[68:71], a[224:227], v[188:191]
    s_add_u32 s15, s15, s19
    ds_read_b64_tr_b16 v[46:47], v58 offset:49152
    v_mul_f32 v16, 0x3ae38e39, v16
    v_mfma_f32_16x16x32_bf16 v[192:195], v[60:63], a[196:199], v[192:195]
    ds_read_b64_tr_b16 v[48:49], v58 offset:40960
    v_mul_f32 v17, 0x3ae38e39, v17
    v_mfma_f32_16x16x32_bf16 v[192:195], v[64:67], a[212:215], v[192:195]
    ds_read_b64_tr_b16 v[50:51], v58 offset:50176
    v_mul_f32 v18, 0x3ae38e39, v18
    v_mfma_f32_16x16x32_bf16 v[192:195], v[68:71], a[228:231], v[192:195]
    ds_read_b64_tr_b16 v[52:53], v58 offset:41984
    v_mul_f32 v19, 0x3ae38e39, v19
    v_mfma_f32_16x16x32_bf16 v[196:199], v[60:63], a[200:203], v[196:199]
    buffer_load_dwordx4 v11, s[40:43], s15 offen  lds
    v_mfma_f32_16x16x32_bf16 v[196:199], v[64:67], a[216:219], v[196:199]
    s_add_u32 m0, s12, 115712
    ds_read_b64_tr_b16 v[54:55], v58 offset:51200
    v_add_f32 v16, 0x3727c5ac, v16
    v_mfma_f32_16x16x32_bf16 v[196:199], v[68:71], a[232:235], v[196:199]
    s_add_u32 s15, s15, s19
    v_rsq_f32 v12, v16
    v_mfma_f32_16x16x32_bf16 v[200:203], v[60:63], a[204:207], v[200:203]
    v_add_f32 v17, 0x3727c5ac, v17
    v_add_f32 v18, 0x3727c5ac, v18
    v_mfma_f32_16x16x32_bf16 v[200:203], v[64:67], a[220:223], v[200:203]
    v_rsq_f32 v13, v17
    v_mfma_f32_16x16x32_bf16 v[200:203], v[68:71], a[236:239], v[200:203]
    s_waitcnt lgkmcnt(0)
    v_rsq_f32 v14, v18
    v_mfma_f32_16x16x32_bf16 v[204:207], v[44:47], a[192:195], v[204:207]
    buffer_load_dwordx4 v11, s[40:43], s15 offen  lds
    v_mfma_f32_16x16x32_bf16 v[204:207], v[48:51], a[208:211], v[204:207]
    s_add_u32 m0, s12, 116736
    ds_read_b64_tr_b16 v[60:61], v59 offset:39936
    v_add_f32 v19, 0x3727c5ac, v19
    v_mfma_f32_16x16x32_bf16 v[204:207], v[52:55], a[224:227], v[204:207]
    s_add_u32 s15, s15, s19
    ds_read_b64_tr_b16 v[62:63], v59 offset:49152
    v_mul_f32 v12, 0xbfb8aa3b, v12
    v_mfma_f32_16x16x32_bf16 v[208:211], v[44:47], a[196:199], v[208:211]
    ds_read_b64_tr_b16 v[64:65], v59 offset:40960
    v_mul_f32 v13, 0xbfb8aa3b, v13
    v_mfma_f32_16x16x32_bf16 v[208:211], v[48:51], a[212:215], v[208:211]
    buffer_load_dwordx4 v11, s[40:43], s15 offen  lds
    v_mfma_f32_16x16x32_bf16 v[208:211], v[52:55], a[228:231], v[208:211]
    s_add_u32 m0, s12, 117760
    ds_read_b64_tr_b16 v[66:67], v59 offset:50176
    v_mul_f32 v14, 0xbfb8aa3b, v14
    v_mfma_f32_16x16x32_bf16 v[212:215], v[44:47], a[200:203], v[212:215]
    s_add_u32 s15, s15, s19
    ds_read_b64_tr_b16 v[68:69], v59 offset:41984
    ds_read_b64_tr_b16 v[70:71], v59 offset:51200
    v_mfma_f32_16x16x32_bf16 v[212:215], v[48:51], a[216:219], v[212:215]
    v_rsq_f32 v15, v19
    v_mfma_f32_16x16x32_bf16 v[212:215], v[52:55], a[232:235], v[212:215]
    v_mul_f32 v15, 0xbfb8aa3b, v15
    v_mfma_f32_16x16x32_bf16 v[216:219], v[44:47], a[204:207], v[216:219]
    buffer_load_dwordx4 v11, s[40:43], s15 offen  lds
    v_mfma_f32_16x16x32_bf16 v[216:219], v[48:51], a[220:223], v[216:219]
    s_add_u32 m0, s12, 118784
    v_mfma_f32_16x16x32_bf16 v[216:219], v[52:55], a[236:239], v[216:219]
    s_waitcnt lgkmcnt(0)
    v_mfma_f32_16x16x32_bf16 v[172:175], v[60:63], a[192:195], v[172:175]
    s_add_u32 s15, s15, s19
    ds_read_b64_tr_b16 v[44:45], v56 offset:43008
    v_mfma_f32_16x16x32_bf16 v[172:175], v[64:67], a[208:211], v[172:175]
    ds_read_b64_tr_b16 v[46:47], v56 offset:52224
    v_mfma_f32_16x16x32_bf16 v[172:175], v[68:71], a[224:227], v[172:175]
    buffer_load_dwordx4 v11, s[40:43], s15 offen  lds
    v_mfma_f32_16x16x32_bf16 v[176:179], v[60:63], a[196:199], v[176:179]
    s_add_u32 m0, s12, 0
    ds_read_b64_tr_b16 v[48:49], v56 offset:44032
    v_mfma_f32_16x16x32_bf16 v[176:179], v[64:67], a[212:215], v[176:179]
    s_mov_b64 s[40:41], s[48:49]
    ds_read_b64_tr_b16 v[50:51], v56 offset:53248
    v_mfma_f32_16x16x32_bf16 v[176:179], v[68:71], a[228:231], v[176:179]
    s_mul_i32 s15, s19, 9
    ds_read_b64_tr_b16 v[52:53], v56 offset:45056
    v_mfma_f32_16x16x32_bf16 v[180:183], v[60:63], a[200:203], v[180:183]
    s_add_u32 s15, s15, s18
    ds_read_b64_tr_b16 v[54:55], v56 offset:54272
    v_mfma_f32_16x16x32_bf16 v[180:183], v[64:67], a[216:219], v[180:183]
    s_add_u32 s15, s15, 4096
    v_mfma_f32_16x16x32_bf16 v[180:183], v[68:71], a[232:235], v[180:183]
    buffer_load_dwordx4 v11, s[40:43], s15 offen  lds
    v_mfma_f32_16x16x32_bf16 v[184:187], v[60:63], a[204:207], v[184:187]
    s_add_u32 m0, s12, 1024
    v_mfma_f32_16x16x32_bf16 v[184:187], v[64:67], a[220:223], v[184:187]
    s_add_u32 s15, s15, s19
    v_mfma_f32_16x16x32_bf16 v[184:187], v[68:71], a[236:239], v[184:187]
    s_waitcnt lgkmcnt(0)
    s_waitcnt vmcnt(21)
    v_mfma_f32_16x16x32_bf16 v[140:143], v[44:47], a[240:243], v[140:143]
    ds_read_b64_tr_b16 v[60:61], v57 offset:43008
    s_waitcnt vmcnt(17)
    v_mfma_f32_16x16x32_bf16 v[140:143], v[48:51], v[220:223], v[140:143]
    buffer_load_dwordx4 v11, s[40:43], s15 offen  lds
    s_waitcnt vmcnt(14)
    v_mfma_f32_16x16x32_bf16 v[140:143], v[52:55], v[236:239], v[140:143]
    s_add_u32 m0, s12, 2048
    ds_read_b64_tr_b16 v[62:63], v57 offset:52224
    v_mfma_f32_16x16x32_bf16 v[144:147], v[44:47], a[244:247], v[144:147]
    s_add_u32 s15, s15, s19
    ds_read_b64_tr_b16 v[64:65], v57 offset:44032
    v_mfma_f32_16x16x32_bf16 v[144:147], v[48:51], v[224:227], v[144:147]
    ds_read_b64_tr_b16 v[66:67], v57 offset:53248
    s_waitcnt vmcnt(13)
    v_mfma_f32_16x16x32_bf16 v[144:147], v[52:55], v[240:243], v[144:147]
    ds_read_b64_tr_b16 v[68:69], v57 offset:45056
    v_mfma_f32_16x16x32_bf16 v[148:151], v[44:47], a[248:251], v[148:151]
    buffer_load_dwordx4 v11, s[40:43], s15 offen  lds
    v_mfma_f32_16x16x32_bf16 v[148:151], v[48:51], v[228:231], v[148:151]
    s_add_u32 m0, s12, 3072
    ds_read_b64_tr_b16 v[70:71], v57 offset:54272
    s_waitcnt vmcnt(13)
    v_mfma_f32_16x16x32_bf16 v[148:151], v[52:55], v[244:247], v[148:151]
    s_add_u32 s15, s15, s19
    v_mfma_f32_16x16x32_bf16 v[152:155], v[44:47], a[252:255], v[152:155]
    v_mfma_f32_16x16x32_bf16 v[152:155], v[48:51], v[232:235], v[152:155]
    s_waitcnt vmcnt(12)
    v_mfma_f32_16x16x32_bf16 v[152:155], v[52:55], v[248:251], v[152:155]
    s_waitcnt lgkmcnt(0)
    v_mfma_f32_16x16x32_bf16 v[188:191], v[60:63], a[240:243], v[188:191]
    buffer_load_dwordx4 v11, s[40:43], s15 offen  lds
    v_mfma_f32_16x16x32_bf16 v[188:191], v[64:67], v[220:223], v[188:191]
    s_add_u32 m0, s12, 4096
    ds_read_b64_tr_b16 v[44:45], v58 offset:43008
    ds_read_b64_tr_b16 v[46:47], v58 offset:52224
    v_mfma_f32_16x16x32_bf16 v[188:191], v[68:71], v[236:239], v[188:191]
    s_add_u32 s15, s15, s19
    ds_read_b64_tr_b16 v[48:49], v58 offset:44032
    ds_read_b64_tr_b16 v[50:51], v58 offset:53248
    v_mfma_f32_16x16x32_bf16 v[192:195], v[60:63], a[244:247], v[192:195]
    ds_read_b64_tr_b16 v[52:53], v58 offset:45056
    v_mul_f32 v20, v12, v140
    v_mfma_f32_16x16x32_bf16 v[192:195], v[64:67], v[224:227], v[192:195]
    buffer_load_dwordx4 v11, s[40:43], s15 offen  lds
    v_mfma_f32_16x16x32_bf16 v[192:195], v[68:71], v[240:243], v[192:195]
    s_add_u32 m0, s12, 5120
    ds_read_b64_tr_b16 v[54:55], v58 offset:54272
    v_mul_f32 v21, v12, v141
    v_mfma_f32_16x16x32_bf16 v[196:199], v[60:63], a[248:251], v[196:199]
    s_add_u32 s15, s15, s19
    v_exp_f32 v20, v20
    v_mfma_f32_16x16x32_bf16 v[196:199], v[64:67], v[228:231], v[196:199]
    v_exp_f32 v21, v21
    v_mfma_f32_16x16x32_bf16 v[196:199], v[68:71], v[244:247], v[196:199]
    v_mul_f32 v22, v12, v142
    v_mul_f32 v23, v12, v143
    v_mfma_f32_16x16x32_bf16 v[200:203], v[60:63], a[252:255], v[200:203]
    v_exp_f32 v22, v22
    v_mfma_f32_16x16x32_bf16 v[200:203], v[64:67], v[232:235], v[200:203]
    buffer_load_dwordx4 v11, s[40:43], s15 offen  lds
    v_mfma_f32_16x16x32_bf16 v[200:203], v[68:71], v[248:251], v[200:203]
    s_waitcnt lgkmcnt(0)
    v_exp_f32 v23, v23
    v_mfma_f32_16x16x32_bf16 v[204:207], v[44:47], a[240:243], v[204:207]
    s_add_u32 m0, s12, 6144
    ds_read_b64_tr_b16 v[60:61], v59 offset:43008
    v_fma_f32 v20, v20, v16, v16
    v_mfma_f32_16x16x32_bf16 v[204:207], v[48:51], v[220:223], v[204:207]
    s_add_u32 s15, s15, s19
    ds_read_b64_tr_b16 v[62:63], v59 offset:52224
    v_fma_f32 v21, v21, v16, v16
    v_mfma_f32_16x16x32_bf16 v[204:207], v[52:55], v[236:239], v[204:207]
    ds_read_b64_tr_b16 v[64:65], v59 offset:44032
    v_fma_f32 v22, v22, v16, v16
    v_mfma_f32_16x16x32_bf16 v[208:211], v[44:47], a[244:247], v[208:211]
    buffer_load_dwordx4 v11, s[40:43], s15 offen  lds
    ds_read_b64_tr_b16 v[66:67], v59 offset:53248
    v_mfma_f32_16x16x32_bf16 v[208:211], v[48:51], v[224:227], v[208:211]
L_pad_c3_1:
    s_cbranch_execz L_pad_c3_5
    s_add_u32 m0, s12, 7168
    ds_read_b64_tr_b16 v[68:69], v59 offset:45056
    v_fma_f32 v23, v23, v16, v16
    v_mfma_f32_16x16x32_bf16 v[208:211], v[52:55], v[240:243], v[208:211]
    s_add_u32 s15, s15, s19
    ds_read_b64_tr_b16 v[70:71], v59 offset:54272
    v_mul_f32 v24, v13, v144
    v_mfma_f32_16x16x32_bf16 v[212:215], v[44:47], a[248:251], v[212:215]
    v_rcp_f32 v20, v20
    v_mfma_f32_16x16x32_bf16 v[212:215], v[48:51], v[228:231], v[212:215]
    v_rcp_f32 v21, v21
    v_mfma_f32_16x16x32_bf16 v[212:215], v[52:55], v[244:247], v[212:215]
    buffer_load_dwordx4 v11, s[40:43], s15 offen  lds
    v_mul_f32 v140, v20, v140
    v_mfma_f32_16x16x32_bf16 v[216:219], v[44:47], a[252:255], v[216:219]
    s_add_u32 m0, s12, 8192
    v_rcp_f32 v22, v22
    v_mfma_f32_16x16x32_bf16 v[216:219], v[48:51], v[232:235], v[216:219]
    s_add_u32 s15, s15, s19
    v_rcp_f32 v23, v23
    v_mfma_f32_16x16x32_bf16 v[216:219], v[52:55], v[248:251], v[216:219]
    s_waitcnt lgkmcnt(0)
    v_exp_f32 v24, v24
    v_mfma_f32_16x16x32_bf16 v[172:175], v[60:63], a[240:243], v[172:175]
    s_barrier
    v_add_u32 v56, 73728, v56
    v_mul_f32 v141, v21, v141
    v_mfma_f32_16x16x32_bf16 v[172:175], v[64:67], v[220:223], v[172:175]
    buffer_load_dwordx4 v11, s[40:43], s15 offen  lds
    ds_read_b64_tr_b16 v[44:45], v56 offset:0
    v_mfma_f32_16x16x32_bf16 v[172:175], v[68:71], v[236:239], v[172:175]
    s_add_u32 m0, s12, 36864
    ds_read_b64_tr_b16 v[46:47], v56 offset:9216
    v_mul_f32 v142, v22, v142
    v_mfma_f32_16x16x32_bf16 v[176:179], v[60:63], a[244:247], v[176:179]
    s_add_u32 s15, s13, 0
    ds_read_b64_tr_b16 v[48:49], v56 offset:1024
    v_mul_f32 v143, v23, v143
    v_mfma_f32_16x16x32_bf16 v[176:179], v[64:67], v[224:227], v[176:179]
    ds_read_b64_tr_b16 v[50:51], v56 offset:10240
    v_mul_f32 v25, v13, v145
    v_mfma_f32_16x16x32_bf16 v[176:179], v[68:71], v[240:243], v[176:179]
    ds_read_b64_tr_b16 v[52:53], v56 offset:2048
    v_mul_f32 v26, v13, v146
    v_mfma_f32_16x16x32_bf16 v[180:183], v[60:63], a[248:251], v[180:183]
    buffer_load_dwordx4 v1, s[8:11], s15 offen offset:0 sc1 lds
    ds_read_b64_tr_b16 v[54:55], v56 offset:11264
    v_mfma_f32_16x16x32_bf16 v[180:183], v[64:67], v[228:231], v[180:183]
    v_exp_f32 v25, v25
    v_mfma_f32_16x16x32_bf16 v[180:183], v[68:71], v[244:247], v[180:183]
    v_exp_f32 v26, v26
    v_mfma_f32_16x16x32_bf16 v[184:187], v[60:63], a[252:255], v[184:187]
    v_mul_f32 v27, v13, v147
    v_fma_f32 v24, v24, v17, v17
    v_mfma_f32_16x16x32_bf16 v[184:187], v[64:67], v[232:235], v[184:187]
    v_exp_f32 v27, v27
    v_mfma_f32_16x16x32_bf16 v[184:187], v[68:71], v[248:251], v[184:187]
    s_waitcnt lgkmcnt(0)
    v_rcp_f32 v24, v24
    v_mfma_f32_16x16x32_bf16 v[92:95], v[44:47], a[144:147], v[92:95]
    buffer_load_dwordx4 v1, s[8:11], s15 offen offset:1024 sc1 lds
    ds_read_b64_tr_b16 v[60:61], v56 offset:3072
    v_mfma_f32_16x16x32_bf16 v[92:95], v[48:51], a[160:163], v[92:95]
    ds_read_b64_tr_b16 v[62:63], v56 offset:12288
    v_fma_f32 v25, v25, v17, v17
    v_mfma_f32_16x16x32_bf16 v[92:95], v[52:55], a[176:179], v[92:95]
    ds_read_b64_tr_b16 v[64:65], v56 offset:4096
    v_fma_f32 v26, v26, v17, v17
    v_mfma_f32_16x16x32_bf16 v[96:99], v[44:47], a[148:151], v[96:99]
    ds_read_b64_tr_b16 v[66:67], v56 offset:13312
    v_fma_f32 v27, v27, v17, v17
    v_mfma_f32_16x16x32_bf16 v[96:99], v[48:51], a[164:167], v[96:99]
    ds_read_b64_tr_b16 v[68:69], v56 offset:5120
    v_mul_f32 v144, v24, v144
    v_mfma_f32_16x16x32_bf16 v[96:99], v[52:55], a[180:183], v[96:99]
    ds_read_b64_tr_b16 v[70:71], v56 offset:14336
    v_mul_f32 v28, v14, v148
    v_mfma_f32_16x16x32_bf16 v[100:103], v[44:47], a[152:155], v[100:103]
    buffer_load_dwordx4 v1, s[8:11], s15 offen offset:2048 sc1 lds
    v_mul_f32 v29, v14, v149
    v_mfma_f32_16x16x32_bf16 v[100:103], v[48:51], a[168:171], v[100:103]
    v_rcp_f32 v25, v25
    v_mfma_f32_16x16x32_bf16 v[100:103], v[52:55], a[184:187], v[100:103]
    v_rcp_f32 v26, v26
    v_mfma_f32_16x16x32_bf16 v[104:107], v[44:47], a[156:159], v[104:107]
    v_rcp_f32 v27, v27
    v_mfma_f32_16x16x32_bf16 v[104:107], v[48:51], a[172:175], v[104:107]
    v_exp_f32 v28, v28
    v_mfma_f32_16x16x32_bf16 v[104:107], v[52:55], a[188:191], v[104:107]
    s_waitcnt lgkmcnt(0)
    v_exp_f32 v29, v29
    v_mfma_f32_16x16x32_bf16 v[104:107], v[60:63], a[204:207], v[104:107]
    buffer_load_dwordx4 v1, s[8:11], s15 offen offset:3072 sc1 lds
    ds_read_b64_tr_b16 v[44:45], v56 offset:6144
    v_mfma_f32_16x16x32_bf16 v[104:107], v[64:67], a[220:223], v[104:107]
    s_add_u32 m0, s12, 40960
    ds_read_b64_tr_b16 v[46:47], v56 offset:15360
    v_mul_f32 v145, v25, v145
    v_mfma_f32_16x16x32_bf16 v[104:107], v[68:71], a[236:239], v[104:107]
    s_add_u32 s15, s13, 4096
    ds_read_b64_tr_b16 v[48:49], v56 offset:7168
    v_mul_f32 v146, v26, v146
    v_mfma_f32_16x16x32_bf16 v[100:103], v[60:63], a[200:203], v[100:103]
    ds_read_b64_tr_b16 v[50:51], v56 offset:16384
    v_mul_f32 v147, v27, v147
    v_mfma_f32_16x16x32_bf16 v[100:103], v[64:67], a[216:219], v[100:103]
    ds_read_b64_tr_b16 v[52:53], v56 offset:8192
    v_mul_f32 v30, v14, v150
    v_mfma_f32_16x16x32_bf16 v[100:103], v[68:71], a[232:235], v[100:103]
    ds_read_b64_tr_b16 v[54:55], v56 offset:17408
    v_mul_f32 v31, v14, v151
    v_mfma_f32_16x16x32_bf16 v[96:99], v[60:63], a[196:199], v[96:99]
    buffer_load_dwordx4 v1, s[8:11], s15 offen offset:0 sc1 lds
    v_fma_f32 v28, v28, v18, v18
    v_mfma_f32_16x16x32_bf16 v[96:99], v[64:67], a[212:215], v[96:99]
    v_exp_f32 v30, v30
    v_mfma_f32_16x16x32_bf16 v[96:99], v[68:71], a[228:231], v[96:99]
    v_exp_f32 v31, v31
    v_mfma_f32_16x16x32_bf16 v[92:95], v[60:63], a[192:195], v[92:95]
    v_rcp_f32 v28, v28
    v_mfma_f32_16x16x32_bf16 v[92:95], v[64:67], a[208:211], v[92:95]
    v_fma_f32 v29, v29, v18, v18
    v_fma_f32 v30, v30, v18, v18
    v_mfma_f32_16x16x32_bf16 v[92:95], v[68:71], a[224:227], v[92:95]
    s_waitcnt lgkmcnt(0)
    v_rcp_f32 v29, v29
    v_mfma_f32_16x16x32_bf16 v[92:95], v[44:47], a[240:243], v[92:95]
    buffer_load_dwordx4 v1, s[8:11], s15 offen offset:1024 sc1 lds
    v_add_u32 v57, 73728, v57
    v_mfma_f32_16x16x32_bf16 v[92:95], v[48:51], v[220:223], v[92:95]
    ds_read_b64_tr_b16 v[60:61], v57 offset:0
    v_fma_f32 v31, v31, v18, v18
    v_mfma_f32_16x16x32_bf16 v[92:95], v[52:55], v[236:239], v[92:95]
    ds_read_b64_tr_b16 v[62:63], v57 offset:9216
    v_mul_f32 v148, v28, v148
    v_mfma_f32_16x16x32_bf16 v[96:99], v[44:47], a[244:247], v[96:99]
    ds_read_b64_tr_b16 v[64:65], v57 offset:1024
    v_mul_f32 v149, v29, v149
    v_mfma_f32_16x16x32_bf16 v[96:99], v[48:51], v[224:227], v[96:99]
    ds_read_b64_tr_b16 v[66:67], v57 offset:10240
    v_mul_f32 v32, v15, v152
    v_mfma_f32_16x16x32_bf16 v[96:99], v[52:55], v[240:243], v[96:99]
    ds_read_b64_tr_b16 v[68:69], v57 offset:2048
    v_mul_f32 v33, v15, v153
    v_mfma_f32_16x16x32_bf16 v[100:103], v[44:47], a[248:251], v[100:103]
    buffer_load_dwordx4 v1, s[8:11], s15 offen offset:2048 sc1 lds
    ds_read_b64_tr_b16 v[70:71], v57 offset:11264
    v_mfma_f32_16x16x32_bf16 v[100:103], v[48:51], v[228:231], v[100:103]
    v_rcp_f32 v30, v30
    v_mfma_f32_16x16x32_bf16 v[100:103], v[52:55], v[244:247], v[100:103]
    v_rcp_f32 v31, v31
    v_mfma_f32_16x16x32_bf16 v[104:107], v[44:47], a[252:255], v[104:107]
    v_exp_f32 v32, v32
    v_mfma_f32_16x16x32_bf16 v[104:107], v[48:51], v[232:235], v[104:107]
    v_exp_f32 v33, v33
    v_mfma_f32_16x16x32_bf16 v[104:107], v[52:55], v[248:251], v[104:107]
    s_waitcnt lgkmcnt(0)
    v_mul_f32 v150, v30, v150
    v_mul_f32 v151, v31, v151
    v_mfma_f32_16x16x32_bf16 v[124:127], v[60:63], a[144:147], v[124:127]
    buffer_load_dwordx4 v1, s[8:11], s15 offen offset:3072 sc1 lds
    ds_read_b64_tr_b16 v[44:45], v57 offset:3072
    v_mfma_f32_16x16x32_bf16 v[124:127], v[64:67], a[160:163], v[124:127]
    s_add_u32 m0, s12, 45056
    ds_read_b64_tr_b16 v[46:47], v57 offset:12288
    v_mul_f32 v34, v15, v154
    v_mfma_f32_16x16x32_bf16 v[124:127], v[68:71], a[176:179], v[124:127]
    s_add_u32 s15, s13, 8192
    ds_read_b64_tr_b16 v[48:49], v57 offset:4096
    v_mul_f32 v35, v15, v155
    v_mfma_f32_16x16x32_bf16 v[128:131], v[60:63], a[148:151], v[128:131]
    ds_read_b64_tr_b16 v[50:51], v57 offset:13312
    v_fma_f32 v32, v32, v19, v19
    v_mfma_f32_16x16x32_bf16 v[128:131], v[64:67], a[164:167], v[128:131]
    ds_read_b64_tr_b16 v[52:53], v57 offset:5120
    v_fma_f32 v33, v33, v19, v19
    v_mfma_f32_16x16x32_bf16 v[128:131], v[68:71], a[180:183], v[128:131]
    ds_read_b64_tr_b16 v[54:55], v57 offset:14336
    v_mul_f32 v20, v12, v188
    v_mfma_f32_16x16x32_bf16 v[132:135], v[60:63], a[152:155], v[132:135]
    buffer_load_dwordx4 v1, s[8:11], s15 offen offset:0 sc1 lds
    v_mul_f32 v21, v12, v189
    v_mfma_f32_16x16x32_bf16 v[132:135], v[64:67], a[168:171], v[132:135]
    v_exp_f32 v34, v34
    v_mfma_f32_16x16x32_bf16 v[132:135], v[68:71], a[184:187], v[132:135]
    v_exp_f32 v35, v35
    v_mfma_f32_16x16x32_bf16 v[136:139], v[60:63], a[156:159], v[136:139]
    v_rcp_f32 v32, v32
    v_mfma_f32_16x16x32_bf16 v[136:139], v[64:67], a[172:175], v[136:139]
    v_rcp_f32 v33, v33
    v_mfma_f32_16x16x32_bf16 v[136:139], v[68:71], a[188:191], v[136:139]
    s_waitcnt lgkmcnt(0)
    v_fma_f32 v34, v34, v19, v19
    v_fma_f32 v35, v35, v19, v19
    v_mfma_f32_16x16x32_bf16 v[136:139], v[44:47], a[204:207], v[136:139]
    ds_read_b64_tr_b16 v[60:61], v57 offset:6144
    v_mul_f32 v152, v32, v152
    v_mfma_f32_16x16x32_bf16 v[136:139], v[48:51], a[220:223], v[136:139]
    ds_read_b64_tr_b16 v[62:63], v57 offset:15360
    v_mul_f32 v153, v33, v153
    v_mfma_f32_16x16x32_bf16 v[136:139], v[52:55], a[236:239], v[136:139]
    ds_read_b64_tr_b16 v[64:65], v57 offset:7168
    v_mul_f32 v22, v12, v190
    v_mfma_f32_16x16x32_bf16 v[132:135], v[44:47], a[200:203], v[132:135]
    ds_read_b64_tr_b16 v[66:67], v57 offset:16384
    v_mul_f32 v23, v12, v191
    v_mfma_f32_16x16x32_bf16 v[132:135], v[48:51], a[216:219], v[132:135]
    ds_read_b64_tr_b16 v[68:69], v57 offset:8192
    ds_read_b64_tr_b16 v[70:71], v57 offset:17408
    v_mfma_f32_16x16x32_bf16 v[132:135], v[52:55], a[232:235], v[132:135]
    v_rcp_f32 v34, v34
    v_mfma_f32_16x16x32_bf16 v[128:131], v[44:47], a[196:199], v[128:131]
    v_rcp_f32 v35, v35
    v_mfma_f32_16x16x32_bf16 v[128:131], v[48:51], a[212:215], v[128:131]
    v_exp_f32 v20, v20
    v_mfma_f32_16x16x32_bf16 v[128:131], v[52:55], a[228:231], v[128:131]
    v_exp_f32 v21, v21
    v_mfma_f32_16x16x32_bf16 v[124:127], v[44:47], a[192:195], v[124:127]
    v_exp_f32 v22, v22
    v_mfma_f32_16x16x32_bf16 v[124:127], v[48:51], a[208:211], v[124:127]
    v_exp_f32 v23, v23
    v_mfma_f32_16x16x32_bf16 v[124:127], v[52:55], a[224:227], v[124:127]
    s_waitcnt lgkmcnt(0)
    v_mul_f32 v154, v34, v154
    v_mul_f32 v155, v35, v155
    v_mfma_f32_16x16x32_bf16 v[124:127], v[60:63], a[240:243], v[124:127]
    s_mov_b32 s17, 0
    v_add_u32 v58, 73728, v58
    v_mul_f32 v140, v140, v92
    v_mfma_f32_16x16x32_bf16 v[124:127], v[64:67], v[220:223], v[124:127]
    ds_read_b64_tr_b16 v[44:45], v58 offset:0
    v_mul_f32 v141, v141, v93
    v_mfma_f32_16x16x32_bf16 v[124:127], v[68:71], v[236:239], v[124:127]
    ds_read_b64_tr_b16 v[46:47], v58 offset:9216
    v_mul_f32 v142, v142, v94
    v_mfma_f32_16x16x32_bf16 v[128:131], v[60:63], a[244:247], v[128:131]
    ds_read_b64_tr_b16 v[48:49], v58 offset:1024
    v_mul_f32 v143, v143, v95
    v_mfma_f32_16x16x32_bf16 v[128:131], v[64:67], v[224:227], v[128:131]
    ds_read_b64_tr_b16 v[50:51], v58 offset:10240
    v_mul_f32 v144, v144, v96
    v_mfma_f32_16x16x32_bf16 v[128:131], v[68:71], v[240:243], v[128:131]
    ds_read_b64_tr_b16 v[52:53], v58 offset:2048
    v_mul_f32 v145, v145, v97
    v_mfma_f32_16x16x32_bf16 v[132:135], v[60:63], a[248:251], v[132:135]
    ds_read_b64_tr_b16 v[54:55], v58 offset:11264
    v_mul_f32 v146, v146, v98
    v_mfma_f32_16x16x32_bf16 v[132:135], v[64:67], v[228:231], v[132:135]
    v_mul_f32 v147, v147, v99
    v_cvt_pk_bf16_f32 v36, v140, v141
    v_mfma_f32_16x16x32_bf16 v[132:135], v[68:71], v[244:247], v[132:135]
    v_cvt_pk_bf16_f32 v37, v142, v143
    v_cvt_pk_bf16_f32 v38, v144, v145
    v_mfma_f32_16x16x32_bf16 v[136:139], v[60:63], a[252:255], v[136:139]
    v_cvt_pk_bf16_f32 v39, v146, v147
    v_mul_f32 v148, v148, v100
    v_mfma_f32_16x16x32_bf16 v[136:139], v[64:67], v[232:235], v[136:139]
    v_mul_f32 v149, v149, v101
    v_mul_f32 v150, v150, v102
    v_mfma_f32_16x16x32_bf16 v[136:139], v[68:71], v[248:251], v[136:139]
    s_waitcnt lgkmcnt(0)
    v_mul_f32 v151, v151, v103
    v_mul_f32 v152, v152, v104
    v_mfma_f32_16x16x32_bf16 v[156:159], v[44:47], a[144:147], v[156:159]
    ds_read_b64_tr_b16 v[60:61], v58 offset:3072
    v_mul_f32 v153, v153, v105
    v_mfma_f32_16x16x32_bf16 v[156:159], v[48:51], a[160:163], v[156:159]
    ds_read_b64_tr_b16 v[62:63], v58 offset:12288
    v_mul_f32 v154, v154, v106
    v_mfma_f32_16x16x32_bf16 v[156:159], v[52:55], a[176:179], v[156:159]
    ds_read_b64_tr_b16 v[64:65], v58 offset:4096
    v_mul_f32 v155, v155, v107
    v_mfma_f32_16x16x32_bf16 v[160:163], v[44:47], a[148:151], v[160:163]
    ds_read_b64_tr_b16 v[66:67], v58 offset:13312
    v_cvt_pk_bf16_f32 v40, v148, v149
    v_mfma_f32_16x16x32_bf16 v[160:163], v[48:51], a[164:167], v[160:163]
    ds_read_b64_tr_b16 v[68:69], v58 offset:5120
    v_cvt_pk_bf16_f32 v41, v150, v151
    v_mfma_f32_16x16x32_bf16 v[160:163], v[52:55], a[180:183], v[160:163]
    ds_read_b64_tr_b16 v[70:71], v58 offset:14336
    v_cvt_pk_bf16_f32 v42, v152, v153
    v_mfma_f32_16x16x32_bf16 v[164:167], v[44:47], a[152:155], v[164:167]
    v_cvt_pk_bf16_f32 v43, v154, v155
    v_permlane16_swap_b32 v36, v38
    v_mfma_f32_16x16x32_bf16 v[164:167], v[48:51], a[168:171], v[164:167]
    v_permlane16_swap_b32 v37, v39
    v_permlane16_swap_b32 v40, v42
    v_mfma_f32_16x16x32_bf16 v[164:167], v[52:55], a[184:187], v[164:167]
    buffer_store_dwordx4 v[36:39], v7, s[8:11], s17 offen sc1
    v_permlane16_swap_b32 v41, v43
    v_mfma_f32_16x16x32_bf16 v[168:171], v[44:47], a[156:159], v[168:171]
    s_mov_b32 s17, 294912
    v_fma_f32 v20, v20, v16, v16
    v_fma_f32 v21, v21, v16, v16
    v_mfma_f32_16x16x32_bf16 v[168:171], v[48:51], a[172:175], v[168:171]
    v_rcp_f32 v20, v20
    v_mfma_f32_16x16x32_bf16 v[168:171], v[52:55], a[188:191], v[168:171]
    s_waitcnt lgkmcnt(0)
    v_rcp_f32 v21, v21
    v_mfma_f32_16x16x32_bf16 v[168:171], v[60:63], a[204:207], v[168:171]
    buffer_store_dwordx4 v[40:43], v7, s[8:11], s17 offen sc1
    ds_read_b64_tr_b16 v[44:45], v58 offset:6144
    v_mfma_f32_16x16x32_bf16 v[168:171], v[64:67], a[220:223], v[168:171]
    ds_read_b64_tr_b16 v[46:47], v58 offset:15360
    v_fma_f32 v22, v22, v16, v16
    v_mfma_f32_16x16x32_bf16 v[168:171], v[68:71], a[236:239], v[168:171]
    ds_read_b64_tr_b16 v[48:49], v58 offset:7168
    v_fma_f32 v23, v23, v16, v16
    v_mfma_f32_16x16x32_bf16 v[164:167], v[60:63], a[200:203], v[164:167]
    ds_read_b64_tr_b16 v[50:51], v58 offset:16384
    v_mul_f32 v188, v20, v188
    v_mfma_f32_16x16x32_bf16 v[164:167], v[64:67], a[216:219], v[164:167]
    ds_read_b64_tr_b16 v[52:53], v58 offset:8192
    v_mul_f32 v189, v21, v189
    v_mfma_f32_16x16x32_bf16 v[164:167], v[68:71], a[232:235], v[164:167]
    ds_read_b64_tr_b16 v[54:55], v58 offset:17408
    v_mul_f32 v24, v13, v192
    v_mfma_f32_16x16x32_bf16 v[160:163], v[60:63], a[196:199], v[160:163]
    v_rcp_f32 v22, v22
    v_mfma_f32_16x16x32_bf16 v[160:163], v[64:67], a[212:215], v[160:163]
    v_rcp_f32 v23, v23
    v_mfma_f32_16x16x32_bf16 v[160:163], v[68:71], a[228:231], v[160:163]
    v_exp_f32 v24, v24
    v_mfma_f32_16x16x32_bf16 v[156:159], v[60:63], a[192:195], v[156:159]
    v_mul_f32 v190, v22, v190
    v_mul_f32 v191, v23, v191
    v_mfma_f32_16x16x32_bf16 v[156:159], v[64:67], a[208:211], v[156:159]
    v_mul_f32 v25, v13, v193
    v_mul_f32 v26, v13, v194
    v_mfma_f32_16x16x32_bf16 v[156:159], v[68:71], a[224:227], v[156:159]
    s_waitcnt lgkmcnt(0)
    v_exp_f32 v25, v25
    v_mfma_f32_16x16x32_bf16 v[156:159], v[44:47], a[240:243], v[156:159]
    v_add_u32 v59, 73728, v59
    v_mul_f32 v27, v13, v195
    v_mfma_f32_16x16x32_bf16 v[156:159], v[48:51], v[220:223], v[156:159]
    ds_read_b64_tr_b16 v[60:61], v59 offset:0
    v_fma_f32 v24, v24, v17, v17
    v_mfma_f32_16x16x32_bf16 v[156:159], v[52:55], v[236:239], v[156:159]
    ds_read_b64_tr_b16 v[62:63], v59 offset:9216
    v_fma_f32 v25, v25, v17, v17
    v_mfma_f32_16x16x32_bf16 v[160:163], v[44:47], a[244:247], v[160:163]
    ds_read_b64_tr_b16 v[64:65], v59 offset:1024
    v_mul_f32 v28, v14, v196
    v_mfma_f32_16x16x32_bf16 v[160:163], v[48:51], v[224:227], v[160:163]
    ds_read_b64_tr_b16 v[66:67], v59 offset:10240
    v_mul_f32 v29, v14, v197
    v_mfma_f32_16x16x32_bf16 v[160:163], v[52:55], v[240:243], v[160:163]
    ds_read_b64_tr_b16 v[68:69], v59 offset:2048
    v_mul_f32 v30, v14, v198
    v_mfma_f32_16x16x32_bf16 v[164:167], v[44:47], a[248:251], v[164:167]
    ds_read_b64_tr_b16 v[70:71], v59 offset:11264
    v_mul_f32 v31, v14, v199
    v_mfma_f32_16x16x32_bf16 v[164:167], v[48:51], v[228:231], v[164:167]
    v_exp_f32 v26, v26
    v_mfma_f32_16x16x32_bf16 v[164:167], v[52:55], v[244:247], v[164:167]
    v_exp_f32 v27, v27
    v_mfma_f32_16x16x32_bf16 v[168:171], v[44:47], a[252:255], v[168:171]
    v_rcp_f32 v24, v24
    v_mfma_f32_16x16x32_bf16 v[168:171], v[48:51], v[232:235], v[168:171]
    v_rcp_f32 v25, v25
    v_mfma_f32_16x16x32_bf16 v[168:171], v[52:55], v[248:251], v[168:171]
    s_waitcnt lgkmcnt(0)
    v_exp_f32 v28, v28
    v_mfma_f32_16x16x32_bf16 v[108:111], v[60:63], a[144:147], v[108:111]
    ds_read_b64_tr_b16 v[44:45], v59 offset:3072
    v_fma_f32 v26, v26, v17, v17
    v_mfma_f32_16x16x32_bf16 v[108:111], v[64:67], a[160:163], v[108:111]
    ds_read_b64_tr_b16 v[46:47], v59 offset:12288
    v_fma_f32 v27, v27, v17, v17
    v_mfma_f32_16x16x32_bf16 v[108:111], v[68:71], a[176:179], v[108:111]
    ds_read_b64_tr_b16 v[48:49], v59 offset:4096
    v_mul_f32 v192, v24, v192
    v_mfma_f32_16x16x32_bf16 v[112:115], v[60:63], a[148:151], v[112:115]
    ds_read_b64_tr_b16 v[50:51], v59 offset:13312
    v_mul_f32 v193, v25, v193
    v_mfma_f32_16x16x32_bf16 v[112:115], v[64:67], a[164:167], v[112:115]
    ds_read_b64_tr_b16 v[52:53], v59 offset:5120
    v_fma_f32 v28, v28, v18, v18
    v_mfma_f32_16x16x32_bf16 v[112:115], v[68:71], a[180:183], v[112:115]
    ds_read_b64_tr_b16 v[54:55], v59 offset:14336
    v_mfma_f32_16x16x32_bf16 v[116:119], v[60:63], a[152:155], v[116:119]
    v_rcp_f32 v26, v26
    v_mfma_f32_16x16x32_bf16 v[116:119], v[64:67], a[168:171], v[116:119]
    v_rcp_f32 v27, v27
    v_mfma_f32_16x16x32_bf16 v[116:119], v[68:71], a[184:187], v[116:119]
    v_exp_f32 v29, v29
    v_mfma_f32_16x16x32_bf16 v[120:123], v[60:63], a[156:159], v[120:123]
    v_exp_f32 v30, v30
    v_mfma_f32_16x16x32_bf16 v[120:123], v[64:67], a[172:175], v[120:123]
    v_exp_f32 v31, v31
    v_mfma_f32_16x16x32_bf16 v[120:123], v[68:71], a[188:191], v[120:123]
    s_waitcnt lgkmcnt(0)
    v_rcp_f32 v28, v28
    v_mfma_f32_16x16x32_bf16 v[120:123], v[44:47], a[204:207], v[120:123]
    ds_read_b64_tr_b16 v[60:61], v59 offset:6144
    v_mul_f32 v194, v26, v194
    v_mfma_f32_16x16x32_bf16 v[120:123], v[48:51], a[220:223], v[120:123]
    ds_read_b64_tr_b16 v[62:63], v59 offset:15360
    v_mul_f32 v195, v27, v195
    v_mfma_f32_16x16x32_bf16 v[120:123], v[52:55], a[236:239], v[120:123]
    ds_read_b64_tr_b16 v[64:65], v59 offset:7168
    v_fma_f32 v29, v29, v18, v18
    v_mfma_f32_16x16x32_bf16 v[116:119], v[44:47], a[200:203], v[116:119]
    ds_read_b64_tr_b16 v[66:67], v59 offset:16384
    v_fma_f32 v30, v30, v18, v18
    v_mfma_f32_16x16x32_bf16 v[116:119], v[48:51], a[216:219], v[116:119]
    ds_read_b64_tr_b16 v[68:69], v59 offset:8192
    v_fma_f32 v31, v31, v18, v18
    v_mfma_f32_16x16x32_bf16 v[116:119], v[52:55], a[232:235], v[116:119]
    ds_read_b64_tr_b16 v[70:71], v59 offset:17408
    v_mul_f32 v196, v28, v196
    v_mfma_f32_16x16x32_bf16 v[112:115], v[44:47], a[196:199], v[112:115]
    v_rcp_f32 v29, v29
    v_mfma_f32_16x16x32_bf16 v[112:115], v[48:51], a[212:215], v[112:115]
    v_rcp_f32 v30, v30
    v_mfma_f32_16x16x32_bf16 v[112:115], v[52:55], a[228:231], v[112:115]
    v_rcp_f32 v31, v31
    v_mfma_f32_16x16x32_bf16 v[108:111], v[44:47], a[192:195], v[108:111]
    v_mul_f32 v197, v29, v197
    v_mul_f32 v198, v30, v198
    v_mfma_f32_16x16x32_bf16 v[108:111], v[48:51], a[208:211], v[108:111]
    v_mul_f32 v199, v31, v199
    v_mul_f32 v32, v15, v200
    v_mfma_f32_16x16x32_bf16 v[108:111], v[52:55], a[224:227], v[108:111]
    s_waitcnt lgkmcnt(0)
    v_exp_f32 v32, v32
    v_mfma_f32_16x16x32_bf16 v[108:111], v[60:63], a[240:243], v[108:111]
    s_waitcnt vmcnt(11)
    s_barrier
    s_add_u32 m0, s12, 73728
    v_mfma_f32_16x16x32_bf16 v[108:111], v[64:67], v[220:223], v[108:111]
    s_mov_b64 s[40:41], s[50:51]
    s_add_u32 s15, s18, 4096
    ds_read_b64_tr_b16 v[44:45], v56 offset:36864
    v_mfma_f32_16x16x32_bf16 v[108:111], v[68:71], v[236:239], v[108:111]
    buffer_load_dwordx4 v11, s[40:43], s15 offen  lds
    ds_read_b64_tr_b16 v[46:47], v56 offset:46080
    v_mfma_f32_16x16x32_bf16 v[112:115], v[60:63], a[244:247], v[112:115]
    s_add_u32 m0, s12, 74752
    ds_read_b64_tr_b16 v[48:49], v56 offset:37888
    v_mul_f32 v33, v15, v201
    v_mfma_f32_16x16x32_bf16 v[112:115], v[64:67], v[224:227], v[112:115]
    s_add_u32 s15, s15, s19
    ds_read_b64_tr_b16 v[50:51], v56 offset:47104
    v_mul_f32 v34, v15, v202
    v_mfma_f32_16x16x32_bf16 v[112:115], v[68:71], v[240:243], v[112:115]
    ds_read_b64_tr_b16 v[52:53], v56 offset:38912
    v_mul_f32 v35, v15, v203
    v_mfma_f32_16x16x32_bf16 v[116:119], v[60:63], a[248:251], v[116:119]
    ds_read_b64_tr_b16 v[54:55], v56 offset:48128
    v_fma_f32 v32, v32, v19, v19
    v_mfma_f32_16x16x32_bf16 v[116:119], v[64:67], v[228:231], v[116:119]
    buffer_load_dwordx4 v11, s[40:43], s15 offen  lds
    v_mul_f32 v20, v12, v204
    v_mfma_f32_16x16x32_bf16 v[116:119], v[68:71], v[244:247], v[116:119]
    s_add_u32 m0, s12, 75776
    v_exp_f32 v33, v33
    v_mfma_f32_16x16x32_bf16 v[120:123], v[60:63], a[252:255], v[120:123]
    s_add_u32 s15, s15, s19
    v_exp_f32 v34, v34
    v_mfma_f32_16x16x32_bf16 v[120:123], v[64:67], v[232:235], v[120:123]
    v_exp_f32 v35, v35
    v_mfma_f32_16x16x32_bf16 v[120:123], v[68:71], v[248:251], v[120:123]
    s_waitcnt lgkmcnt(0)
    v_rcp_f32 v32, v32
    v_mfma_f32_16x16x32_bf16 v[76:79], v[44:47], a[0:3], 0
    ds_read_b64_tr_b16 v[60:61], v56 offset:39936
    v_fma_f32 v33, v33, v19, v19
    v_mfma_f32_16x16x32_bf16 v[76:79], v[48:51], a[16:19], v[76:79]
    buffer_load_dwordx4 v11, s[40:43], s15 offen  lds
    ds_read_b64_tr_b16 v[62:63], v56 offset:49152
    v_mfma_f32_16x16x32_bf16 v[76:79], v[52:55], a[32:35], v[76:79]
    s_add_u32 m0, s12, 76800
    ds_read_b64_tr_b16 v[64:65], v56 offset:40960
    v_fma_f32 v34, v34, v19, v19
    v_mfma_f32_16x16x32_bf16 v[80:83], v[44:47], a[4:7], 0
    s_add_u32 s15, s15, s19
    ds_read_b64_tr_b16 v[66:67], v56 offset:50176
    v_fma_f32 v35, v35, v19, v19
    v_mfma_f32_16x16x32_bf16 v[80:83], v[48:51], a[20:23], v[80:83]
    ds_read_b64_tr_b16 v[68:69], v56 offset:41984
    v_mul_f32 v200, v32, v200
    v_mfma_f32_16x16x32_bf16 v[80:83], v[52:55], a[36:39], v[80:83]
    ds_read_b64_tr_b16 v[70:71], v56 offset:51200
    v_mul_f32 v21, v12, v205
    v_mfma_f32_16x16x32_bf16 v[84:87], v[44:47], a[8:11], 0
    v_rcp_f32 v33, v33
    v_mfma_f32_16x16x32_bf16 v[84:87], v[48:51], a[24:27], v[84:87]
    buffer_load_dwordx4 v11, s[40:43], s15 offen  lds
    v_mul_f32 v201, v33, v201
    v_mfma_f32_16x16x32_bf16 v[84:87], v[52:55], a[40:43], v[84:87]
    s_add_u32 m0, s12, 77824
    v_rcp_f32 v34, v34
    v_mfma_f32_16x16x32_bf16 v[88:91], v[44:47], a[12:15], 0
    s_add_u32 s15, s15, s19
    v_rcp_f32 v35, v35
    v_mfma_f32_16x16x32_bf16 v[88:91], v[48:51], a[28:31], v[88:91]
    v_exp_f32 v20, v20
    v_mfma_f32_16x16x32_bf16 v[88:91], v[52:55], a[44:47], v[88:91]
    s_waitcnt lgkmcnt(0)
    v_exp_f32 v21, v21
    v_mfma_f32_16x16x32_bf16 v[88:91], v[60:63], a[60:63], v[88:91]
    ds_read_b64_tr_b16 v[44:45], v56 offset:43008
    v_mul_f32 v202, v34, v202
    v_mfma_f32_16x16x32_bf16 v[88:91], v[64:67], a[76:79], v[88:91]
    buffer_load_dwordx4 v11, s[40:43], s15 offen  lds
    ds_read_b64_tr_b16 v[46:47], v56 offset:52224
    v_mfma_f32_16x16x32_bf16 v[88:91], v[68:71], a[92:95], v[88:91]
    s_add_u32 m0, s12, 78848
    ds_read_b64_tr_b16 v[48:49], v56 offset:44032
    v_mul_f32 v203, v35, v203
    v_mfma_f32_16x16x32_bf16 v[84:87], v[60:63], a[56:59], v[84:87]
    s_add_u32 s15, s15, s19
    ds_read_b64_tr_b16 v[50:51], v56 offset:53248
    v_mul_f32 v188, v188, v124
    v_mfma_f32_16x16x32_bf16 v[84:87], v[64:67], a[72:75], v[84:87]
    s_mov_b32 s17, 1024
    ds_read_b64_tr_b16 v[52:53], v56 offset:45056
    v_mul_f32 v189, v189, v125
    v_mfma_f32_16x16x32_bf16 v[84:87], v[68:71], a[88:91], v[84:87]
    ds_read_b64_tr_b16 v[54:55], v56 offset:54272
    v_mul_f32 v190, v190, v126
    v_mfma_f32_16x16x32_bf16 v[80:83], v[60:63], a[52:55], v[80:83]
    v_mul_f32 v191, v191, v127
    v_mul_f32 v192, v192, v128
    v_mfma_f32_16x16x32_bf16 v[80:83], v[64:67], a[68:71], v[80:83]
    buffer_load_dwordx4 v11, s[40:43], s15 offen  lds
    v_mul_f32 v193, v193, v129
    v_mfma_f32_16x16x32_bf16 v[80:83], v[68:71], a[84:87], v[80:83]
    s_add_u32 m0, s12, 79872
    v_mul_f32 v194, v194, v130
    v_mul_f32 v195, v195, v131
    v_mfma_f32_16x16x32_bf16 v[76:79], v[60:63], a[48:51], v[76:79]
    s_add_u32 s15, s15, s19
    v_cvt_pk_bf16_f32 v36, v188, v189
    v_cvt_pk_bf16_f32 v37, v190, v191
    v_mfma_f32_16x16x32_bf16 v[76:79], v[64:67], a[64:67], v[76:79]
    v_cvt_pk_bf16_f32 v38, v192, v193
    v_cvt_pk_bf16_f32 v39, v194, v195
    v_mfma_f32_16x16x32_bf16 v[76:79], v[68:71], a[80:83], v[76:79]
    s_waitcnt lgkmcnt(0)
    v_mul_f32 v196, v196, v132
    v_mul_f32 v197, v197, v133
    v_mfma_f32_16x16x32_bf16 v[76:79], v[44:47], a[96:99], v[76:79]
    v_add_u32 v56, 4294893568, v56
    v_mul_f32 v198, v198, v134
    v_mfma_f32_16x16x32_bf16 v[76:79], v[48:51], a[112:115], v[76:79]
    buffer_load_dwordx4 v11, s[40:43], s15 offen  lds
    ds_read_b64_tr_b16 v[60:61], v56 offset:0
    v_mfma_f32_16x16x32_bf16 v[76:79], v[52:55], a[128:131], v[76:79]
    s_add_u32 m0, s12, 80896
    ds_read_b64_tr_b16 v[62:63], v56 offset:9216
    v_mul_f32 v199, v199, v135
    v_mfma_f32_16x16x32_bf16 v[80:83], v[44:47], a[100:103], v[80:83]
    s_add_u32 s15, s15, s19
    ds_read_b64_tr_b16 v[64:65], v56 offset:1024
    v_mul_f32 v200, v200, v136
    v_mfma_f32_16x16x32_bf16 v[80:83], v[48:51], a[116:119], v[80:83]
    ds_read_b64_tr_b16 v[66:67], v56 offset:10240
    v_mul_f32 v201, v201, v137
    v_mfma_f32_16x16x32_bf16 v[80:83], v[52:55], a[132:135], v[80:83]
    ds_read_b64_tr_b16 v[68:69], v56 offset:2048
    v_mul_f32 v202, v202, v138
    v_mfma_f32_16x16x32_bf16 v[84:87], v[44:47], a[104:107], v[84:87]
    ds_read_b64_tr_b16 v[70:71], v56 offset:11264
    v_mul_f32 v203, v203, v139
    v_mfma_f32_16x16x32_bf16 v[84:87], v[48:51], a[120:123], v[84:87]
    buffer_load_dwordx4 v11, s[40:43], s15 offen  lds
    v_cvt_pk_bf16_f32 v40, v196, v197
    v_mfma_f32_16x16x32_bf16 v[84:87], v[52:55], a[136:139], v[84:87]
    s_add_u32 m0, s12, 81920
    v_cvt_pk_bf16_f32 v41, v198, v199
    v_cvt_pk_bf16_f32 v42, v200, v201
    v_mfma_f32_16x16x32_bf16 v[88:91], v[44:47], a[108:111], v[88:91]
    s_add_u32 s15, s15, s19
    v_cvt_pk_bf16_f32 v43, v202, v203
    v_permlane16_swap_b32 v36, v38
    v_mfma_f32_16x16x32_bf16 v[88:91], v[48:51], a[124:127], v[88:91]
    v_permlane16_swap_b32 v37, v39
    v_permlane16_swap_b32 v40, v42
    v_mfma_f32_16x16x32_bf16 v[88:91], v[52:55], a[140:143], v[88:91]
    s_waitcnt lgkmcnt(0)
    v_permlane16_swap_b32 v41, v43
    v_mul_f32 v22, v12, v206
    v_mfma_f32_16x16x32_bf16 v[88:91], v[60:63], a[156:159], v[88:91]
    ds_read_b64_tr_b16 v[44:45], v56 offset:3072
    v_mul_f32 v23, v12, v207
    v_mfma_f32_16x16x32_bf16 v[88:91], v[64:67], a[172:175], v[88:91]
    buffer_store_dwordx4 v[36:39], v7, s[8:11], s17 offen sc1
    ds_read_b64_tr_b16 v[46:47], v56 offset:12288
    v_mfma_f32_16x16x32_bf16 v[88:91], v[68:71], a[188:191], v[88:91]
    s_mov_b32 s17, 295936
    ds_read_b64_tr_b16 v[48:49], v56 offset:4096
    v_fma_f32 v20, v20, v16, v16
    v_mfma_f32_16x16x32_bf16 v[84:87], v[60:63], a[152:155], v[84:87]
    ds_read_b64_tr_b16 v[50:51], v56 offset:13312
    v_fma_f32 v21, v21, v16, v16
    v_mfma_f32_16x16x32_bf16 v[84:87], v[64:67], a[168:171], v[84:87]
    ds_read_b64_tr_b16 v[52:53], v56 offset:5120
    v_mul_f32 v24, v13, v208
    v_mfma_f32_16x16x32_bf16 v[84:87], v[68:71], a[184:187], v[84:87]
    ds_read_b64_tr_b16 v[54:55], v56 offset:14336
    v_mul_f32 v25, v13, v209
    v_mfma_f32_16x16x32_bf16 v[80:83], v[60:63], a[148:151], v[80:83]
    buffer_store_dwordx4 v[40:43], v7, s[8:11], s17 offen sc1
    v_mul_f32 v26, v13, v210
    v_mfma_f32_16x16x32_bf16 v[80:83], v[64:67], a[164:167], v[80:83]
    v_exp_f32 v22, v22
    v_mfma_f32_16x16x32_bf16 v[80:83], v[68:71], a[180:183], v[80:83]
    v_exp_f32 v23, v23
    v_mfma_f32_16x16x32_bf16 v[76:79], v[60:63], a[144:147], v[76:79]
L_pad_c3_2:
    s_cbranch_execz L_pad_c3_6
    v_rcp_f32 v20, v20
    v_mfma_f32_16x16x32_bf16 v[76:79], v[64:67], a[160:163], v[76:79]
    v_rcp_f32 v21, v21
    v_mfma_f32_16x16x32_bf16 v[76:79], v[68:71], a[176:179], v[76:79]
    s_waitcnt lgkmcnt(0)
    v_exp_f32 v24, v24
    v_mfma_f32_16x16x32_bf16 v[76:79], v[44:47], a[192:195], v[76:79]
    buffer_load_dwordx4 v11, s[40:43], s15 offen  lds
    ds_read_b64_tr_b16 v[60:61], v56 offset:6144
    v_mfma_f32_16x16x32_bf16 v[76:79], v[48:51], a[208:211], v[76:79]
    ds_read_b64_tr_b16 v[62:63], v56 offset:15360
    v_fma_f32 v22, v22, v16, v16
    v_mfma_f32_16x16x32_bf16 v[76:79], v[52:55], a[224:227], v[76:79]
    ds_read_b64_tr_b16 v[64:65], v56 offset:7168
    v_fma_f32 v23, v23, v16, v16
    v_mfma_f32_16x16x32_bf16 v[80:83], v[44:47], a[196:199], v[80:83]
    ds_read_b64_tr_b16 v[66:67], v56 offset:16384
    v_mul_f32 v204, v20, v204
    v_mfma_f32_16x16x32_bf16 v[80:83], v[48:51], a[212:215], v[80:83]
    ds_read_b64_tr_b16 v[68:69], v56 offset:8192
    v_mul_f32 v205, v21, v205
    v_mfma_f32_16x16x32_bf16 v[80:83], v[52:55], a[228:231], v[80:83]
    ds_read_b64_tr_b16 v[70:71], v56 offset:17408
    v_mul_f32 v27, v13, v211
    v_mfma_f32_16x16x32_bf16 v[84:87], v[44:47], a[200:203], v[84:87]
    v_rcp_f32 v22, v22
    v_mfma_f32_16x16x32_bf16 v[84:87], v[48:51], a[216:219], v[84:87]
    v_rcp_f32 v23, v23
    v_mfma_f32_16x16x32_bf16 v[84:87], v[52:55], a[232:235], v[84:87]
    v_exp_f32 v25, v25
    v_mfma_f32_16x16x32_bf16 v[88:91], v[44:47], a[204:207], v[88:91]
    v_exp_f32 v26, v26
    v_mfma_f32_16x16x32_bf16 v[88:91], v[48:51], a[220:223], v[88:91]
    v_exp_f32 v27, v27
    v_mfma_f32_16x16x32_bf16 v[88:91], v[52:55], a[236:239], v[88:91]
    s_waitcnt lgkmcnt(0)
    v_mul_f32 v206, v22, v206
    v_mul_f32 v207, v23, v207
    v_mfma_f32_16x16x32_bf16 v[88:91], v[60:63], a[252:255], v[88:91]
    ds_read_b64_tr_b16 v[44:45], v57 offset:36864
    v_fma_f32 v24, v24, v17, v17
    v_mfma_f32_16x16x32_bf16 v[88:91], v[64:67], v[232:235], v[88:91]
    ds_read_b64_tr_b16 v[46:47], v57 offset:46080
    v_fma_f32 v25, v25, v17, v17
    v_mfma_f32_16x16x32_bf16 v[88:91], v[68:71], v[248:251], v[88:91]
    ds_read_b64_tr_b16 v[48:49], v57 offset:37888
    v_fma_f32 v26, v26, v17, v17
    v_mfma_f32_16x16x32_bf16 v[84:87], v[60:63], a[248:251], v[84:87]
    ds_read_b64_tr_b16 v[50:51], v57 offset:47104
    v_fma_f32 v27, v27, v17, v17
    v_mfma_f32_16x16x32_bf16 v[84:87], v[64:67], v[228:231], v[84:87]
    ds_read_b64_tr_b16 v[52:53], v57 offset:38912
    v_mul_f32 v28, v14, v212
    v_mfma_f32_16x16x32_bf16 v[84:87], v[68:71], v[244:247], v[84:87]
    ds_read_b64_tr_b16 v[54:55], v57 offset:48128
    v_mul_f32 v29, v14, v213
    v_mfma_f32_16x16x32_bf16 v[80:83], v[60:63], a[244:247], v[80:83]
    v_rcp_f32 v24, v24
    v_mfma_f32_16x16x32_bf16 v[80:83], v[64:67], v[224:227], v[80:83]
    v_rcp_f32 v25, v25
    v_mfma_f32_16x16x32_bf16 v[80:83], v[68:71], v[240:243], v[80:83]
    v_rcp_f32 v26, v26
    v_mfma_f32_16x16x32_bf16 v[76:79], v[60:63], a[240:243], v[76:79]
    v_rcp_f32 v27, v27
    v_mfma_f32_16x16x32_bf16 v[76:79], v[64:67], v[220:223], v[76:79]
    v_exp_f32 v28, v28
    v_mfma_f32_16x16x32_bf16 v[76:79], v[68:71], v[236:239], v[76:79]
    s_waitcnt lgkmcnt(0)
    v_exp_f32 v29, v29
    v_mfma_f32_16x16x32_bf16 v[140:143], v[44:47], a[0:3], 0
    ds_read_b64_tr_b16 v[60:61], v57 offset:39936
    v_mul_f32 v208, v24, v208
    v_mfma_f32_16x16x32_bf16 v[140:143], v[48:51], a[16:19], v[140:143]
    ds_read_b64_tr_b16 v[62:63], v57 offset:49152
    v_mul_f32 v209, v25, v209
    v_mfma_f32_16x16x32_bf16 v[140:143], v[52:55], a[32:35], v[140:143]
    ds_read_b64_tr_b16 v[64:65], v57 offset:40960
    v_mul_f32 v210, v26, v210
    v_mfma_f32_16x16x32_bf16 v[144:147], v[44:47], a[4:7], 0
    ds_read_b64_tr_b16 v[66:67], v57 offset:50176
    v_mul_f32 v211, v27, v211
    v_mfma_f32_16x16x32_bf16 v[144:147], v[48:51], a[20:23], v[144:147]
    ds_read_b64_tr_b16 v[68:69], v57 offset:41984
    v_mul_f32 v30, v14, v214
    v_mfma_f32_16x16x32_bf16 v[144:147], v[52:55], a[36:39], v[144:147]
    ds_read_b64_tr_b16 v[70:71], v57 offset:51200
    v_mul_f32 v31, v14, v215
    v_mfma_f32_16x16x32_bf16 v[148:151], v[44:47], a[8:11], 0
    v_exp_f32 v30, v30
    v_mfma_f32_16x16x32_bf16 v[148:151], v[48:51], a[24:27], v[148:151]
    v_exp_f32 v31, v31
    v_mfma_f32_16x16x32_bf16 v[148:151], v[52:55], a[40:43], v[148:151]
    v_fma_f32 v28, v28, v18, v18
    v_fma_f32 v29, v29, v18, v18
    v_mfma_f32_16x16x32_bf16 v[152:155], v[44:47], a[12:15], 0
    v_rcp_f32 v28, v28
    v_mfma_f32_16x16x32_bf16 v[152:155], v[48:51], a[28:31], v[152:155]
    v_rcp_f32 v29, v29
    v_mfma_f32_16x16x32_bf16 v[152:155], v[52:55], a[44:47], v[152:155]
    s_waitcnt lgkmcnt(0)
    v_fma_f32 v30, v30, v18, v18
    v_fma_f32 v31, v31, v18, v18
    v_mfma_f32_16x16x32_bf16 v[152:155], v[60:63], a[60:63], v[152:155]
    ds_read_b64_tr_b16 v[44:45], v57 offset:43008
    v_mul_f32 v212, v28, v212
    v_mfma_f32_16x16x32_bf16 v[152:155], v[64:67], a[76:79], v[152:155]
    ds_read_b64_tr_b16 v[46:47], v57 offset:52224
    v_mul_f32 v213, v29, v213
    v_mfma_f32_16x16x32_bf16 v[152:155], v[68:71], a[92:95], v[152:155]
    ds_read_b64_tr_b16 v[48:49], v57 offset:44032
    v_mul_f32 v32, v15, v216
    v_mfma_f32_16x16x32_bf16 v[148:151], v[60:63], a[56:59], v[148:151]
    ds_read_b64_tr_b16 v[50:51], v57 offset:53248
    v_mul_f32 v33, v15, v217
    v_mfma_f32_16x16x32_bf16 v[148:151], v[64:67], a[72:75], v[148:151]
    ds_read_b64_tr_b16 v[52:53], v57 offset:45056
    v_mul_f32 v34, v15, v218
    v_mfma_f32_16x16x32_bf16 v[148:151], v[68:71], a[88:91], v[148:151]
    ds_read_b64_tr_b16 v[54:55], v57 offset:54272
    v_mul_f32 v35, v15, v219
    v_mfma_f32_16x16x32_bf16 v[144:147], v[60:63], a[52:55], v[144:147]
    v_rcp_f32 v30, v30
    v_mfma_f32_16x16x32_bf16 v[144:147], v[64:67], a[68:71], v[144:147]
    v_rcp_f32 v31, v31
    v_mfma_f32_16x16x32_bf16 v[144:147], v[68:71], a[84:87], v[144:147]
    v_exp_f32 v32, v32
    v_mfma_f32_16x16x32_bf16 v[140:143], v[60:63], a[48:51], v[140:143]
    v_exp_f32 v33, v33
    v_mfma_f32_16x16x32_bf16 v[140:143], v[64:67], a[64:67], v[140:143]
    v_exp_f32 v34, v34
    v_mfma_f32_16x16x32_bf16 v[140:143], v[68:71], a[80:83], v[140:143]
    s_waitcnt lgkmcnt(0)
    v_exp_f32 v35, v35
    v_mfma_f32_16x16x32_bf16 v[140:143], v[44:47], a[96:99], v[140:143]
    v_add_u32 v57, 4294893568, v57
    v_mul_f32 v214, v30, v214
    v_mfma_f32_16x16x32_bf16 v[140:143], v[48:51], a[112:115], v[140:143]
    ds_read_b64_tr_b16 v[60:61], v57 offset:0
    v_mul_f32 v215, v31, v215
    v_mfma_f32_16x16x32_bf16 v[140:143], v[52:55], a[128:131], v[140:143]
    ds_read_b64_tr_b16 v[62:63], v57 offset:9216
    v_fma_f32 v32, v32, v19, v19
    v_mfma_f32_16x16x32_bf16 v[144:147], v[44:47], a[100:103], v[144:147]
    ds_read_b64_tr_b16 v[64:65], v57 offset:1024
    v_fma_f32 v33, v33, v19, v19
    v_mfma_f32_16x16x32_bf16 v[144:147], v[48:51], a[116:119], v[144:147]
    ds_read_b64_tr_b16 v[66:67], v57 offset:10240
    v_fma_f32 v34, v34, v19, v19
    v_mfma_f32_16x16x32_bf16 v[144:147], v[52:55], a[132:135], v[144:147]
    ds_read_b64_tr_b16 v[68:69], v57 offset:2048
    v_fma_f32 v35, v35, v19, v19
    v_mfma_f32_16x16x32_bf16 v[148:151], v[44:47], a[104:107], v[148:151]
    ds_read_b64_tr_b16 v[70:71], v57 offset:11264
    v_mul_f32 v20, v12, v172
    v_mfma_f32_16x16x32_bf16 v[148:151], v[48:51], a[120:123], v[148:151]
    v_rcp_f32 v32, v32
    v_mfma_f32_16x16x32_bf16 v[148:151], v[52:55], a[136:139], v[148:151]
    v_rcp_f32 v33, v33
    v_mfma_f32_16x16x32_bf16 v[152:155], v[44:47], a[108:111], v[152:155]
    v_rcp_f32 v34, v34
    v_mfma_f32_16x16x32_bf16 v[152:155], v[48:51], a[124:127], v[152:155]
    v_rcp_f32 v35, v35
    v_mfma_f32_16x16x32_bf16 v[152:155], v[52:55], a[140:143], v[152:155]
    s_waitcnt lgkmcnt(0)
    v_exp_f32 v20, v20
    v_mfma_f32_16x16x32_bf16 v[152:155], v[60:63], a[156:159], v[152:155]
    ds_read_b64_tr_b16 v[44:45], v57 offset:3072
    v_mul_f32 v216, v32, v216
    v_mfma_f32_16x16x32_bf16 v[152:155], v[64:67], a[172:175], v[152:155]
    ds_read_b64_tr_b16 v[46:47], v57 offset:12288
    v_mul_f32 v217, v33, v217
    v_mfma_f32_16x16x32_bf16 v[152:155], v[68:71], a[188:191], v[152:155]
    ds_read_b64_tr_b16 v[48:49], v57 offset:4096
    v_mul_f32 v218, v34, v218
    v_mfma_f32_16x16x32_bf16 v[148:151], v[60:63], a[152:155], v[148:151]
    ds_read_b64_tr_b16 v[50:51], v57 offset:13312
    v_mul_f32 v219, v35, v219
    v_mfma_f32_16x16x32_bf16 v[148:151], v[64:67], a[168:171], v[148:151]
    s_mov_b32 s17, 2048
    ds_read_b64_tr_b16 v[52:53], v57 offset:5120
    v_mul_f32 v204, v204, v156
    v_mfma_f32_16x16x32_bf16 v[148:151], v[68:71], a[184:187], v[148:151]
    ds_read_b64_tr_b16 v[54:55], v57 offset:14336
    v_mul_f32 v205, v205, v157
    v_mfma_f32_16x16x32_bf16 v[144:147], v[60:63], a[148:151], v[144:147]
    v_mul_f32 v206, v206, v158
    v_mul_f32 v207, v207, v159
    v_mfma_f32_16x16x32_bf16 v[144:147], v[64:67], a[164:167], v[144:147]
    v_mul_f32 v208, v208, v160
    v_mul_f32 v209, v209, v161
    v_mfma_f32_16x16x32_bf16 v[144:147], v[68:71], a[180:183], v[144:147]
    v_mul_f32 v210, v210, v162
    v_mul_f32 v211, v211, v163
    v_mfma_f32_16x16x32_bf16 v[140:143], v[60:63], a[144:147], v[140:143]
    v_cvt_pk_bf16_f32 v36, v204, v205
    v_cvt_pk_bf16_f32 v37, v206, v207
    v_mfma_f32_16x16x32_bf16 v[140:143], v[64:67], a[160:163], v[140:143]
    v_cvt_pk_bf16_f32 v38, v208, v209
    v_cvt_pk_bf16_f32 v39, v210, v211
    v_mfma_f32_16x16x32_bf16 v[140:143], v[68:71], a[176:179], v[140:143]
    s_waitcnt lgkmcnt(0)
    v_mul_f32 v212, v212, v164
    v_mul_f32 v213, v213, v165
    v_mfma_f32_16x16x32_bf16 v[140:143], v[44:47], a[192:195], v[140:143]
    ds_read_b64_tr_b16 v[60:61], v57 offset:6144
    v_mul_f32 v214, v214, v166
    v_mfma_f32_16x16x32_bf16 v[140:143], v[48:51], a[208:211], v[140:143]
    ds_read_b64_tr_b16 v[62:63], v57 offset:15360
    v_mul_f32 v215, v215, v167
    v_mfma_f32_16x16x32_bf16 v[140:143], v[52:55], a[224:227], v[140:143]
    ds_read_b64_tr_b16 v[64:65], v57 offset:7168
    v_mul_f32 v216, v216, v168
    v_mfma_f32_16x16x32_bf16 v[144:147], v[44:47], a[196:199], v[144:147]
    ds_read_b64_tr_b16 v[66:67], v57 offset:16384
    v_mul_f32 v217, v217, v169
    v_mfma_f32_16x16x32_bf16 v[144:147], v[48:51], a[212:215], v[144:147]
    ds_read_b64_tr_b16 v[68:69], v57 offset:8192
    v_mul_f32 v218, v218, v170
    v_mfma_f32_16x16x32_bf16 v[144:147], v[52:55], a[228:231], v[144:147]
    ds_read_b64_tr_b16 v[70:71], v57 offset:17408
    v_mul_f32 v219, v219, v171
    v_mfma_f32_16x16x32_bf16 v[148:151], v[44:47], a[200:203], v[148:151]
    v_cvt_pk_bf16_f32 v40, v212, v213
    v_cvt_pk_bf16_f32 v41, v214, v215
    v_mfma_f32_16x16x32_bf16 v[148:151], v[48:51], a[216:219], v[148:151]
    v_cvt_pk_bf16_f32 v42, v216, v217
    v_cvt_pk_bf16_f32 v43, v218, v219
    v_mfma_f32_16x16x32_bf16 v[148:151], v[52:55], a[232:235], v[148:151]
    v_permlane16_swap_b32 v36, v38
    v_permlane16_swap_b32 v37, v39
    v_mfma_f32_16x16x32_bf16 v[152:155], v[44:47], a[204:207], v[152:155]
    buffer_store_dwordx4 v[36:39], v7, s[8:11], s17 offen sc1
    v_permlane16_swap_b32 v40, v42
    v_mfma_f32_16x16x32_bf16 v[152:155], v[48:51], a[220:223], v[152:155]
    s_mov_b32 s17, 296960
    v_permlane16_swap_b32 v41, v43
    v_mul_f32 v21, v12, v173
    v_mfma_f32_16x16x32_bf16 v[152:155], v[52:55], a[236:239], v[152:155]
    s_waitcnt lgkmcnt(0)
    v_exp_f32 v21, v21
    v_mfma_f32_16x16x32_bf16 v[152:155], v[60:63], a[252:255], v[152:155]
    ds_read_b64_tr_b16 v[44:45], v58 offset:36864
    v_mul_f32 v22, v12, v174
    v_mfma_f32_16x16x32_bf16 v[152:155], v[64:67], v[232:235], v[152:155]
    buffer_store_dwordx4 v[40:43], v7, s[8:11], s17 offen sc1
    ds_read_b64_tr_b16 v[46:47], v58 offset:46080
    v_mfma_f32_16x16x32_bf16 v[152:155], v[68:71], v[248:251], v[152:155]
    ds_read_b64_tr_b16 v[48:49], v58 offset:37888
    v_mul_f32 v23, v12, v175
    v_mfma_f32_16x16x32_bf16 v[148:151], v[60:63], a[248:251], v[148:151]
    ds_read_b64_tr_b16 v[50:51], v58 offset:47104
    v_fma_f32 v20, v20, v16, v16
    v_mfma_f32_16x16x32_bf16 v[148:151], v[64:67], v[228:231], v[148:151]
    ds_read_b64_tr_b16 v[52:53], v58 offset:38912
    v_fma_f32 v21, v21, v16, v16
    v_mfma_f32_16x16x32_bf16 v[148:151], v[68:71], v[244:247], v[148:151]
    ds_read_b64_tr_b16 v[54:55], v58 offset:48128
    v_mul_f32 v24, v13, v176
    v_mfma_f32_16x16x32_bf16 v[144:147], v[60:63], a[244:247], v[144:147]
    v_exp_f32 v22, v22
    v_mfma_f32_16x16x32_bf16 v[144:147], v[64:67], v[224:227], v[144:147]
    v_exp_f32 v23, v23
    v_mfma_f32_16x16x32_bf16 v[144:147], v[68:71], v[240:243], v[144:147]
    v_rcp_f32 v20, v20
    v_mfma_f32_16x16x32_bf16 v[140:143], v[60:63], a[240:243], v[140:143]
    v_rcp_f32 v21, v21
    v_mfma_f32_16x16x32_bf16 v[140:143], v[64:67], v[220:223], v[140:143]
    v_fma_f32 v22, v22, v16, v16
    v_fma_f32 v23, v23, v16, v16
    v_mfma_f32_16x16x32_bf16 v[140:143], v[68:71], v[236:239], v[140:143]
    s_waitcnt lgkmcnt(0)
    v_rcp_f32 v22, v22
    v_mfma_f32_16x16x32_bf16 v[92:95], v[44:47], a[0:3], 0
    ds_read_b64_tr_b16 v[60:61], v58 offset:39936
    v_mul_f32 v172, v20, v172
    v_mfma_f32_16x16x32_bf16 v[92:95], v[48:51], a[16:19], v[92:95]
    ds_read_b64_tr_b16 v[62:63], v58 offset:49152
    v_mul_f32 v173, v21, v173
    v_mfma_f32_16x16x32_bf16 v[92:95], v[52:55], a[32:35], v[92:95]
    ds_read_b64_tr_b16 v[64:65], v58 offset:40960
    v_mul_f32 v174, v22, v174
    v_mfma_f32_16x16x32_bf16 v[96:99], v[44:47], a[4:7], 0
    ds_read_b64_tr_b16 v[66:67], v58 offset:50176
    v_mul_f32 v25, v13, v177
    v_mfma_f32_16x16x32_bf16 v[96:99], v[48:51], a[20:23], v[96:99]
    ds_read_b64_tr_b16 v[68:69], v58 offset:41984
    v_mul_f32 v26, v13, v178
    v_mfma_f32_16x16x32_bf16 v[96:99], v[52:55], a[36:39], v[96:99]
    ds_read_b64_tr_b16 v[70:71], v58 offset:51200
    v_mul_f32 v27, v13, v179
    v_mfma_f32_16x16x32_bf16 v[100:103], v[44:47], a[8:11], 0
    v_rcp_f32 v23, v23
    v_mfma_f32_16x16x32_bf16 v[100:103], v[48:51], a[24:27], v[100:103]
    v_exp_f32 v24, v24
    v_mfma_f32_16x16x32_bf16 v[100:103], v[52:55], a[40:43], v[100:103]
    v_exp_f32 v25, v25
    v_mfma_f32_16x16x32_bf16 v[104:107], v[44:47], a[12:15], 0
    v_exp_f32 v26, v26
    v_mfma_f32_16x16x32_bf16 v[104:107], v[48:51], a[28:31], v[104:107]
    v_exp_f32 v27, v27
    v_mfma_f32_16x16x32_bf16 v[104:107], v[52:55], a[44:47], v[104:107]
    s_waitcnt lgkmcnt(0)
    v_mul_f32 v175, v23, v175
    v_fma_f32 v24, v24, v17, v17
    v_mfma_f32_16x16x32_bf16 v[104:107], v[60:63], a[60:63], v[104:107]
    ds_read_b64_tr_b16 v[44:45], v58 offset:43008
    v_fma_f32 v25, v25, v17, v17
    v_mfma_f32_16x16x32_bf16 v[104:107], v[64:67], a[76:79], v[104:107]
    ds_read_b64_tr_b16 v[46:47], v58 offset:52224
    v_fma_f32 v26, v26, v17, v17
    v_mfma_f32_16x16x32_bf16 v[104:107], v[68:71], a[92:95], v[104:107]
    ds_read_b64_tr_b16 v[48:49], v58 offset:44032
    v_fma_f32 v27, v27, v17, v17
    v_mfma_f32_16x16x32_bf16 v[100:103], v[60:63], a[56:59], v[100:103]
    ds_read_b64_tr_b16 v[50:51], v58 offset:53248
    v_mul_f32 v28, v14, v180
    v_mfma_f32_16x16x32_bf16 v[100:103], v[64:67], a[72:75], v[100:103]
    ds_read_b64_tr_b16 v[52:53], v58 offset:45056
    v_mul_f32 v29, v14, v181
    v_mfma_f32_16x16x32_bf16 v[100:103], v[68:71], a[88:91], v[100:103]
    ds_read_b64_tr_b16 v[54:55], v58 offset:54272
    v_mul_f32 v30, v14, v182
    v_mfma_f32_16x16x32_bf16 v[96:99], v[60:63], a[52:55], v[96:99]
    v_rcp_f32 v24, v24
    v_mfma_f32_16x16x32_bf16 v[96:99], v[64:67], a[68:71], v[96:99]
    v_rcp_f32 v25, v25
    v_mfma_f32_16x16x32_bf16 v[96:99], v[68:71], a[84:87], v[96:99]
    v_rcp_f32 v26, v26
    v_mfma_f32_16x16x32_bf16 v[92:95], v[60:63], a[48:51], v[92:95]
    v_rcp_f32 v27, v27
    v_mfma_f32_16x16x32_bf16 v[92:95], v[64:67], a[64:67], v[92:95]
    v_exp_f32 v28, v28
    v_mfma_f32_16x16x32_bf16 v[92:95], v[68:71], a[80:83], v[92:95]
    s_waitcnt lgkmcnt(0)
    v_exp_f32 v29, v29
    v_mfma_f32_16x16x32_bf16 v[92:95], v[44:47], a[96:99], v[92:95]
    v_add_u32 v58, 4294893568, v58
    v_mul_f32 v176, v24, v176
    v_mfma_f32_16x16x32_bf16 v[92:95], v[48:51], a[112:115], v[92:95]
    ds_read_b64_tr_b16 v[60:61], v58 offset:0
    v_mul_f32 v177, v25, v177
    v_mfma_f32_16x16x32_bf16 v[92:95], v[52:55], a[128:131], v[92:95]
    ds_read_b64_tr_b16 v[62:63], v58 offset:9216
    v_mul_f32 v178, v26, v178
    v_mfma_f32_16x16x32_bf16 v[96:99], v[44:47], a[100:103], v[96:99]
    ds_read_b64_tr_b16 v[64:65], v58 offset:1024
    v_mul_f32 v179, v27, v179
    v_mfma_f32_16x16x32_bf16 v[96:99], v[48:51], a[116:119], v[96:99]
    ds_read_b64_tr_b16 v[66:67], v58 offset:10240
    v_mul_f32 v31, v14, v183
    v_mfma_f32_16x16x32_bf16 v[96:99], v[52:55], a[132:135], v[96:99]
    ds_read_b64_tr_b16 v[68:69], v58 offset:2048
    v_fma_f32 v28, v28, v18, v18
    v_mfma_f32_16x16x32_bf16 v[100:103], v[44:47], a[104:107], v[100:103]
    ds_read_b64_tr_b16 v[70:71], v58 offset:11264
    v_fma_f32 v29, v29, v18, v18
    v_mfma_f32_16x16x32_bf16 v[100:103], v[48:51], a[120:123], v[100:103]
    v_exp_f32 v30, v30
    v_mfma_f32_16x16x32_bf16 v[100:103], v[52:55], a[136:139], v[100:103]
    v_exp_f32 v31, v31
    v_mfma_f32_16x16x32_bf16 v[104:107], v[44:47], a[108:111], v[104:107]
    v_rcp_f32 v28, v28
    v_mfma_f32_16x16x32_bf16 v[104:107], v[48:51], a[124:127], v[104:107]
    v_rcp_f32 v29, v29
    v_mfma_f32_16x16x32_bf16 v[104:107], v[52:55], a[140:143], v[104:107]
    s_waitcnt lgkmcnt(0)
    v_fma_f32 v30, v30, v18, v18
    v_fma_f32 v31, v31, v18, v18
    v_mfma_f32_16x16x32_bf16 v[104:107], v[60:63], a[156:159], v[104:107]
    ds_read_b64_tr_b16 v[44:45], v58 offset:3072
    v_mul_f32 v180, v28, v180
    v_mfma_f32_16x16x32_bf16 v[104:107], v[64:67], a[172:175], v[104:107]
    ds_read_b64_tr_b16 v[46:47], v58 offset:12288
    v_mul_f32 v181, v29, v181
    v_mfma_f32_16x16x32_bf16 v[104:107], v[68:71], a[188:191], v[104:107]
    ds_read_b64_tr_b16 v[48:49], v58 offset:4096
    v_mul_f32 v32, v15, v184
    v_mfma_f32_16x16x32_bf16 v[100:103], v[60:63], a[152:155], v[100:103]
    ds_read_b64_tr_b16 v[50:51], v58 offset:13312
    v_mul_f32 v33, v15, v185
    v_mfma_f32_16x16x32_bf16 v[100:103], v[64:67], a[168:171], v[100:103]
    ds_read_b64_tr_b16 v[52:53], v58 offset:5120
    v_mul_f32 v34, v15, v186
    v_mfma_f32_16x16x32_bf16 v[100:103], v[68:71], a[184:187], v[100:103]
    ds_read_b64_tr_b16 v[54:55], v58 offset:14336
    v_mul_f32 v35, v15, v187
    v_mfma_f32_16x16x32_bf16 v[96:99], v[60:63], a[148:151], v[96:99]
    v_rcp_f32 v30, v30
    v_mfma_f32_16x16x32_bf16 v[96:99], v[64:67], a[164:167], v[96:99]
    v_rcp_f32 v31, v31
    v_mfma_f32_16x16x32_bf16 v[96:99], v[68:71], a[180:183], v[96:99]
    v_exp_f32 v32, v32
    v_mfma_f32_16x16x32_bf16 v[92:95], v[60:63], a[144:147], v[92:95]
    v_exp_f32 v33, v33
    v_mfma_f32_16x16x32_bf16 v[92:95], v[64:67], a[160:163], v[92:95]
    v_exp_f32 v34, v34
    v_mfma_f32_16x16x32_bf16 v[92:95], v[68:71], a[176:179], v[92:95]
    s_waitcnt lgkmcnt(0)
    v_exp_f32 v35, v35
    v_mfma_f32_16x16x32_bf16 v[92:95], v[44:47], a[192:195], v[92:95]
    ds_read_b64_tr_b16 v[60:61], v58 offset:6144
    v_mul_f32 v182, v30, v182
    v_mfma_f32_16x16x32_bf16 v[92:95], v[48:51], a[208:211], v[92:95]
    v_mov_b32 v255, 9
    ds_read_b64_tr_b16 v[62:63], v58 offset:15360
    v_mfma_f32_16x16x32_bf16 v[92:95], v[52:55], a[224:227], v[92:95]
    ds_read_b64_tr_b16 v[64:65], v58 offset:7168
    v_mul_f32 v183, v31, v183
    v_mfma_f32_16x16x32_bf16 v[96:99], v[44:47], a[196:199], v[96:99]
    s_waitcnt vmcnt(0)
    ds_read_b64_tr_b16 v[66:67], v58 offset:16384
    v_fma_f32 v32, v32, v19, v19
    v_mfma_f32_16x16x32_bf16 v[96:99], v[48:51], a[212:215], v[96:99]
    buffer_store_dword v255, v252, s[8:11], 0 offen sc1
    ds_read_b64_tr_b16 v[68:69], v58 offset:8192
    v_mfma_f32_16x16x32_bf16 v[96:99], v[52:55], a[228:231], v[96:99]
    ds_read_b64_tr_b16 v[70:71], v58 offset:17408
    v_fma_f32 v33, v33, v19, v19
    v_mfma_f32_16x16x32_bf16 v[100:103], v[44:47], a[200:203], v[100:103]
    v_rcp_f32 v32, v32
    v_mfma_f32_16x16x32_bf16 v[100:103], v[48:51], a[216:219], v[100:103]
    v_rcp_f32 v33, v33
    v_mfma_f32_16x16x32_bf16 v[100:103], v[52:55], a[232:235], v[100:103]
    v_fma_f32 v34, v34, v19, v19
    v_fma_f32 v35, v35, v19, v19
    v_mfma_f32_16x16x32_bf16 v[104:107], v[44:47], a[204:207], v[104:107]
    v_rcp_f32 v34, v34
    v_mfma_f32_16x16x32_bf16 v[104:107], v[48:51], a[220:223], v[104:107]
    v_rcp_f32 v35, v35
    v_mfma_f32_16x16x32_bf16 v[104:107], v[52:55], a[236:239], v[104:107]
    s_waitcnt lgkmcnt(0)
    v_mul_f32 v184, v32, v184
    v_mul_f32 v185, v33, v185
    v_mfma_f32_16x16x32_bf16 v[104:107], v[60:63], a[252:255], v[104:107]
    ds_read_b64_tr_b16 v[44:45], v59 offset:36864
    v_mul_f32 v186, v34, v186
    v_mfma_f32_16x16x32_bf16 v[104:107], v[64:67], v[232:235], v[104:107]
    ds_read_b64_tr_b16 v[46:47], v59 offset:46080
    v_mul_f32 v187, v35, v187
    v_mfma_f32_16x16x32_bf16 v[104:107], v[68:71], v[248:251], v[104:107]
    s_mov_b32 s17, 3072
    ds_read_b64_tr_b16 v[48:49], v59 offset:37888
    v_mul_f32 v172, v172, v108
    v_mfma_f32_16x16x32_bf16 v[100:103], v[60:63], a[248:251], v[100:103]
    ds_read_b64_tr_b16 v[50:51], v59 offset:47104
    v_mul_f32 v173, v173, v109
    v_mfma_f32_16x16x32_bf16 v[100:103], v[64:67], v[228:231], v[100:103]
    ds_read_b64_tr_b16 v[52:53], v59 offset:38912
    v_mul_f32 v174, v174, v110
    v_mfma_f32_16x16x32_bf16 v[100:103], v[68:71], v[244:247], v[100:103]
    ds_read_b64_tr_b16 v[54:55], v59 offset:48128
    v_mul_f32 v175, v175, v111
    v_mfma_f32_16x16x32_bf16 v[96:99], v[60:63], a[244:247], v[96:99]
    v_mul_f32 v176, v176, v112
    v_mul_f32 v177, v177, v113
    v_mfma_f32_16x16x32_bf16 v[96:99], v[64:67], v[224:227], v[96:99]
    v_mul_f32 v178, v178, v114
    v_mul_f32 v179, v179, v115
    v_mfma_f32_16x16x32_bf16 v[96:99], v[68:71], v[240:243], v[96:99]
    v_cvt_pk_bf16_f32 v36, v172, v173
    v_cvt_pk_bf16_f32 v37, v174, v175
    v_mfma_f32_16x16x32_bf16 v[92:95], v[60:63], a[240:243], v[92:95]
    v_cvt_pk_bf16_f32 v38, v176, v177
    v_cvt_pk_bf16_f32 v39, v178, v179
    v_mfma_f32_16x16x32_bf16 v[92:95], v[64:67], v[220:223], v[92:95]
    v_mul_f32 v180, v180, v116
    v_mul_f32 v181, v181, v117
    v_mfma_f32_16x16x32_bf16 v[92:95], v[68:71], v[236:239], v[92:95]
    s_waitcnt lgkmcnt(0)
    v_mul_f32 v182, v182, v118
    v_mul_f32 v183, v183, v119
    v_mfma_f32_16x16x32_bf16 v[188:191], v[44:47], a[0:3], 0
    ds_read_b64_tr_b16 v[60:61], v59 offset:39936
    v_mul_f32 v184, v184, v120
    v_mfma_f32_16x16x32_bf16 v[188:191], v[48:51], a[16:19], v[188:191]
    ds_read_b64_tr_b16 v[62:63], v59 offset:49152
    v_mul_f32 v185, v185, v121
    v_mfma_f32_16x16x32_bf16 v[188:191], v[52:55], a[32:35], v[188:191]
    ds_read_b64_tr_b16 v[64:65], v59 offset:40960
    v_mul_f32 v186, v186, v122
    v_mfma_f32_16x16x32_bf16 v[192:195], v[44:47], a[4:7], 0
    ds_read_b64_tr_b16 v[66:67], v59 offset:50176
    v_mul_f32 v187, v187, v123
    v_mfma_f32_16x16x32_bf16 v[192:195], v[48:51], a[20:23], v[192:195]
    ds_read_b64_tr_b16 v[68:69], v59 offset:41984
    v_cvt_pk_bf16_f32 v40, v180, v181
    v_mfma_f32_16x16x32_bf16 v[192:195], v[52:55], a[36:39], v[192:195]
    ds_read_b64_tr_b16 v[70:71], v59 offset:51200
    v_cvt_pk_bf16_f32 v41, v182, v183
    v_mfma_f32_16x16x32_bf16 v[196:199], v[44:47], a[8:11], 0
    v_cvt_pk_bf16_f32 v42, v184, v185
    v_cvt_pk_bf16_f32 v43, v186, v187
    v_mfma_f32_16x16x32_bf16 v[196:199], v[48:51], a[24:27], v[196:199]
    v_permlane16_swap_b32 v36, v38
    v_permlane16_swap_b32 v37, v39
    v_mfma_f32_16x16x32_bf16 v[196:199], v[52:55], a[40:43], v[196:199]
    buffer_store_dwordx4 v[36:39], v7, s[8:11], s17 offen sc1
    v_permlane16_swap_b32 v40, v42
    v_mfma_f32_16x16x32_bf16 v[200:203], v[44:47], a[12:15], 0
    s_mov_b32 s17, 297984
    v_permlane16_swap_b32 v41, v43
    v_mul_f32 v20, v12, v76
    v_mfma_f32_16x16x32_bf16 v[200:203], v[48:51], a[28:31], v[200:203]
    v_exp_f32 v20, v20
    v_mfma_f32_16x16x32_bf16 v[200:203], v[52:55], a[44:47], v[200:203]
    s_waitcnt lgkmcnt(0)
    v_mul_f32 v21, v12, v77
    v_mul_f32 v22, v12, v78
    v_mfma_f32_16x16x32_bf16 v[200:203], v[60:63], a[60:63], v[200:203]
    buffer_store_dwordx4 v[40:43], v7, s[8:11], s17 offen sc1
    ds_read_b64_tr_b16 v[44:45], v59 offset:43008
    v_mfma_f32_16x16x32_bf16 v[200:203], v[64:67], a[76:79], v[200:203]
    ds_read_b64_tr_b16 v[46:47], v59 offset:52224
    v_mul_f32 v23, v12, v79
    v_mfma_f32_16x16x32_bf16 v[200:203], v[68:71], a[92:95], v[200:203]
    ds_read_b64_tr_b16 v[48:49], v59 offset:44032
    v_fma_f32 v20, v20, v16, v16
    v_mfma_f32_16x16x32_bf16 v[196:199], v[60:63], a[56:59], v[196:199]
    ds_read_b64_tr_b16 v[50:51], v59 offset:53248
    v_mul_f32 v24, v13, v80
    v_mfma_f32_16x16x32_bf16 v[196:199], v[64:67], a[72:75], v[196:199]
    ds_read_b64_tr_b16 v[52:53], v59 offset:45056
    v_mul_f32 v25, v13, v81
    v_mfma_f32_16x16x32_bf16 v[196:199], v[68:71], a[88:91], v[196:199]
    ds_read_b64_tr_b16 v[54:55], v59 offset:54272
    v_mul_f32 v26, v13, v82
    v_mfma_f32_16x16x32_bf16 v[192:195], v[60:63], a[52:55], v[192:195]
    v_exp_f32 v21, v21
    v_mfma_f32_16x16x32_bf16 v[192:195], v[64:67], a[68:71], v[192:195]
    v_exp_f32 v22, v22
    v_mfma_f32_16x16x32_bf16 v[192:195], v[68:71], a[84:87], v[192:195]
    v_exp_f32 v23, v23
    v_mfma_f32_16x16x32_bf16 v[188:191], v[60:63], a[48:51], v[188:191]
    v_rcp_f32 v20, v20
    v_mfma_f32_16x16x32_bf16 v[188:191], v[64:67], a[64:67], v[188:191]
    v_fma_f32 v21, v21, v16, v16
    v_fma_f32 v22, v22, v16, v16
    v_mfma_f32_16x16x32_bf16 v[188:191], v[68:71], a[80:83], v[188:191]
    s_waitcnt lgkmcnt(0)
    v_rcp_f32 v21, v21
    v_mfma_f32_16x16x32_bf16 v[188:191], v[44:47], a[96:99], v[188:191]
    v_add_u32 v59, 4294893568, v59
    v_fma_f32 v23, v23, v16, v16
    v_mfma_f32_16x16x32_bf16 v[188:191], v[48:51], a[112:115], v[188:191]
    ds_read_b64_tr_b16 v[60:61], v59 offset:0
    v_mul_f32 v76, v20, v76
    v_mfma_f32_16x16x32_bf16 v[188:191], v[52:55], a[128:131], v[188:191]
    ds_read_b64_tr_b16 v[62:63], v59 offset:9216
    v_mul_f32 v77, v21, v77
    v_mfma_f32_16x16x32_bf16 v[192:195], v[44:47], a[100:103], v[192:195]
    ds_read_b64_tr_b16 v[64:65], v59 offset:1024
    v_mul_f32 v27, v13, v83
    v_mfma_f32_16x16x32_bf16 v[192:195], v[48:51], a[116:119], v[192:195]
    ds_read_b64_tr_b16 v[66:67], v59 offset:10240
    ds_read_b64_tr_b16 v[68:69], v59 offset:2048
    v_mfma_f32_16x16x32_bf16 v[192:195], v[52:55], a[132:135], v[192:195]
    ds_read_b64_tr_b16 v[70:71], v59 offset:11264
    v_mfma_f32_16x16x32_bf16 v[196:199], v[44:47], a[104:107], v[196:199]
    v_rcp_f32 v22, v22
    v_mfma_f32_16x16x32_bf16 v[196:199], v[48:51], a[120:123], v[196:199]
    v_rcp_f32 v23, v23
    v_mfma_f32_16x16x32_bf16 v[196:199], v[52:55], a[136:139], v[196:199]
    v_exp_f32 v24, v24
    v_mfma_f32_16x16x32_bf16 v[200:203], v[44:47], a[108:111], v[200:203]
    v_exp_f32 v25, v25
    v_mfma_f32_16x16x32_bf16 v[200:203], v[48:51], a[124:127], v[200:203]
    v_exp_f32 v26, v26
    v_mfma_f32_16x16x32_bf16 v[200:203], v[52:55], a[140:143], v[200:203]
    s_waitcnt lgkmcnt(0)
    v_exp_f32 v27, v27
    v_mfma_f32_16x16x32_bf16 v[200:203], v[60:63], a[156:159], v[200:203]
    ds_read_b64_tr_b16 v[44:45], v59 offset:3072
    v_mul_f32 v78, v22, v78
    v_mfma_f32_16x16x32_bf16 v[200:203], v[64:67], a[172:175], v[200:203]
    ds_read_b64_tr_b16 v[46:47], v59 offset:12288
    v_mul_f32 v79, v23, v79
    v_mfma_f32_16x16x32_bf16 v[200:203], v[68:71], a[188:191], v[200:203]
    ds_read_b64_tr_b16 v[48:49], v59 offset:4096
    v_fma_f32 v24, v24, v17, v17
    v_mfma_f32_16x16x32_bf16 v[196:199], v[60:63], a[152:155], v[196:199]
    ds_read_b64_tr_b16 v[50:51], v59 offset:13312
    v_fma_f32 v25, v25, v17, v17
    v_mfma_f32_16x16x32_bf16 v[196:199], v[64:67], a[168:171], v[196:199]
    ds_read_b64_tr_b16 v[52:53], v59 offset:5120
    v_fma_f32 v26, v26, v17, v17
    v_mfma_f32_16x16x32_bf16 v[196:199], v[68:71], a[184:187], v[196:199]
    ds_read_b64_tr_b16 v[54:55], v59 offset:14336
    v_fma_f32 v27, v27, v17, v17
    v_mfma_f32_16x16x32_bf16 v[192:195], v[60:63], a[148:151], v[192:195]
    v_rcp_f32 v24, v24
    v_mfma_f32_16x16x32_bf16 v[192:195], v[64:67], a[164:167], v[192:195]
    v_rcp_f32 v25, v25
    v_mfma_f32_16x16x32_bf16 v[192:195], v[68:71], a[180:183], v[192:195]
    v_rcp_f32 v26, v26
    v_mfma_f32_16x16x32_bf16 v[188:191], v[60:63], a[144:147], v[188:191]
    v_rcp_f32 v27, v27
    v_mfma_f32_16x16x32_bf16 v[188:191], v[64:67], a[160:163], v[188:191]
    v_mul_f32 v80, v24, v80
    v_mul_f32 v81, v25, v81
    v_mfma_f32_16x16x32_bf16 v[188:191], v[68:71], a[176:179], v[188:191]
    s_waitcnt lgkmcnt(0)
    v_mul_f32 v82, v26, v82
    v_mul_f32 v83, v27, v83
    v_mfma_f32_16x16x32_bf16 v[188:191], v[44:47], a[192:195], v[188:191]
    ds_read_b64_tr_b16 v[60:61], v59 offset:6144
    v_mul_f32 v28, v14, v84
    v_mfma_f32_16x16x32_bf16 v[188:191], v[48:51], a[208:211], v[188:191]
    ds_read_b64_tr_b16 v[62:63], v59 offset:15360
    v_mul_f32 v29, v14, v85
    v_mfma_f32_16x16x32_bf16 v[188:191], v[52:55], a[224:227], v[188:191]
    ds_read_b64_tr_b16 v[64:65], v59 offset:7168
    v_mul_f32 v30, v14, v86
    v_mfma_f32_16x16x32_bf16 v[192:195], v[44:47], a[196:199], v[192:195]
    buffer_load_dword v254, v253, s[8:11], 0 offen sc1
    ds_read_b64_tr_b16 v[66:67], v59 offset:16384
    v_mfma_f32_16x16x32_bf16 v[192:195], v[48:51], a[212:215], v[192:195]
    ds_read_b64_tr_b16 v[68:69], v59 offset:8192
    v_mul_f32 v31, v14, v87
    v_mfma_f32_16x16x32_bf16 v[192:195], v[52:55], a[228:231], v[192:195]
L_pad_c3_3:
    s_cbranch_execz L_pad_c3_7
    ds_read_b64_tr_b16 v[70:71], v59 offset:17408
    v_mfma_f32_16x16x32_bf16 v[196:199], v[44:47], a[200:203], v[196:199]
    v_exp_f32 v28, v28
    v_mfma_f32_16x16x32_bf16 v[196:199], v[48:51], a[216:219], v[196:199]
    v_exp_f32 v29, v29
    v_mfma_f32_16x16x32_bf16 v[196:199], v[52:55], a[232:235], v[196:199]
    v_exp_f32 v30, v30
    v_mfma_f32_16x16x32_bf16 v[200:203], v[44:47], a[204:207], v[200:203]
    v_exp_f32 v31, v31
    v_mfma_f32_16x16x32_bf16 v[200:203], v[48:51], a[220:223], v[200:203]
    v_fma_f32 v28, v28, v18, v18
    v_fma_f32 v29, v29, v18, v18
    v_mfma_f32_16x16x32_bf16 v[200:203], v[52:55], a[236:239], v[200:203]
    s_waitcnt lgkmcnt(0)
    v_rcp_f32 v28, v28
    v_mfma_f32_16x16x32_bf16 v[200:203], v[60:63], a[252:255], v[200:203]
    s_barrier
    s_add_u32 m0, s12, 110592
    ds_read_b128 v[44:47], v3 offset:0
    v_mfma_f32_16x16x32_bf16 v[200:203], v[64:67], v[232:235], v[200:203]
    s_mov_b64 s[40:41], s[50:51]
    s_mul_i32 s15, s19, 9
    ds_read_b128 v[48:51], v3 offset:1024
    v_mfma_f32_16x16x32_bf16 v[200:203], v[68:71], v[248:251], v[200:203]
    s_add_u32 s15, s15, s18
    s_add_u32 s15, s15, 4096
    ds_read_b128 v[52:55], v3 offset:2048
    v_mfma_f32_16x16x32_bf16 v[196:199], v[60:63], a[248:251], v[196:199]
    buffer_load_dwordx4 v11, s[40:43], s15 offen  lds
    v_fma_f32 v30, v30, v18, v18
    v_mfma_f32_16x16x32_bf16 v[196:199], v[64:67], v[228:231], v[196:199]
    s_add_u32 m0, s12, 111616
    v_rcp_f32 v29, v29
    v_mfma_f32_16x16x32_bf16 v[196:199], v[68:71], v[244:247], v[196:199]
    s_add_u32 s15, s15, s19
    v_rcp_f32 v30, v30
    v_mfma_f32_16x16x32_bf16 v[192:195], v[60:63], a[244:247], v[192:195]
    v_fma_f32 v31, v31, v18, v18
    v_mul_f32 v84, v28, v84
    v_mfma_f32_16x16x32_bf16 v[192:195], v[64:67], v[224:227], v[192:195]
    v_rcp_f32 v31, v31
    v_mfma_f32_16x16x32_bf16 v[192:195], v[68:71], v[240:243], v[192:195]
    buffer_load_dwordx4 v11, s[40:43], s15 offen  lds
    v_mul_f32 v85, v29, v85
    v_mfma_f32_16x16x32_bf16 v[188:191], v[60:63], a[240:243], v[188:191]
    s_add_u32 m0, s12, 112640
    v_mul_f32 v86, v30, v86
    v_mul_f32 v87, v31, v87
    v_mfma_f32_16x16x32_bf16 v[188:191], v[64:67], v[220:223], v[188:191]
    s_add_u32 s15, s15, s19
    v_mul_f32 v32, v15, v88
    v_mul_f32 v33, v15, v89
    v_mfma_f32_16x16x32_bf16 v[188:191], v[68:71], v[236:239], v[188:191]
    s_waitcnt lgkmcnt(0)
    v_exp_f32 v32, v32
    v_mfma_f32_16x16x32_bf16 v[124:127], v[44:47], a[0:3], 0
    ds_read_b128 v[60:63], v3 offset:3072
    v_mul_f32 v34, v15, v90
    v_mfma_f32_16x16x32_bf16 v[124:127], v[48:51], a[16:19], v[124:127]
    ds_read_b128 v[64:67], v3 offset:4096
    v_mul_f32 v35, v15, v91
    v_mfma_f32_16x16x32_bf16 v[124:127], v[52:55], a[32:35], v[124:127]
    buffer_load_dwordx4 v11, s[40:43], s15 offen  lds
    ds_read_b128 v[68:71], v3 offset:5120
    v_mfma_f32_16x16x32_bf16 v[128:131], v[44:47], a[4:7], 0
    s_add_u32 m0, s12, 113664
    v_exp_f32 v33, v33
    v_mfma_f32_16x16x32_bf16 v[128:131], v[48:51], a[20:23], v[128:131]
    s_add_u32 s15, s15, s19
    v_exp_f32 v34, v34
    v_mfma_f32_16x16x32_bf16 v[128:131], v[52:55], a[36:39], v[128:131]
    v_exp_f32 v35, v35
    v_mfma_f32_16x16x32_bf16 v[132:135], v[44:47], a[8:11], 0
    v_fma_f32 v32, v32, v19, v19
    v_fma_f32 v33, v33, v19, v19
    v_mfma_f32_16x16x32_bf16 v[132:135], v[48:51], a[24:27], v[132:135]
    v_rcp_f32 v32, v32
    v_mfma_f32_16x16x32_bf16 v[132:135], v[52:55], a[40:43], v[132:135]
    buffer_load_dwordx4 v11, s[40:43], s15 offen  lds
    v_fma_f32 v34, v34, v19, v19
    v_mfma_f32_16x16x32_bf16 v[136:139], v[44:47], a[12:15], 0
    s_add_u32 m0, s12, 114688
    v_rcp_f32 v33, v33
    v_mfma_f32_16x16x32_bf16 v[136:139], v[48:51], a[28:31], v[136:139]
    s_add_u32 s15, s15, s19
    v_rcp_f32 v34, v34
    v_mfma_f32_16x16x32_bf16 v[136:139], v[52:55], a[44:47], v[136:139]
    s_waitcnt lgkmcnt(0)
    v_fma_f32 v35, v35, v19, v19
    v_mul_f32 v88, v32, v88
    v_mfma_f32_16x16x32_bf16 v[136:139], v[60:63], a[60:63], v[136:139]
    ds_read_b128 v[44:47], v3 offset:6144
    v_mul_f32 v89, v33, v89
    v_mfma_f32_16x16x32_bf16 v[136:139], v[64:67], a[76:79], v[136:139]
    ds_read_b128 v[48:51], v3 offset:7168
    v_mul_f32 v90, v34, v90
    v_mfma_f32_16x16x32_bf16 v[136:139], v[68:71], a[92:95], v[136:139]
    buffer_load_dwordx4 v11, s[40:43], s15 offen  lds
    ds_read_b128 v[52:55], v3 offset:8192
    v_mfma_f32_16x16x32_bf16 v[132:135], v[60:63], a[56:59], v[132:135]
    s_add_u32 m0, s12, 115712
    v_rcp_f32 v35, v35
    v_mfma_f32_16x16x32_bf16 v[132:135], v[64:67], a[72:75], v[132:135]
    s_add_u32 s15, s15, s19
    v_mul_f32 v91, v35, v91
    v_mul_f32 v20, v12, v140
    v_mfma_f32_16x16x32_bf16 v[132:135], v[68:71], a[88:91], v[132:135]
    v_exp_f32 v20, v20
    v_mfma_f32_16x16x32_bf16 v[128:131], v[60:63], a[52:55], v[128:131]
    v_mul_f32 v21, v12, v141
    v_mul_f32 v22, v12, v142
    v_mfma_f32_16x16x32_bf16 v[128:131], v[64:67], a[68:71], v[128:131]
    v_exp_f32 v21, v21
    v_mfma_f32_16x16x32_bf16 v[128:131], v[68:71], a[84:87], v[128:131]
    buffer_load_dwordx4 v11, s[40:43], s15 offen  lds
    v_mul_f32 v23, v12, v143
    v_mfma_f32_16x16x32_bf16 v[124:127], v[60:63], a[48:51], v[124:127]
    s_add_u32 m0, s12, 116736
    v_exp_f32 v22, v22
    v_mfma_f32_16x16x32_bf16 v[124:127], v[64:67], a[64:67], v[124:127]
    s_add_u32 s15, s15, s19
    v_exp_f32 v23, v23
    v_mfma_f32_16x16x32_bf16 v[124:127], v[68:71], a[80:83], v[124:127]
    s_waitcnt lgkmcnt(0)
    v_fma_f32 v20, v20, v16, v16
    v_fma_f32 v21, v21, v16, v16
    v_mfma_f32_16x16x32_bf16 v[124:127], v[44:47], a[96:99], v[124:127]
    ds_read_b128 v[60:63], v3 offset:9216
    v_fma_f32 v22, v22, v16, v16
    v_mfma_f32_16x16x32_bf16 v[124:127], v[48:51], a[112:115], v[124:127]
    ds_read_b128 v[64:67], v3 offset:10240
    v_fma_f32 v23, v23, v16, v16
    v_mfma_f32_16x16x32_bf16 v[124:127], v[52:55], a[128:131], v[124:127]
    buffer_load_dwordx4 v11, s[40:43], s15 offen  lds
    ds_read_b128 v[68:71], v3 offset:11264
    v_mfma_f32_16x16x32_bf16 v[128:131], v[44:47], a[100:103], v[128:131]
    s_add_u32 m0, s12, 117760
    v_rcp_f32 v20, v20
    v_mfma_f32_16x16x32_bf16 v[128:131], v[48:51], a[116:119], v[128:131]
    s_add_u32 s15, s15, s19
    v_rcp_f32 v21, v21
    v_mfma_f32_16x16x32_bf16 v[128:131], v[52:55], a[132:135], v[128:131]
    v_rcp_f32 v22, v22
    v_mfma_f32_16x16x32_bf16 v[132:135], v[44:47], a[104:107], v[132:135]
    v_rcp_f32 v23, v23
    v_mfma_f32_16x16x32_bf16 v[132:135], v[48:51], a[120:123], v[132:135]
    v_mul_f32 v140, v20, v140
    v_mul_f32 v141, v21, v141
    v_mfma_f32_16x16x32_bf16 v[132:135], v[52:55], a[136:139], v[132:135]
    buffer_load_dwordx4 v11, s[40:43], s15 offen  lds
    v_mul_f32 v142, v22, v142
    v_mfma_f32_16x16x32_bf16 v[136:139], v[44:47], a[108:111], v[136:139]
    s_add_u32 m0, s12, 118784
    v_mul_f32 v143, v23, v143
    v_mul_f32 v24, v13, v144
    v_mfma_f32_16x16x32_bf16 v[136:139], v[48:51], a[124:127], v[136:139]
    s_add_u32 s15, s15, s19
    v_exp_f32 v24, v24
    v_mfma_f32_16x16x32_bf16 v[136:139], v[52:55], a[140:143], v[136:139]
    s_waitcnt lgkmcnt(0)
    v_mul_f32 v25, v13, v145
    v_mul_f32 v26, v13, v146
    v_mfma_f32_16x16x32_bf16 v[136:139], v[60:63], a[156:159], v[136:139]
    ds_read_b128 v[44:47], v3 offset:12288
    v_mul_f32 v27, v13, v147
    v_mfma_f32_16x16x32_bf16 v[136:139], v[64:67], a[172:175], v[136:139]
    ds_read_b128 v[48:51], v3 offset:13312
    v_fma_f32 v24, v24, v17, v17
    v_mfma_f32_16x16x32_bf16 v[136:139], v[68:71], a[188:191], v[136:139]
    buffer_load_dwordx4 v11, s[40:43], s15 offen  lds
    ds_read_b128 v[52:55], v3 offset:14336
    v_mfma_f32_16x16x32_bf16 v[132:135], v[60:63], a[152:155], v[132:135]
    s_waitcnt vmcnt(9)
    v_cmp_gt_u32 s[46:47], 9, v254
    v_mul_f32 v28, v14, v148
    v_mfma_f32_16x16x32_bf16 v[132:135], v[64:67], a[168:171], v[132:135]
    s_add_u32 m0, s12, 0
    v_exp_f32 v25, v25
    v_mfma_f32_16x16x32_bf16 v[132:135], v[68:71], a[184:187], v[132:135]
    s_cmp_lg_u64 s[46:47], 0
    s_cbranch_scc1 L_slow29
L_slow29_ret:
    v_fma_f32 v25, v25, v17, v17
    v_mfma_f32_16x16x32_bf16 v[128:131], v[60:63], a[148:151], v[128:131]
    s_add_u32 s15, s14, 0
    v_exp_f32 v26, v26
    v_mfma_f32_16x16x32_bf16 v[128:131], v[64:67], a[164:167], v[128:131]
    v_exp_f32 v27, v27
    v_mfma_f32_16x16x32_bf16 v[128:131], v[68:71], a[180:183], v[128:131]
    buffer_load_dwordx4 v1, s[8:11], s15 offen offset:0 sc1 lds
    v_fma_f32 v26, v26, v17, v17
    v_mfma_f32_16x16x32_bf16 v[124:127], v[60:63], a[144:147], v[124:127]
    v_rcp_f32 v24, v24
    v_mfma_f32_16x16x32_bf16 v[124:127], v[64:67], a[160:163], v[124:127]
    v_rcp_f32 v25, v25
    v_mfma_f32_16x16x32_bf16 v[124:127], v[68:71], a[176:179], v[124:127]
    s_waitcnt lgkmcnt(0)
    v_rcp_f32 v26, v26
    v_mfma_f32_16x16x32_bf16 v[124:127], v[44:47], a[192:195], v[124:127]
    ds_read_b128 v[60:63], v3 offset:15360
    v_fma_f32 v27, v27, v17, v17
    v_mfma_f32_16x16x32_bf16 v[124:127], v[48:51], a[208:211], v[124:127]
    ds_read_b128 v[64:67], v3 offset:16384
    v_mul_f32 v144, v24, v144
    v_mfma_f32_16x16x32_bf16 v[124:127], v[52:55], a[224:227], v[124:127]
    buffer_load_dwordx4 v1, s[8:11], s15 offen offset:1024 sc1 lds
    ds_read_b128 v[68:71], v3 offset:17408
    v_mfma_f32_16x16x32_bf16 v[128:131], v[44:47], a[196:199], v[128:131]
    v_rcp_f32 v27, v27
    v_mfma_f32_16x16x32_bf16 v[128:131], v[48:51], a[212:215], v[128:131]
    v_exp_f32 v28, v28
    v_mfma_f32_16x16x32_bf16 v[128:131], v[52:55], a[228:231], v[128:131]
    v_mul_f32 v145, v25, v145
    v_mul_f32 v146, v26, v146
    v_mfma_f32_16x16x32_bf16 v[132:135], v[44:47], a[200:203], v[132:135]
    v_mul_f32 v147, v27, v147
    v_mul_f32 v29, v14, v149
    v_mfma_f32_16x16x32_bf16 v[132:135], v[48:51], a[216:219], v[132:135]
    v_exp_f32 v29, v29
    v_mfma_f32_16x16x32_bf16 v[132:135], v[52:55], a[232:235], v[132:135]
    buffer_load_dwordx4 v1, s[8:11], s15 offen offset:2048 sc1 lds
    v_mul_f32 v30, v14, v150
    v_mfma_f32_16x16x32_bf16 v[136:139], v[44:47], a[204:207], v[136:139]
    v_exp_f32 v30, v30
    v_mfma_f32_16x16x32_bf16 v[136:139], v[48:51], a[220:223], v[136:139]
    v_mul_f32 v31, v14, v151
    v_fma_f32 v28, v28, v18, v18
    v_mfma_f32_16x16x32_bf16 v[136:139], v[52:55], a[236:239], v[136:139]
    s_waitcnt lgkmcnt(0)
    v_exp_f32 v31, v31
    v_mfma_f32_16x16x32_bf16 v[136:139], v[60:63], a[252:255], v[136:139]
    ds_read_b128 v[44:47], v3 offset:18432
    v_fma_f32 v29, v29, v18, v18
    v_mfma_f32_16x16x32_bf16 v[136:139], v[64:67], v[232:235], v[136:139]
    ds_read_b128 v[48:51], v3 offset:19456
    v_fma_f32 v30, v30, v18, v18
    v_mfma_f32_16x16x32_bf16 v[136:139], v[68:71], v[248:251], v[136:139]
    buffer_load_dwordx4 v1, s[8:11], s15 offen offset:3072 sc1 lds
    ds_read_b128 v[52:55], v3 offset:20480
    v_mfma_f32_16x16x32_bf16 v[132:135], v[60:63], a[248:251], v[132:135]
    s_add_u32 m0, s12, 4096
    v_rcp_f32 v28, v28
    v_mfma_f32_16x16x32_bf16 v[132:135], v[64:67], v[228:231], v[132:135]
    s_add_u32 s15, s14, 4096
    v_rcp_f32 v29, v29
    v_mfma_f32_16x16x32_bf16 v[132:135], v[68:71], v[244:247], v[132:135]
    v_rcp_f32 v30, v30
    v_mfma_f32_16x16x32_bf16 v[128:131], v[60:63], a[244:247], v[128:131]
    v_fma_f32 v31, v31, v18, v18
    v_mul_f32 v148, v28, v148
    v_mfma_f32_16x16x32_bf16 v[128:131], v[64:67], v[224:227], v[128:131]
    v_rcp_f32 v31, v31
    v_mfma_f32_16x16x32_bf16 v[128:131], v[68:71], v[240:243], v[128:131]
    buffer_load_dwordx4 v1, s[8:11], s15 offen offset:0 sc1 lds
    v_mul_f32 v149, v29, v149
    v_mfma_f32_16x16x32_bf16 v[124:127], v[60:63], a[240:243], v[124:127]
    v_mul_f32 v150, v30, v150
    v_mul_f32 v151, v31, v151
    v_mfma_f32_16x16x32_bf16 v[124:127], v[64:67], v[220:223], v[124:127]
    v_mul_f32 v32, v15, v152
    v_mul_f32 v33, v15, v153
    v_mfma_f32_16x16x32_bf16 v[124:127], v[68:71], v[236:239], v[124:127]
    s_waitcnt lgkmcnt(0)
    v_exp_f32 v32, v32
    v_mfma_f32_16x16x32_bf16 v[204:207], v[44:47], a[0:3], 0
    ds_read_b128 v[60:63], v3 offset:21504
    v_mul_f32 v34, v15, v154
    v_mfma_f32_16x16x32_bf16 v[204:207], v[48:51], a[16:19], v[204:207]
    ds_read_b128 v[64:67], v3 offset:22528
    v_mul_f32 v35, v15, v155
    v_mfma_f32_16x16x32_bf16 v[204:207], v[52:55], a[32:35], v[204:207]
    buffer_load_dwordx4 v1, s[8:11], s15 offen offset:1024 sc1 lds
    ds_read_b128 v[68:71], v3 offset:23552
    v_mfma_f32_16x16x32_bf16 v[208:211], v[44:47], a[4:7], 0
    v_exp_f32 v33, v33
    v_mfma_f32_16x16x32_bf16 v[208:211], v[48:51], a[20:23], v[208:211]
    v_exp_f32 v34, v34
    v_mfma_f32_16x16x32_bf16 v[208:211], v[52:55], a[36:39], v[208:211]
    v_exp_f32 v35, v35
    v_mfma_f32_16x16x32_bf16 v[212:215], v[44:47], a[8:11], 0
    v_fma_f32 v32, v32, v19, v19
    v_fma_f32 v33, v33, v19, v19
    v_mfma_f32_16x16x32_bf16 v[212:215], v[48:51], a[24:27], v[212:215]
    v_rcp_f32 v32, v32
    v_mfma_f32_16x16x32_bf16 v[212:215], v[52:55], a[40:43], v[212:215]
    buffer_load_dwordx4 v1, s[8:11], s15 offen offset:2048 sc1 lds
    v_fma_f32 v34, v34, v19, v19
    v_mfma_f32_16x16x32_bf16 v[216:219], v[44:47], a[12:15], 0
    v_rcp_f32 v33, v33
    v_mfma_f32_16x16x32_bf16 v[216:219], v[48:51], a[28:31], v[216:219]
    v_rcp_f32 v34, v34
    v_mfma_f32_16x16x32_bf16 v[216:219], v[52:55], a[44:47], v[216:219]
    s_waitcnt lgkmcnt(0)
    v_fma_f32 v35, v35, v19, v19
    v_mul_f32 v152, v32, v152
    v_mfma_f32_16x16x32_bf16 v[216:219], v[60:63], a[60:63], v[216:219]
    ds_read_b128 v[44:47], v3 offset:24576
    v_mul_f32 v153, v33, v153
    v_mfma_f32_16x16x32_bf16 v[216:219], v[64:67], a[76:79], v[216:219]
    ds_read_b128 v[48:51], v3 offset:25600
    v_mul_f32 v154, v34, v154
    v_mfma_f32_16x16x32_bf16 v[216:219], v[68:71], a[92:95], v[216:219]
    buffer_load_dwordx4 v1, s[8:11], s15 offen offset:3072 sc1 lds
    ds_read_b128 v[52:55], v3 offset:26624
    v_mfma_f32_16x16x32_bf16 v[212:215], v[60:63], a[56:59], v[212:215]
    s_add_u32 m0, s12, 8192
    v_rcp_f32 v35, v35
    v_mfma_f32_16x16x32_bf16 v[212:215], v[64:67], a[72:75], v[212:215]
    s_add_u32 s15, s14, 8192
    v_mul_f32 v155, v35, v155
    v_mul_f32 v20, v12, v124
    v_mfma_f32_16x16x32_bf16 v[212:215], v[68:71], a[88:91], v[212:215]
    v_exp_f32 v20, v20
    v_mfma_f32_16x16x32_bf16 v[208:211], v[60:63], a[52:55], v[208:211]
    v_mul_f32 v21, v12, v125
    v_mul_f32 v22, v12, v126
    v_mfma_f32_16x16x32_bf16 v[208:211], v[64:67], a[68:71], v[208:211]
    v_exp_f32 v21, v21
    v_mfma_f32_16x16x32_bf16 v[208:211], v[68:71], a[84:87], v[208:211]
    buffer_load_dwordx4 v1, s[8:11], s15 offen offset:0 sc1 lds
    v_mul_f32 v23, v12, v127
    v_mfma_f32_16x16x32_bf16 v[204:207], v[60:63], a[48:51], v[204:207]
    v_exp_f32 v22, v22
    v_mfma_f32_16x16x32_bf16 v[204:207], v[64:67], a[64:67], v[204:207]
    v_exp_f32 v23, v23
    v_mfma_f32_16x16x32_bf16 v[204:207], v[68:71], a[80:83], v[204:207]
    s_waitcnt lgkmcnt(0)
    v_fma_f32 v20, v20, v16, v16
    v_fma_f32 v21, v21, v16, v16
    v_mfma_f32_16x16x32_bf16 v[204:207], v[44:47], a[96:99], v[204:207]
    ds_read_b128 v[60:63], v3 offset:27648
    v_fma_f32 v22, v22, v16, v16
    v_mfma_f32_16x16x32_bf16 v[204:207], v[48:51], a[112:115], v[204:207]
    ds_read_b128 v[64:67], v3 offset:28672
    v_fma_f32 v23, v23, v16, v16
    v_mfma_f32_16x16x32_bf16 v[204:207], v[52:55], a[128:131], v[204:207]
    ds_read_b128 v[68:71], v3 offset:29696
    v_mul_f32 v24, v13, v128
    v_mfma_f32_16x16x32_bf16 v[208:211], v[44:47], a[100:103], v[208:211]
    v_rcp_f32 v20, v20
    v_mfma_f32_16x16x32_bf16 v[208:211], v[48:51], a[116:119], v[208:211]
    v_rcp_f32 v21, v21
    v_mfma_f32_16x16x32_bf16 v[208:211], v[52:55], a[132:135], v[208:211]
    v_rcp_f32 v22, v22
    v_mfma_f32_16x16x32_bf16 v[212:215], v[44:47], a[104:107], v[212:215]
    v_rcp_f32 v23, v23
    v_mfma_f32_16x16x32_bf16 v[212:215], v[48:51], a[120:123], v[212:215]
    v_exp_f32 v24, v24
    v_mfma_f32_16x16x32_bf16 v[212:215], v[52:55], a[136:139], v[212:215]
    v_mul_f32 v124, v20, v124
    v_mul_f32 v125, v21, v125
    v_mfma_f32_16x16x32_bf16 v[216:219], v[44:47], a[108:111], v[216:219]
    v_mul_f32 v126, v22, v126
    v_mul_f32 v127, v23, v127
    v_mfma_f32_16x16x32_bf16 v[216:219], v[48:51], a[124:127], v[216:219]
    v_mul_f32 v25, v13, v129
    v_mul_f32 v26, v13, v130
    v_mfma_f32_16x16x32_bf16 v[216:219], v[52:55], a[140:143], v[216:219]
    s_waitcnt lgkmcnt(0)
    v_exp_f32 v25, v25
    v_mfma_f32_16x16x32_bf16 v[216:219], v[60:63], a[156:159], v[216:219]
    ds_read_b128 v[44:47], v3 offset:30720
    v_mul_f32 v27, v13, v131
    v_mfma_f32_16x16x32_bf16 v[216:219], v[64:67], a[172:175], v[216:219]
    ds_read_b128 v[48:51], v3 offset:31744
    v_fma_f32 v24, v24, v17, v17
    v_mfma_f32_16x16x32_bf16 v[216:219], v[68:71], a[188:191], v[216:219]
    ds_read_b128 v[52:55], v3 offset:32768
    v_fma_f32 v25, v25, v17, v17
    v_mfma_f32_16x16x32_bf16 v[212:215], v[60:63], a[152:155], v[212:215]
    v_exp_f32 v26, v26
    v_mfma_f32_16x16x32_bf16 v[212:215], v[64:67], a[168:171], v[212:215]
    v_exp_f32 v27, v27
    v_mfma_f32_16x16x32_bf16 v[212:215], v[68:71], a[184:187], v[212:215]
    v_rcp_f32 v24, v24
    v_mfma_f32_16x16x32_bf16 v[208:211], v[60:63], a[148:151], v[208:211]
    v_rcp_f32 v25, v25
    v_mfma_f32_16x16x32_bf16 v[208:211], v[64:67], a[164:167], v[208:211]
    v_fma_f32 v26, v26, v17, v17
    v_fma_f32 v27, v27, v17, v17
    v_mfma_f32_16x16x32_bf16 v[208:211], v[68:71], a[180:183], v[208:211]
    v_rcp_f32 v26, v26
    v_mfma_f32_16x16x32_bf16 v[204:207], v[60:63], a[144:147], v[204:207]
    v_rcp_f32 v27, v27
    v_mfma_f32_16x16x32_bf16 v[204:207], v[64:67], a[160:163], v[204:207]
    v_mul_f32 v128, v24, v128
    v_mul_f32 v129, v25, v129
    v_mfma_f32_16x16x32_bf16 v[204:207], v[68:71], a[176:179], v[204:207]
    s_waitcnt lgkmcnt(0)
    v_mul_f32 v130, v26, v130
    v_mul_f32 v131, v27, v131
    v_mfma_f32_16x16x32_bf16 v[204:207], v[44:47], a[192:195], v[204:207]
    ds_read_b128 v[60:63], v3 offset:33792
    v_mul_f32 v28, v14, v132
    v_mfma_f32_16x16x32_bf16 v[204:207], v[48:51], a[208:211], v[204:207]
    ds_read_b128 v[64:67], v3 offset:34816
    v_mul_f32 v29, v14, v133
    v_mfma_f32_16x16x32_bf16 v[204:207], v[52:55], a[224:227], v[204:207]
    ds_read_b128 v[68:71], v3 offset:35840
    v_mul_f32 v30, v14, v134
    v_mfma_f32_16x16x32_bf16 v[208:211], v[44:47], a[196:199], v[208:211]
    v_exp_f32 v28, v28
    v_mfma_f32_16x16x32_bf16 v[208:211], v[48:51], a[212:215], v[208:211]
    v_exp_f32 v29, v29
    v_mfma_f32_16x16x32_bf16 v[208:211], v[52:55], a[228:231], v[208:211]
    v_exp_f32 v30, v30
    v_mfma_f32_16x16x32_bf16 v[212:215], v[44:47], a[200:203], v[212:215]
    v_mul_f32 v31, v14, v135
    v_fma_f32 v28, v28, v18, v18
    v_mfma_f32_16x16x32_bf16 v[212:215], v[48:51], a[216:219], v[212:215]
    v_exp_f32 v31, v31
    v_mfma_f32_16x16x32_bf16 v[212:215], v[52:55], a[232:235], v[212:215]
    v_rcp_f32 v28, v28
    v_mfma_f32_16x16x32_bf16 v[216:219], v[44:47], a[204:207], v[216:219]
    v_fma_f32 v29, v29, v18, v18
    v_fma_f32 v30, v30, v18, v18
    v_mfma_f32_16x16x32_bf16 v[216:219], v[48:51], a[220:223], v[216:219]
    v_rcp_f32 v29, v29
    v_mfma_f32_16x16x32_bf16 v[216:219], v[52:55], a[236:239], v[216:219]
    s_waitcnt lgkmcnt(0)
    v_rcp_f32 v30, v30
    v_mfma_f32_16x16x32_bf16 v[216:219], v[60:63], a[252:255], v[216:219]
    s_barrier
    s_add_u32 m0, s12, 36864
    v_add_u32 v56, 73728, v56
    v_mfma_f32_16x16x32_bf16 v[216:219], v[64:67], v[232:235], v[216:219]
    s_add_u32 s15, s14, 36864
    ds_read_b64_tr_b16 v[44:45], v56 offset:0
    v_fma_f32 v31, v31, v18, v18
    v_mfma_f32_16x16x32_bf16 v[216:219], v[68:71], v[248:251], v[216:219]
    buffer_load_dwordx4 v1, s[8:11], s15 offen offset:0 sc1 lds
    ds_read_b64_tr_b16 v[46:47], v56 offset:9216
    v_mfma_f32_16x16x32_bf16 v[212:215], v[60:63], a[248:251], v[212:215]
    ds_read_b64_tr_b16 v[48:49], v56 offset:1024
    v_mul_f32 v132, v28, v132
    v_mfma_f32_16x16x32_bf16 v[212:215], v[64:67], v[228:231], v[212:215]
    ds_read_b64_tr_b16 v[50:51], v56 offset:10240
    v_mul_f32 v133, v29, v133
    v_mfma_f32_16x16x32_bf16 v[212:215], v[68:71], v[244:247], v[212:215]
    ds_read_b64_tr_b16 v[52:53], v56 offset:2048
    v_mul_f32 v134, v30, v134
    v_mfma_f32_16x16x32_bf16 v[208:211], v[60:63], a[244:247], v[208:211]
    ds_read_b64_tr_b16 v[54:55], v56 offset:11264
    v_mul_f32 v32, v15, v136
    v_mfma_f32_16x16x32_bf16 v[208:211], v[64:67], v[224:227], v[208:211]
    buffer_load_dwordx4 v1, s[8:11], s15 offen offset:1024 sc1 lds
    v_mul_f32 v33, v15, v137
    v_mfma_f32_16x16x32_bf16 v[208:211], v[68:71], v[240:243], v[208:211]
    v_rcp_f32 v31, v31
    v_mfma_f32_16x16x32_bf16 v[204:207], v[60:63], a[240:243], v[204:207]
    v_exp_f32 v32, v32
    v_mfma_f32_16x16x32_bf16 v[204:207], v[64:67], v[220:223], v[204:207]
    v_exp_f32 v33, v33
    v_mfma_f32_16x16x32_bf16 v[204:207], v[68:71], v[236:239], v[204:207]
    s_waitcnt lgkmcnt(0)
    v_mul_f32 v135, v31, v135
    v_mul_f32 v34, v15, v138
    v_mfma_f32_16x16x32_bf16 v[156:159], v[44:47], a[0:3], 0
    v_add_u32 v57, 73728, v57
    v_mul_f32 v35, v15, v139
    v_mfma_f32_16x16x32_bf16 v[156:159], v[48:51], a[16:19], v[156:159]
    buffer_load_dwordx4 v1, s[8:11], s15 offen offset:2048 sc1 lds
    ds_read_b64_tr_b16 v[60:61], v57 offset:0
    v_mfma_f32_16x16x32_bf16 v[156:159], v[52:55], a[32:35], v[156:159]
    ds_read_b64_tr_b16 v[62:63], v57 offset:9216
    v_fma_f32 v32, v32, v19, v19
    v_mfma_f32_16x16x32_bf16 v[160:163], v[44:47], a[4:7], 0
    ds_read_b64_tr_b16 v[64:65], v57 offset:1024
    v_fma_f32 v33, v33, v19, v19
    v_mfma_f32_16x16x32_bf16 v[160:163], v[48:51], a[20:23], v[160:163]
    ds_read_b64_tr_b16 v[66:67], v57 offset:10240
    v_mul_f32 v20, v12, v92
    v_mfma_f32_16x16x32_bf16 v[160:163], v[52:55], a[36:39], v[160:163]
    ds_read_b64_tr_b16 v[68:69], v57 offset:2048
    v_mul_f32 v21, v12, v93
    v_mfma_f32_16x16x32_bf16 v[164:167], v[44:47], a[8:11], 0
    buffer_load_dwordx4 v1, s[8:11], s15 offen offset:3072 sc1 lds
    ds_read_b64_tr_b16 v[70:71], v57 offset:11264
    v_mfma_f32_16x16x32_bf16 v[164:167], v[48:51], a[24:27], v[164:167]
    s_add_u32 m0, s12, 40960
    v_exp_f32 v34, v34
    v_mfma_f32_16x16x32_bf16 v[164:167], v[52:55], a[40:43], v[164:167]
    s_add_u32 s15, s14, 40960
    v_exp_f32 v35, v35
    v_mfma_f32_16x16x32_bf16 v[168:171], v[44:47], a[12:15], 0
    v_rcp_f32 v32, v32
    v_mfma_f32_16x16x32_bf16 v[168:171], v[48:51], a[28:31], v[168:171]
    v_rcp_f32 v33, v33
    v_mfma_f32_16x16x32_bf16 v[168:171], v[52:55], a[44:47], v[168:171]
    s_waitcnt lgkmcnt(0)
    v_fma_f32 v34, v34, v19, v19
    v_fma_f32 v35, v35, v19, v19
    v_mfma_f32_16x16x32_bf16 v[172:175], v[60:63], a[0:3], 0
    buffer_load_dwordx4 v1, s[8:11], s15 offen offset:0 sc1 lds
    v_add_u32 v58, 73728, v58
    v_mfma_f32_16x16x32_bf16 v[172:175], v[64:67], a[16:19], v[172:175]
    ds_read_b64_tr_b16 v[44:45], v58 offset:0
    v_mul_f32 v136, v32, v136
    v_mfma_f32_16x16x32_bf16 v[172:175], v[68:71], a[32:35], v[172:175]
    ds_read_b64_tr_b16 v[46:47], v58 offset:9216
    v_mul_f32 v137, v33, v137
    v_mfma_f32_16x16x32_bf16 v[176:179], v[60:63], a[4:7], 0
    ds_read_b64_tr_b16 v[48:49], v58 offset:1024
    v_mul_f32 v22, v12, v94
    v_mfma_f32_16x16x32_bf16 v[176:179], v[64:67], a[20:23], v[176:179]
    buffer_load_dwordx4 v1, s[8:11], s15 offen offset:1024 sc1 lds
    ds_read_b64_tr_b16 v[50:51], v58 offset:10240
    v_mfma_f32_16x16x32_bf16 v[176:179], v[68:71], a[36:39], v[176:179]
    ds_read_b64_tr_b16 v[52:53], v58 offset:2048
    v_mul_f32 v23, v12, v95
    v_mfma_f32_16x16x32_bf16 v[180:183], v[60:63], a[8:11], 0
    ds_read_b64_tr_b16 v[54:55], v58 offset:11264
    v_mfma_f32_16x16x32_bf16 v[180:183], v[64:67], a[24:27], v[180:183]
    v_rcp_f32 v34, v34
    v_mfma_f32_16x16x32_bf16 v[180:183], v[68:71], a[40:43], v[180:183]
    v_rcp_f32 v35, v35
    v_mfma_f32_16x16x32_bf16 v[184:187], v[60:63], a[12:15], 0
    buffer_load_dwordx4 v1, s[8:11], s15 offen offset:2048 sc1 lds
    v_mul_f32 v138, v34, v138
    v_mfma_f32_16x16x32_bf16 v[184:187], v[64:67], a[28:31], v[184:187]
    v_exp_f32 v20, v20
    v_mfma_f32_16x16x32_bf16 v[184:187], v[68:71], a[44:47], v[184:187]
    s_waitcnt lgkmcnt(0)
    v_exp_f32 v21, v21
    v_mfma_f32_16x16x32_bf16 v[108:111], v[44:47], a[0:3], 0
    v_add_u32 v59, 73728, v59
    v_mul_f32 v139, v35, v139
    v_mfma_f32_16x16x32_bf16 v[108:111], v[48:51], a[16:19], v[108:111]
    s_mov_b32 s17, 4096
    ds_read_b64_tr_b16 v[60:61], v59 offset:0
    v_mul_f32 v124, v124, v204
    v_mfma_f32_16x16x32_bf16 v[108:111], v[52:55], a[32:35], v[108:111]
    buffer_load_dwordx4 v1, s[8:11], s15 offen offset:3072 sc1 lds
    ds_read_b64_tr_b16 v[62:63], v59 offset:9216
    v_mfma_f32_16x16x32_bf16 v[112:115], v[44:47], a[4:7], 0
    s_add_u32 m0, s12, 45056
    ds_read_b64_tr_b16 v[64:65], v59 offset:1024
    v_mul_f32 v125, v125, v205
    v_mfma_f32_16x16x32_bf16 v[112:115], v[48:51], a[20:23], v[112:115]
    s_add_u32 s15, s14, 45056
    ds_read_b64_tr_b16 v[66:67], v59 offset:10240
    v_mul_f32 v126, v126, v206
    v_mfma_f32_16x16x32_bf16 v[112:115], v[52:55], a[36:39], v[112:115]
    ds_read_b64_tr_b16 v[68:69], v59 offset:2048
    v_mul_f32 v127, v127, v207
    v_mfma_f32_16x16x32_bf16 v[116:119], v[44:47], a[8:11], 0
    ds_read_b64_tr_b16 v[70:71], v59 offset:11264
    v_mul_f32 v128, v128, v208
    v_mfma_f32_16x16x32_bf16 v[116:119], v[48:51], a[24:27], v[116:119]
    buffer_load_dwordx4 v1, s[8:11], s15 offen offset:0 sc1 lds
    v_mul_f32 v129, v129, v209
    v_mfma_f32_16x16x32_bf16 v[116:119], v[52:55], a[40:43], v[116:119]
    v_mul_f32 v130, v130, v210
    v_mul_f32 v131, v131, v211
    v_mfma_f32_16x16x32_bf16 v[120:123], v[44:47], a[12:15], 0
    v_cvt_pk_bf16_f32 v36, v124, v125
    v_cvt_pk_bf16_f32 v37, v126, v127
    v_mfma_f32_16x16x32_bf16 v[120:123], v[48:51], a[28:31], v[120:123]
    v_cvt_pk_bf16_f32 v38, v128, v129
    v_cvt_pk_bf16_f32 v39, v130, v131
    v_mfma_f32_16x16x32_bf16 v[120:123], v[52:55], a[44:47], v[120:123]
    s_waitcnt lgkmcnt(0)
    v_exp_f32 v22, v22
    v_mfma_f32_16x16x32_bf16 v[204:207], v[60:63], a[0:3], 0
    ds_read_b64_tr_b16 v[44:45], v56 offset:3072
    v_mul_f32 v132, v132, v212
    v_mfma_f32_16x16x32_bf16 v[204:207], v[64:67], a[16:19], v[204:207]
    ds_read_b64_tr_b16 v[46:47], v56 offset:12288
    v_mul_f32 v133, v133, v213
    v_mfma_f32_16x16x32_bf16 v[204:207], v[68:71], a[32:35], v[204:207]
    ds_read_b64_tr_b16 v[48:49], v56 offset:4096
    v_mul_f32 v134, v134, v214
    v_mfma_f32_16x16x32_bf16 v[208:211], v[60:63], a[4:7], 0
    ds_read_b64_tr_b16 v[50:51], v56 offset:13312
    v_mul_f32 v135, v135, v215
    v_mfma_f32_16x16x32_bf16 v[208:211], v[64:67], a[20:23], v[208:211]
    ds_read_b64_tr_b16 v[52:53], v56 offset:5120
    v_mul_f32 v136, v136, v216
    v_mfma_f32_16x16x32_bf16 v[208:211], v[68:71], a[36:39], v[208:211]
    ds_read_b64_tr_b16 v[54:55], v56 offset:14336
    v_mul_f32 v137, v137, v217
    v_mfma_f32_16x16x32_bf16 v[212:215], v[60:63], a[8:11], 0
    v_exp_f32 v23, v23
    v_mfma_f32_16x16x32_bf16 v[212:215], v[64:67], a[24:27], v[212:215]
    v_mul_f32 v138, v138, v218
    v_mul_f32 v139, v139, v219
    v_mfma_f32_16x16x32_bf16 v[212:215], v[68:71], a[40:43], v[212:215]
    v_cvt_pk_bf16_f32 v40, v132, v133
    v_cvt_pk_bf16_f32 v41, v134, v135
    v_mfma_f32_16x16x32_bf16 v[216:219], v[60:63], a[12:15], 0
    v_cvt_pk_bf16_f32 v42, v136, v137
    v_cvt_pk_bf16_f32 v43, v138, v139
    v_mfma_f32_16x16x32_bf16 v[216:219], v[64:67], a[28:31], v[216:219]
    v_permlane16_swap_b32 v36, v38
    v_permlane16_swap_b32 v37, v39
    v_mfma_f32_16x16x32_bf16 v[216:219], v[68:71], a[44:47], v[216:219]
    s_waitcnt lgkmcnt(0)
    v_permlane16_swap_b32 v40, v42
    v_permlane16_swap_b32 v41, v43
    v_mfma_f32_16x16x32_bf16 v[156:159], v[44:47], a[48:51], v[156:159]
    buffer_store_dwordx4 v[36:39], v7, s[8:11], s17 offen sc1
    ds_read_b64_tr_b16 v[60:61], v57 offset:3072
    v_mfma_f32_16x16x32_bf16 v[156:159], v[48:51], a[64:67], v[156:159]
    s_mov_b32 s16, 0
    ds_read_b64_tr_b16 v[62:63], v57 offset:12288
    v_fma_f32 v20, v20, v16, v16
    v_mfma_f32_16x16x32_bf16 v[156:159], v[52:55], a[80:83], v[156:159]
    s_mov_b32 s17, 299008
    ds_read_b64_tr_b16 v[64:65], v57 offset:4096
    v_fma_f32 v21, v21, v16, v16
    v_mfma_f32_16x16x32_bf16 v[160:163], v[44:47], a[52:55], v[160:163]
    ds_read_b64_tr_b16 v[66:67], v57 offset:13312
    v_fma_f32 v22, v22, v16, v16
    v_mfma_f32_16x16x32_bf16 v[160:163], v[48:51], a[68:71], v[160:163]
    buffer_store_dwordx4 v[40:43], v7, s[8:11], s17 offen sc1
    ds_read_b64_tr_b16 v[68:69], v57 offset:5120
    v_mfma_f32_16x16x32_bf16 v[160:163], v[52:55], a[84:87], v[160:163]
    ds_read_b64_tr_b16 v[70:71], v57 offset:14336
    v_fma_f32 v23, v23, v16, v16
    v_mfma_f32_16x16x32_bf16 v[164:167], v[44:47], a[56:59], v[164:167]
    v_rcp_f32 v20, v20
    v_mfma_f32_16x16x32_bf16 v[164:167], v[48:51], a[72:75], v[164:167]
    v_rcp_f32 v21, v21
    v_mfma_f32_16x16x32_bf16 v[164:167], v[52:55], a[88:91], v[164:167]
L_pad_c3_4:
    s_cbranch_execz L_pad_c3_8
    v_rcp_f32 v22, v22
    v_mfma_f32_16x16x32_bf16 v[168:171], v[44:47], a[60:63], v[168:171]
    buffer_load_dwordx4 a[0:3], v8, s[8:11], s16 offen offset:0 sc1
    v_mul_f32 v92, v20, v92
    v_mfma_f32_16x16x32_bf16 v[168:171], v[48:51], a[76:79], v[168:171]
    v_rcp_f32 v23, v23
    v_mfma_f32_16x16x32_bf16 v[168:171], v[52:55], a[92:95], v[168:171]
    s_waitcnt lgkmcnt(0)
    v_mul_f32 v93, v21, v93
    v_mul_f32 v94, v22, v94
    v_mfma_f32_16x16x32_bf16 v[172:175], v[60:63], a[48:51], v[172:175]
    ds_read_b64_tr_b16 v[44:45], v58 offset:3072
    v_mul_f32 v95, v23, v95
    v_mfma_f32_16x16x32_bf16 v[172:175], v[64:67], a[64:67], v[172:175]
    ds_read_b64_tr_b16 v[46:47], v58 offset:12288
    v_mul_f32 v24, v13, v96
    v_mfma_f32_16x16x32_bf16 v[172:175], v[68:71], a[80:83], v[172:175]
    buffer_load_dwordx4 a[4:7], v8, s[8:11], s16 offen offset:256 sc1
    ds_read_b64_tr_b16 v[48:49], v58 offset:4096
    v_mfma_f32_16x16x32_bf16 v[176:179], v[60:63], a[52:55], v[176:179]
    s_mov_b32 s16, 18432
    ds_read_b64_tr_b16 v[50:51], v58 offset:13312
    v_mul_f32 v25, v13, v97
    v_mfma_f32_16x16x32_bf16 v[176:179], v[64:67], a[68:71], v[176:179]
    ds_read_b64_tr_b16 v[52:53], v58 offset:5120
    v_mul_f32 v26, v13, v98
    v_mfma_f32_16x16x32_bf16 v[176:179], v[68:71], a[84:87], v[176:179]
    ds_read_b64_tr_b16 v[54:55], v58 offset:14336
    v_mul_f32 v27, v13, v99
    v_mfma_f32_16x16x32_bf16 v[180:183], v[60:63], a[56:59], v[180:183]
    v_exp_f32 v24, v24
    v_mfma_f32_16x16x32_bf16 v[180:183], v[64:67], a[72:75], v[180:183]
    buffer_load_dwordx4 a[8:11], v8, s[8:11], s16 offen offset:0 sc1
    v_fma_f32 v24, v24, v17, v17
    v_mfma_f32_16x16x32_bf16 v[180:183], v[68:71], a[88:91], v[180:183]
    v_exp_f32 v25, v25
    v_mfma_f32_16x16x32_bf16 v[184:187], v[60:63], a[60:63], v[184:187]
    v_exp_f32 v26, v26
    v_mfma_f32_16x16x32_bf16 v[184:187], v[64:67], a[76:79], v[184:187]
    v_exp_f32 v27, v27
    v_mfma_f32_16x16x32_bf16 v[184:187], v[68:71], a[92:95], v[184:187]
    s_waitcnt lgkmcnt(0)
    v_rcp_f32 v24, v24
    v_mfma_f32_16x16x32_bf16 v[108:111], v[44:47], a[48:51], v[108:111]
    buffer_load_dwordx4 a[12:15], v8, s[8:11], s16 offen offset:256 sc1
    v_mfma_f32_16x16x32_bf16 v[108:111], v[48:51], a[64:67], v[108:111]
    s_mov_b32 s16, 36864
    ds_read_b64_tr_b16 v[60:61], v59 offset:3072
    v_fma_f32 v25, v25, v17, v17
    v_mfma_f32_16x16x32_bf16 v[108:111], v[52:55], a[80:83], v[108:111]
    ds_read_b64_tr_b16 v[62:63], v59 offset:12288
    v_fma_f32 v26, v26, v17, v17
    v_mfma_f32_16x16x32_bf16 v[112:115], v[44:47], a[52:55], v[112:115]
    ds_read_b64_tr_b16 v[64:65], v59 offset:4096
    v_fma_f32 v27, v27, v17, v17
    v_mfma_f32_16x16x32_bf16 v[112:115], v[48:51], a[68:71], v[112:115]
    ds_read_b64_tr_b16 v[66:67], v59 offset:13312
    v_mul_f32 v96, v24, v96
    v_mfma_f32_16x16x32_bf16 v[112:115], v[52:55], a[84:87], v[112:115]
    buffer_load_dwordx4 a[16:19], v8, s[8:11], s16 offen offset:0 sc1
    v_mfma_f32_16x16x32_bf16 v[116:119], v[44:47], a[56:59], v[116:119]
    ds_read_b64_tr_b16 v[68:69], v59 offset:5120
    v_mul_f32 v28, v14, v100
    v_mfma_f32_16x16x32_bf16 v[116:119], v[48:51], a[72:75], v[116:119]
    ds_read_b64_tr_b16 v[70:71], v59 offset:14336
    v_mul_f32 v29, v14, v101
    v_mfma_f32_16x16x32_bf16 v[116:119], v[52:55], a[88:91], v[116:119]
    v_rcp_f32 v25, v25
    v_mfma_f32_16x16x32_bf16 v[120:123], v[44:47], a[60:63], v[120:123]
    v_rcp_f32 v26, v26
    v_mfma_f32_16x16x32_bf16 v[120:123], v[48:51], a[76:79], v[120:123]
    buffer_load_dwordx4 a[20:23], v8, s[8:11], s16 offen offset:256 sc1
    v_mfma_f32_16x16x32_bf16 v[120:123], v[52:55], a[92:95], v[120:123]
    s_waitcnt lgkmcnt(0)
    v_rcp_f32 v27, v27
    v_mfma_f32_16x16x32_bf16 v[204:207], v[60:63], a[48:51], v[204:207]
    s_mov_b32 s16, 55296
    ds_read_b64_tr_b16 v[44:45], v56 offset:6144
    v_mul_f32 v97, v25, v97
    v_mfma_f32_16x16x32_bf16 v[204:207], v[64:67], a[64:67], v[204:207]
    ds_read_b64_tr_b16 v[46:47], v56 offset:15360
    v_mul_f32 v98, v26, v98
    v_mfma_f32_16x16x32_bf16 v[204:207], v[68:71], a[80:83], v[204:207]
    ds_read_b64_tr_b16 v[48:49], v56 offset:7168
    v_mul_f32 v99, v27, v99
    v_mfma_f32_16x16x32_bf16 v[208:211], v[60:63], a[52:55], v[208:211]
    buffer_load_dwordx4 a[24:27], v8, s[8:11], s16 offen offset:0 sc1
    v_mfma_f32_16x16x32_bf16 v[208:211], v[64:67], a[68:71], v[208:211]
    ds_read_b64_tr_b16 v[50:51], v56 offset:16384
    v_mul_f32 v30, v14, v102
    v_mfma_f32_16x16x32_bf16 v[208:211], v[68:71], a[84:87], v[208:211]
    ds_read_b64_tr_b16 v[52:53], v56 offset:8192
    v_mul_f32 v31, v14, v103
    v_mfma_f32_16x16x32_bf16 v[212:215], v[60:63], a[56:59], v[212:215]
    ds_read_b64_tr_b16 v[54:55], v56 offset:17408
    v_mfma_f32_16x16x32_bf16 v[212:215], v[64:67], a[72:75], v[212:215]
    v_exp_f32 v28, v28
    v_mfma_f32_16x16x32_bf16 v[212:215], v[68:71], a[88:91], v[212:215]
    buffer_load_dwordx4 a[28:31], v8, s[8:11], s16 offen offset:256 sc1
    v_mfma_f32_16x16x32_bf16 v[216:219], v[60:63], a[60:63], v[216:219]
    v_exp_f32 v29, v29
    v_mfma_f32_16x16x32_bf16 v[216:219], v[64:67], a[76:79], v[216:219]
    v_exp_f32 v30, v30
    v_mfma_f32_16x16x32_bf16 v[216:219], v[68:71], a[92:95], v[216:219]
    s_waitcnt lgkmcnt(0)
    v_exp_f32 v31, v31
    v_mfma_f32_16x16x32_bf16 v[156:159], v[44:47], a[96:99], v[156:159]
    s_mov_b32 s16, 1024
    ds_read_b64_tr_b16 v[60:61], v57 offset:6144
    v_fma_f32 v28, v28, v18, v18
    v_mfma_f32_16x16x32_bf16 v[156:159], v[48:51], a[112:115], v[156:159]
    buffer_load_dwordx4 a[32:35], v8, s[8:11], s16 offen offset:0 sc1
    v_mfma_f32_16x16x32_bf16 v[156:159], v[52:55], a[128:131], v[156:159]
    ds_read_b64_tr_b16 v[62:63], v57 offset:15360
    v_fma_f32 v29, v29, v18, v18
    v_mfma_f32_16x16x32_bf16 v[160:163], v[44:47], a[100:103], v[160:163]
    ds_read_b64_tr_b16 v[64:65], v57 offset:7168
    v_fma_f32 v30, v30, v18, v18
    v_mfma_f32_16x16x32_bf16 v[160:163], v[48:51], a[116:119], v[160:163]
    ds_read_b64_tr_b16 v[66:67], v57 offset:16384
    v_fma_f32 v31, v31, v18, v18
    v_mfma_f32_16x16x32_bf16 v[160:163], v[52:55], a[132:135], v[160:163]
    ds_read_b64_tr_b16 v[68:69], v57 offset:8192
    v_mul_f32 v32, v15, v104
    v_mfma_f32_16x16x32_bf16 v[164:167], v[44:47], a[104:107], v[164:167]
    buffer_load_dwordx4 a[36:39], v8, s[8:11], s16 offen offset:256 sc1
    v_mfma_f32_16x16x32_bf16 v[164:167], v[48:51], a[120:123], v[164:167]
    s_mov_b32 s16, 19456
    ds_read_b64_tr_b16 v[70:71], v57 offset:17408
    v_mul_f32 v33, v15, v105
    v_mfma_f32_16x16x32_bf16 v[164:167], v[52:55], a[136:139], v[164:167]
    v_rcp_f32 v28, v28
    v_mfma_f32_16x16x32_bf16 v[168:171], v[44:47], a[108:111], v[168:171]
    v_rcp_f32 v29, v29
    v_mfma_f32_16x16x32_bf16 v[168:171], v[48:51], a[124:127], v[168:171]
    v_rcp_f32 v30, v30
    v_mfma_f32_16x16x32_bf16 v[168:171], v[52:55], a[140:143], v[168:171]
    s_waitcnt lgkmcnt(0)
    v_rcp_f32 v31, v31
    v_mfma_f32_16x16x32_bf16 v[172:175], v[60:63], a[96:99], v[172:175]
    buffer_load_dwordx4 a[40:43], v8, s[8:11], s16 offen offset:0 sc1
    v_mfma_f32_16x16x32_bf16 v[172:175], v[64:67], a[112:115], v[172:175]
    ds_read_b64_tr_b16 v[44:45], v58 offset:6144
    v_mul_f32 v100, v28, v100
    v_mfma_f32_16x16x32_bf16 v[172:175], v[68:71], a[128:131], v[172:175]
    ds_read_b64_tr_b16 v[46:47], v58 offset:15360
    v_mul_f32 v101, v29, v101
    v_mfma_f32_16x16x32_bf16 v[176:179], v[60:63], a[100:103], v[176:179]
    ds_read_b64_tr_b16 v[48:49], v58 offset:7168
    v_mul_f32 v102, v30, v102
    v_mfma_f32_16x16x32_bf16 v[176:179], v[64:67], a[116:119], v[176:179]
    buffer_load_dwordx4 a[44:47], v8, s[8:11], s16 offen offset:256 sc1
    v_mfma_f32_16x16x32_bf16 v[176:179], v[68:71], a[132:135], v[176:179]
    v_mov_b32 v255, 10
    ds_read_b64_tr_b16 v[50:51], v58 offset:16384
    v_mfma_f32_16x16x32_bf16 v[180:183], v[60:63], a[104:107], v[180:183]
    s_mov_b32 s16, 37888
    ds_read_b64_tr_b16 v[52:53], v58 offset:8192
    v_mul_f32 v103, v31, v103
    v_mfma_f32_16x16x32_bf16 v[180:183], v[64:67], a[120:123], v[180:183]
    s_waitcnt vmcnt(12)
    ds_read_b64_tr_b16 v[54:55], v58 offset:17408
    v_mul_f32 v34, v15, v106
    v_mfma_f32_16x16x32_bf16 v[180:183], v[68:71], a[136:139], v[180:183]
    v_exp_f32 v32, v32
    v_mfma_f32_16x16x32_bf16 v[184:187], v[60:63], a[108:111], v[184:187]
    buffer_store_dword v255, v252, s[8:11], 0 offen sc1
    v_mfma_f32_16x16x32_bf16 v[184:187], v[64:67], a[124:127], v[184:187]
    buffer_load_dwordx4 a[48:51], v8, s[8:11], s16 offen offset:0 sc1
    v_mfma_f32_16x16x32_bf16 v[184:187], v[68:71], a[140:143], v[184:187]
    s_waitcnt lgkmcnt(0)
    v_exp_f32 v33, v33
    v_mfma_f32_16x16x32_bf16 v[108:111], v[44:47], a[96:99], v[108:111]
    ds_read_b64_tr_b16 v[60:61], v59 offset:6144
    v_mul_f32 v35, v15, v107
    v_mfma_f32_16x16x32_bf16 v[108:111], v[48:51], a[112:115], v[108:111]
    ds_read_b64_tr_b16 v[62:63], v59 offset:15360
    v_fma_f32 v32, v32, v19, v19
    v_mfma_f32_16x16x32_bf16 v[108:111], v[52:55], a[128:131], v[108:111]
    ds_read_b64_tr_b16 v[64:65], v59 offset:7168
    v_fma_f32 v33, v33, v19, v19
    v_mfma_f32_16x16x32_bf16 v[112:115], v[44:47], a[100:103], v[112:115]
    buffer_load_dwordx4 a[52:55], v8, s[8:11], s16 offen offset:256 sc1
    v_mfma_f32_16x16x32_bf16 v[112:115], v[48:51], a[116:119], v[112:115]
    s_mov_b32 s16, 56320
    ds_read_b64_tr_b16 v[66:67], v59 offset:16384
    v_mul_f32 v20, v12, v188
    v_mfma_f32_16x16x32_bf16 v[112:115], v[52:55], a[132:135], v[112:115]
    ds_read_b64_tr_b16 v[68:69], v59 offset:8192
    v_mul_f32 v21, v12, v189
    v_mfma_f32_16x16x32_bf16 v[116:119], v[44:47], a[104:107], v[116:119]
    ds_read_b64_tr_b16 v[70:71], v59 offset:17408
    v_mul_f32 v22, v12, v190
    v_mfma_f32_16x16x32_bf16 v[116:119], v[48:51], a[120:123], v[116:119]
    v_exp_f32 v34, v34
    v_mfma_f32_16x16x32_bf16 v[116:119], v[52:55], a[136:139], v[116:119]
    buffer_load_dwordx4 a[56:59], v8, s[8:11], s16 offen offset:0 sc1
    v_mfma_f32_16x16x32_bf16 v[120:123], v[44:47], a[108:111], v[120:123]
    v_exp_f32 v35, v35
    v_mfma_f32_16x16x32_bf16 v[120:123], v[48:51], a[124:127], v[120:123]
    v_rcp_f32 v32, v32
    v_mfma_f32_16x16x32_bf16 v[120:123], v[52:55], a[140:143], v[120:123]
    s_waitcnt lgkmcnt(0)
    v_rcp_f32 v33, v33
    v_mfma_f32_16x16x32_bf16 v[204:207], v[60:63], a[96:99], v[204:207]
    s_barrier
    ds_read_b64_tr_b16 v[44:45], v56 offset:36864
    v_fma_f32 v34, v34, v19, v19
    v_mfma_f32_16x16x32_bf16 v[204:207], v[64:67], a[112:115], v[204:207]
    buffer_load_dwordx4 a[60:63], v8, s[8:11], s16 offen offset:256 sc1
    v_mfma_f32_16x16x32_bf16 v[204:207], v[68:71], a[128:131], v[204:207]
    s_add_u32 m0, s12, 73728
    ds_read_b64_tr_b16 v[46:47], v56 offset:46080
    v_fma_f32 v35, v35, v19, v19
    v_mfma_f32_16x16x32_bf16 v[208:211], v[60:63], a[100:103], v[208:211]
    s_add_u32 s15, s14, 73728
    ds_read_b64_tr_b16 v[48:49], v56 offset:37888
    v_mul_f32 v104, v32, v104
    v_mfma_f32_16x16x32_bf16 v[208:211], v[64:67], a[116:119], v[208:211]
    s_mov_b32 s16, 2048
    ds_read_b64_tr_b16 v[50:51], v56 offset:47104
    v_mul_f32 v105, v33, v105
    v_mfma_f32_16x16x32_bf16 v[208:211], v[68:71], a[132:135], v[208:211]
    ds_read_b64_tr_b16 v[52:53], v56 offset:38912
    v_mul_f32 v23, v12, v191
    v_mfma_f32_16x16x32_bf16 v[212:215], v[60:63], a[104:107], v[212:215]
    buffer_load_dwordx4 v1, s[8:11], s15 offen offset:0 sc1 lds
    v_mfma_f32_16x16x32_bf16 v[212:215], v[64:67], a[120:123], v[212:215]
    ds_read_b64_tr_b16 v[54:55], v56 offset:48128
    v_mfma_f32_16x16x32_bf16 v[212:215], v[68:71], a[136:139], v[212:215]
    v_rcp_f32 v34, v34
    v_mfma_f32_16x16x32_bf16 v[216:219], v[60:63], a[108:111], v[216:219]
    v_rcp_f32 v35, v35
    v_mfma_f32_16x16x32_bf16 v[216:219], v[64:67], a[124:127], v[216:219]
    v_exp_f32 v20, v20
    v_mfma_f32_16x16x32_bf16 v[216:219], v[68:71], a[140:143], v[216:219]
    s_waitcnt lgkmcnt(0)
    v_exp_f32 v21, v21
    v_mfma_f32_16x16x32_bf16 v[156:159], v[44:47], a[144:147], v[156:159]
    buffer_load_dwordx4 v1, s[8:11], s15 offen offset:1024 sc1 lds
    v_mfma_f32_16x16x32_bf16 v[156:159], v[48:51], a[160:163], v[156:159]
    ds_read_b64_tr_b16 v[60:61], v56 offset:39936
    v_mul_f32 v106, v34, v106
    v_mfma_f32_16x16x32_bf16 v[156:159], v[52:55], a[176:179], v[156:159]
    ds_read_b64_tr_b16 v[62:63], v56 offset:49152
    v_mul_f32 v107, v35, v107
    v_mfma_f32_16x16x32_bf16 v[160:163], v[44:47], a[148:151], v[160:163]
    ds_read_b64_tr_b16 v[64:65], v56 offset:40960
    v_fma_f32 v20, v20, v16, v16
    v_mfma_f32_16x16x32_bf16 v[160:163], v[48:51], a[164:167], v[160:163]
    buffer_load_dwordx4 v1, s[8:11], s15 offen offset:2048 sc1 lds
    v_mfma_f32_16x16x32_bf16 v[160:163], v[52:55], a[180:183], v[160:163]
    ds_read_b64_tr_b16 v[66:67], v56 offset:50176
    v_fma_f32 v21, v21, v16, v16
    v_mfma_f32_16x16x32_bf16 v[164:167], v[44:47], a[152:155], v[164:167]
    ds_read_b64_tr_b16 v[68:69], v56 offset:41984
    v_mul_f32 v24, v13, v192
    v_mfma_f32_16x16x32_bf16 v[164:167], v[48:51], a[168:171], v[164:167]
    ds_read_b64_tr_b16 v[70:71], v56 offset:51200
    v_mul_f32 v25, v13, v193
    v_mfma_f32_16x16x32_bf16 v[164:167], v[52:55], a[184:187], v[164:167]
    v_exp_f32 v22, v22
    v_mfma_f32_16x16x32_bf16 v[168:171], v[44:47], a[156:159], v[168:171]
    buffer_load_dwordx4 v1, s[8:11], s15 offen offset:3072 sc1 lds
    v_mfma_f32_16x16x32_bf16 v[168:171], v[48:51], a[172:175], v[168:171]
    s_add_u32 m0, s12, 77824
    v_exp_f32 v23, v23
    v_mfma_f32_16x16x32_bf16 v[168:171], v[52:55], a[188:191], v[168:171]
    s_waitcnt lgkmcnt(0)
    v_rcp_f32 v20, v20
    v_mfma_f32_16x16x32_bf16 v[168:171], v[60:63], a[204:207], v[168:171]
    s_add_u32 s15, s14, 77824
    ds_read_b64_tr_b16 v[44:45], v56 offset:43008
    v_fma_f32 v22, v22, v16, v16
    v_mfma_f32_16x16x32_bf16 v[168:171], v[64:67], a[220:223], v[168:171]
    ds_read_b64_tr_b16 v[46:47], v56 offset:52224
    v_fma_f32 v23, v23, v16, v16
    v_mfma_f32_16x16x32_bf16 v[168:171], v[68:71], a[236:239], v[168:171]
    buffer_load_dwordx4 v1, s[8:11], s15 offen offset:0 sc1 lds
    v_mfma_f32_16x16x32_bf16 v[164:167], v[60:63], a[200:203], v[164:167]
    ds_read_b64_tr_b16 v[48:49], v56 offset:44032
    v_mul_f32 v188, v20, v188
    v_mfma_f32_16x16x32_bf16 v[164:167], v[64:67], a[216:219], v[164:167]
    ds_read_b64_tr_b16 v[50:51], v56 offset:53248
    v_mul_f32 v26, v13, v194
    v_mfma_f32_16x16x32_bf16 v[164:167], v[68:71], a[232:235], v[164:167]
    ds_read_b64_tr_b16 v[52:53], v56 offset:45056
    v_mul_f32 v27, v13, v195
    v_mfma_f32_16x16x32_bf16 v[160:163], v[60:63], a[196:199], v[160:163]
    ds_read_b64_tr_b16 v[54:55], v56 offset:54272
    v_mfma_f32_16x16x32_bf16 v[160:163], v[64:67], a[212:215], v[160:163]
    buffer_load_dwordx4 v1, s[8:11], s15 offen offset:1024 sc1 lds
    v_mfma_f32_16x16x32_bf16 v[160:163], v[68:71], a[228:231], v[160:163]
    v_rcp_f32 v21, v21
    v_mfma_f32_16x16x32_bf16 v[156:159], v[60:63], a[192:195], v[156:159]
    v_rcp_f32 v22, v22
    v_mfma_f32_16x16x32_bf16 v[156:159], v[64:67], a[208:211], v[156:159]
    v_rcp_f32 v23, v23
    v_mfma_f32_16x16x32_bf16 v[156:159], v[68:71], a[224:227], v[156:159]
    s_waitcnt lgkmcnt(0)
    v_exp_f32 v24, v24
    v_mfma_f32_16x16x32_bf16 v[156:159], v[44:47], a[240:243], v[156:159]
    buffer_load_dwordx4 v1, s[8:11], s15 offen offset:2048 sc1 lds
    v_mfma_f32_16x16x32_bf16 v[156:159], v[48:51], v[220:223], v[156:159]
    ds_read_b64_tr_b16 v[60:61], v57 offset:36864
    v_mul_f32 v189, v21, v189
    v_mfma_f32_16x16x32_bf16 v[156:159], v[52:55], v[236:239], v[156:159]
    ds_read_b64_tr_b16 v[62:63], v57 offset:46080
    v_mul_f32 v190, v22, v190
    v_mfma_f32_16x16x32_bf16 v[160:163], v[44:47], a[244:247], v[160:163]
    ds_read_b64_tr_b16 v[64:65], v57 offset:37888
    v_mul_f32 v191, v23, v191
    v_mfma_f32_16x16x32_bf16 v[160:163], v[48:51], v[224:227], v[160:163]
    ds_read_b64_tr_b16 v[66:67], v57 offset:47104
    v_fma_f32 v24, v24, v17, v17
    v_mfma_f32_16x16x32_bf16 v[160:163], v[52:55], v[240:243], v[160:163]
    buffer_load_dwordx4 v1, s[8:11], s15 offen offset:3072 sc1 lds
    v_mfma_f32_16x16x32_bf16 v[164:167], v[44:47], a[248:251], v[164:167]
    s_add_u32 m0, s12, 81920
    ds_read_b64_tr_b16 v[68:69], v57 offset:38912
    v_mul_f32 v28, v14, v196
    v_mfma_f32_16x16x32_bf16 v[164:167], v[48:51], v[228:231], v[164:167]
    s_add_u32 s15, s14, 81920
    ds_read_b64_tr_b16 v[70:71], v57 offset:48128
    v_mul_f32 v29, v14, v197
    v_mfma_f32_16x16x32_bf16 v[164:167], v[52:55], v[244:247], v[164:167]
    v_exp_f32 v25, v25
    v_mfma_f32_16x16x32_bf16 v[168:171], v[44:47], a[252:255], v[168:171]
    v_exp_f32 v26, v26
    v_mfma_f32_16x16x32_bf16 v[168:171], v[48:51], v[232:235], v[168:171]
    buffer_load_dwordx4 v1, s[8:11], s15 offen offset:0 sc1 lds
    v_mfma_f32_16x16x32_bf16 v[168:171], v[52:55], v[248:251], v[168:171]
    s_waitcnt lgkmcnt(0)
    v_exp_f32 v27, v27
    v_mfma_f32_16x16x32_bf16 v[172:175], v[60:63], a[144:147], v[172:175]
    s_mov_b32 s17, 5120
    ds_read_b64_tr_b16 v[44:45], v57 offset:39936
    ds_read_b64_tr_b16 v[46:47], v57 offset:49152
    v_mfma_f32_16x16x32_bf16 v[172:175], v[64:67], a[160:163], v[172:175]
    ds_read_b64_tr_b16 v[48:49], v57 offset:40960
    ds_read_b64_tr_b16 v[50:51], v57 offset:50176
    v_mfma_f32_16x16x32_bf16 v[172:175], v[68:71], a[176:179], v[172:175]
    ds_read_b64_tr_b16 v[52:53], v57 offset:41984
    ds_read_b64_tr_b16 v[54:55], v57 offset:51200
    v_mfma_f32_16x16x32_bf16 v[176:179], v[60:63], a[148:151], v[176:179]
    buffer_load_dwordx4 a[64:67], v8, s[8:11], s16 offen offset:0 sc1
    v_mfma_f32_16x16x32_bf16 v[176:179], v[64:67], a[164:167], v[176:179]
    v_mul_f32 v76, v76, v156
    v_mul_f32 v77, v77, v157
    v_mfma_f32_16x16x32_bf16 v[176:179], v[68:71], a[180:183], v[176:179]
    v_mul_f32 v78, v78, v158
    v_mul_f32 v79, v79, v159
    v_mfma_f32_16x16x32_bf16 v[180:183], v[60:63], a[152:155], v[180:183]
    v_mul_f32 v80, v80, v160
    v_mul_f32 v81, v81, v161
    v_mfma_f32_16x16x32_bf16 v[180:183], v[64:67], a[168:171], v[180:183]
    v_mul_f32 v82, v82, v162
    v_mul_f32 v83, v83, v163
    v_mfma_f32_16x16x32_bf16 v[180:183], v[68:71], a[184:187], v[180:183]
    buffer_load_dword v254, v253, s[8:11], 0 offen sc1
    v_mfma_f32_16x16x32_bf16 v[184:187], v[60:63], a[156:159], v[184:187]
    buffer_load_dwordx4 a[68:71], v8, s[8:11], s16 offen offset:256 sc1
    v_mfma_f32_16x16x32_bf16 v[184:187], v[64:67], a[172:175], v[184:187]
    s_mov_b32 s16, 20480
    v_cvt_pk_bf16_f32 v36, v76, v77
    v_cvt_pk_bf16_f32 v37, v78, v79
    v_mfma_f32_16x16x32_bf16 v[184:187], v[68:71], a[188:191], v[184:187]
    s_waitcnt lgkmcnt(0)
    v_cvt_pk_bf16_f32 v38, v80, v81
    v_cvt_pk_bf16_f32 v39, v82, v83
    v_mfma_f32_16x16x32_bf16 v[184:187], v[44:47], a[204:207], v[184:187]
    ds_read_b64_tr_b16 v[60:61], v57 offset:43008
    v_mul_f32 v84, v84, v164
    v_mfma_f32_16x16x32_bf16 v[184:187], v[48:51], a[220:223], v[184:187]
    ds_read_b64_tr_b16 v[62:63], v57 offset:52224
    v_mul_f32 v85, v85, v165
    v_mfma_f32_16x16x32_bf16 v[184:187], v[52:55], a[236:239], v[184:187]
    buffer_load_dwordx4 a[72:75], v8, s[8:11], s16 offen offset:0 sc1
    v_mfma_f32_16x16x32_bf16 v[180:183], v[44:47], a[200:203], v[180:183]
    ds_read_b64_tr_b16 v[64:65], v57 offset:44032
    v_mul_f32 v86, v86, v166
    v_mfma_f32_16x16x32_bf16 v[180:183], v[48:51], a[216:219], v[180:183]
    ds_read_b64_tr_b16 v[66:67], v57 offset:53248
    v_mul_f32 v87, v87, v167
    v_mfma_f32_16x16x32_bf16 v[180:183], v[52:55], a[232:235], v[180:183]
    ds_read_b64_tr_b16 v[68:69], v57 offset:45056
    v_mul_f32 v88, v88, v168
    v_mfma_f32_16x16x32_bf16 v[176:179], v[44:47], a[196:199], v[176:179]
    ds_read_b64_tr_b16 v[70:71], v57 offset:54272
    v_mul_f32 v89, v89, v169
    v_mfma_f32_16x16x32_bf16 v[176:179], v[48:51], a[212:215], v[176:179]
    buffer_load_dwordx4 a[76:79], v8, s[8:11], s16 offen offset:256 sc1
    v_mfma_f32_16x16x32_bf16 v[176:179], v[52:55], a[228:231], v[176:179]
    s_mov_b32 s16, 38912
    v_mul_f32 v90, v90, v170
    v_mul_f32 v91, v91, v171
    v_mfma_f32_16x16x32_bf16 v[172:175], v[44:47], a[192:195], v[172:175]
    v_cvt_pk_bf16_f32 v40, v84, v85
    v_cvt_pk_bf16_f32 v41, v86, v87
    v_mfma_f32_16x16x32_bf16 v[172:175], v[48:51], a[208:211], v[172:175]
    v_cvt_pk_bf16_f32 v42, v88, v89
    v_cvt_pk_bf16_f32 v43, v90, v91
    v_mfma_f32_16x16x32_bf16 v[172:175], v[52:55], a[224:227], v[172:175]
    s_waitcnt lgkmcnt(0)
    v_rcp_f32 v24, v24
    v_mfma_f32_16x16x32_bf16 v[172:175], v[60:63], a[240:243], v[172:175]
    buffer_load_dwordx4 a[80:83], v8, s[8:11], s16 offen offset:0 sc1
    v_mfma_f32_16x16x32_bf16 v[172:175], v[64:67], v[220:223], v[172:175]
    ds_read_b64_tr_b16 v[44:45], v58 offset:36864
    v_permlane16_swap_b32 v36, v38
    v_mfma_f32_16x16x32_bf16 v[172:175], v[68:71], v[236:239], v[172:175]
    ds_read_b64_tr_b16 v[46:47], v58 offset:46080
    v_permlane16_swap_b32 v37, v39
    v_mfma_f32_16x16x32_bf16 v[176:179], v[60:63], a[244:247], v[176:179]
    ds_read_b64_tr_b16 v[48:49], v58 offset:37888
    v_permlane16_swap_b32 v40, v42
    v_mfma_f32_16x16x32_bf16 v[176:179], v[64:67], v[224:227], v[176:179]
    ds_read_b64_tr_b16 v[50:51], v58 offset:47104
    v_permlane16_swap_b32 v41, v43
    v_mfma_f32_16x16x32_bf16 v[176:179], v[68:71], v[240:243], v[176:179]
    buffer_store_dwordx4 v[36:39], v7, s[8:11], s17 offen sc1
    v_mfma_f32_16x16x32_bf16 v[180:183], v[60:63], a[248:251], v[180:183]
    s_mov_b32 s17, 300032
    ds_read_b64_tr_b16 v[52:53], v58 offset:38912
    v_fma_f32 v25, v25, v17, v17
    v_mfma_f32_16x16x32_bf16 v[180:183], v[64:67], v[228:231], v[180:183]
    ds_read_b64_tr_b16 v[54:55], v58 offset:48128
    v_fma_f32 v26, v26, v17, v17
    v_mfma_f32_16x16x32_bf16 v[180:183], v[68:71], v[244:247], v[180:183]
    v_rcp_f32 v25, v25
    v_mfma_f32_16x16x32_bf16 v[184:187], v[60:63], a[252:255], v[184:187]
    v_rcp_f32 v26, v26
    v_mfma_f32_16x16x32_bf16 v[184:187], v[64:67], v[232:235], v[184:187]
    buffer_store_dwordx4 v[40:43], v7, s[8:11], s17 offen sc1
    v_mfma_f32_16x16x32_bf16 v[184:187], v[68:71], v[248:251], v[184:187]
    s_waitcnt lgkmcnt(0)
    v_exp_f32 v28, v28
    v_mfma_f32_16x16x32_bf16 v[108:111], v[44:47], a[144:147], v[108:111]
    s_mov_b32 s17, 6144
    ds_read_b64_tr_b16 v[60:61], v58 offset:39936
    ds_read_b64_tr_b16 v[62:63], v58 offset:49152
    v_mfma_f32_16x16x32_bf16 v[108:111], v[48:51], a[160:163], v[108:111]
    ds_read_b64_tr_b16 v[64:65], v58 offset:40960
    ds_read_b64_tr_b16 v[66:67], v58 offset:50176
    v_mfma_f32_16x16x32_bf16 v[108:111], v[52:55], a[176:179], v[108:111]
    ds_read_b64_tr_b16 v[68:69], v58 offset:41984
    ds_read_b64_tr_b16 v[70:71], v58 offset:51200
    v_mfma_f32_16x16x32_bf16 v[112:115], v[44:47], a[148:151], v[112:115]
    buffer_load_dwordx4 a[84:87], v8, s[8:11], s16 offen offset:256 sc1
    v_mfma_f32_16x16x32_bf16 v[112:115], v[48:51], a[164:167], v[112:115]
    s_mov_b32 s16, 57344
    v_mul_f32 v140, v140, v172
    v_mul_f32 v141, v141, v173
    v_mfma_f32_16x16x32_bf16 v[112:115], v[52:55], a[180:183], v[112:115]
    v_mul_f32 v142, v142, v174
    v_mul_f32 v143, v143, v175
    v_mfma_f32_16x16x32_bf16 v[116:119], v[44:47], a[152:155], v[116:119]
    v_mul_f32 v144, v144, v176
    v_mul_f32 v145, v145, v177
    v_mfma_f32_16x16x32_bf16 v[116:119], v[48:51], a[168:171], v[116:119]
    v_mul_f32 v146, v146, v178
    v_mul_f32 v147, v147, v179
    v_mfma_f32_16x16x32_bf16 v[116:119], v[52:55], a[184:187], v[116:119]
    buffer_load_dwordx4 a[88:91], v8, s[8:11], s16 offen offset:0 sc1
    v_mfma_f32_16x16x32_bf16 v[120:123], v[44:47], a[156:159], v[120:123]
    v_cvt_pk_bf16_f32 v36, v140, v141
    v_cvt_pk_bf16_f32 v37, v142, v143
    v_mfma_f32_16x16x32_bf16 v[120:123], v[48:51], a[172:175], v[120:123]
    v_cvt_pk_bf16_f32 v38, v144, v145
    v_cvt_pk_bf16_f32 v39, v146, v147
    v_mfma_f32_16x16x32_bf16 v[120:123], v[52:55], a[188:191], v[120:123]
    s_waitcnt lgkmcnt(0)
    v_mul_f32 v148, v148, v180
    v_mul_f32 v149, v149, v181
    v_mfma_f32_16x16x32_bf16 v[120:123], v[60:63], a[204:207], v[120:123]
    ds_read_b64_tr_b16 v[44:45], v58 offset:43008
    v_mul_f32 v150, v150, v182
    v_mfma_f32_16x16x32_bf16 v[120:123], v[64:67], a[220:223], v[120:123]
    buffer_load_dwordx4 a[92:95], v8, s[8:11], s16 offen offset:256 sc1
    v_mfma_f32_16x16x32_bf16 v[120:123], v[68:71], a[236:239], v[120:123]
    ds_read_b64_tr_b16 v[46:47], v58 offset:52224
    v_mul_f32 v151, v151, v183
    v_mfma_f32_16x16x32_bf16 v[116:119], v[60:63], a[200:203], v[116:119]
    ds_read_b64_tr_b16 v[48:49], v58 offset:44032
    v_mul_f32 v152, v152, v184
    v_mfma_f32_16x16x32_bf16 v[116:119], v[64:67], a[216:219], v[116:119]
    ds_read_b64_tr_b16 v[50:51], v58 offset:53248
    v_mul_f32 v153, v153, v185
    v_mfma_f32_16x16x32_bf16 v[116:119], v[68:71], a[232:235], v[116:119]
    ds_read_b64_tr_b16 v[52:53], v58 offset:45056
    v_mul_f32 v154, v154, v186
    v_mfma_f32_16x16x32_bf16 v[112:115], v[60:63], a[196:199], v[112:115]
    ds_read_b64_tr_b16 v[54:55], v58 offset:54272
    v_mul_f32 v155, v155, v187
    v_mfma_f32_16x16x32_bf16 v[112:115], v[64:67], a[212:215], v[112:115]
    v_cvt_pk_bf16_f32 v40, v148, v149
    v_cvt_pk_bf16_f32 v41, v150, v151
    v_mfma_f32_16x16x32_bf16 v[112:115], v[68:71], a[228:231], v[112:115]
    v_cvt_pk_bf16_f32 v42, v152, v153
    v_cvt_pk_bf16_f32 v43, v154, v155
    v_mfma_f32_16x16x32_bf16 v[108:111], v[60:63], a[192:195], v[108:111]
    v_permlane16_swap_b32 v36, v38
    v_permlane16_swap_b32 v37, v39
    v_mfma_f32_16x16x32_bf16 v[108:111], v[64:67], a[208:211], v[108:111]
    buffer_store_dwordx4 v[36:39], v7, s[8:11], s17 offen sc1
    v_mfma_f32_16x16x32_bf16 v[108:111], v[68:71], a[224:227], v[108:111]
    s_waitcnt lgkmcnt(0)
    v_permlane16_swap_b32 v40, v42
    v_permlane16_swap_b32 v41, v43
    v_mfma_f32_16x16x32_bf16 v[108:111], v[44:47], a[240:243], v[108:111]
    s_mov_b32 s17, 301056
    ds_read_b64_tr_b16 v[60:61], v59 offset:36864
    v_fma_f32 v27, v27, v17, v17
    v_mfma_f32_16x16x32_bf16 v[108:111], v[48:51], v[220:223], v[108:111]
    ds_read_b64_tr_b16 v[62:63], v59 offset:46080
    v_mul_f32 v192, v24, v192
    v_mfma_f32_16x16x32_bf16 v[108:111], v[52:55], v[236:239], v[108:111]
    buffer_store_dwordx4 v[40:43], v7, s[8:11], s17 offen sc1
    v_mfma_f32_16x16x32_bf16 v[112:115], v[44:47], a[244:247], v[112:115]
    ds_read_b64_tr_b16 v[64:65], v59 offset:37888
    v_mul_f32 v193, v25, v193
    v_mfma_f32_16x16x32_bf16 v[112:115], v[48:51], v[224:227], v[112:115]
    ds_read_b64_tr_b16 v[66:67], v59 offset:47104
    v_mul_f32 v194, v26, v194
    v_mfma_f32_16x16x32_bf16 v[112:115], v[52:55], v[240:243], v[112:115]
    ds_read_b64_tr_b16 v[68:69], v59 offset:38912
    v_mul_f32 v30, v14, v198
    v_mfma_f32_16x16x32_bf16 v[116:119], v[44:47], a[248:251], v[116:119]
    ds_read_b64_tr_b16 v[70:71], v59 offset:48128
    v_mul_f32 v31, v14, v199
    v_mfma_f32_16x16x32_bf16 v[116:119], v[48:51], v[228:231], v[116:119]
    v_rcp_f32 v27, v27
    v_mfma_f32_16x16x32_bf16 v[116:119], v[52:55], v[244:247], v[116:119]
    s_waitcnt vmcnt(11)
    v_cmp_gt_u32 s[46:47], 10, v254
    v_mul_f32 v195, v27, v195
    v_mfma_f32_16x16x32_bf16 v[120:123], v[44:47], a[252:255], v[120:123]
    v_exp_f32 v29, v29
    v_mfma_f32_16x16x32_bf16 v[120:123], v[48:51], v[232:235], v[120:123]
    s_cmp_lg_u64 s[46:47], 0
    s_cbranch_scc1 L_slow30
L_slow30_ret:
    s_mov_b32 s16, 3072
    v_mfma_f32_16x16x32_bf16 v[120:123], v[52:55], v[248:251], v[120:123]
    s_waitcnt lgkmcnt(0)
    v_exp_f32 v30, v30
    v_mfma_f32_16x16x32_bf16 v[204:207], v[60:63], a[144:147], v[204:207]
    buffer_load_dwordx4 a[96:99], v8, s[8:11], s16 offen offset:0 sc1
    v_mfma_f32_16x16x32_bf16 v[204:207], v[64:67], a[160:163], v[204:207]
    s_mov_b32 s17, 7168
    ds_read_b64_tr_b16 v[44:45], v59 offset:39936
    ds_read_b64_tr_b16 v[46:47], v59 offset:49152
    v_mfma_f32_16x16x32_bf16 v[204:207], v[68:71], a[176:179], v[204:207]
    ds_read_b64_tr_b16 v[48:49], v59 offset:40960
    ds_read_b64_tr_b16 v[50:51], v59 offset:50176
    v_mfma_f32_16x16x32_bf16 v[208:211], v[60:63], a[148:151], v[208:211]
    ds_read_b64_tr_b16 v[52:53], v59 offset:41984
    v_mul_f32 v92, v92, v108
    v_mfma_f32_16x16x32_bf16 v[208:211], v[64:67], a[164:167], v[208:211]
    buffer_load_dwordx4 a[100:103], v8, s[8:11], s16 offen offset:256 sc1
    v_mfma_f32_16x16x32_bf16 v[208:211], v[68:71], a[180:183], v[208:211]
    s_mov_b32 s16, 21504
    ds_read_b64_tr_b16 v[54:55], v59 offset:51200
    v_mul_f32 v93, v93, v109
    v_mfma_f32_16x16x32_bf16 v[212:215], v[60:63], a[152:155], v[212:215]
    v_mul_f32 v94, v94, v110
    v_mul_f32 v95, v95, v111
    v_mfma_f32_16x16x32_bf16 v[212:215], v[64:67], a[168:171], v[212:215]
    v_mul_f32 v96, v96, v112
    v_mul_f32 v97, v97, v113
    v_mfma_f32_16x16x32_bf16 v[212:215], v[68:71], a[184:187], v[212:215]
    v_mul_f32 v98, v98, v114
    v_mul_f32 v99, v99, v115
    v_mfma_f32_16x16x32_bf16 v[216:219], v[60:63], a[156:159], v[216:219]
    buffer_load_dwordx4 a[104:107], v8, s[8:11], s16 offen offset:0 sc1
    v_mfma_f32_16x16x32_bf16 v[216:219], v[64:67], a[172:175], v[216:219]
    v_cvt_pk_bf16_f32 v36, v92, v93
    v_cvt_pk_bf16_f32 v37, v94, v95
    v_mfma_f32_16x16x32_bf16 v[216:219], v[68:71], a[188:191], v[216:219]
    s_waitcnt lgkmcnt(0)
    v_cvt_pk_bf16_f32 v38, v96, v97
    v_cvt_pk_bf16_f32 v39, v98, v99
    v_mfma_f32_16x16x32_bf16 v[216:219], v[44:47], a[204:207], v[216:219]
    ds_read_b64_tr_b16 v[60:61], v59 offset:43008
    v_mul_f32 v100, v100, v116
    v_mfma_f32_16x16x32_bf16 v[216:219], v[48:51], a[220:223], v[216:219]
    ds_read_b64_tr_b16 v[62:63], v59 offset:52224
    v_mul_f32 v101, v101, v117
    v_mfma_f32_16x16x32_bf16 v[216:219], v[52:55], a[236:239], v[216:219]
    buffer_load_dwordx4 a[108:111], v8, s[8:11], s16 offen offset:256 sc1
    v_mfma_f32_16x16x32_bf16 v[212:215], v[44:47], a[200:203], v[212:215]
    s_mov_b32 s16, 39936
    ds_read_b64_tr_b16 v[64:65], v59 offset:44032
    v_mul_f32 v102, v102, v118
    v_mfma_f32_16x16x32_bf16 v[212:215], v[48:51], a[216:219], v[212:215]
    ds_read_b64_tr_b16 v[66:67], v59 offset:53248
    v_mul_f32 v103, v103, v119
    v_mfma_f32_16x16x32_bf16 v[212:215], v[52:55], a[232:235], v[212:215]
L_pad_c3_5:
    s_cbranch_execz L_hopret_c3
    ds_read_b64_tr_b16 v[68:69], v59 offset:45056
    v_mul_f32 v104, v104, v120
    v_mfma_f32_16x16x32_bf16 v[208:211], v[44:47], a[196:199], v[208:211]
    ds_read_b64_tr_b16 v[70:71], v59 offset:54272
    v_mul_f32 v105, v105, v121
    v_mfma_f32_16x16x32_bf16 v[208:211], v[48:51], a[212:215], v[208:211]
    buffer_load_dwordx4 a[112:115], v8, s[8:11], s16 offen offset:0 sc1
    v_mfma_f32_16x16x32_bf16 v[208:211], v[52:55], a[228:231], v[208:211]
    v_exp_f32 v31, v31
    v_mfma_f32_16x16x32_bf16 v[204:207], v[44:47], a[192:195], v[204:207]
    v_mul_f32 v106, v106, v122
    v_mul_f32 v107, v107, v123
    v_mfma_f32_16x16x32_bf16 v[204:207], v[48:51], a[208:211], v[204:207]
    v_cvt_pk_bf16_f32 v40, v100, v101
    v_cvt_pk_bf16_f32 v41, v102, v103
    v_mfma_f32_16x16x32_bf16 v[204:207], v[52:55], a[224:227], v[204:207]
    s_waitcnt lgkmcnt(0)
    v_cvt_pk_bf16_f32 v42, v104, v105
    v_cvt_pk_bf16_f32 v43, v106, v107
    v_mfma_f32_16x16x32_bf16 v[204:207], v[60:63], a[240:243], v[204:207]
    s_barrier
    s_add_u32 m0, s12, 110592
    ds_read_b128 v[44:47], v2 offset:0
    v_mfma_f32_16x16x32_bf16 v[204:207], v[64:67], v[220:223], v[204:207]
    s_add_u32 s15, s14, 110592
    ds_read_b128 v[48:51], v2 offset:1024
    v_permlane16_swap_b32 v36, v38
    v_mfma_f32_16x16x32_bf16 v[204:207], v[68:71], v[236:239], v[204:207]
    buffer_load_dwordx4 v1, s[8:11], s15 offen offset:0 sc1 lds
    v_mfma_f32_16x16x32_bf16 v[208:211], v[60:63], a[244:247], v[208:211]
    ds_read_b128 v[52:55], v2 offset:2048
    v_permlane16_swap_b32 v37, v39
    v_mfma_f32_16x16x32_bf16 v[208:211], v[64:67], v[224:227], v[208:211]
    ds_read_b128 v[56:59], v2 offset:3072
    v_permlane16_swap_b32 v40, v42
    v_mfma_f32_16x16x32_bf16 v[208:211], v[68:71], v[240:243], v[208:211]
    v_permlane16_swap_b32 v41, v43
    v_fma_f32 v28, v28, v18, v18
    v_mfma_f32_16x16x32_bf16 v[212:215], v[60:63], a[248:251], v[212:215]
    buffer_store_dwordx4 v[36:39], v7, s[8:11], s17 offen sc1
    v_mfma_f32_16x16x32_bf16 v[212:215], v[64:67], v[228:231], v[212:215]
    s_mov_b32 s17, 302080
    v_rcp_f32 v28, v28
    v_mfma_f32_16x16x32_bf16 v[212:215], v[68:71], v[244:247], v[212:215]
    v_fma_f32 v29, v29, v18, v18
    v_fma_f32 v30, v30, v18, v18
    v_mfma_f32_16x16x32_bf16 v[216:219], v[60:63], a[252:255], v[216:219]
    v_rcp_f32 v29, v29
    v_mfma_f32_16x16x32_bf16 v[216:219], v[64:67], v[232:235], v[216:219]
    v_rcp_f32 v30, v30
    v_mfma_f32_16x16x32_bf16 v[216:219], v[68:71], v[248:251], v[216:219]
    s_waitcnt lgkmcnt(0)
    v_fma_f32 v31, v31, v18, v18
    v_mul_f32 v196, v28, v196
    v_mfma_f32_16x16x32_bf16 v[124:127], v[44:47], a[0:3], 0
    buffer_store_dwordx4 v[40:43], v7, s[8:11], s17 offen sc1
    v_mfma_f32_16x16x32_bf16 v[124:127], v[48:51], a[8:11], v[124:127]
    ds_read_b128 v[60:63], v2 offset:4096
    ds_read_b128 v[64:67], v2 offset:5120
    v_mfma_f32_16x16x32_bf16 v[124:127], v[52:55], a[16:19], v[124:127]
    ds_read_b128 v[68:71], v2 offset:6144
    v_mul_f32 v197, v29, v197
    v_mfma_f32_16x16x32_bf16 v[124:127], v[56:59], a[24:27], v[124:127]
    ds_read_b128 v[72:75], v2 offset:7168
    v_mul_f32 v198, v30, v198
    v_mfma_f32_16x16x32_bf16 v[128:131], v[44:47], a[4:7], 0
    buffer_load_dwordx4 v1, s[8:11], s15 offen offset:1024 sc1 lds
    v_mfma_f32_16x16x32_bf16 v[128:131], v[48:51], a[12:15], v[128:131]
    v_rcp_f32 v31, v31
    v_mfma_f32_16x16x32_bf16 v[128:131], v[52:55], a[20:23], v[128:131]
    v_mul_f32 v199, v31, v199
    v_mul_f32 v32, v15, v200
    v_mfma_f32_16x16x32_bf16 v[128:131], v[56:59], a[28:31], v[128:131]
    s_waitcnt lgkmcnt(0)
    v_exp_f32 v32, v32
    v_mfma_f32_16x16x32_bf16 v[132:135], v[60:63], a[0:3], 0
    ds_read_b128 v[44:47], v2 offset:8192
    v_mul_f32 v33, v15, v201
    v_mfma_f32_16x16x32_bf16 v[132:135], v[64:67], a[8:11], v[132:135]
    buffer_load_dwordx4 v1, s[8:11], s15 offen offset:2048 sc1 lds
    v_mfma_f32_16x16x32_bf16 v[132:135], v[68:71], a[16:19], v[132:135]
    ds_read_b128 v[48:51], v2 offset:9216
    ds_read_b128 v[52:55], v2 offset:10240
    v_mfma_f32_16x16x32_bf16 v[132:135], v[72:75], a[24:27], v[132:135]
    ds_read_b128 v[56:59], v2 offset:11264
    v_mul_f32 v34, v15, v202
    v_mfma_f32_16x16x32_bf16 v[136:139], v[60:63], a[4:7], 0
    v_exp_f32 v33, v33
    v_mfma_f32_16x16x32_bf16 v[136:139], v[64:67], a[12:15], v[136:139]
    v_exp_f32 v34, v34
    v_mfma_f32_16x16x32_bf16 v[136:139], v[68:71], a[20:23], v[136:139]
    buffer_load_dwordx4 v1, s[8:11], s15 offen offset:3072 sc1 lds
    v_mfma_f32_16x16x32_bf16 v[136:139], v[72:75], a[28:31], v[136:139]
    s_waitcnt lgkmcnt(0)
    v_mul_f32 v35, v15, v203
    v_fma_f32 v32, v32, v19, v19
    v_mfma_f32_16x16x32_bf16 v[76:79], v[44:47], a[0:3], 0
    v_mov_b32 v255, 11
    ds_read_b128 v[60:63], v2 offset:12288
    v_mfma_f32_16x16x32_bf16 v[76:79], v[48:51], a[8:11], v[76:79]
    s_add_u32 m0, s12, 114688
    ds_read_b128 v[64:67], v2 offset:13312
    v_fma_f32 v33, v33, v19, v19
    v_mfma_f32_16x16x32_bf16 v[76:79], v[52:55], a[16:19], v[76:79]
    s_waitcnt vmcnt(11)
    ds_read_b128 v[68:71], v2 offset:14336
    v_fma_f32 v34, v34, v19, v19
    v_mfma_f32_16x16x32_bf16 v[76:79], v[56:59], a[24:27], v[76:79]
    buffer_store_dword v255, v252, s[8:11], 0 offen sc1
    v_mfma_f32_16x16x32_bf16 v[80:83], v[44:47], a[4:7], 0
    s_add_u32 s15, s14, 114688
    ds_read_b128 v[72:75], v2 offset:15360
    v_mfma_f32_16x16x32_bf16 v[80:83], v[48:51], a[12:15], v[80:83]
    buffer_load_dwordx4 v1, s[8:11], s15 offen offset:0 sc1 lds
    v_mfma_f32_16x16x32_bf16 v[80:83], v[52:55], a[20:23], v[80:83]
    v_exp_f32 v35, v35
    v_mfma_f32_16x16x32_bf16 v[80:83], v[56:59], a[28:31], v[80:83]
    s_waitcnt lgkmcnt(0)
    v_rcp_f32 v32, v32
    v_mfma_f32_16x16x32_bf16 v[156:159], v[60:63], a[0:3], 0
    ds_read_b128 v[44:47], v2 offset:16384
    v_fma_f32 v35, v35, v19, v19
    v_mfma_f32_16x16x32_bf16 v[156:159], v[64:67], a[8:11], v[156:159]
    buffer_load_dwordx4 v1, s[8:11], s15 offen offset:1024 sc1 lds
    v_mfma_f32_16x16x32_bf16 v[156:159], v[68:71], a[16:19], v[156:159]
    ds_read_b128 v[48:51], v2 offset:17408
    ds_read_b128 v[52:55], v2 offset:18432
    v_mfma_f32_16x16x32_bf16 v[156:159], v[72:75], a[24:27], v[156:159]
    ds_read_b128 v[56:59], v2 offset:19456
    v_mul_f32 v200, v32, v200
    v_mfma_f32_16x16x32_bf16 v[160:163], v[60:63], a[4:7], 0
    v_rcp_f32 v33, v33
    v_mfma_f32_16x16x32_bf16 v[160:163], v[64:67], a[12:15], v[160:163]
    v_rcp_f32 v34, v34
    v_mfma_f32_16x16x32_bf16 v[160:163], v[68:71], a[20:23], v[160:163]
    buffer_load_dwordx4 v1, s[8:11], s15 offen offset:2048 sc1 lds
    v_mfma_f32_16x16x32_bf16 v[160:163], v[72:75], a[28:31], v[160:163]
    s_waitcnt lgkmcnt(0)
    v_rcp_f32 v35, v35
    v_mfma_f32_16x16x32_bf16 v[164:167], v[44:47], a[0:3], 0
    ds_read_b128 v[60:63], v2 offset:20480
    v_mul_f32 v201, v33, v201
    v_mfma_f32_16x16x32_bf16 v[164:167], v[48:51], a[8:11], v[164:167]
    ds_read_b128 v[64:67], v2 offset:21504
    v_mul_f32 v202, v34, v202
    v_mfma_f32_16x16x32_bf16 v[164:167], v[52:55], a[16:19], v[164:167]
    ds_read_b128 v[68:71], v2 offset:22528
    v_mul_f32 v203, v35, v203
    v_mfma_f32_16x16x32_bf16 v[164:167], v[56:59], a[24:27], v[164:167]
    buffer_load_dwordx4 v1, s[8:11], s15 offen offset:3072 sc1 lds
    v_mfma_f32_16x16x32_bf16 v[168:171], v[44:47], a[4:7], 0
    s_add_u32 m0, s12, 118784
    ds_read_b128 v[72:75], v2 offset:23552
    v_mul_f32 v188, v188, v204
    v_mfma_f32_16x16x32_bf16 v[168:171], v[48:51], a[12:15], v[168:171]
    s_add_u32 s15, s14, 118784
    v_mul_f32 v189, v189, v205
    v_mul_f32 v190, v190, v206
    v_mfma_f32_16x16x32_bf16 v[168:171], v[52:55], a[20:23], v[168:171]
    s_mov_b32 s17, 8192
    v_mul_f32 v191, v191, v207
    v_mul_f32 v192, v192, v208
    v_mfma_f32_16x16x32_bf16 v[168:171], v[56:59], a[28:31], v[168:171]
    s_waitcnt lgkmcnt(0)
    v_mul_f32 v193, v193, v209
    v_mul_f32 v194, v194, v210
    v_mfma_f32_16x16x32_bf16 v[140:143], v[60:63], a[0:3], 0
    buffer_load_dwordx4 v1, s[8:11], s15 offen offset:0 sc1 lds
    v_mfma_f32_16x16x32_bf16 v[140:143], v[64:67], a[8:11], v[140:143]
    s_lshl_b32 s24, s7, 5
    ds_read_b128 v[44:47], v2 offset:24576
    ds_read_b128 v[48:51], v2 offset:25600
    v_mfma_f32_16x16x32_bf16 v[140:143], v[68:71], a[16:19], v[140:143]
    s_lshl_b32 s25, s4, 3
    ds_read_b128 v[52:55], v2 offset:26624
    v_mul_f32 v195, v195, v211
    v_mfma_f32_16x16x32_bf16 v[140:143], v[72:75], a[24:27], v[140:143]
    s_add_u32 s24, s24, s25
    ds_read_b128 v[56:59], v2 offset:27648
    v_cvt_pk_bf16_f32 v36, v188, v189
    v_mfma_f32_16x16x32_bf16 v[144:147], v[60:63], a[4:7], 0
    s_mul_i32 s26, s3, 18
    v_cvt_pk_bf16_f32 v37, v190, v191
    v_cvt_pk_bf16_f32 v38, v192, v193
    v_mfma_f32_16x16x32_bf16 v[144:147], v[64:67], a[12:15], v[144:147]
    buffer_load_dwordx4 a[116:119], v8, s[8:11], s16 offen offset:256 sc1
    v_mfma_f32_16x16x32_bf16 v[144:147], v[68:71], a[20:23], v[144:147]
    s_mov_b32 s16, 58368
    v_cvt_pk_bf16_f32 v39, v194, v195
    v_mul_f32 v196, v196, v212
    v_mfma_f32_16x16x32_bf16 v[144:147], v[72:75], a[28:31], v[144:147]
    s_waitcnt lgkmcnt(0)
    v_mul_f32 v197, v197, v213
    v_mul_f32 v198, v198, v214
    v_mfma_f32_16x16x32_bf16 v[148:151], v[44:47], a[0:3], 0
    ds_read_b128 v[60:63], v2 offset:28672
    v_mul_f32 v199, v199, v215
    v_mfma_f32_16x16x32_bf16 v[148:151], v[48:51], a[8:11], v[148:151]
    ds_read_b128 v[64:67], v2 offset:29696
    v_mul_f32 v200, v200, v216
    v_mfma_f32_16x16x32_bf16 v[148:151], v[52:55], a[16:19], v[148:151]
    buffer_load_dwordx4 a[120:123], v8, s[8:11], s16 offen offset:0 sc1
    v_mfma_f32_16x16x32_bf16 v[148:151], v[56:59], a[24:27], v[148:151]
    ds_read_b128 v[68:71], v2 offset:30720
    ds_read_b128 v[72:75], v2 offset:31744
    v_mfma_f32_16x16x32_bf16 v[152:155], v[44:47], a[4:7], 0
    v_mul_f32 v201, v201, v217
    v_mul_f32 v202, v202, v218
    v_mfma_f32_16x16x32_bf16 v[152:155], v[48:51], a[12:15], v[152:155]
    v_mul_f32 v203, v203, v219
    v_cvt_pk_bf16_f32 v40, v196, v197
    v_mfma_f32_16x16x32_bf16 v[152:155], v[52:55], a[20:23], v[152:155]
    v_cvt_pk_bf16_f32 v41, v198, v199
    v_cvt_pk_bf16_f32 v42, v200, v201
    v_mfma_f32_16x16x32_bf16 v[152:155], v[56:59], a[28:31], v[152:155]
    s_waitcnt lgkmcnt(0)
    v_cvt_pk_bf16_f32 v43, v202, v203
    v_permlane16_swap_b32 v36, v38
    v_mfma_f32_16x16x32_bf16 v[172:175], v[60:63], a[0:3], 0
    buffer_load_dwordx4 a[124:127], v8, s[8:11], s16 offen offset:256 sc1
    v_mfma_f32_16x16x32_bf16 v[172:175], v[64:67], a[8:11], v[172:175]
    s_mov_b32 s16, 4096
    ds_read_b128 v[44:47], v2 offset:32768
    ds_read_b128 v[48:51], v2 offset:33792
    v_mfma_f32_16x16x32_bf16 v[172:175], v[68:71], a[16:19], v[172:175]
    s_movk_i32 s27, 896
    ds_read_b128 v[52:55], v2 offset:34816
    v_permlane16_swap_b32 v37, v39
    v_mfma_f32_16x16x32_bf16 v[172:175], v[72:75], a[24:27], v[172:175]
    ds_read_b128 v[56:59], v2 offset:35840
    v_permlane16_swap_b32 v40, v42
    v_mfma_f32_16x16x32_bf16 v[176:179], v[60:63], a[4:7], 0
    buffer_store_dwordx4 v[36:39], v7, s[8:11], s17 offen sc1
    v_mfma_f32_16x16x32_bf16 v[176:179], v[64:67], a[12:15], v[176:179]
    s_mov_b32 s17, 303104
    v_permlane16_swap_b32 v41, v43
    v_and_b32 v217, 7, v0
    v_mfma_f32_16x16x32_bf16 v[176:179], v[68:71], a[20:23], v[176:179]
    v_bfe_u32 v36, v0, 3, 3
    v_add_u32 v216, s24, v217
    v_mfma_f32_16x16x32_bf16 v[176:179], v[72:75], a[28:31], v[176:179]
    s_waitcnt lgkmcnt(0)
    v_add_u32 v215, s26, v36
    v_and_b32 v37, 1, v36
    v_mfma_f32_16x16x32_bf16 v[180:183], v[44:47], a[0:3], 0
    s_barrier
    s_add_u32 m0, s12, 0
    ds_read_b128 v[60:63], v3 offset:0
    v_mfma_f32_16x16x32_bf16 v[180:183], v[48:51], a[8:11], v[180:183]
    buffer_store_dwordx4 v[40:43], v7, s[8:11], s17 offen sc1
    v_mfma_f32_16x16x32_bf16 v[180:183], v[52:55], a[16:19], v[180:183]
    s_add_u32 s15, s14, 147456
    ds_read_b128 v[64:67], v3 offset:1024
    ds_read_b128 v[68:71], v3 offset:2048
    v_mfma_f32_16x16x32_bf16 v[180:183], v[56:59], a[24:27], v[180:183]
    ds_read_b128 v[72:75], v3 offset:3072
    v_add3_u32 v37, v37, s26, 16
    v_mfma_f32_16x16x32_bf16 v[184:187], v[44:47], a[4:7], 0
    v_lshrrev_b32 v38, 1, v36
    v_lshl_add_u32 v208, v215, 11, v216
    v_mfma_f32_16x16x32_bf16 v[184:187], v[48:51], a[12:15], v[184:187]
    v_lshlrev_b32 v208, 4, v208
    v_lshl_add_u32 v209, v37, 11, v216
    v_mfma_f32_16x16x32_bf16 v[184:187], v[52:55], a[20:23], v[184:187]
    buffer_load_dwordx4 v1, s[8:11], s15 offen offset:0 sc1 lds
    v_mfma_f32_16x16x32_bf16 v[184:187], v[56:59], a[28:31], v[184:187]
    s_waitcnt lgkmcnt(0)
    v_lshl_add_u32 v209, v209, 2, v38
    v_cmp_gt_u32 vcc, 2, v38
    v_mfma_f32_16x16x32_bf16 v[124:127], v[60:63], a[32:35], v[124:127]
    ds_read_b128 v[44:47], v3 offset:4096
    v_lshlrev_b32 v209, 2, v209
    v_mfma_f32_16x16x32_bf16 v[124:127], v[64:67], a[40:43], v[124:127]
    ds_read_b128 v[48:51], v3 offset:5120
    v_lshlrev_b32 v39, 2, v37
    v_mfma_f32_16x16x32_bf16 v[124:127], v[68:71], a[48:51], v[124:127]
    s_lshr_b32 s26, s7, 5
    ds_read_b128 v[52:55], v3 offset:6144
    v_sub_u32 v40, 568, v39
    v_mfma_f32_16x16x32_bf16 v[124:127], v[72:75], a[56:59], v[124:127]
    buffer_load_dwordx4 v1, s[8:11], s15 offen offset:1024 sc1 lds
    v_mfma_f32_16x16x32_bf16 v[128:131], v[60:63], a[36:39], v[128:131]
    ds_read_b128 v[56:59], v3 offset:7168
    v_cndmask_b32 v39, v40, v39, vcc
    v_mfma_f32_16x16x32_bf16 v[128:131], v[64:67], a[44:47], v[128:131]
    v_lshl_add_u32 v214, v38, 1, v39
    v_and_b32 v39, 6, v217
    v_mfma_f32_16x16x32_bf16 v[128:131], v[68:71], a[52:55], v[128:131]
    v_lshlrev_b32 v39, 4, v39
    v_lshlrev_b32 v40, 7, v217
    v_mfma_f32_16x16x32_bf16 v[128:131], v[72:75], a[60:63], v[128:131]
    s_waitcnt lgkmcnt(0)
    v_add_u32 v40, 61440, v40
    v_lshlrev_b32 v84, 3, v215
    v_mfma_f32_16x16x32_bf16 v[132:135], v[44:47], a[32:35], v[132:135]
    buffer_load_dwordx4 v1, s[8:11], s15 offen offset:2048 sc1 lds
    v_mfma_f32_16x16x32_bf16 v[132:135], v[48:51], a[40:43], v[132:135]
    ds_read_b128 v[60:63], v3 offset:8192
    ds_read_b128 v[64:67], v3 offset:9216
    v_mfma_f32_16x16x32_bf16 v[132:135], v[52:55], a[48:51], v[132:135]
    ds_read_b128 v[68:71], v3 offset:10240
    v_sub_u32 v85, 1144, v84
    v_mfma_f32_16x16x32_bf16 v[132:135], v[56:59], a[56:59], v[132:135]
    ds_read_b128 v[72:75], v3 offset:11264
    v_add_u32 v86, 64, v84
    v_mfma_f32_16x16x32_bf16 v[136:139], v[44:47], a[36:39], v[136:139]
    v_sub_u32 v87, 1080, v84
    v_lshlrev_b32 v88, 1, v214
    v_mfma_f32_16x16x32_bf16 v[136:139], v[48:51], a[44:47], v[136:139]
    buffer_load_dwordx4 v1, s[8:11], s15 offen offset:3072 sc1 lds
    v_mfma_f32_16x16x32_bf16 v[136:139], v[52:55], a[52:55], v[136:139]
    s_add_u32 m0, s12, 4096
    v_lshrrev_b32 v41, 7, v84
    v_xad_u32 v84, v84, v39, v40
    v_mfma_f32_16x16x32_bf16 v[136:139], v[56:59], a[60:63], v[136:139]
    s_waitcnt lgkmcnt(0)
    v_mad_u32_u24 v84, v41, s27, v84
    v_lshrrev_b32 v42, 7, v85
    v_mfma_f32_16x16x32_bf16 v[76:79], v[60:63], a[32:35], v[76:79]
    s_add_u32 s15, s14, 151552
    ds_read_b128 v[44:47], v3 offset:12288
    v_xad_u32 v85, v85, v39, v40
    v_mfma_f32_16x16x32_bf16 v[76:79], v[64:67], a[40:43], v[76:79]
    ds_read_b128 v[48:51], v3 offset:13312
    v_mad_u32_u24 v85, v42, s27, v85
    v_mfma_f32_16x16x32_bf16 v[76:79], v[68:71], a[48:51], v[76:79]
    buffer_load_dword v254, v253, s[8:11], 0 offen sc1
    v_mfma_f32_16x16x32_bf16 v[76:79], v[72:75], a[56:59], v[76:79]
    buffer_load_dwordx4 v1, s[8:11], s15 offen offset:0 sc1 lds
    v_mfma_f32_16x16x32_bf16 v[80:83], v[60:63], a[36:39], v[80:83]
    ds_read_b128 v[52:55], v3 offset:14336
    ds_read_b128 v[56:59], v3 offset:15360
    v_mfma_f32_16x16x32_bf16 v[80:83], v[64:67], a[44:47], v[80:83]
    v_lshrrev_b32 v41, 7, v86
    v_xad_u32 v86, v86, v39, v40
    v_mfma_f32_16x16x32_bf16 v[80:83], v[68:71], a[52:55], v[80:83]
    v_mad_u32_u24 v86, v41, s27, v86
    v_lshrrev_b32 v42, 7, v87
    v_mfma_f32_16x16x32_bf16 v[80:83], v[72:75], a[60:63], v[80:83]
    s_waitcnt lgkmcnt(0)
    v_xad_u32 v87, v87, v39, v40
    v_lshrrev_b32 v41, 7, v88
    v_mfma_f32_16x16x32_bf16 v[156:159], v[44:47], a[32:35], v[156:159]
    buffer_load_dwordx4 v1, s[8:11], s15 offen offset:1024 sc1 lds
    v_mfma_f32_16x16x32_bf16 v[156:159], v[48:51], a[40:43], v[156:159]
    s_lshl_b32 s28, s4, 8
    ds_read_b128 v[60:63], v3 offset:16384
    ds_read_b128 v[64:67], v3 offset:17408
    v_mfma_f32_16x16x32_bf16 v[156:159], v[52:55], a[48:51], v[156:159]
    s_add_u32 s28, s28, s7
    ds_read_b128 v[68:71], v3 offset:18432
    v_mad_u32_u24 v87, v42, s27, v87
    v_mfma_f32_16x16x32_bf16 v[156:159], v[56:59], a[56:59], v[156:159]
    s_mul_i32 s28, s28, 9
    ds_read_b128 v[72:75], v3 offset:19456
    v_xad_u32 v88, v88, v39, v40
    v_mfma_f32_16x16x32_bf16 v[160:163], v[44:47], a[36:39], v[160:163]
    s_add_u32 s28, s28, s3
    v_mad_u32_u24 v88, v41, s27, v88
    s_bfe_u32 s27, s7, 0x20003
    v_mfma_f32_16x16x32_bf16 v[160:163], v[48:51], a[44:47], v[160:163]
    buffer_load_dwordx4 v1, s[8:11], s15 offen offset:2048 sc1 lds
    v_mfma_f32_16x16x32_bf16 v[160:163], v[52:55], a[52:55], v[160:163]
    s_lshl_b32 s27, s27, 6
    s_add_u32 s26, s26, s27
    s_bfe_u32 s27, s7, 0x10002
    v_mfma_f32_16x16x32_bf16 v[160:163], v[56:59], a[60:63], v[160:163]
    s_waitcnt lgkmcnt(0)
    s_lshl_b32 s27, s27, 5
    s_add_u32 s26, s26, s27
    v_mfma_f32_16x16x32_bf16 v[164:167], v[60:63], a[32:35], v[164:167]
    s_lshl_b32 s26, s26, 2
    ds_read_b128 v[44:47], v3 offset:20480
    s_and_b32 s27, s7, 3
    v_mfma_f32_16x16x32_bf16 v[164:167], v[64:67], a[40:43], v[164:167]
    s_add_u32 s26, s26, s27
    ds_read_b128 v[48:51], v3 offset:21504
    s_lshl_b32 s26, s26, 7
    v_mfma_f32_16x16x32_bf16 v[164:167], v[68:71], a[48:51], v[164:167]
    buffer_load_dwordx4 v1, s[8:11], s15 offen offset:3072 sc1 lds
    v_mfma_f32_16x16x32_bf16 v[164:167], v[72:75], a[56:59], v[164:167]
    s_add_u32 m0, s12, 8192
    ds_read_b128 v[52:55], v3 offset:22528
    ds_read_b128 v[56:59], v3 offset:23552
    v_mfma_f32_16x16x32_bf16 v[168:171], v[60:63], a[36:39], v[168:171]
    s_add_u32 s15, s14, 155648
    s_add_u32 s26, s26, 58720256
    s_lshl_b32 s27, s3, 12
    v_mfma_f32_16x16x32_bf16 v[168:171], v[64:67], a[44:47], v[168:171]
    s_add_u32 s26, s26, s27
    v_and_b32 v210, 3, v0
    v_bfe_u32 v90, v0, 3, 3
    v_mfma_f32_16x16x32_bf16 v[168:171], v[68:71], a[52:55], v[168:171]
    s_lshl_b32 s28, s28, 7
    v_lshl_add_u32 v210, v210, 10, s26
    v_and_b32 v43, 6, v90
    v_mfma_f32_16x16x32_bf16 v[168:171], v[72:75], a[60:63], v[168:171]
    s_waitcnt lgkmcnt(0)
    v_xor_b32 v43, v43, v0
    v_and_b32 v91, 4, v90
    v_mfma_f32_16x16x32_bf16 v[140:143], v[44:47], a[32:35], v[140:143]
    buffer_load_dwordx4 v1, s[8:11], s15 offen offset:0 sc1 lds
    v_mfma_f32_16x16x32_bf16 v[140:143], v[48:51], a[40:43], v[140:143]
    s_lshl_b32 s29, s3, 10
    ds_read_b128 v[60:63], v3 offset:24576
    ds_read_b128 v[64:67], v3 offset:25600
    v_mfma_f32_16x16x32_bf16 v[140:143], v[52:55], a[48:51], v[140:143]
    s_add_u32 s29, s29, 61440
    ds_read_b128 v[68:71], v3 offset:26624
    v_and_b32 v43, 7, v43
    v_mfma_f32_16x16x32_bf16 v[140:143], v[56:59], a[56:59], v[140:143]
    ds_read_b128 v[72:75], v3 offset:27648
    v_mad_u32_u24 v90, v91, 3, v90
    v_mfma_f32_16x16x32_bf16 v[144:147], v[44:47], a[36:39], v[144:147]
    buffer_load_dwordx4 a[128:131], v8, s[8:11], s16 offen offset:0 sc1
    v_mfma_f32_16x16x32_bf16 v[144:147], v[48:51], a[44:47], v[144:147]
    v_mul_u32_u24 v90, 73728, v90
    v_cmp_gt_u32 vcc, 64, v0
    v_mfma_f32_16x16x32_bf16 v[144:147], v[52:55], a[52:55], v[144:147]
    v_lshl_add_u32 v90, v43, 4, v90
    v_lshlrev_b32 v207, 3, v216
    v_mfma_f32_16x16x32_bf16 v[144:147], v[56:59], a[60:63], v[144:147]
    s_waitcnt lgkmcnt(0)
    v_add_u32 v90, s28, v90
    v_lshlrev_b32 v216, 2, v216
    v_mfma_f32_16x16x32_bf16 v[148:151], v[60:63], a[32:35], v[148:151]
    ds_read_b128 v[44:47], v3 offset:28672
    v_cndmask_b32 v91, -2.0, v90, vcc
    v_mfma_f32_16x16x32_bf16 v[148:151], v[64:67], a[40:43], v[148:151]
    buffer_load_dwordx4 a[132:135], v8, s[8:11], s16 offen offset:256 sc1
    v_mfma_f32_16x16x32_bf16 v[148:151], v[68:71], a[48:51], v[148:151]
    s_mov_b32 s16, 22528
    ds_read_b128 v[48:51], v3 offset:29696
    ds_read_b128 v[52:55], v3 offset:30720
    v_mfma_f32_16x16x32_bf16 v[148:151], v[72:75], a[56:59], v[148:151]
    ds_read_b128 v[56:59], v3 offset:31744
    v_add_u32 v92, s29, v1
    v_mfma_f32_16x16x32_bf16 v[152:155], v[60:63], a[36:39], v[152:155]
    v_mfma_f32_16x16x32_bf16 v[152:155], v[64:67], a[44:47], v[152:155]
    v_mov_b32 v255, 12
    v_mfma_f32_16x16x32_bf16 v[152:155], v[68:71], a[52:55], v[152:155]
    buffer_load_dwordx4 a[136:139], v8, s[8:11], s16 offen offset:0 sc1
    v_mfma_f32_16x16x32_bf16 v[152:155], v[72:75], a[60:63], v[152:155]
    s_waitcnt lgkmcnt(0)
    v_mfma_f32_16x16x32_bf16 v[172:175], v[44:47], a[32:35], v[172:175]
    s_waitcnt vmcnt(13)
    ds_read_b128 v[60:63], v3 offset:32768
    v_mfma_f32_16x16x32_bf16 v[172:175], v[48:51], a[40:43], v[172:175]
    ds_read_b128 v[64:67], v3 offset:33792
    v_mfma_f32_16x16x32_bf16 v[172:175], v[52:55], a[48:51], v[172:175]
    ds_read_b128 v[68:71], v3 offset:34816
    v_mfma_f32_16x16x32_bf16 v[172:175], v[56:59], a[56:59], v[172:175]
    buffer_store_dword v255, v252, s[8:11], 0 offen sc1
    v_mfma_f32_16x16x32_bf16 v[176:179], v[44:47], a[36:39], v[176:179]
    buffer_load_dwordx4 a[140:143], v8, s[8:11], s16 offen offset:256 sc1
    v_mfma_f32_16x16x32_bf16 v[176:179], v[48:51], a[44:47], v[176:179]
    s_mov_b32 s16, 40960
    ds_read_b128 v[72:75], v3 offset:35840
    v_mfma_f32_16x16x32_bf16 v[176:179], v[52:55], a[52:55], v[176:179]
    v_mfma_f32_16x16x32_bf16 v[176:179], v[56:59], a[60:63], v[176:179]
    s_waitcnt lgkmcnt(0)
    v_mfma_f32_16x16x32_bf16 v[180:183], v[60:63], a[32:35], v[180:183]
    s_barrier
    ds_read_b128 v[44:47], v4 offset:0
    v_mfma_f32_16x16x32_bf16 v[180:183], v[64:67], a[40:43], v[180:183]
    buffer_load_dwordx4 a[144:147], v8, s[8:11], s16 offen offset:0 sc1
    v_mfma_f32_16x16x32_bf16 v[180:183], v[68:71], a[48:51], v[180:183]
    s_add_u32 m0, s12, 36864
    ds_read_b128 v[48:51], v4 offset:1024
    ds_read_b128 v[52:55], v4 offset:2048
    v_mfma_f32_16x16x32_bf16 v[180:183], v[72:75], a[56:59], v[180:183]
    s_add_u32 s15, s14, 184320
    ds_read_b128 v[56:59], v4 offset:3072
    v_mfma_f32_16x16x32_bf16 v[184:187], v[60:63], a[36:39], v[184:187]
    v_mfma_f32_16x16x32_bf16 v[184:187], v[64:67], a[44:47], v[184:187]
    v_mfma_f32_16x16x32_bf16 v[184:187], v[68:71], a[52:55], v[184:187]
    buffer_load_dwordx4 a[148:151], v8, s[8:11], s16 offen offset:256 sc1
    v_mfma_f32_16x16x32_bf16 v[184:187], v[72:75], a[60:63], v[184:187]
    s_waitcnt lgkmcnt(0)
    v_mfma_f32_16x16x32_bf16 v[124:127], v[44:47], a[64:67], v[124:127]
    s_mov_b32 s16, 59392
    ds_read_b128 v[60:63], v4 offset:4096
    v_mfma_f32_16x16x32_bf16 v[124:127], v[48:51], a[72:75], v[124:127]
    ds_read_b128 v[64:67], v4 offset:5120
    v_mfma_f32_16x16x32_bf16 v[124:127], v[52:55], a[80:83], v[124:127]
    ds_read_b128 v[68:71], v4 offset:6144
    v_mfma_f32_16x16x32_bf16 v[124:127], v[56:59], a[88:91], v[124:127]
    buffer_load_dwordx4 a[152:155], v8, s[8:11], s16 offen offset:0 sc1
    v_mfma_f32_16x16x32_bf16 v[128:131], v[44:47], a[68:71], v[128:131]
    ds_read_b128 v[72:75], v4 offset:7168
    v_mfma_f32_16x16x32_bf16 v[128:131], v[48:51], a[76:79], v[128:131]
    v_mfma_f32_16x16x32_bf16 v[128:131], v[52:55], a[84:87], v[128:131]
    s_waitcnt vmcnt(13)
    v_cmp_gt_u32 s[46:47], 11, v254
    v_mfma_f32_16x16x32_bf16 v[128:131], v[56:59], a[92:95], v[128:131]
    s_waitcnt lgkmcnt(0)
    v_mfma_f32_16x16x32_bf16 v[132:135], v[60:63], a[64:67], v[132:135]
    buffer_load_dwordx4 a[156:159], v8, s[8:11], s16 offen offset:256 sc1
    v_mfma_f32_16x16x32_bf16 v[132:135], v[64:67], a[72:75], v[132:135]
    s_cmp_lg_u64 s[46:47], 0
    s_cbranch_scc1 L_slow31
L_slow31_ret:
    ds_read_b128 v[44:47], v4 offset:8192
    v_mfma_f32_16x16x32_bf16 v[132:135], v[68:71], a[80:83], v[132:135]
    s_mov_b32 s16, 5120
    ds_read_b128 v[48:51], v4 offset:9216
    ds_read_b128 v[52:55], v4 offset:10240
    v_mfma_f32_16x16x32_bf16 v[132:135], v[72:75], a[88:91], v[132:135]
    ds_read_b128 v[56:59], v4 offset:11264
    v_mfma_f32_16x16x32_bf16 v[136:139], v[60:63], a[68:71], v[136:139]
    v_mfma_f32_16x16x32_bf16 v[136:139], v[64:67], a[76:79], v[136:139]
    buffer_load_dwordx4 v1, s[8:11], s15 offen offset:0 sc1 lds
    v_mfma_f32_16x16x32_bf16 v[136:139], v[68:71], a[84:87], v[136:139]
    v_mfma_f32_16x16x32_bf16 v[136:139], v[72:75], a[92:95], v[136:139]
    s_waitcnt lgkmcnt(0)
    v_mfma_f32_16x16x32_bf16 v[76:79], v[44:47], a[64:67], v[76:79]
    ds_read_b128 v[60:63], v4 offset:12288
    v_mfma_f32_16x16x32_bf16 v[76:79], v[48:51], a[72:75], v[76:79]
    ds_read_b128 v[64:67], v4 offset:13312
    v_mfma_f32_16x16x32_bf16 v[76:79], v[52:55], a[80:83], v[76:79]
    buffer_load_dwordx4 v1, s[8:11], s15 offen offset:1024 sc1 lds
    v_mfma_f32_16x16x32_bf16 v[76:79], v[56:59], a[88:91], v[76:79]
    ds_read_b128 v[68:71], v4 offset:14336
    ds_read_b128 v[72:75], v4 offset:15360
    v_mfma_f32_16x16x32_bf16 v[80:83], v[44:47], a[68:71], v[80:83]
    v_mfma_f32_16x16x32_bf16 v[80:83], v[48:51], a[76:79], v[80:83]
    v_mfma_f32_16x16x32_bf16 v[80:83], v[52:55], a[84:87], v[80:83]
    v_mfma_f32_16x16x32_bf16 v[80:83], v[56:59], a[92:95], v[80:83]
    s_waitcnt lgkmcnt(0)
    v_mfma_f32_16x16x32_bf16 v[156:159], v[60:63], a[64:67], v[156:159]
    buffer_load_dwordx4 v1, s[8:11], s15 offen offset:2048 sc1 lds
    v_mfma_f32_16x16x32_bf16 v[156:159], v[64:67], a[72:75], v[156:159]
    ds_read_b128 v[44:47], v4 offset:16384
    ds_read_b128 v[48:51], v4 offset:17408
    v_mfma_f32_16x16x32_bf16 v[156:159], v[68:71], a[80:83], v[156:159]
    ds_read_b128 v[52:55], v4 offset:18432
    v_mfma_f32_16x16x32_bf16 v[156:159], v[72:75], a[88:91], v[156:159]
    ds_read_b128 v[56:59], v4 offset:19456
    v_mfma_f32_16x16x32_bf16 v[160:163], v[60:63], a[68:71], v[160:163]
    buffer_load_dwordx4 v1, s[8:11], s15 offen offset:3072 sc1 lds
    v_mfma_f32_16x16x32_bf16 v[160:163], v[64:67], a[76:79], v[160:163]
    s_add_u32 m0, s12, 40960
    v_mfma_f32_16x16x32_bf16 v[160:163], v[68:71], a[84:87], v[160:163]
    s_add_u32 s15, s14, 188416
    v_mfma_f32_16x16x32_bf16 v[160:163], v[72:75], a[92:95], v[160:163]
    s_waitcnt lgkmcnt(0)
    v_mfma_f32_16x16x32_bf16 v[164:167], v[44:47], a[64:67], v[164:167]
    ds_read_b128 v[60:63], v4 offset:20480
    v_mfma_f32_16x16x32_bf16 v[164:167], v[48:51], a[72:75], v[164:167]
    buffer_load_dwordx4 v1, s[8:11], s15 offen offset:0 sc1 lds
    v_mfma_f32_16x16x32_bf16 v[164:167], v[52:55], a[80:83], v[164:167]
    ds_read_b128 v[64:67], v4 offset:21504
    ds_read_b128 v[68:71], v4 offset:22528
    v_mfma_f32_16x16x32_bf16 v[164:167], v[56:59], a[88:91], v[164:167]
    ds_read_b128 v[72:75], v4 offset:23552
    v_mfma_f32_16x16x32_bf16 v[168:171], v[44:47], a[68:71], v[168:171]
    v_mfma_f32_16x16x32_bf16 v[168:171], v[48:51], a[76:79], v[168:171]
    v_mfma_f32_16x16x32_bf16 v[168:171], v[52:55], a[84:87], v[168:171]
    buffer_load_dwordx4 v1, s[8:11], s15 offen offset:1024 sc1 lds
    v_mfma_f32_16x16x32_bf16 v[168:171], v[56:59], a[92:95], v[168:171]
    s_waitcnt lgkmcnt(0)
    v_mfma_f32_16x16x32_bf16 v[140:143], v[60:63], a[64:67], v[140:143]
    ds_read_b128 v[44:47], v4 offset:24576
    v_mfma_f32_16x16x32_bf16 v[140:143], v[64:67], a[72:75], v[140:143]
    ds_read_b128 v[48:51], v4 offset:25600
    v_mfma_f32_16x16x32_bf16 v[140:143], v[68:71], a[80:83], v[140:143]
    ds_read_b128 v[52:55], v4 offset:26624
    v_mfma_f32_16x16x32_bf16 v[140:143], v[72:75], a[88:91], v[140:143]
    buffer_load_dwordx4 v1, s[8:11], s15 offen offset:2048 sc1 lds
    v_mfma_f32_16x16x32_bf16 v[144:147], v[60:63], a[68:71], v[144:147]
    ds_read_b128 v[56:59], v4 offset:27648
    v_mfma_f32_16x16x32_bf16 v[144:147], v[64:67], a[76:79], v[144:147]
    v_mfma_f32_16x16x32_bf16 v[144:147], v[68:71], a[84:87], v[144:147]
    v_mfma_f32_16x16x32_bf16 v[144:147], v[72:75], a[92:95], v[144:147]
    s_waitcnt lgkmcnt(0)
    v_mfma_f32_16x16x32_bf16 v[148:151], v[44:47], a[64:67], v[148:151]
    buffer_load_dwordx4 v1, s[8:11], s15 offen offset:3072 sc1 lds
    v_mfma_f32_16x16x32_bf16 v[148:151], v[48:51], a[72:75], v[148:151]
    s_add_u32 m0, s12, 45056
    ds_read_b128 v[60:63], v4 offset:28672
    ds_read_b128 v[64:67], v4 offset:29696
    v_mfma_f32_16x16x32_bf16 v[148:151], v[52:55], a[80:83], v[148:151]
    s_add_u32 s15, s14, 192512
    ds_read_b128 v[68:71], v4 offset:30720
    v_mfma_f32_16x16x32_bf16 v[148:151], v[56:59], a[88:91], v[148:151]
L_pad_c3_6:
    s_cbranch_execz L_hopret_c3
    ds_read_b128 v[72:75], v4 offset:31744
    v_mfma_f32_16x16x32_bf16 v[152:155], v[44:47], a[68:71], v[152:155]
    v_mfma_f32_16x16x32_bf16 v[152:155], v[48:51], a[76:79], v[152:155]
    buffer_load_dwordx4 v1, s[8:11], s15 offen offset:0 sc1 lds
    v_mfma_f32_16x16x32_bf16 v[152:155], v[52:55], a[84:87], v[152:155]
    v_mfma_f32_16x16x32_bf16 v[152:155], v[56:59], a[92:95], v[152:155]
    s_waitcnt lgkmcnt(0)
    v_mfma_f32_16x16x32_bf16 v[172:175], v[60:63], a[64:67], v[172:175]
    ds_read_b128 v[44:47], v4 offset:32768
    v_mfma_f32_16x16x32_bf16 v[172:175], v[64:67], a[72:75], v[172:175]
    ds_read_b128 v[48:51], v4 offset:33792
    v_mfma_f32_16x16x32_bf16 v[172:175], v[68:71], a[80:83], v[172:175]
    buffer_load_dword v254, v253, s[8:11], 0 offen sc1
    v_mfma_f32_16x16x32_bf16 v[172:175], v[72:75], a[88:91], v[172:175]
    buffer_load_dwordx4 a[160:163], v8, s[8:11], s16 offen offset:0 sc1
    v_mfma_f32_16x16x32_bf16 v[176:179], v[60:63], a[68:71], v[176:179]
    ds_read_b128 v[52:55], v4 offset:34816
    ds_read_b128 v[56:59], v4 offset:35840
    v_mfma_f32_16x16x32_bf16 v[176:179], v[64:67], a[76:79], v[176:179]
    v_mfma_f32_16x16x32_bf16 v[176:179], v[68:71], a[84:87], v[176:179]
    v_mfma_f32_16x16x32_bf16 v[176:179], v[72:75], a[92:95], v[176:179]
    s_waitcnt lgkmcnt(0)
    v_mfma_f32_16x16x32_bf16 v[180:183], v[44:47], a[64:67], v[180:183]
    s_barrier
    ds_read_b128 v[60:63], v5 offset:0
    v_mfma_f32_16x16x32_bf16 v[180:183], v[48:51], a[72:75], v[180:183]
    buffer_load_dwordx4 a[164:167], v8, s[8:11], s16 offen offset:256 sc1
    v_mfma_f32_16x16x32_bf16 v[180:183], v[52:55], a[80:83], v[180:183]
    s_mov_b32 s16, 23552
    ds_read_b128 v[64:67], v5 offset:1024
    ds_read_b128 v[68:71], v5 offset:2048
    v_mfma_f32_16x16x32_bf16 v[180:183], v[56:59], a[88:91], v[180:183]
    s_add_u32 m0, s12, 73728
    ds_read_b128 v[72:75], v5 offset:3072
    v_mfma_f32_16x16x32_bf16 v[184:187], v[44:47], a[68:71], v[184:187]
    s_add_u32 s15, s14, 221184
    v_mfma_f32_16x16x32_bf16 v[184:187], v[48:51], a[76:79], v[184:187]
    buffer_load_dwordx4 a[168:171], v8, s[8:11], s16 offen offset:0 sc1
    v_mfma_f32_16x16x32_bf16 v[184:187], v[52:55], a[84:87], v[184:187]
    v_mfma_f32_16x16x32_bf16 v[184:187], v[56:59], a[92:95], v[184:187]
    s_waitcnt lgkmcnt(0)
    v_mfma_f32_16x16x32_bf16 v[124:127], v[60:63], a[96:99], v[124:127]
    ds_read_b128 v[44:47], v5 offset:4096
    v_mfma_f32_16x16x32_bf16 v[124:127], v[64:67], a[104:107], v[124:127]
    ds_read_b128 v[48:51], v5 offset:5120
    v_mfma_f32_16x16x32_bf16 v[124:127], v[68:71], a[112:115], v[124:127]
    buffer_load_dwordx4 a[172:175], v8, s[8:11], s16 offen offset:256 sc1
    v_mfma_f32_16x16x32_bf16 v[124:127], v[72:75], a[120:123], v[124:127]
    s_mov_b32 s16, 41984
    ds_read_b128 v[52:55], v5 offset:6144
    ds_read_b128 v[56:59], v5 offset:7168
    v_mfma_f32_16x16x32_bf16 v[128:131], v[60:63], a[100:103], v[128:131]
    v_mfma_f32_16x16x32_bf16 v[128:131], v[64:67], a[108:111], v[128:131]
    v_mfma_f32_16x16x32_bf16 v[128:131], v[68:71], a[116:119], v[128:131]
    v_mfma_f32_16x16x32_bf16 v[128:131], v[72:75], a[124:127], v[128:131]
    s_waitcnt lgkmcnt(0)
    v_mfma_f32_16x16x32_bf16 v[132:135], v[44:47], a[96:99], v[132:135]
    buffer_load_dwordx4 a[176:179], v8, s[8:11], s16 offen offset:0 sc1
    v_mfma_f32_16x16x32_bf16 v[132:135], v[48:51], a[104:107], v[132:135]
    ds_read_b128 v[60:63], v5 offset:8192
    ds_read_b128 v[64:67], v5 offset:9216
    v_mfma_f32_16x16x32_bf16 v[132:135], v[52:55], a[112:115], v[132:135]
    ds_read_b128 v[68:71], v5 offset:10240
    v_mfma_f32_16x16x32_bf16 v[132:135], v[56:59], a[120:123], v[132:135]
    ds_read_b128 v[72:75], v5 offset:11264
    v_mfma_f32_16x16x32_bf16 v[136:139], v[44:47], a[100:103], v[136:139]
    buffer_load_dwordx4 a[180:183], v8, s[8:11], s16 offen offset:256 sc1
    v_mfma_f32_16x16x32_bf16 v[136:139], v[48:51], a[108:111], v[136:139]
    s_mov_b32 s16, 60416
    v_mfma_f32_16x16x32_bf16 v[136:139], v[52:55], a[116:119], v[136:139]
    v_mfma_f32_16x16x32_bf16 v[136:139], v[56:59], a[124:127], v[136:139]
    s_waitcnt lgkmcnt(0)
    v_mfma_f32_16x16x32_bf16 v[76:79], v[60:63], a[96:99], v[76:79]
    ds_read_b128 v[44:47], v5 offset:12288
    v_mfma_f32_16x16x32_bf16 v[76:79], v[64:67], a[104:107], v[76:79]
    buffer_load_dwordx4 a[184:187], v8, s[8:11], s16 offen offset:0 sc1
    v_mfma_f32_16x16x32_bf16 v[76:79], v[68:71], a[112:115], v[76:79]
    ds_read_b128 v[48:51], v5 offset:13312
    ds_read_b128 v[52:55], v5 offset:14336
    v_mfma_f32_16x16x32_bf16 v[76:79], v[72:75], a[120:123], v[76:79]
    ds_read_b128 v[56:59], v5 offset:15360
    v_mfma_f32_16x16x32_bf16 v[80:83], v[60:63], a[100:103], v[80:83]
    v_mfma_f32_16x16x32_bf16 v[80:83], v[64:67], a[108:111], v[80:83]
    v_mfma_f32_16x16x32_bf16 v[80:83], v[68:71], a[116:119], v[80:83]
    buffer_load_dwordx4 a[188:191], v8, s[8:11], s16 offen offset:256 sc1
    v_mfma_f32_16x16x32_bf16 v[80:83], v[72:75], a[124:127], v[80:83]
    s_waitcnt lgkmcnt(0)
    v_mfma_f32_16x16x32_bf16 v[156:159], v[44:47], a[96:99], v[156:159]
    s_mov_b32 s16, 6144
    ds_read_b128 v[60:63], v5 offset:16384
    v_mfma_f32_16x16x32_bf16 v[156:159], v[48:51], a[104:107], v[156:159]
    ds_read_b128 v[64:67], v5 offset:17408
    v_mfma_f32_16x16x32_bf16 v[156:159], v[52:55], a[112:115], v[156:159]
    ds_read_b128 v[68:71], v5 offset:18432
    v_mfma_f32_16x16x32_bf16 v[156:159], v[56:59], a[120:123], v[156:159]
    buffer_load_dwordx4 v1, s[8:11], s15 offen offset:0 sc1 lds
    v_mfma_f32_16x16x32_bf16 v[160:163], v[44:47], a[100:103], v[160:163]
    ds_read_b128 v[72:75], v5 offset:19456
    v_mfma_f32_16x16x32_bf16 v[160:163], v[48:51], a[108:111], v[160:163]
    v_mfma_f32_16x16x32_bf16 v[160:163], v[52:55], a[116:119], v[160:163]
    v_mfma_f32_16x16x32_bf16 v[160:163], v[56:59], a[124:127], v[160:163]
    s_waitcnt lgkmcnt(0)
    v_mfma_f32_16x16x32_bf16 v[164:167], v[60:63], a[96:99], v[164:167]
    buffer_load_dwordx4 v1, s[8:11], s15 offen offset:1024 sc1 lds
    v_mfma_f32_16x16x32_bf16 v[164:167], v[64:67], a[104:107], v[164:167]
    ds_read_b128 v[44:47], v5 offset:20480
    ds_read_b128 v[48:51], v5 offset:21504
    v_mfma_f32_16x16x32_bf16 v[164:167], v[68:71], a[112:115], v[164:167]
    ds_read_b128 v[52:55], v5 offset:22528
    v_mfma_f32_16x16x32_bf16 v[164:167], v[72:75], a[120:123], v[164:167]
    ds_read_b128 v[56:59], v5 offset:23552
    v_mfma_f32_16x16x32_bf16 v[168:171], v[60:63], a[100:103], v[168:171]
    v_mfma_f32_16x16x32_bf16 v[168:171], v[64:67], a[108:111], v[168:171]
    buffer_load_dwordx4 v1, s[8:11], s15 offen offset:2048 sc1 lds
    v_mfma_f32_16x16x32_bf16 v[168:171], v[68:71], a[116:119], v[168:171]
    v_mfma_f32_16x16x32_bf16 v[168:171], v[72:75], a[124:127], v[168:171]
    s_waitcnt lgkmcnt(0)
    v_mfma_f32_16x16x32_bf16 v[140:143], v[44:47], a[96:99], v[140:143]
    ds_read_b128 v[60:63], v5 offset:24576
    v_mfma_f32_16x16x32_bf16 v[140:143], v[48:51], a[104:107], v[140:143]
    ds_read_b128 v[64:67], v5 offset:25600
    v_mfma_f32_16x16x32_bf16 v[140:143], v[52:55], a[112:115], v[140:143]
    buffer_load_dwordx4 v1, s[8:11], s15 offen offset:3072 sc1 lds
    v_mfma_f32_16x16x32_bf16 v[140:143], v[56:59], a[120:123], v[140:143]
    s_add_u32 m0, s12, 77824
    ds_read_b128 v[68:71], v5 offset:26624
    ds_read_b128 v[72:75], v5 offset:27648
    v_mfma_f32_16x16x32_bf16 v[144:147], v[44:47], a[100:103], v[144:147]
    s_add_u32 s15, s14, 225280
    v_mfma_f32_16x16x32_bf16 v[144:147], v[48:51], a[108:111], v[144:147]
    v_mfma_f32_16x16x32_bf16 v[144:147], v[52:55], a[116:119], v[144:147]
    s_waitcnt vmcnt(12)
    v_cmp_gt_u32 s[46:47], 12, v254
    v_mfma_f32_16x16x32_bf16 v[144:147], v[56:59], a[124:127], v[144:147]
    s_waitcnt lgkmcnt(0)
    v_mfma_f32_16x16x32_bf16 v[148:151], v[60:63], a[96:99], v[148:151]
    buffer_load_dwordx4 v1, s[8:11], s15 offen offset:0 sc1 lds
    v_mfma_f32_16x16x32_bf16 v[148:151], v[64:67], a[104:107], v[148:151]
    s_cmp_lg_u64 s[46:47], 0
    s_cbranch_scc1 L_slow32
L_slow32_ret:
    ds_read_b128 v[44:47], v5 offset:28672
    v_mfma_f32_16x16x32_bf16 v[148:151], v[68:71], a[112:115], v[148:151]
    ds_read_b128 v[48:51], v5 offset:29696
    ds_read_b128 v[52:55], v5 offset:30720
    v_mfma_f32_16x16x32_bf16 v[148:151], v[72:75], a[120:123], v[148:151]
    ds_read_b128 v[56:59], v5 offset:31744
    v_mfma_f32_16x16x32_bf16 v[152:155], v[60:63], a[100:103], v[152:155]
    buffer_load_dwordx4 v1, s[8:11], s15 offen offset:1024 sc1 lds
    v_mfma_f32_16x16x32_bf16 v[152:155], v[64:67], a[108:111], v[152:155]
    v_mfma_f32_16x16x32_bf16 v[152:155], v[68:71], a[116:119], v[152:155]
    v_mfma_f32_16x16x32_bf16 v[152:155], v[72:75], a[124:127], v[152:155]
    s_waitcnt lgkmcnt(0)
    v_mfma_f32_16x16x32_bf16 v[172:175], v[44:47], a[96:99], v[172:175]
    ds_read_b128 v[60:63], v5 offset:32768
    v_mfma_f32_16x16x32_bf16 v[172:175], v[48:51], a[104:107], v[172:175]
    buffer_load_dwordx4 v1, s[8:11], s15 offen offset:2048 sc1 lds
    v_mfma_f32_16x16x32_bf16 v[172:175], v[52:55], a[112:115], v[172:175]
    ds_read_b128 v[64:67], v5 offset:33792
    ds_read_b128 v[68:71], v5 offset:34816
    v_mfma_f32_16x16x32_bf16 v[172:175], v[56:59], a[120:123], v[172:175]
    ds_read_b128 v[72:75], v5 offset:35840
    v_mfma_f32_16x16x32_bf16 v[176:179], v[44:47], a[100:103], v[176:179]
    v_mfma_f32_16x16x32_bf16 v[176:179], v[48:51], a[108:111], v[176:179]
    v_mfma_f32_16x16x32_bf16 v[176:179], v[52:55], a[116:119], v[176:179]
    buffer_load_dwordx4 v1, s[8:11], s15 offen offset:3072 sc1 lds
    v_mfma_f32_16x16x32_bf16 v[176:179], v[56:59], a[124:127], v[176:179]
    s_waitcnt lgkmcnt(0)
    v_mfma_f32_16x16x32_bf16 v[180:183], v[60:63], a[96:99], v[180:183]
    s_barrier
    ds_read_b128 v[44:47], v2 offset:0
    v_mfma_f32_16x16x32_bf16 v[180:183], v[64:67], a[104:107], v[180:183]
    s_add_u32 m0, s12, 81920
    ds_read_b128 v[48:51], v2 offset:1024
    v_mfma_f32_16x16x32_bf16 v[180:183], v[68:71], a[112:115], v[180:183]
    s_add_u32 s15, s14, 229376
    ds_read_b128 v[52:55], v2 offset:2048
    v_mfma_f32_16x16x32_bf16 v[180:183], v[72:75], a[120:123], v[180:183]
    buffer_load_dwordx4 v1, s[8:11], s15 offen offset:0 sc1 lds
    v_mfma_f32_16x16x32_bf16 v[184:187], v[60:63], a[100:103], v[184:187]
    s_add_u32 m0, s12, 110592
    ds_read_b128 v[56:59], v2 offset:3072
    v_mfma_f32_16x16x32_bf16 v[184:187], v[64:67], a[108:111], v[184:187]
    s_add_u32 s15, s14, 258048
    v_mfma_f32_16x16x32_bf16 v[184:187], v[68:71], a[116:119], v[184:187]
    v_mfma_f32_16x16x32_bf16 v[184:187], v[72:75], a[124:127], v[184:187]
    s_waitcnt lgkmcnt(0)
    v_mfma_f32_16x16x32_bf16 v[124:127], v[44:47], a[128:131], v[124:127]
    buffer_load_dwordx4 a[192:195], v8, s[8:11], s16 offen offset:0 sc1
    v_mfma_f32_16x16x32_bf16 v[124:127], v[48:51], a[136:139], v[124:127]
    ds_read_b128 v[60:63], v2 offset:4096
    ds_read_b128 v[64:67], v2 offset:5120
    v_mfma_f32_16x16x32_bf16 v[124:127], v[52:55], a[144:147], v[124:127]
    ds_read_b128 v[68:71], v2 offset:6144
    v_mfma_f32_16x16x32_bf16 v[124:127], v[56:59], a[152:155], v[124:127]
    ds_read_b128 v[72:75], v2 offset:7168
    v_mfma_f32_16x16x32_bf16 v[128:131], v[44:47], a[132:135], v[128:131]
    v_mfma_f32_16x16x32_bf16 v[128:131], v[48:51], a[140:143], v[128:131]
    buffer_load_dwordx4 a[196:199], v8, s[8:11], s16 offen offset:256 sc1
    v_mfma_f32_16x16x32_bf16 v[128:131], v[52:55], a[148:151], v[128:131]
    s_mov_b32 s16, 24576
    v_mfma_f32_16x16x32_bf16 v[128:131], v[56:59], a[156:159], v[128:131]
    s_waitcnt lgkmcnt(0)
    v_mfma_f32_16x16x32_bf16 v[132:135], v[60:63], a[128:131], v[132:135]
    ds_read_b128 v[44:47], v2 offset:8192
    v_mfma_f32_16x16x32_bf16 v[132:135], v[64:67], a[136:139], v[132:135]
    ds_read_b128 v[48:51], v2 offset:9216
    v_mfma_f32_16x16x32_bf16 v[132:135], v[68:71], a[144:147], v[132:135]
    buffer_load_dwordx4 a[200:203], v8, s[8:11], s16 offen offset:0 sc1
    v_mfma_f32_16x16x32_bf16 v[132:135], v[72:75], a[152:155], v[132:135]
    ds_read_b128 v[52:55], v2 offset:10240
    ds_read_b128 v[56:59], v2 offset:11264
    v_mfma_f32_16x16x32_bf16 v[136:139], v[60:63], a[132:135], v[136:139]
    v_mfma_f32_16x16x32_bf16 v[136:139], v[64:67], a[140:143], v[136:139]
    v_mfma_f32_16x16x32_bf16 v[136:139], v[68:71], a[148:151], v[136:139]
    v_mfma_f32_16x16x32_bf16 v[136:139], v[72:75], a[156:159], v[136:139]
    s_waitcnt lgkmcnt(0)
    v_mfma_f32_16x16x32_bf16 v[76:79], v[44:47], a[128:131], v[76:79]
    buffer_load_dwordx4 a[204:207], v8, s[8:11], s16 offen offset:256 sc1
    v_mfma_f32_16x16x32_bf16 v[76:79], v[48:51], a[136:139], v[76:79]
    s_mov_b32 s16, 43008
    ds_read_b128 v[60:63], v2 offset:12288
    ds_read_b128 v[64:67], v2 offset:13312
    v_mfma_f32_16x16x32_bf16 v[76:79], v[52:55], a[144:147], v[76:79]
    ds_read_b128 v[68:71], v2 offset:14336
    v_mfma_f32_16x16x32_bf16 v[76:79], v[56:59], a[152:155], v[76:79]
    ds_read_b128 v[72:75], v2 offset:15360
    v_mfma_f32_16x16x32_bf16 v[80:83], v[44:47], a[132:135], v[80:83]
    buffer_load_dwordx4 a[208:211], v8, s[8:11], s16 offen offset:0 sc1
    v_mfma_f32_16x16x32_bf16 v[80:83], v[48:51], a[140:143], v[80:83]
    v_mfma_f32_16x16x32_bf16 v[80:83], v[52:55], a[148:151], v[80:83]
    v_mfma_f32_16x16x32_bf16 v[80:83], v[56:59], a[156:159], v[80:83]
    s_waitcnt lgkmcnt(0)
    v_mfma_f32_16x16x32_bf16 v[156:159], v[60:63], a[128:131], v[156:159]
    ds_read_b128 v[44:47], v2 offset:16384
    v_mfma_f32_16x16x32_bf16 v[156:159], v[64:67], a[136:139], v[156:159]
    buffer_load_dwordx4 a[212:215], v8, s[8:11], s16 offen offset:256 sc1
    v_mfma_f32_16x16x32_bf16 v[156:159], v[68:71], a[144:147], v[156:159]
    s_mov_b32 s16, 61440
    ds_read_b128 v[48:51], v2 offset:17408
    ds_read_b128 v[52:55], v2 offset:18432
    v_mfma_f32_16x16x32_bf16 v[156:159], v[72:75], a[152:155], v[156:159]
    ds_read_b128 v[56:59], v2 offset:19456
    v_mfma_f32_16x16x32_bf16 v[160:163], v[60:63], a[132:135], v[160:163]
    v_mfma_f32_16x16x32_bf16 v[160:163], v[64:67], a[140:143], v[160:163]
    v_mfma_f32_16x16x32_bf16 v[160:163], v[68:71], a[148:151], v[160:163]
    buffer_load_dwordx4 a[216:219], v8, s[8:11], s16 offen offset:0 sc1
    v_mfma_f32_16x16x32_bf16 v[160:163], v[72:75], a[156:159], v[160:163]
    s_waitcnt lgkmcnt(0)
    v_mfma_f32_16x16x32_bf16 v[164:167], v[44:47], a[128:131], v[164:167]
    ds_read_b128 v[60:63], v2 offset:20480
    v_mfma_f32_16x16x32_bf16 v[164:167], v[48:51], a[136:139], v[164:167]
    ds_read_b128 v[64:67], v2 offset:21504
    v_mfma_f32_16x16x32_bf16 v[164:167], v[52:55], a[144:147], v[164:167]
    ds_read_b128 v[68:71], v2 offset:22528
    v_mfma_f32_16x16x32_bf16 v[164:167], v[56:59], a[152:155], v[164:167]
    buffer_load_dwordx4 a[220:223], v8, s[8:11], s16 offen offset:256 sc1
    v_mfma_f32_16x16x32_bf16 v[168:171], v[44:47], a[132:135], v[168:171]
    s_mov_b32 s16, 7168
    ds_read_b128 v[72:75], v2 offset:23552
    v_mfma_f32_16x16x32_bf16 v[168:171], v[48:51], a[140:143], v[168:171]
    v_mfma_f32_16x16x32_bf16 v[168:171], v[52:55], a[148:151], v[168:171]
    v_mfma_f32_16x16x32_bf16 v[168:171], v[56:59], a[156:159], v[168:171]
    s_waitcnt lgkmcnt(0)
    v_mfma_f32_16x16x32_bf16 v[140:143], v[60:63], a[128:131], v[140:143]
    buffer_load_dwordx4 v1, s[8:11], s15 offen offset:0 sc1 lds
    v_mfma_f32_16x16x32_bf16 v[140:143], v[64:67], a[136:139], v[140:143]
    ds_read_b128 v[44:47], v2 offset:24576
    ds_read_b128 v[48:51], v2 offset:25600
    v_mfma_f32_16x16x32_bf16 v[140:143], v[68:71], a[144:147], v[140:143]
    ds_read_b128 v[52:55], v2 offset:26624
    v_mfma_f32_16x16x32_bf16 v[140:143], v[72:75], a[152:155], v[140:143]
    ds_read_b128 v[56:59], v2 offset:27648
    v_mfma_f32_16x16x32_bf16 v[144:147], v[60:63], a[132:135], v[144:147]
    v_mfma_f32_16x16x32_bf16 v[144:147], v[64:67], a[140:143], v[144:147]
    buffer_load_dwordx4 v1, s[8:11], s15 offen offset:1024 sc1 lds
    v_mfma_f32_16x16x32_bf16 v[144:147], v[68:71], a[148:151], v[144:147]
    v_mfma_f32_16x16x32_bf16 v[144:147], v[72:75], a[156:159], v[144:147]
    s_waitcnt lgkmcnt(0)
    v_mfma_f32_16x16x32_bf16 v[148:151], v[44:47], a[128:131], v[148:151]
    ds_read_b128 v[60:63], v2 offset:28672
    v_mfma_f32_16x16x32_bf16 v[148:151], v[48:51], a[136:139], v[148:151]
    ds_read_b128 v[64:67], v2 offset:29696
    v_mfma_f32_16x16x32_bf16 v[148:151], v[52:55], a[144:147], v[148:151]
    buffer_load_dwordx4 v1, s[8:11], s15 offen offset:2048 sc1 lds
    v_mfma_f32_16x16x32_bf16 v[148:151], v[56:59], a[152:155], v[148:151]
    ds_read_b128 v[68:71], v2 offset:30720
    ds_read_b128 v[72:75], v2 offset:31744
    v_mfma_f32_16x16x32_bf16 v[152:155], v[44:47], a[132:135], v[152:155]
    v_mfma_f32_16x16x32_bf16 v[152:155], v[48:51], a[140:143], v[152:155]
    v_mfma_f32_16x16x32_bf16 v[152:155], v[52:55], a[148:151], v[152:155]
    v_mfma_f32_16x16x32_bf16 v[152:155], v[56:59], a[156:159], v[152:155]
    s_waitcnt lgkmcnt(0)
    v_mfma_f32_16x16x32_bf16 v[172:175], v[60:63], a[128:131], v[172:175]
    buffer_load_dwordx4 v1, s[8:11], s15 offen offset:3072 sc1 lds
    v_mfma_f32_16x16x32_bf16 v[172:175], v[64:67], a[136:139], v[172:175]
    s_add_u32 m0, s12, 114688
    ds_read_b128 v[44:47], v2 offset:32768
    ds_read_b128 v[48:51], v2 offset:33792
    v_mfma_f32_16x16x32_bf16 v[172:175], v[68:71], a[144:147], v[172:175]
    s_add_u32 s15, s14, 262144
    ds_read_b128 v[52:55], v2 offset:34816
    v_mfma_f32_16x16x32_bf16 v[172:175], v[72:75], a[152:155], v[172:175]
    ds_read_b128 v[56:59], v2 offset:35840
    v_mfma_f32_16x16x32_bf16 v[176:179], v[60:63], a[132:135], v[176:179]
    buffer_load_dwordx4 v1, s[8:11], s15 offen offset:0 sc1 lds
    v_mfma_f32_16x16x32_bf16 v[176:179], v[64:67], a[140:143], v[176:179]
    v_mfma_f32_16x16x32_bf16 v[176:179], v[68:71], a[148:151], v[176:179]
    v_mfma_f32_16x16x32_bf16 v[176:179], v[72:75], a[156:159], v[176:179]
    s_waitcnt lgkmcnt(0)
    v_mfma_f32_16x16x32_bf16 v[180:183], v[44:47], a[128:131], v[180:183]
    s_waitcnt vmcnt(22)
    s_barrier
    ds_read_b128 v[60:63], v3 offset:0
    v_mfma_f32_16x16x32_bf16 v[180:183], v[48:51], a[136:139], v[180:183]
    buffer_load_dwordx4 v1, s[8:11], s15 offen offset:1024 sc1 lds
    v_mfma_f32_16x16x32_bf16 v[180:183], v[52:55], a[144:147], v[180:183]
    ds_read_b128 v[64:67], v3 offset:1024
    ds_read_b128 v[68:71], v3 offset:2048
    v_mfma_f32_16x16x32_bf16 v[180:183], v[56:59], a[152:155], v[180:183]
    ds_read_b128 v[72:75], v3 offset:3072
    v_mfma_f32_16x16x32_bf16 v[184:187], v[44:47], a[132:135], v[184:187]
    v_mfma_f32_16x16x32_bf16 v[184:187], v[48:51], a[140:143], v[184:187]
    v_mfma_f32_16x16x32_bf16 v[184:187], v[52:55], a[148:151], v[184:187]
    buffer_load_dwordx4 v1, s[8:11], s15 offen offset:2048 sc1 lds
    v_mfma_f32_16x16x32_bf16 v[184:187], v[56:59], a[156:159], v[184:187]
    s_waitcnt lgkmcnt(0)
    v_mfma_f32_16x16x32_bf16 v[124:127], v[60:63], a[160:163], v[124:127]
    ds_read_b128 v[44:47], v3 offset:4096
    v_mfma_f32_16x16x32_bf16 v[124:127], v[64:67], a[168:171], v[124:127]
    ds_read_b128 v[48:51], v3 offset:5120
    v_mfma_f32_16x16x32_bf16 v[124:127], v[68:71], a[176:179], v[124:127]
    ds_read_b128 v[52:55], v3 offset:6144
    v_mfma_f32_16x16x32_bf16 v[124:127], v[72:75], a[184:187], v[124:127]
    buffer_load_dwordx4 v1, s[8:11], s15 offen offset:3072 sc1 lds
    v_mfma_f32_16x16x32_bf16 v[128:131], v[60:63], a[164:167], v[128:131]
    s_add_u32 m0, s12, 118784
    ds_read_b128 v[56:59], v3 offset:7168
    v_mfma_f32_16x16x32_bf16 v[128:131], v[64:67], a[172:175], v[128:131]
    s_add_u32 s15, s14, 266240
    v_mfma_f32_16x16x32_bf16 v[128:131], v[68:71], a[180:183], v[128:131]
    v_mfma_f32_16x16x32_bf16 v[128:131], v[72:75], a[188:191], v[128:131]
    s_waitcnt lgkmcnt(0)
    v_mfma_f32_16x16x32_bf16 v[132:135], v[44:47], a[160:163], v[132:135]
    buffer_load_dwordx4 v1, s[8:11], s15 offen offset:0 sc1 lds
    v_mfma_f32_16x16x32_bf16 v[132:135], v[48:51], a[168:171], v[132:135]
    s_add_u32 m0, s12, 0
    ds_read_b128 v[60:63], v3 offset:8192
    ds_read_b128 v[64:67], v3 offset:9216
    v_mfma_f32_16x16x32_bf16 v[132:135], v[52:55], a[176:179], v[132:135]
    s_add_u32 s15, s14, 294912
    ds_read_b128 v[68:71], v3 offset:10240
    v_mfma_f32_16x16x32_bf16 v[132:135], v[56:59], a[184:187], v[132:135]
    ds_read_b128 v[72:75], v3 offset:11264
    v_mfma_f32_16x16x32_bf16 v[136:139], v[44:47], a[164:167], v[136:139]
    v_mfma_f32_16x16x32_bf16 v[136:139], v[48:51], a[172:175], v[136:139]
    buffer_load_dwordx4 a[224:227], v8, s[8:11], s16 offen offset:0 sc1
    v_mfma_f32_16x16x32_bf16 v[136:139], v[52:55], a[180:183], v[136:139]
    v_mfma_f32_16x16x32_bf16 v[136:139], v[56:59], a[188:191], v[136:139]
    s_waitcnt lgkmcnt(0)
    v_mfma_f32_16x16x32_bf16 v[76:79], v[60:63], a[160:163], v[76:79]
    ds_read_b128 v[44:47], v3 offset:12288
    v_mfma_f32_16x16x32_bf16 v[76:79], v[64:67], a[168:171], v[76:79]
    ds_read_b128 v[48:51], v3 offset:13312
    v_mfma_f32_16x16x32_bf16 v[76:79], v[68:71], a[176:179], v[76:79]
    buffer_load_dwordx4 a[228:231], v8, s[8:11], s16 offen offset:256 sc1
    v_mfma_f32_16x16x32_bf16 v[76:79], v[72:75], a[184:187], v[76:79]
    s_mov_b32 s16, 25600
    ds_read_b128 v[52:55], v3 offset:14336
    ds_read_b128 v[56:59], v3 offset:15360
    v_mfma_f32_16x16x32_bf16 v[80:83], v[60:63], a[164:167], v[80:83]
    v_mfma_f32_16x16x32_bf16 v[80:83], v[64:67], a[172:175], v[80:83]
    v_mfma_f32_16x16x32_bf16 v[80:83], v[68:71], a[180:183], v[80:83]
    v_mfma_f32_16x16x32_bf16 v[80:83], v[72:75], a[188:191], v[80:83]
    s_waitcnt lgkmcnt(0)
    v_mfma_f32_16x16x32_bf16 v[156:159], v[44:47], a[160:163], v[156:159]
    buffer_load_dwordx4 a[232:235], v8, s[8:11], s16 offen offset:0 sc1
    v_mfma_f32_16x16x32_bf16 v[156:159], v[48:51], a[168:171], v[156:159]
    ds_read_b128 v[60:63], v3 offset:16384
    ds_read_b128 v[64:67], v3 offset:17408
    v_mfma_f32_16x16x32_bf16 v[156:159], v[52:55], a[176:179], v[156:159]
    ds_read_b128 v[68:71], v3 offset:18432
    v_mfma_f32_16x16x32_bf16 v[156:159], v[56:59], a[184:187], v[156:159]
    ds_read_b128 v[72:75], v3 offset:19456
    v_mfma_f32_16x16x32_bf16 v[160:163], v[44:47], a[164:167], v[160:163]
    buffer_load_dwordx4 a[236:239], v8, s[8:11], s16 offen offset:256 sc1
    v_mfma_f32_16x16x32_bf16 v[160:163], v[48:51], a[172:175], v[160:163]
    s_mov_b32 s16, 44032
    v_mfma_f32_16x16x32_bf16 v[160:163], v[52:55], a[180:183], v[160:163]
    v_mfma_f32_16x16x32_bf16 v[160:163], v[56:59], a[188:191], v[160:163]
    s_waitcnt lgkmcnt(0)
    v_mfma_f32_16x16x32_bf16 v[164:167], v[60:63], a[160:163], v[164:167]
    ds_read_b128 v[44:47], v3 offset:20480
    v_mfma_f32_16x16x32_bf16 v[164:167], v[64:67], a[168:171], v[164:167]
    buffer_load_dwordx4 a[240:243], v8, s[8:11], s16 offen offset:0 sc1
    v_mfma_f32_16x16x32_bf16 v[164:167], v[68:71], a[176:179], v[164:167]
    ds_read_b128 v[48:51], v3 offset:21504
    ds_read_b128 v[52:55], v3 offset:22528
    v_mfma_f32_16x16x32_bf16 v[164:167], v[72:75], a[184:187], v[164:167]
    ds_read_b128 v[56:59], v3 offset:23552
    v_mfma_f32_16x16x32_bf16 v[168:171], v[60:63], a[164:167], v[168:171]
    v_mfma_f32_16x16x32_bf16 v[168:171], v[64:67], a[172:175], v[168:171]
    v_mfma_f32_16x16x32_bf16 v[168:171], v[68:71], a[180:183], v[168:171]
    buffer_load_dwordx4 a[244:247], v8, s[8:11], s16 offen offset:256 sc1
    v_mfma_f32_16x16x32_bf16 v[168:171], v[72:75], a[188:191], v[168:171]
    s_waitcnt lgkmcnt(0)
    v_mfma_f32_16x16x32_bf16 v[140:143], v[44:47], a[160:163], v[140:143]
    s_mov_b32 s16, 62464
    ds_read_b128 v[60:63], v3 offset:24576
    v_mfma_f32_16x16x32_bf16 v[140:143], v[48:51], a[168:171], v[140:143]
    ds_read_b128 v[64:67], v3 offset:25600
    v_mfma_f32_16x16x32_bf16 v[140:143], v[52:55], a[176:179], v[140:143]
    ds_read_b128 v[68:71], v3 offset:26624
    v_mfma_f32_16x16x32_bf16 v[140:143], v[56:59], a[184:187], v[140:143]
    buffer_load_dwordx4 a[248:251], v8, s[8:11], s16 offen offset:0 sc1
    v_mfma_f32_16x16x32_bf16 v[144:147], v[44:47], a[164:167], v[144:147]
    ds_read_b128 v[72:75], v3 offset:27648
    v_mfma_f32_16x16x32_bf16 v[144:147], v[48:51], a[172:175], v[144:147]
    v_mfma_f32_16x16x32_bf16 v[144:147], v[52:55], a[180:183], v[144:147]
    v_mfma_f32_16x16x32_bf16 v[144:147], v[56:59], a[188:191], v[144:147]
    s_waitcnt lgkmcnt(0)
    v_mfma_f32_16x16x32_bf16 v[148:151], v[60:63], a[160:163], v[148:151]
    buffer_load_dwordx4 a[252:255], v8, s[8:11], s16 offen offset:256 sc1
    v_mfma_f32_16x16x32_bf16 v[148:151], v[64:67], a[168:171], v[148:151]
    s_mov_b32 s16, 8192
    ds_read_b128 v[44:47], v3 offset:28672
    ds_read_b128 v[48:51], v3 offset:29696
    v_mfma_f32_16x16x32_bf16 v[148:151], v[68:71], a[176:179], v[148:151]
    ds_read_b128 v[52:55], v3 offset:30720
    v_mfma_f32_16x16x32_bf16 v[148:151], v[72:75], a[184:187], v[148:151]
    ds_read_b128 v[56:59], v3 offset:31744
    v_mfma_f32_16x16x32_bf16 v[152:155], v[60:63], a[164:167], v[152:155]
    v_mfma_f32_16x16x32_bf16 v[152:155], v[64:67], a[172:175], v[152:155]
    buffer_load_dwordx4 v[220:223], v8, s[8:11], s16 offen offset:0 sc1
    v_mfma_f32_16x16x32_bf16 v[152:155], v[68:71], a[180:183], v[152:155]
    v_mfma_f32_16x16x32_bf16 v[152:155], v[72:75], a[188:191], v[152:155]
    s_waitcnt lgkmcnt(0)
    v_mfma_f32_16x16x32_bf16 v[172:175], v[44:47], a[160:163], v[172:175]
    ds_read_b128 v[60:63], v3 offset:32768
    v_mfma_f32_16x16x32_bf16 v[172:175], v[48:51], a[168:171], v[172:175]
    ds_read_b128 v[64:67], v3 offset:33792
    v_mfma_f32_16x16x32_bf16 v[172:175], v[52:55], a[176:179], v[172:175]
    buffer_load_dwordx4 v[224:227], v8, s[8:11], s16 offen offset:256 sc1
    v_mfma_f32_16x16x32_bf16 v[172:175], v[56:59], a[184:187], v[172:175]
    s_mov_b32 s16, 26624
    ds_read_b128 v[68:71], v3 offset:34816
    ds_read_b128 v[72:75], v3 offset:35840
    v_mfma_f32_16x16x32_bf16 v[176:179], v[44:47], a[164:167], v[176:179]
    v_mfma_f32_16x16x32_bf16 v[176:179], v[48:51], a[172:175], v[176:179]
    v_mfma_f32_16x16x32_bf16 v[176:179], v[52:55], a[180:183], v[176:179]
    v_mfma_f32_16x16x32_bf16 v[176:179], v[56:59], a[188:191], v[176:179]
    s_waitcnt lgkmcnt(0)
    v_mfma_f32_16x16x32_bf16 v[180:183], v[60:63], a[160:163], v[180:183]
    s_waitcnt vmcnt(19)
    s_barrier
    ds_read_b128 v[44:47], v4 offset:0
    v_mfma_f32_16x16x32_bf16 v[180:183], v[64:67], a[168:171], v[180:183]
    buffer_load_dwordx4 v[228:231], v8, s[8:11], s16 offen offset:0 sc1
    v_mfma_f32_16x16x32_bf16 v[180:183], v[68:71], a[176:179], v[180:183]
    ds_read_b128 v[48:51], v4 offset:1024
    ds_read_b128 v[52:55], v4 offset:2048
    v_mfma_f32_16x16x32_bf16 v[180:183], v[72:75], a[184:187], v[180:183]
    ds_read_b128 v[56:59], v4 offset:3072
    v_mfma_f32_16x16x32_bf16 v[184:187], v[60:63], a[164:167], v[184:187]
    v_mfma_f32_16x16x32_bf16 v[184:187], v[64:67], a[172:175], v[184:187]
    buffer_load_dwordx4 v[232:235], v8, s[8:11], s16 offen offset:256 sc1
    v_mfma_f32_16x16x32_bf16 v[184:187], v[68:71], a[180:183], v[184:187]
    s_mov_b32 s16, 45056
    v_mfma_f32_16x16x32_bf16 v[184:187], v[72:75], a[188:191], v[184:187]
    s_waitcnt lgkmcnt(0)
    v_mfma_f32_16x16x32_bf16 v[124:127], v[44:47], a[192:195], v[124:127]
    ds_read_b128 v[60:63], v4 offset:4096
    v_mfma_f32_16x16x32_bf16 v[124:127], v[48:51], a[200:203], v[124:127]
    ds_read_b128 v[64:67], v4 offset:5120
    v_mfma_f32_16x16x32_bf16 v[124:127], v[52:55], a[208:211], v[124:127]
    buffer_load_dwordx4 v[236:239], v8, s[8:11], s16 offen offset:0 sc1
    v_mfma_f32_16x16x32_bf16 v[124:127], v[56:59], a[216:219], v[124:127]
    ds_read_b128 v[68:71], v4 offset:6144
    ds_read_b128 v[72:75], v4 offset:7168
    v_mfma_f32_16x16x32_bf16 v[128:131], v[44:47], a[196:199], v[128:131]
    v_mfma_f32_16x16x32_bf16 v[128:131], v[48:51], a[204:207], v[128:131]
    v_mfma_f32_16x16x32_bf16 v[128:131], v[52:55], a[212:215], v[128:131]
    v_mfma_f32_16x16x32_bf16 v[128:131], v[56:59], a[220:223], v[128:131]
    s_waitcnt lgkmcnt(0)
    v_mfma_f32_16x16x32_bf16 v[132:135], v[60:63], a[192:195], v[132:135]
    buffer_load_dwordx4 v[240:243], v8, s[8:11], s16 offen offset:256 sc1
    v_mfma_f32_16x16x32_bf16 v[132:135], v[64:67], a[200:203], v[132:135]
    s_mov_b32 s16, 63488
    ds_read_b128 v[44:47], v4 offset:8192
    ds_read_b128 v[48:51], v4 offset:9216
    v_mfma_f32_16x16x32_bf16 v[132:135], v[68:71], a[208:211], v[132:135]
    ds_read_b128 v[52:55], v4 offset:10240
    v_mfma_f32_16x16x32_bf16 v[132:135], v[72:75], a[216:219], v[132:135]
    ds_read_b128 v[56:59], v4 offset:11264
    v_mfma_f32_16x16x32_bf16 v[136:139], v[60:63], a[196:199], v[136:139]
    buffer_load_dwordx4 v[244:247], v8, s[8:11], s16 offen offset:0 sc1
    v_mfma_f32_16x16x32_bf16 v[136:139], v[64:67], a[204:207], v[136:139]
    v_mfma_f32_16x16x32_bf16 v[136:139], v[68:71], a[212:215], v[136:139]
    v_mfma_f32_16x16x32_bf16 v[136:139], v[72:75], a[220:223], v[136:139]
    s_waitcnt lgkmcnt(0)
    v_mfma_f32_16x16x32_bf16 v[76:79], v[44:47], a[192:195], v[76:79]
    ds_read_b128 v[60:63], v4 offset:12288
    v_mfma_f32_16x16x32_bf16 v[76:79], v[48:51], a[200:203], v[76:79]
    buffer_load_dwordx4 v[248:251], v8, s[8:11], s16 offen offset:256 sc1
    v_mfma_f32_16x16x32_bf16 v[76:79], v[52:55], a[208:211], v[76:79]
    ds_read_b128 v[64:67], v4 offset:13312
    ds_read_b128 v[68:71], v4 offset:14336
    v_mfma_f32_16x16x32_bf16 v[76:79], v[56:59], a[216:219], v[76:79]
    ds_read_b128 v[72:75], v4 offset:15360
    v_mfma_f32_16x16x32_bf16 v[80:83], v[44:47], a[196:199], v[80:83]
    v_mfma_f32_16x16x32_bf16 v[80:83], v[48:51], a[204:207], v[80:83]
    v_mfma_f32_16x16x32_bf16 v[80:83], v[52:55], a[212:215], v[80:83]
    buffer_load_dwordx4 v1, s[8:11], s15 offen offset:0 sc1 lds
    v_mfma_f32_16x16x32_bf16 v[80:83], v[56:59], a[220:223], v[80:83]
    s_waitcnt lgkmcnt(0)
    v_mfma_f32_16x16x32_bf16 v[156:159], v[60:63], a[192:195], v[156:159]
    ds_read_b128 v[44:47], v4 offset:16384
    v_mfma_f32_16x16x32_bf16 v[156:159], v[64:67], a[200:203], v[156:159]
    ds_read_b128 v[48:51], v4 offset:17408
    v_mfma_f32_16x16x32_bf16 v[156:159], v[68:71], a[208:211], v[156:159]
    ds_read_b128 v[52:55], v4 offset:18432
    v_mfma_f32_16x16x32_bf16 v[156:159], v[72:75], a[216:219], v[156:159]
    buffer_load_dwordx4 v1, s[8:11], s15 offen offset:1024 sc1 lds
    v_mfma_f32_16x16x32_bf16 v[160:163], v[60:63], a[196:199], v[160:163]
    ds_read_b128 v[56:59], v4 offset:19456
    v_mfma_f32_16x16x32_bf16 v[160:163], v[64:67], a[204:207], v[160:163]
    v_mfma_f32_16x16x32_bf16 v[160:163], v[68:71], a[212:215], v[160:163]
    v_mfma_f32_16x16x32_bf16 v[160:163], v[72:75], a[220:223], v[160:163]
    s_waitcnt lgkmcnt(0)
    v_mfma_f32_16x16x32_bf16 v[164:167], v[44:47], a[192:195], v[164:167]
    buffer_load_dwordx4 v1, s[8:11], s15 offen offset:2048 sc1 lds
    v_mfma_f32_16x16x32_bf16 v[164:167], v[48:51], a[200:203], v[164:167]
    ds_read_b128 v[60:63], v4 offset:20480
    ds_read_b128 v[64:67], v4 offset:21504
    v_mfma_f32_16x16x32_bf16 v[164:167], v[52:55], a[208:211], v[164:167]
L_pad_c3_7:
    s_cbranch_execz L_hopret_c3
    ds_read_b128 v[68:71], v4 offset:22528
    v_mfma_f32_16x16x32_bf16 v[164:167], v[56:59], a[216:219], v[164:167]
    ds_read_b128 v[72:75], v4 offset:23552
    v_mfma_f32_16x16x32_bf16 v[168:171], v[44:47], a[196:199], v[168:171]
    v_mfma_f32_16x16x32_bf16 v[168:171], v[48:51], a[204:207], v[168:171]
    buffer_load_dwordx4 v1, s[8:11], s15 offen offset:3072 sc1 lds
    v_mfma_f32_16x16x32_bf16 v[168:171], v[52:55], a[212:215], v[168:171]
    s_add_u32 m0, s12, 4096
    v_mfma_f32_16x16x32_bf16 v[168:171], v[56:59], a[220:223], v[168:171]
    s_waitcnt lgkmcnt(0)
    v_mfma_f32_16x16x32_bf16 v[140:143], v[60:63], a[192:195], v[140:143]
    s_add_u32 s15, s14, 299008
    ds_read_b128 v[44:47], v4 offset:24576
    v_mfma_f32_16x16x32_bf16 v[140:143], v[64:67], a[200:203], v[140:143]
    ds_read_b128 v[48:51], v4 offset:25600
    v_mfma_f32_16x16x32_bf16 v[140:143], v[68:71], a[208:211], v[140:143]
    buffer_load_dwordx4 v1, s[8:11], s15 offen offset:0 sc1 lds
    v_mfma_f32_16x16x32_bf16 v[140:143], v[72:75], a[216:219], v[140:143]
    ds_read_b128 v[52:55], v4 offset:26624
    ds_read_b128 v[56:59], v4 offset:27648
    v_mfma_f32_16x16x32_bf16 v[144:147], v[60:63], a[196:199], v[144:147]
    v_mfma_f32_16x16x32_bf16 v[144:147], v[64:67], a[204:207], v[144:147]
    v_mfma_f32_16x16x32_bf16 v[144:147], v[68:71], a[212:215], v[144:147]
    v_mfma_f32_16x16x32_bf16 v[144:147], v[72:75], a[220:223], v[144:147]
    s_waitcnt lgkmcnt(0)
    v_mfma_f32_16x16x32_bf16 v[148:151], v[44:47], a[192:195], v[148:151]
    buffer_load_dwordx4 v1, s[8:11], s15 offen offset:1024 sc1 lds
    v_mfma_f32_16x16x32_bf16 v[148:151], v[48:51], a[200:203], v[148:151]
    ds_read_b128 v[60:63], v4 offset:28672
    ds_read_b128 v[64:67], v4 offset:29696
    v_mfma_f32_16x16x32_bf16 v[148:151], v[52:55], a[208:211], v[148:151]
    ds_read_b128 v[68:71], v4 offset:30720
    v_mfma_f32_16x16x32_bf16 v[148:151], v[56:59], a[216:219], v[148:151]
    ds_read_b128 v[72:75], v4 offset:31744
    v_mfma_f32_16x16x32_bf16 v[152:155], v[44:47], a[196:199], v[152:155]
    buffer_load_dwordx4 v1, s[8:11], s15 offen offset:2048 sc1 lds
    v_mfma_f32_16x16x32_bf16 v[152:155], v[48:51], a[204:207], v[152:155]
    v_mfma_f32_16x16x32_bf16 v[152:155], v[52:55], a[212:215], v[152:155]
    v_mfma_f32_16x16x32_bf16 v[152:155], v[56:59], a[220:223], v[152:155]
    s_waitcnt lgkmcnt(0)
    v_mfma_f32_16x16x32_bf16 v[172:175], v[60:63], a[192:195], v[172:175]
    ds_read_b128 v[44:47], v4 offset:32768
    v_mfma_f32_16x16x32_bf16 v[172:175], v[64:67], a[200:203], v[172:175]
    buffer_load_dwordx4 v1, s[8:11], s15 offen offset:3072 sc1 lds
    v_mfma_f32_16x16x32_bf16 v[172:175], v[68:71], a[208:211], v[172:175]
    s_add_u32 m0, s12, 8192
    ds_read_b128 v[48:51], v4 offset:33792
    ds_read_b128 v[52:55], v4 offset:34816
    v_mfma_f32_16x16x32_bf16 v[172:175], v[72:75], a[216:219], v[172:175]
    s_add_u32 s15, s14, 303104
    ds_read_b128 v[56:59], v4 offset:35840
    v_mfma_f32_16x16x32_bf16 v[176:179], v[60:63], a[196:199], v[176:179]
    v_mfma_f32_16x16x32_bf16 v[176:179], v[64:67], a[204:207], v[176:179]
    v_mfma_f32_16x16x32_bf16 v[176:179], v[68:71], a[212:215], v[176:179]
    buffer_load_dwordx4 v1, s[8:11], s15 offen offset:0 sc1 lds
    v_mfma_f32_16x16x32_bf16 v[176:179], v[72:75], a[220:223], v[176:179]
    s_waitcnt lgkmcnt(0)
    v_mfma_f32_16x16x32_bf16 v[180:183], v[44:47], a[192:195], v[180:183]
    s_waitcnt vmcnt(9)
    s_barrier
    ds_read_b128 v[60:63], v5 offset:0
    v_mfma_f32_16x16x32_bf16 v[180:183], v[48:51], a[200:203], v[180:183]
    ds_read_b128 v[64:67], v5 offset:1024
    v_mfma_f32_16x16x32_bf16 v[180:183], v[52:55], a[208:211], v[180:183]
    ds_read_b128 v[68:71], v5 offset:2048
    v_mfma_f32_16x16x32_bf16 v[180:183], v[56:59], a[216:219], v[180:183]
    ds_read_b128 v[72:75], v5 offset:3072
    v_mfma_f32_16x16x32_bf16 v[184:187], v[44:47], a[196:199], v[184:187]
    v_mfma_f32_16x16x32_bf16 v[184:187], v[48:51], a[204:207], v[184:187]
    v_mfma_f32_16x16x32_bf16 v[184:187], v[52:55], a[212:215], v[184:187]
    v_mfma_f32_16x16x32_bf16 v[184:187], v[56:59], a[220:223], v[184:187]
    s_waitcnt lgkmcnt(0)
    v_mfma_f32_16x16x32_bf16 v[124:127], v[60:63], a[224:227], v[124:127]
    ds_read_b128 v[44:47], v5 offset:4096
    v_mfma_f32_16x16x32_bf16 v[124:127], v[64:67], a[232:235], v[124:127]
    ds_read_b128 v[48:51], v5 offset:5120
    v_mfma_f32_16x16x32_bf16 v[124:127], v[68:71], a[240:243], v[124:127]
    ds_read_b128 v[52:55], v5 offset:6144
    v_mfma_f32_16x16x32_bf16 v[124:127], v[72:75], a[248:251], v[124:127]
    ds_read_b128 v[56:59], v5 offset:7168
    v_mfma_f32_16x16x32_bf16 v[128:131], v[60:63], a[228:231], v[128:131]
    v_mfma_f32_16x16x32_bf16 v[128:131], v[64:67], a[236:239], v[128:131]
    v_mfma_f32_16x16x32_bf16 v[128:131], v[68:71], a[244:247], v[128:131]
    v_mfma_f32_16x16x32_bf16 v[128:131], v[72:75], a[252:255], v[128:131]
    s_waitcnt lgkmcnt(0)
    v_mfma_f32_16x16x32_bf16 v[128:131], v[44:47], v[224:227], v[128:131]
    ds_read_b128 v[60:63], v5 offset:8192
    v_mfma_f32_16x16x32_bf16 v[128:131], v[48:51], v[232:235], v[128:131]
    ds_read_b128 v[64:67], v5 offset:9216
    v_mfma_f32_16x16x32_bf16 v[128:131], v[52:55], v[240:243], v[128:131]
    ds_read_b128 v[68:71], v5 offset:10240
    v_mfma_f32_16x16x32_bf16 v[128:131], v[56:59], v[248:251], v[128:131]
    ds_read_b128 v[72:75], v5 offset:11264
    v_mfma_f32_16x16x32_bf16 v[124:127], v[44:47], v[220:223], v[124:127]
    v_mfma_f32_16x16x32_bf16 v[124:127], v[48:51], v[228:231], v[124:127]
    v_mfma_f32_16x16x32_bf16 v[124:127], v[52:55], v[236:239], v[124:127]
    v_mfma_f32_16x16x32_bf16 v[124:127], v[56:59], v[244:247], v[124:127]
    s_waitcnt lgkmcnt(0)
    v_mfma_f32_16x16x32_bf16 v[132:135], v[60:63], a[224:227], v[132:135]
    ds_read_b128 v[44:47], v5 offset:12288
    v_mfma_f32_16x16x32_bf16 v[132:135], v[64:67], a[232:235], v[132:135]
    ds_read_b128 v[48:51], v5 offset:13312
    v_mfma_f32_16x16x32_bf16 v[132:135], v[68:71], a[240:243], v[132:135]
    ds_read_b128 v[52:55], v5 offset:14336
    v_mfma_f32_16x16x32_bf16 v[132:135], v[72:75], a[248:251], v[132:135]
    ds_read_b128 v[56:59], v5 offset:15360
    v_cvt_pk_bf16_f32 v20, v124, v125
    v_mfma_f32_16x16x32_bf16 v[136:139], v[60:63], a[228:231], v[136:139]
    v_cvt_pk_bf16_f32 v21, v126, v127
    v_cvt_pk_bf16_f32 v22, v128, v129
    v_mfma_f32_16x16x32_bf16 v[136:139], v[64:67], a[236:239], v[136:139]
    v_cvt_pk_bf16_f32 v23, v130, v131
    v_mfma_f32_16x16x32_bf16 v[136:139], v[68:71], a[244:247], v[136:139]
    v_permlane32_swap_b32 v20, v22
    v_mfma_f32_16x16x32_bf16 v[136:139], v[72:75], a[252:255], v[136:139]
    s_waitcnt lgkmcnt(0)
    v_permlane32_swap_b32 v21, v23
    v_mfma_f32_16x16x32_bf16 v[136:139], v[44:47], v[224:227], v[136:139]
    buffer_store_dwordx4 v[20:23], v10, s[8:11], 0 offen sc1
    v_mfma_f32_16x16x32_bf16 v[136:139], v[48:51], v[232:235], v[136:139]
    ds_read_b128 v[60:63], v5 offset:16384
    ds_read_b128 v[64:67], v5 offset:17408
    v_mfma_f32_16x16x32_bf16 v[136:139], v[52:55], v[240:243], v[136:139]
    ds_read_b128 v[68:71], v5 offset:18432
    v_mfma_f32_16x16x32_bf16 v[136:139], v[56:59], v[248:251], v[136:139]
    ds_read_b128 v[72:75], v5 offset:19456
    v_mfma_f32_16x16x32_bf16 v[132:135], v[44:47], v[220:223], v[132:135]
    v_mfma_f32_16x16x32_bf16 v[132:135], v[48:51], v[228:231], v[132:135]
    s_getpc_b64 s[20:21]
L_pc33:
    s_add_u32 s20, s20, L_after1-L_pc33
    s_addc_u32 s21, s21, 0
    v_mfma_f32_16x16x32_bf16 v[132:135], v[52:55], v[236:239], v[132:135]
    v_lshlrev_b32 v7, 7, v0
    v_mfma_f32_16x16x32_bf16 v[132:135], v[56:59], v[244:247], v[132:135]
    s_waitcnt lgkmcnt(0)
    v_min_u32 v7, L_code_end-L_after1, v7
    v_mfma_f32_16x16x32_bf16 v[76:79], v[60:63], a[224:227], v[76:79]
    ds_read_b128 v[44:47], v5 offset:20480
    v_mfma_f32_16x16x32_bf16 v[76:79], v[64:67], a[232:235], v[76:79]
    global_load_dword v6, v7, s[20:21]
    ds_read_b128 v[48:51], v5 offset:21504
    v_mfma_f32_16x16x32_bf16 v[76:79], v[68:71], a[240:243], v[76:79]
    ds_read_b128 v[52:55], v5 offset:22528
    v_mfma_f32_16x16x32_bf16 v[76:79], v[72:75], a[248:251], v[76:79]
    ds_read_b128 v[56:59], v5 offset:23552
    v_mfma_f32_16x16x32_bf16 v[80:83], v[60:63], a[228:231], v[80:83]
    v_mfma_f32_16x16x32_bf16 v[80:83], v[64:67], a[236:239], v[80:83]
    v_mfma_f32_16x16x32_bf16 v[80:83], v[68:71], a[244:247], v[80:83]
    v_mfma_f32_16x16x32_bf16 v[80:83], v[72:75], a[252:255], v[80:83]
    s_waitcnt lgkmcnt(0)
    v_mfma_f32_16x16x32_bf16 v[80:83], v[44:47], v[224:227], v[80:83]
    ds_read_b128 v[60:63], v5 offset:24576
    v_mfma_f32_16x16x32_bf16 v[80:83], v[48:51], v[232:235], v[80:83]
    ds_read_b128 v[64:67], v5 offset:25600
    v_mfma_f32_16x16x32_bf16 v[80:83], v[52:55], v[240:243], v[80:83]
    ds_read_b128 v[68:71], v5 offset:26624
    v_mfma_f32_16x16x32_bf16 v[80:83], v[56:59], v[248:251], v[80:83]
    ds_read_b128 v[72:75], v5 offset:27648
    v_mfma_f32_16x16x32_bf16 v[76:79], v[44:47], v[220:223], v[76:79]
    v_mfma_f32_16x16x32_bf16 v[76:79], v[48:51], v[228:231], v[76:79]
    v_mfma_f32_16x16x32_bf16 v[76:79], v[52:55], v[236:239], v[76:79]
    v_mfma_f32_16x16x32_bf16 v[76:79], v[56:59], v[244:247], v[76:79]
    s_waitcnt lgkmcnt(0)
    v_mfma_f32_16x16x32_bf16 v[156:159], v[60:63], a[224:227], v[156:159]
    s_mov_b32 s17, 0
    ds_read_b128 v[44:47], v5 offset:28672
    v_mfma_f32_16x16x32_bf16 v[156:159], v[64:67], a[232:235], v[156:159]
    ds_read_b128 v[48:51], v5 offset:29696
    v_mfma_f32_16x16x32_bf16 v[156:159], v[68:71], a[240:243], v[156:159]
    ds_read_b128 v[52:55], v5 offset:30720
    v_mfma_f32_16x16x32_bf16 v[156:159], v[72:75], a[248:251], v[156:159]
    ds_read_b128 v[56:59], v5 offset:31744
    v_cvt_pk_bf16_f32 v20, v132, v133
    v_mfma_f32_16x16x32_bf16 v[160:163], v[60:63], a[228:231], v[160:163]
    v_cvt_pk_bf16_f32 v21, v134, v135
    v_cvt_pk_bf16_f32 v22, v76, v77
    v_mfma_f32_16x16x32_bf16 v[160:163], v[64:67], a[236:239], v[160:163]
    v_cvt_pk_bf16_f32 v23, v78, v79
    v_cvt_pk_bf16_f32 v24, v136, v137
    v_mfma_f32_16x16x32_bf16 v[160:163], v[68:71], a[244:247], v[160:163]
    buffer_store_dwordx4 v[20:23], v9, s[8:11], s17 offen offset:0 sc1
    v_mfma_f32_16x16x32_bf16 v[160:163], v[72:75], a[252:255], v[160:163]
    s_waitcnt lgkmcnt(0)
    v_cvt_pk_bf16_f32 v25, v138, v139
    v_cvt_pk_bf16_f32 v26, v80, v81
    v_mfma_f32_16x16x32_bf16 v[160:163], v[44:47], v[224:227], v[160:163]
    ds_read_b128 v[60:63], v5 offset:32768
    v_cvt_pk_bf16_f32 v27, v82, v83
    v_mfma_f32_16x16x32_bf16 v[160:163], v[48:51], v[232:235], v[160:163]
    ds_read_b128 v[64:67], v5 offset:33792
    v_mfma_f32_16x16x32_bf16 v[160:163], v[52:55], v[240:243], v[160:163]
    buffer_store_dwordx4 v[24:27], v9, s[8:11], s17 offen offset:256 sc1
    v_mfma_f32_16x16x32_bf16 v[160:163], v[56:59], v[248:251], v[160:163]
    ds_read_b128 v[68:71], v5 offset:34816
    ds_read_b128 v[72:75], v5 offset:35840
    v_mfma_f32_16x16x32_bf16 v[156:159], v[44:47], v[220:223], v[156:159]
    v_mfma_f32_16x16x32_bf16 v[156:159], v[48:51], v[228:231], v[156:159]
    v_mfma_f32_16x16x32_bf16 v[156:159], v[52:55], v[236:239], v[156:159]
    v_mfma_f32_16x16x32_bf16 v[156:159], v[56:59], v[244:247], v[156:159]
    s_waitcnt lgkmcnt(0)
    v_mfma_f32_16x16x32_bf16 v[164:167], v[60:63], a[224:227], v[164:167]
    s_waitcnt vmcnt(4)
    s_barrier
    ds_read_b128 v[44:47], v2 offset:0
    v_mfma_f32_16x16x32_bf16 v[164:167], v[64:67], a[232:235], v[164:167]
    ds_read_b128 v[48:51], v2 offset:1024
    v_mfma_f32_16x16x32_bf16 v[164:167], v[68:71], a[240:243], v[164:167]
    ds_read_b128 v[52:55], v2 offset:2048
    v_mfma_f32_16x16x32_bf16 v[164:167], v[72:75], a[248:251], v[164:167]
    ds_read_b128 v[56:59], v2 offset:3072
    v_mfma_f32_16x16x32_bf16 v[168:171], v[60:63], a[228:231], v[168:171]
    v_mfma_f32_16x16x32_bf16 v[168:171], v[64:67], a[236:239], v[168:171]
    v_mfma_f32_16x16x32_bf16 v[168:171], v[68:71], a[244:247], v[168:171]
    v_mfma_f32_16x16x32_bf16 v[168:171], v[72:75], a[252:255], v[168:171]
    s_waitcnt lgkmcnt(0)
    v_mfma_f32_16x16x32_bf16 v[168:171], v[44:47], v[224:227], v[168:171]
    ds_read_b128 v[60:63], v2 offset:4096
    v_mfma_f32_16x16x32_bf16 v[168:171], v[48:51], v[232:235], v[168:171]
    ds_read_b128 v[64:67], v2 offset:5120
    v_mfma_f32_16x16x32_bf16 v[168:171], v[52:55], v[240:243], v[168:171]
    ds_read_b128 v[68:71], v2 offset:6144
    v_mfma_f32_16x16x32_bf16 v[168:171], v[56:59], v[248:251], v[168:171]
    ds_read_b128 v[72:75], v2 offset:7168
    v_mfma_f32_16x16x32_bf16 v[164:167], v[44:47], v[220:223], v[164:167]
    v_mfma_f32_16x16x32_bf16 v[164:167], v[48:51], v[228:231], v[164:167]
    v_mfma_f32_16x16x32_bf16 v[164:167], v[52:55], v[236:239], v[164:167]
    v_mfma_f32_16x16x32_bf16 v[164:167], v[56:59], v[244:247], v[164:167]
    s_waitcnt lgkmcnt(0)
    v_mfma_f32_16x16x32_bf16 v[140:143], v[60:63], a[224:227], v[140:143]
    s_mov_b32 s17, 131072
    ds_read_b128 v[44:47], v2 offset:8192
    v_mfma_f32_16x16x32_bf16 v[140:143], v[64:67], a[232:235], v[140:143]
    ds_read_b128 v[48:51], v2 offset:9216
    v_mfma_f32_16x16x32_bf16 v[140:143], v[68:71], a[240:243], v[140:143]
    ds_read_b128 v[52:55], v2 offset:10240
    v_mfma_f32_16x16x32_bf16 v[140:143], v[72:75], a[248:251], v[140:143]
    ds_read_b128 v[56:59], v2 offset:11264
    v_cvt_pk_bf16_f32 v28, v156, v157
    v_mfma_f32_16x16x32_bf16 v[144:147], v[60:63], a[228:231], v[144:147]
    v_cvt_pk_bf16_f32 v29, v158, v159
    v_cvt_pk_bf16_f32 v30, v164, v165
    v_mfma_f32_16x16x32_bf16 v[144:147], v[64:67], a[236:239], v[144:147]
    v_cvt_pk_bf16_f32 v31, v166, v167
    v_cvt_pk_bf16_f32 v32, v160, v161
    v_mfma_f32_16x16x32_bf16 v[144:147], v[68:71], a[244:247], v[144:147]
    buffer_store_dwordx4 v[28:31], v9, s[8:11], s17 offen offset:0 sc1
    v_mfma_f32_16x16x32_bf16 v[144:147], v[72:75], a[252:255], v[144:147]
    s_waitcnt lgkmcnt(0)
    v_cvt_pk_bf16_f32 v33, v162, v163
    v_cvt_pk_bf16_f32 v34, v168, v169
    v_mfma_f32_16x16x32_bf16 v[144:147], v[44:47], v[224:227], v[144:147]
    ds_read_b128 v[60:63], v2 offset:12288
    v_cvt_pk_bf16_f32 v35, v170, v171
    v_mfma_f32_16x16x32_bf16 v[144:147], v[48:51], v[232:235], v[144:147]
    ds_read_b128 v[64:67], v2 offset:13312
    v_mfma_f32_16x16x32_bf16 v[144:147], v[52:55], v[240:243], v[144:147]
    buffer_store_dwordx4 v[32:35], v9, s[8:11], s17 offen offset:256 sc1
    v_mfma_f32_16x16x32_bf16 v[144:147], v[56:59], v[248:251], v[144:147]
    ds_read_b128 v[68:71], v2 offset:14336
    ds_read_b128 v[72:75], v2 offset:15360
    v_mfma_f32_16x16x32_bf16 v[140:143], v[44:47], v[220:223], v[140:143]
    v_mfma_f32_16x16x32_bf16 v[140:143], v[48:51], v[228:231], v[140:143]
    v_mfma_f32_16x16x32_bf16 v[140:143], v[52:55], v[236:239], v[140:143]
    v_mfma_f32_16x16x32_bf16 v[140:143], v[56:59], v[244:247], v[140:143]
    s_waitcnt lgkmcnt(0)
    v_mfma_f32_16x16x32_bf16 v[148:151], v[60:63], a[224:227], v[148:151]
    ds_read_b128 v[44:47], v2 offset:16384
    v_mfma_f32_16x16x32_bf16 v[148:151], v[64:67], a[232:235], v[148:151]
    ds_read_b128 v[48:51], v2 offset:17408
    v_mfma_f32_16x16x32_bf16 v[148:151], v[68:71], a[240:243], v[148:151]
    ds_read_b128 v[52:55], v2 offset:18432
    v_mfma_f32_16x16x32_bf16 v[148:151], v[72:75], a[248:251], v[148:151]
    ds_read_b128 v[56:59], v2 offset:19456
    v_mfma_f32_16x16x32_bf16 v[152:155], v[60:63], a[228:231], v[152:155]
    v_mfma_f32_16x16x32_bf16 v[152:155], v[64:67], a[236:239], v[152:155]
    v_mfma_f32_16x16x32_bf16 v[152:155], v[68:71], a[244:247], v[152:155]
    v_mfma_f32_16x16x32_bf16 v[152:155], v[72:75], a[252:255], v[152:155]
    s_waitcnt lgkmcnt(0)
    v_mfma_f32_16x16x32_bf16 v[152:155], v[44:47], v[224:227], v[152:155]
    ds_read_b128 v[60:63], v2 offset:20480
    v_mfma_f32_16x16x32_bf16 v[152:155], v[48:51], v[232:235], v[152:155]
    ds_read_b128 v[64:67], v2 offset:21504
    v_mfma_f32_16x16x32_bf16 v[152:155], v[52:55], v[240:243], v[152:155]
    ds_read_b128 v[68:71], v2 offset:22528
    v_mfma_f32_16x16x32_bf16 v[152:155], v[56:59], v[248:251], v[152:155]
    ds_read_b128 v[72:75], v2 offset:23552
    v_mfma_f32_16x16x32_bf16 v[148:151], v[44:47], v[220:223], v[148:151]
    v_mfma_f32_16x16x32_bf16 v[148:151], v[48:51], v[228:231], v[148:151]
    v_mfma_f32_16x16x32_bf16 v[148:151], v[52:55], v[236:239], v[148:151]
    v_mfma_f32_16x16x32_bf16 v[148:151], v[56:59], v[244:247], v[148:151]
    s_waitcnt lgkmcnt(0)
    v_mfma_f32_16x16x32_bf16 v[172:175], v[60:63], a[224:227], v[172:175]
    s_mov_b32 s17, 262144
    ds_read_b128 v[44:47], v2 offset:24576
    v_mfma_f32_16x16x32_bf16 v[172:175], v[64:67], a[232:235], v[172:175]
    ds_read_b128 v[48:51], v2 offset:25600
    v_mfma_f32_16x16x32_bf16 v[172:175], v[68:71], a[240:243], v[172:175]
    ds_read_b128 v[52:55], v2 offset:26624
    v_mfma_f32_16x16x32_bf16 v[172:175], v[72:75], a[248:251], v[172:175]
    ds_read_b128 v[56:59], v2 offset:27648
    v_cvt_pk_bf16_f32 v20, v140, v141
    v_mfma_f32_16x16x32_bf16 v[176:179], v[60:63], a[228:231], v[176:179]
    v_cvt_pk_bf16_f32 v21, v142, v143
    v_cvt_pk_bf16_f32 v22, v148, v149
    v_mfma_f32_16x16x32_bf16 v[176:179], v[64:67], a[236:239], v[176:179]
    v_cvt_pk_bf16_f32 v23, v150, v151
    v_cvt_pk_bf16_f32 v24, v144, v145
    v_mfma_f32_16x16x32_bf16 v[176:179], v[68:71], a[244:247], v[176:179]
    buffer_store_dwordx4 v[20:23], v9, s[8:11], s17 offen offset:0 sc1
    v_mfma_f32_16x16x32_bf16 v[176:179], v[72:75], a[252:255], v[176:179]
    s_waitcnt lgkmcnt(0)
    v_cvt_pk_bf16_f32 v25, v146, v147
    v_cvt_pk_bf16_f32 v26, v152, v153
    v_mfma_f32_16x16x32_bf16 v[176:179], v[44:47], v[224:227], v[176:179]
    ds_read_b128 v[60:63], v2 offset:28672
    v_cvt_pk_bf16_f32 v27, v154, v155
    v_mfma_f32_16x16x32_bf16 v[176:179], v[48:51], v[232:235], v[176:179]
    ds_read_b128 v[64:67], v2 offset:29696
    v_mfma_f32_16x16x32_bf16 v[176:179], v[52:55], v[240:243], v[176:179]
    buffer_store_dwordx4 v[24:27], v9, s[8:11], s17 offen offset:256 sc1
    v_mfma_f32_16x16x32_bf16 v[176:179], v[56:59], v[248:251], v[176:179]
    ds_read_b128 v[68:71], v2 offset:30720
    ds_read_b128 v[72:75], v2 offset:31744
    v_mfma_f32_16x16x32_bf16 v[172:175], v[44:47], v[220:223], v[172:175]
    v_mfma_f32_16x16x32_bf16 v[172:175], v[48:51], v[228:231], v[172:175]
    v_mfma_f32_16x16x32_bf16 v[172:175], v[52:55], v[236:239], v[172:175]
    v_mfma_f32_16x16x32_bf16 v[172:175], v[56:59], v[244:247], v[172:175]
    s_waitcnt lgkmcnt(0)
    v_mfma_f32_16x16x32_bf16 v[180:183], v[60:63], a[224:227], v[180:183]
    ds_read_b128 v[44:47], v2 offset:32768
    v_mfma_f32_16x16x32_bf16 v[180:183], v[64:67], a[232:235], v[180:183]
    ds_read_b128 v[48:51], v2 offset:33792
    v_mfma_f32_16x16x32_bf16 v[180:183], v[68:71], a[240:243], v[180:183]
    ds_read_b128 v[52:55], v2 offset:34816
    v_mfma_f32_16x16x32_bf16 v[180:183], v[72:75], a[248:251], v[180:183]
    ds_read_b128 v[56:59], v2 offset:35840
    v_mfma_f32_16x16x32_bf16 v[184:187], v[60:63], a[228:231], v[184:187]
    v_mfma_f32_16x16x32_bf16 v[184:187], v[64:67], a[236:239], v[184:187]
    v_mfma_f32_16x16x32_bf16 v[184:187], v[68:71], a[244:247], v[184:187]
    v_mfma_f32_16x16x32_bf16 v[184:187], v[72:75], a[252:255], v[184:187]
    s_waitcnt lgkmcnt(0)
    v_mfma_f32_16x16x32_bf16 v[184:187], v[44:47], v[224:227], v[184:187]
    v_mfma_f32_16x16x32_bf16 v[184:187], v[48:51], v[232:235], v[184:187]
    v_mfma_f32_16x16x32_bf16 v[184:187], v[52:55], v[240:243], v[184:187]
    v_mfma_f32_16x16x32_bf16 v[184:187], v[56:59], v[248:251], v[184:187]
    v_mfma_f32_16x16x32_bf16 v[180:183], v[44:47], v[220:223], v[180:183]
    v_mfma_f32_16x16x32_bf16 v[180:183], v[48:51], v[228:231], v[180:183]
    v_mfma_f32_16x16x32_bf16 v[180:183], v[52:55], v[236:239], v[180:183]
    v_mfma_f32_16x16x32_bf16 v[180:183], v[56:59], v[244:247], v[180:183]
    v_mov_b32 v255, 16
    v_cvt_pk_bf16_f32 v28, v172, v173
    v_cvt_pk_bf16_f32 v29, v174, v175
    s_nop 4
    v_cvt_pk_bf16_f32 v30, v180, v181
    v_cvt_pk_bf16_f32 v31, v182, v183
    s_mov_b32 s17, 393216
    buffer_store_dwordx4 v[28:31], v9, s[8:11], s17 offen offset:0 sc1
    v_cvt_pk_bf16_f32 v32, v176, v177
    v_cvt_pk_bf16_f32 v33, v178, v179
    v_cvt_pk_bf16_f32 v34, v184, v185
    v_cvt_pk_bf16_f32 v35, v186, v187
    buffer_store_dwordx4 v[32:35], v9, s[8:11], s17 offen offset:256 sc1
L_after1:
    s_mov_b32 s26, 84934656
    s_mov_b32 s27, 85196800
    buffer_load_dwordx4 v[12:15], v208, s[8:11], s26 offen sc1
    buffer_load_dwordx4 v[16:19], v208, s[8:11], s27 offen sc1
    buffer_load_dword v20, v209, s[8:11], s26 offen sc1
    s_mov_b32 s26, 57671680
    buffer_load_dword v64, v207, s[8:11], s26 offen sc1
    s_mov_b32 s26, 57688064
    buffer_load_dword v65, v207, s[8:11], s26 offen sc1
    s_mov_b32 s26, 57704448
    buffer_load_dword v66, v216, s[8:11], s26 offen sc1
    s_mov_b32 s26, 57712640
    buffer_load_dword v67, v216, s[8:11], s26 offen sc1
    buffer_load_dword v62, v210, s[8:11], 0 offen sc1
    s_mov_b32 s26, 0
    s_waitcnt vmcnt(8)
    buffer_store_dword v255, v252, s[8:11], s26 offen sc1
    s_mov_b32 s40, s54
    s_mov_b32 s41, s55
    s_mov_b32 s42, 2359296
    s_mov_b32 s43, 0x20000
    s_waitcnt vmcnt(8)
    v_lshlrev_b32 v124, 16, v12
    v_and_b32 v125, 0xffff0000, v12
    v_lshlrev_b32 v126, 16, v13
    v_and_b32 v127, 0xffff0000, v13
    v_lshlrev_b32 v128, 16, v14
    v_and_b32 v129, 0xffff0000, v14
    v_lshlrev_b32 v130, 16, v15
    v_and_b32 v131, 0xffff0000, v15
    s_waitcnt vmcnt(7)
    v_lshlrev_b32 v132, 16, v16
    v_and_b32 v133, 0xffff0000, v16
    v_lshlrev_b32 v134, 16, v17
    v_and_b32 v135, 0xffff0000, v17
    v_lshlrev_b32 v136, 16, v18
    v_and_b32 v137, 0xffff0000, v18
    v_lshlrev_b32 v138, 16, v19
    v_and_b32 v139, 0xffff0000, v19
    s_waitcnt vmcnt(6)
    v_lshlrev_b32 v140, 16, v20
    v_and_b32 v141, 0xffff0000, v20
    s_waitcnt vmcnt(4)
    v_add_f32 v64, v64, v65
    s_waitcnt vmcnt(2)
    v_add_f32 v66, v66, v67
    v_sub_f32 v64, v64, v66
    v_pk_add_f32 v[124:125], v[124:125], v[64:65] op_sel_hi:[1,0]
    v_pk_add_f32 v[126:127], v[126:127], v[64:65] op_sel_hi:[1,0]
    v_pk_add_f32 v[128:129], v[128:129], v[64:65] op_sel_hi:[1,0]
    v_pk_add_f32 v[130:131], v[130:131], v[64:65] op_sel_hi:[1,0]
    v_pk_add_f32 v[132:133], v[132:133], v[64:65] op_sel_hi:[1,0]
    v_pk_add_f32 v[134:135], v[134:135], v[64:65] op_sel_hi:[1,0]
    v_pk_add_f32 v[136:137], v[136:137], v[64:65] op_sel_hi:[1,0]
    v_pk_add_f32 v[138:139], v[138:139], v[64:65] op_sel_hi:[1,0]
    v_pk_add_f32 v[140:141], v[140:141], v[64:65] op_sel_hi:[1,0]
    s_mov_b32 s34, 0
    s_mov_b32 s45, 524288
    s_waitcnt vmcnt(1)
    s_mov_b32 s37, 0
    s_branch L_gp34_f
L_gp34_p0:
    buffer_load_dword v62, v210, s[8:11], 0 offen sc1
    s_sub_u32 s45, s45, 1
    s_cselect_b32 s37, 15, 0
    s_waitcnt vmcnt(0)
L_gp34_f:
    v_cmp_le_u32 s[46:47], 16, v62
    s_nop 0
    s_or_b32 s35, s37, s46
    s_and_b32 s35, s35, 15
    s_lshr_b32 s36, s35, 1
    s_and_b32 s36, s36, s35
    s_and_b32 s36, s36, 5
    s_cbranch_scc0 L_gp34_p0
L_gp34_i0:
    s_ff1_i32_b32 s36, s36
    s_lshl_b32 s34, 3, s36
    s_mul_i32 s26, s36, 2359296
    s_add_u32 s26, s26, 94371840
    s_add_u32 s27, s26, 262144
    buffer_load_dwordx4 v[22:25], v208, s[8:11], s26 offen sc1
    buffer_load_dwordx4 v[26:29], v208, s[8:11], s27 offen sc1
    buffer_load_dword v30, v209, s[8:11], s26 offen sc1
    s_add_u32 s26, s26, 2359296
    s_add_u32 s27, s26, 262144
    buffer_load_dwordx4 v[32:35], v208, s[8:11], s26 offen sc1
    buffer_load_dwordx4 v[36:39], v208, s[8:11], s27 offen sc1
    buffer_load_dword v40, v209, s[8:11], s26 offen sc1
    s_andn2_b32 s36, s35, s34
    s_cbranch_scc1 L_gp34_i2
L_gp34_p2:
    buffer_load_dword v62, v210, s[8:11], 0 offen sc1
    s_sub_u32 s45, s45, 1
    s_cselect_b32 s37, 15, 0
    s_waitcnt vmcnt(0)
    v_cmp_le_u32 s[46:47], 16, v62
    s_nop 0
    s_or_b32 s35, s37, s46
    s_and_b32 s35, s35, 15
    s_andn2_b32 s36, s35, s34
    s_cbranch_scc0 L_gp34_p2
L_gp34_i2:
    s_ff1_i32_b32 s36, s36
    s_bitset1_b32 s34, s36
    s_mul_i32 s26, s36, 2359296
    s_add_u32 s26, s26, 94371840
    s_add_u32 s27, s26, 262144
    buffer_load_dwordx4 v[42:45], v208, s[8:11], s26 offen sc1
    buffer_load_dwordx4 v[46:49], v208, s[8:11], s27 offen sc1
    buffer_load_dword v50, v209, s[8:11], s26 offen sc1
    s_andn2_b32 s36, s35, s34
    s_cbranch_scc1 L_gp34_i3
L_gp34_p3:
    buffer_load_dword v62, v210, s[8:11], 0 offen sc1
    s_sub_u32 s45, s45, 1
    s_cselect_b32 s37, 15, 0
    s_waitcnt vmcnt(0)
    v_cmp_le_u32 s[46:47], 16, v62
    s_nop 0
    s_or_b32 s35, s37, s46
    s_and_b32 s35, s35, 15
    s_andn2_b32 s36, s35, s34
    s_cbranch_scc0 L_gp34_p3
L_gp34_i3:
    s_ff1_i32_b32 s36, s36
    s_bitset1_b32 s34, s36
    s_mul_i32 s26, s36, 2359296
    s_add_u32 s26, s26, 94371840
    s_add_u32 s27, s26, 262144
    buffer_load_dwordx4 v[52:55], v208, s[8:11], s26 offen sc1
    buffer_load_dwordx4 v[56:59], v208, s[8:11], s27 offen sc1
    buffer_load_dword v60, v209, s[8:11], s26 offen sc1
    s_waitcnt vmcnt(11)
    v_lshlrev_b32 v160, 16, v22
    v_and_b32 v161, 0xffff0000, v22
    v_lshlrev_b32 v162, 16, v23
    v_and_b32 v163, 0xffff0000, v23
    v_lshlrev_b32 v164, 16, v24
    v_and_b32 v165, 0xffff0000, v24
    v_lshlrev_b32 v166, 16, v25
    v_and_b32 v167, 0xffff0000, v25
    s_waitcnt vmcnt(10)
    v_lshlrev_b32 v168, 16, v26
    v_and_b32 v169, 0xffff0000, v26
    v_lshlrev_b32 v170, 16, v27
    v_and_b32 v171, 0xffff0000, v27
    v_lshlrev_b32 v172, 16, v28
    v_and_b32 v173, 0xffff0000, v28
    v_lshlrev_b32 v174, 16, v29
    v_and_b32 v175, 0xffff0000, v29
    s_waitcnt vmcnt(9)
    v_lshlrev_b32 v176, 16, v30
    v_and_b32 v177, 0xffff0000, v30
    s_waitcnt vmcnt(8)
    v_lshlrev_b32 v142, 16, v32
    v_and_b32 v143, 0xffff0000, v32
    v_lshlrev_b32 v144, 16, v33
    v_and_b32 v145, 0xffff0000, v33
    v_lshlrev_b32 v146, 16, v34
    v_and_b32 v147, 0xffff0000, v34
    v_lshlrev_b32 v148, 16, v35
    v_and_b32 v149, 0xffff0000, v35
    s_waitcnt vmcnt(7)
    v_lshlrev_b32 v150, 16, v36
    v_and_b32 v151, 0xffff0000, v36
    v_lshlrev_b32 v152, 16, v37
    v_and_b32 v153, 0xffff0000, v37
    v_lshlrev_b32 v154, 16, v38
    v_and_b32 v155, 0xffff0000, v38
    v_lshlrev_b32 v156, 16, v39
    v_and_b32 v157, 0xffff0000, v39
    s_waitcnt vmcnt(6)
    v_lshlrev_b32 v158, 16, v40
    v_and_b32 v159, 0xffff0000, v40
    v_pk_add_f32 v[160:161], v[160:161], v[142:143]
    v_pk_add_f32 v[162:163], v[162:163], v[144:145]
    v_pk_add_f32 v[164:165], v[164:165], v[146:147]
    v_pk_add_f32 v[166:167], v[166:167], v[148:149]
    v_pk_add_f32 v[168:169], v[168:169], v[150:151]
    v_pk_add_f32 v[170:171], v[170:171], v[152:153]
    v_pk_add_f32 v[172:173], v[172:173], v[154:155]
    v_pk_add_f32 v[174:175], v[174:175], v[156:157]
    v_pk_add_f32 v[176:177], v[176:177], v[158:159]
    s_waitcnt vmcnt(5)
    v_lshlrev_b32 v220, 16, v42
    v_and_b32 v221, 0xffff0000, v42
    v_lshlrev_b32 v222, 16, v43
    v_and_b32 v223, 0xffff0000, v43
    v_lshlrev_b32 v224, 16, v44
    v_and_b32 v225, 0xffff0000, v44
    v_lshlrev_b32 v226, 16, v45
    v_and_b32 v227, 0xffff0000, v45
    s_waitcnt vmcnt(4)
    v_lshlrev_b32 v228, 16, v46
    v_and_b32 v229, 0xffff0000, v46
    v_lshlrev_b32 v230, 16, v47
    v_and_b32 v231, 0xffff0000, v47
    v_lshlrev_b32 v232, 16, v48
    v_and_b32 v233, 0xffff0000, v48
    v_lshlrev_b32 v234, 16, v49
    v_and_b32 v235, 0xffff0000, v49
    s_waitcnt vmcnt(3)
    v_lshlrev_b32 v236, 16, v50
    v_and_b32 v237, 0xffff0000, v50
    s_waitcnt vmcnt(2)
    v_lshlrev_b32 v142, 16, v52
    v_lshlrev_b32 v144, 16, v53
    v_and_b32 v143, 0xffff0000, v52
    v_and_b32 v145, 0xffff0000, v53
    v_pk_add_f32 v[142:143], v[142:143], v[220:221]
    v_pk_add_f32 v[144:145], v[144:145], v[222:223]
    v_pk_add_f32 v[142:143], v[142:143], v[160:161]
    v_pk_add_f32 v[144:145], v[144:145], v[162:163]
    v_pk_add_f32 v[124:125], v[124:125], v[142:143]
    v_pk_add_f32 v[126:127], v[126:127], v[144:145]
    v_cvt_pk_bf16_f32 v12, v124, v125
    v_cvt_pk_bf16_f32 v13, v126, v127
    v_lshlrev_b32 v146, 16, v54
    v_lshlrev_b32 v148, 16, v55
    v_and_b32 v147, 0xffff0000, v54
    v_and_b32 v149, 0xffff0000, v55
    v_pk_add_f32 v[146:147], v[146:147], v[224:225]
    v_pk_add_f32 v[148:149], v[148:149], v[226:227]
    v_pk_add_f32 v[146:147], v[146:147], v[164:165]
L_pad_c3_8:
    s_cbranch_execz L_hopret_c3
    v_pk_add_f32 v[148:149], v[148:149], v[166:167]
    v_pk_add_f32 v[128:129], v[128:129], v[146:147]
    v_pk_add_f32 v[130:131], v[130:131], v[148:149]
    v_cvt_pk_bf16_f32 v14, v128, v129
    v_cvt_pk_bf16_f32 v15, v130, v131
    ds_write_b64 v84, v[12:13]
    s_waitcnt vmcnt(1)
    v_lshlrev_b32 v150, 16, v56
    v_lshlrev_b32 v152, 16, v57
    v_and_b32 v151, 0xffff0000, v56
    v_and_b32 v153, 0xffff0000, v57
    v_pk_add_f32 v[150:151], v[150:151], v[228:229]
    v_pk_add_f32 v[152:153], v[152:153], v[230:231]
    v_pk_add_f32 v[150:151], v[150:151], v[168:169]
    v_pk_add_f32 v[152:153], v[152:153], v[170:171]
    v_pk_add_f32 v[132:133], v[132:133], v[150:151]
    v_pk_add_f32 v[134:135], v[134:135], v[152:153]
    v_cvt_pk_bf16_f32 v16, v132, v133
    v_cvt_pk_bf16_f32 v17, v134, v135
    ds_write_b64 v85, v[14:15]
    v_lshlrev_b32 v154, 16, v58
    v_lshlrev_b32 v156, 16, v59
    v_and_b32 v155, 0xffff0000, v58
    v_and_b32 v157, 0xffff0000, v59
    v_pk_add_f32 v[154:155], v[154:155], v[232:233]
    v_pk_add_f32 v[156:157], v[156:157], v[234:235]
    v_pk_add_f32 v[154:155], v[154:155], v[172:173]
    v_pk_add_f32 v[156:157], v[156:157], v[174:175]
    v_pk_add_f32 v[136:137], v[136:137], v[154:155]
    v_pk_add_f32 v[138:139], v[138:139], v[156:157]
    v_cvt_pk_bf16_f32 v18, v136, v137
    v_cvt_pk_bf16_f32 v19, v138, v139
    ds_write_b64 v86, v[16:17]
    s_waitcnt vmcnt(0)
    v_lshlrev_b32 v158, 16, v60
    v_and_b32 v159, 0xffff0000, v60
    v_pk_add_f32 v[158:159], v[158:159], v[236:237]
    v_pk_add_f32 v[158:159], v[158:159], v[176:177]
    v_pk_add_f32 v[140:141], v[140:141], v[158:159]
    v_cvt_pk_bf16_f32 v20, v140, v141
    ds_write_b64 v87, v[18:19]
    ds_write_b32 v88, v20
    s_waitcnt lgkmcnt(0)
    s_barrier
    ds_read_b128 v[24:27], v92 offset:0
    ds_read_b128 v[28:31], v92 offset:4096
    ds_read_b128 v[32:35], v92 offset:8192
    s_waitcnt lgkmcnt(2)
    buffer_store_dwordx4 v[24:27], v90, s[40:43], 0 offen offset:0 sc1
    s_waitcnt lgkmcnt(1)
    buffer_store_dwordx4 v[28:31], v90, s[40:43], 0 offen offset:512 sc1
    s_waitcnt lgkmcnt(0)
    buffer_store_dwordx4 v[32:35], v91, s[40:43], 0 offen offset:1024 sc1
    s_endpgm
L_slow11:
    s_mov_b32 s45, 524288
L_slow11_l:
    buffer_load_dword v16, v88, s[8:11], 0 offen offset:0 sc1
    buffer_load_dword v17, v88, s[8:11], 0 offen offset:512 sc1
    buffer_load_dword v18, v88, s[8:11], 0 offen offset:1024 sc1
    buffer_load_dword v19, v88, s[8:11], 0 offen offset:1536 sc1
    s_waitcnt vmcnt(1)
    v_min3_u32 v91, v16, v17, v18
    s_waitcnt vmcnt(0)
    v_min_u32 v91, v91, v19
    v_cmp_eq_u32 s[46:47], 0, v91
    s_sub_u32 s45, s45, 1
    s_cbranch_scc1 L_slow11_ret
    s_cmp_lg_u64 s[46:47], 0
    s_cbranch_scc1 L_slow11_l
    s_branch L_slow11_ret
L_slow12:
    s_mov_b32 s45, 524288
L_spin35:
    buffer_load_dword v254, v253, s[8:11], 0 offen sc1
    s_sub_u32 s45, s45, 1
    s_cbranch_scc1 L_spin35_x
    s_waitcnt vmcnt(0)
    v_cmp_gt_u32 s[46:47], 1, v254
    s_nop 0
    s_and_b64 exec, exec, s[46:47]
    s_cbranch_scc1 L_spin35
L_spin35_x:
    s_mov_b64 exec, -1
    s_waitcnt vmcnt(0)
    s_branch L_slow12_ret
L_slow13:
    s_mov_b32 s45, 524288
L_spin36:
    buffer_load_dword v254, v8, s[8:11], 0 offen sc1
    s_sub_u32 s45, s45, 1
    s_cbranch_scc1 L_spin36_x
    s_waitcnt vmcnt(0)
    v_cmp_gt_u32 s[46:47], 1, v254
    s_nop 0
    s_and_b64 exec, exec, s[46:47]
    s_cbranch_scc1 L_spin36
L_spin36_x:
    s_mov_b64 exec, -1
    s_waitcnt vmcnt(0)
    s_branch L_slow13_ret
L_slow14:
    s_mov_b32 s45, 524288
L_spin37:
    buffer_load_dword v254, v253, s[8:11], 0 offen sc1
    s_sub_u32 s45, s45, 1
    s_cbranch_scc1 L_spin37_x
    s_waitcnt vmcnt(0)
    v_cmp_gt_u32 s[46:47], 2, v254
    s_nop 0
    s_and_b64 exec, exec, s[46:47]
    s_cbranch_scc1 L_spin37
L_spin37_x:
    s_mov_b64 exec, -1
    s_waitcnt vmcnt(0)
    s_branch L_slow14_ret
L_slow15:
    s_mov_b32 s45, 524288
L_spin38:
    buffer_load_dword v254, v253, s[8:11], 0 offen sc1
    s_sub_u32 s45, s45, 1
    s_cbranch_scc1 L_spin38_x
    s_waitcnt vmcnt(0)
    v_cmp_gt_u32 s[46:47], 3, v254
    s_nop 0
    s_and_b64 exec, exec, s[46:47]
    s_cbranch_scc1 L_spin38
L_spin38_x:
    s_mov_b64 exec, -1
    s_waitcnt vmcnt(0)
    s_branch L_slow15_ret
L_slow16:
    s_mov_b32 s45, 524288
L_spin39:
    buffer_load_dword v254, v253, s[8:11], 0 offen sc1
    s_sub_u32 s45, s45, 1
    s_cbranch_scc1 L_spin39_x
    s_waitcnt vmcnt(0)
    v_cmp_gt_u32 s[46:47], 4, v254
    s_nop 0
    s_and_b64 exec, exec, s[46:47]
    s_cbranch_scc1 L_spin39
L_spin39_x:
    s_mov_b64 exec, -1
    s_waitcnt vmcnt(0)
    s_branch L_slow16_ret
L_slow28:
    s_mov_b32 s45, 524288
L_slow28_l:
    buffer_load_dword v16, v88, s[8:11], 0 offen offset:0 sc1
    buffer_load_dword v17, v88, s[8:11], 0 offen offset:512 sc1
    buffer_load_dword v18, v88, s[8:11], 0 offen offset:1024 sc1
    buffer_load_dword v19, v88, s[8:11], 0 offen offset:1536 sc1
    s_waitcnt vmcnt(1)
    v_min3_u32 v91, v16, v17, v18
    s_waitcnt vmcnt(0)
    v_min_u32 v91, v91, v19
    v_cmp_eq_u32 s[46:47], 0, v91
    s_sub_u32 s45, s45, 1
    s_cbranch_scc1 L_slow28_ret
    s_cmp_lg_u64 s[46:47], 0
    s_cbranch_scc1 L_slow28_l
    s_branch L_slow28_ret
L_slow29:
    s_mov_b32 s45, 524288
L_spin40:
    buffer_load_dword v254, v253, s[8:11], 0 offen sc1
    s_sub_u32 s45, s45, 1
    s_cbranch_scc1 L_spin40_x
    s_waitcnt vmcnt(0)
    v_cmp_gt_u32 s[46:47], 9, v254
    s_nop 0
    s_and_b64 exec, exec, s[46:47]
    s_cbranch_scc1 L_spin40
L_spin40_x:
    s_mov_b64 exec, -1
    s_waitcnt vmcnt(0)
    s_branch L_slow29_ret
L_slow30:
    s_mov_b32 s45, 524288
L_spin41:
    buffer_load_dword v254, v253, s[8:11], 0 offen sc1
    s_sub_u32 s45, s45, 1
    s_cbranch_scc1 L_spin41_x
    s_waitcnt vmcnt(0)
    v_cmp_gt_u32 s[46:47], 10, v254
    s_nop 0
    s_and_b64 exec, exec, s[46:47]
    s_cbranch_scc1 L_spin41
L_spin41_x:
    s_mov_b64 exec, -1
    s_waitcnt vmcnt(0)
    s_branch L_slow30_ret
L_slow31:
    s_mov_b32 s45, 524288
L_spin42:
    buffer_load_dword v254, v253, s[8:11], 0 offen sc1
    s_sub_u32 s45, s45, 1
    s_cbranch_scc1 L_spin42_x
    s_waitcnt vmcnt(0)
    v_cmp_gt_u32 s[46:47], 11, v254
    s_nop 0
    s_and_b64 exec, exec, s[46:47]
    s_cbranch_scc1 L_spin42
L_spin42_x:
    s_mov_b64 exec, -1
    s_waitcnt vmcnt(0)
    s_branch L_slow31_ret
L_slow32:
    s_mov_b32 s45, 524288
L_spin43:
    buffer_load_dword v254, v253, s[8:11], 0 offen sc1
    s_sub_u32 s45, s45, 1
    s_cbranch_scc1 L_spin43_x
    s_waitcnt vmcnt(0)
    v_cmp_gt_u32 s[46:47], 12, v254
    s_nop 0
    s_and_b64 exec, exec, s[46:47]
    s_cbranch_scc1 L_spin43
L_spin43_x:
    s_mov_b64 exec, -1
    s_waitcnt vmcnt(0)
    s_branch L_slow32_ret
L_notready:
    s_mov_b64 s[28:29], s[56:57]
    s_movk_i32 s30, 256
    s_mov_b32 s31, 0x20000
    s_mov_b32 s45, 524288
L_spin44:
    buffer_load_dword v254, v253, s[28:31], 0 offen sc1
    s_sub_u32 s45, s45, 1
    s_cbranch_scc1 L_spin44_x
    s_waitcnt vmcnt(0)
    v_cmp_gt_u32 s[46:47], 1, v254
    s_nop 0
    s_and_b64 exec, exec, s[46:47]
    s_cbranch_scc1 L_spin44
L_spin44_x:
    s_mov_b64 exec, -1
    s_waitcnt vmcnt(0)
    s_branch L_ready
L_code_end:
    s_endpgm
.section .rodata,"a"
.p2align 6
.amdhsa_kernel interleave_layers__spectral_fnet__swiglu_ffn__prompt_kernel
  .amdhsa_next_free_vgpr 512
  .amdhsa_next_free_sgpr 102
  .amdhsa_accum_offset 256
  .amdhsa_group_segment_fixed_size 0
  .amdhsa_kernarg_size 96
  .amdhsa_user_sgpr_count 2
  .amdhsa_user_sgpr_kernarg_segment_ptr 1
  .amdhsa_system_sgpr_workgroup_id_x 1
  .amdhsa_float_denorm_mode_32 3
  .amdhsa_float_denorm_mode_16_64 3
.end_amdhsa_kernel
```
